```python
import torch

def _softmax(x, axis=-1):
    return torch.softmax(x, dim=axis)
def _gelu(x):
    return torch.nn.functional.gelu(x, approximate="tanh")
def _silu(x):
    return torch.nn.functional.silu(x)
def _sigmoid(x):
    return torch.sigmoid(x)
def _layernorm(x, axis=-1, eps=1e-5):
    m = x.mean(dim=axis, keepdim=True)
    v = x.var(dim=axis, keepdim=True, unbiased=False)
    return (x - m) / torch.sqrt(v + eps)
def _scatter_add(tgt, idx, src, axis=0):
    return tgt.clone().index_add_(axis, idx, src)
def _segment_sum(src, seg, n):
    out = torch.zeros((n,) + src.shape[1:], dtype=src.dtype)
    return out.index_add_(0, seg, src)
def _pad(x, pw):
    flat = tuple(v for pair in reversed(pw) for v in pair)
    return torch.nn.functional.pad(x, flat)

kernel_name = 'parallel_sum__sliding_block__glu_gated_glu__prompt'

def setup_inputs():

    _w = (lambda a: (lambda t: t.to(torch.bfloat16) if t.is_floating_point() else t)(torch.as_tensor(a)))
    def _A_setup():
        B, S, D = 1, 2048, 640
        return {
            "x": _w((lambda *s: torch.randn(*s, dtype=torch.bfloat16) * 0.05)(B, S, D)),
            "wqkv": _w((lambda *s: torch.randn(*s, dtype=torch.bfloat16) * 0.05)(D, 3 * D)),
            "wo": _w((lambda *s: torch.randn(*s, dtype=torch.bfloat16) * 0.05)(D, D)),
        }
    _A_in = _A_setup()

    def _B_setup():
        B, S, D, F = 1, 2048, 640, 1728
        return {
            "x": _w((lambda *s: torch.randn(*s, dtype=torch.bfloat16) * 0.05)(B, S, D)),
            "w_gate": _w((lambda *s: torch.randn(*s, dtype=torch.bfloat16) * 0.05)(D, F)),
            "w_up": _w((lambda *s: torch.randn(*s, dtype=torch.bfloat16) * 0.05)(D, F)),
            "w_down": _w((lambda *s: torch.randn(*s, dtype=torch.bfloat16) * 0.05)(F, D)),
        }
    _B_in = _B_setup()

    return {
        "A_x": _A_in["x"],
        "A_wqkv": _A_in["wqkv"],
        "A_wo": _A_in["wo"],
        "B_x": _B_in["x"],
        "B_w_gate": _B_in["w_gate"],
        "B_w_up": _B_in["w_up"],
        "B_w_down": _B_in["w_down"],
    }

def reference(A_x, A_wqkv, A_wo, B_x, B_w_gate, B_w_up, B_w_down):
    def _A_ref(x, wqkv, wo):
        B, S, D = x.shape
        H = 32; Dh = D // H; W = 256
        qkv = (lambda x, *d: x.permute(*d))((x @ wqkv).reshape(B, S, 3, H, Dh), 2, 0, 3, 1, 4)
        q, k, v = qkv[0], qkv[1], qkv[2]
        scores = torch.einsum("bhqd,bhkd->bhqk", q, k) * (Dh ** -0.5)
        idx = torch.arange(S)
        mask = (idx[:, None] - idx[None, :] >= 0) & (idx[:, None] - idx[None, :] < W)
        scores = torch.where(mask[None, None], scores, -1e9)
        p = _softmax(scores, axis=-1)
        o = torch.einsum("bhqk,bhkd->bhqd", p, v)
        return (lambda x, *d: x.permute(*d))(o, 0, 2, 1, 3).reshape(B, S, D) @ wo

    def _B_ref(x, w_gate, w_up, w_down):
        g = torch.einsum("bsd,df->bsf", x, w_gate)
        u = torch.einsum("bsd,df->bsf", x, w_up)
        h = _sigmoid(g) * u
        return torch.einsum("bsf,fd->bsd", h, w_down)

    x = A_x
    xn = _layernorm(x, axis=-1)
    return x + _A_ref(xn, A_wqkv, A_wo) + _B_ref(xn, B_w_gate, B_w_up, B_w_down)
```

```asm
; @launch kernel=k1_kernel grid=(256,1,1) block=(256,1,1) lds=163840
; @launch kernel=parallel_sum__sliding_block__glu_gated_glu__prompt_kernel grid=(256,1,1) block=(512,1,1) lds=88064
.amdgcn_target "amdgcn-amd-amdhsa--gfx950"
.text
.globl k1_kernel
.p2align 8
.type k1_kernel,@function
k1_kernel:
s_cmp_ge_u32 s2, 256
s_cbranch_scc1 K1_END
s_load_dwordx2 s[4:5], s[0:1], 72
s_load_dwordx4 s[36:39], s[0:1], 0
s_load_dwordx4 s[32:35], s[0:1], 32
s_load_dwordx2 s[48:49], s[0:1], 64
s_and_b32 s40, s2, 7
s_lshr_b32 s41, s2, 3
s_and_b32 s42, s40, 1
s_lshl_b32 s42, s42, 3
s_and_b32 s43, s41, 7
s_add_u32 s21, s42, s43
s_lshr_b32 s42, s40, 1
s_lshl_b32 s42, s42, 2
s_lshr_b32 s43, s41, 3
s_add_u32 s22, s42, s43
s_getpc_b64 s[62:63]
K1_PC:
s_mul_i32 s61, s41, 20
v_lshrrev_b32 v2, 6, v0
v_mul_u32_u24 v2, 5, v2
v_and_b32 v3, 63, v0
v_min_u32 v3, 4, v3
v_add_u32 v2, v2, v3
v_add_u32 v2, s61, v2
v_min_u32 v2, (K23_END-K1_PC)/128, v2
v_lshlrev_b32 v2, 7, v2
v_mov_b32 v3, s63
v_add_co_u32 v2, vcc, s62, v2
s_nop 1
v_addc_co_u32 v3, vcc, 0, v3, vcc
global_load_dword v31, v[2:3], off
s_mov_b32 s59, 3072
s_cmp_eq_u32 s22, 15
s_cbranch_scc1 K1_SPARE
v_and_b32 v1, 63, v0
v_lshrrev_b32 v32, 6, v0
s_nop 0
v_readfirstlane_b32 s20, v32
s_lshl_b32 s28, s21, 7
s_lshl_b32 s29, s22, 3
s_add_u32 s28, s28, s29
s_nop 0
s_lshl_b32 s29, s20, 1
s_add_u32 s28, s28, s29
v_lshrrev_b32 v238, 5, v1
v_add_u32 v238, s28, v238
v_and_b32 v237, 31, v1
v_lshlrev_b32 v237, 3, v237
v_mul_u32_u24 v235, 1280, v238
v_add_u32 v237, v237, v235
s_lshl_b32 s28, s21, 7
s_lshl_b32 s29, s20, 5
s_add_u32 s28, s28, s29
v_lshrrev_b32 v32, 3, v1
v_add_u32 v32, s28, v32
v_mul_u32_u24 v32, 1280, v32
v_and_b32 v33, 7, v1
v_lshrrev_b32 v34, 4, v1
v_add_u32 v35, 0, v34
v_xor_b32 v35, v33, v35
v_lshl_add_u32 v17, v35, 4, v32
v_add_u32 v35, 4, v34
v_xor_b32 v35, v33, v35
v_lshl_add_u32 v18, v35, 4, v32
v_add_u32 v18, 9216, v18
v_add_u32 v35, 0, v34
v_xor_b32 v35, v33, v35
v_lshl_add_u32 v19, v35, 4, v32
v_add_u32 v19, 18432, v19
v_add_u32 v35, 4, v34
v_xor_b32 v35, v33, v35
v_lshl_add_u32 v20, v35, 4, v32
v_add_u32 v20, 27648, v20
s_mul_i32 s26, s20, 12288
s_add_u32 s26, s26, 114688
s_and_b32 s56, s21, 3
s_lshr_b32 s57, s21, 2
s_cmp_ge_u32 s22, 6
s_cbranch_scc1 K1_GLU
s_mul_i32 s23, s22, 640
s_mul_i32 s28, s20, 61440
v_lshlrev_b32 v33, 4, v1
v_add_u32 v33, s28, v33
v_add_u32 v34, 4096, v33
s_mov_b32 s28, 3277
s_mov_b32 s29, 3520
v_mul_u32_u24 v35, s28, v1
v_lshrrev_b32 v35, 16, v35
v_mad_u32_u24 v12, v35, s29, v33
v_add_u32 v32, 64, v1
v_mul_u32_u24 v35, s28, v32
v_lshrrev_b32 v35, 16, v35
v_mad_u32_u24 v13, v35, s29, v33
v_add_u32 v32, 128, v1
v_mul_u32_u24 v35, s28, v32
v_lshrrev_b32 v35, 16, v35
v_mad_u32_u24 v14, v35, s29, v33
v_add_u32 v32, 192, v1
v_mul_u32_u24 v35, s28, v32
v_lshrrev_b32 v35, 16, v35
v_mad_u32_u24 v15, v35, s29, v33
v_add_u32 v32, 256, v1
v_mul_u32_u24 v35, s28, v32
v_lshrrev_b32 v35, 16, v35
v_mad_u32_u24 v16, v35, s29, v34
s_mul_i32 s25, s20, 5120
s_mul_i32 s28, s20, 448
s_mul_i32 s29, s22, 640
s_mul_i32 s30, s57, 160
s_mul_i32 s60, s20, 7168
s_cmp_eq_u32 s20, 3
s_cselect_b32 s31, 2147483648, 0
s_add_u32 s60, s60, 81920
s_add_u32 s29, s29, s30
s_mul_i32 s30, s56, 614400
s_add_u32 s29, s29, s30
v_add_u32 v32, s28, v1
v_lshlrev_b32 v33, 4, v32
v_add_u32 v33, s29, v33
v_add_u32 v34, 4096, v33
s_mov_b32 s28, 6554
s_mov_b32 s30, 3680
v_mul_u32_u24 v35, s28, v32
v_lshrrev_b32 v35, 16, v35
v_mad_u32_u24 v224, v35, s30, v33
v_add_u32 v32, 64, v32
v_mul_u32_u24 v35, s28, v32
v_lshrrev_b32 v35, 16, v35
v_mad_u32_u24 v225, v35, s30, v33
v_add_u32 v32, 64, v32
v_mul_u32_u24 v35, s28, v32
v_lshrrev_b32 v35, 16, v35
v_mad_u32_u24 v226, v35, s30, v33
v_add_u32 v32, 64, v32
v_mul_u32_u24 v35, s28, v32
v_lshrrev_b32 v35, 16, v35
v_mad_u32_u24 v227, v35, s30, v33
v_add_u32 v32, 64, v32
v_mul_u32_u24 v35, s28, v32
v_lshrrev_b32 v35, 16, v35
v_mad_u32_u24 v228, v35, s30, v34
v_or_b32 v228, s31, v228
v_add_u32 v32, 64, v32
v_mul_u32_u24 v35, s28, v32
v_lshrrev_b32 v35, 16, v35
v_mad_u32_u24 v229, v35, s30, v34
v_or_b32 v229, s31, v229
v_add_u32 v32, 64, v32
v_mul_u32_u24 v35, s28, v32
v_lshrrev_b32 v35, 16, v35
v_mad_u32_u24 v230, v35, s30, v34
v_or_b32 v230, s31, v230
s_waitcnt lgkmcnt(0)
s_mov_b32 s8, s36
s_and_b32 s9, s37, 0xffff
s_mov_b32 s10, 2621440
s_mov_b32 s11, 0x20000
s_add_u32 m0, s26, 0
s_mov_b32 s24, 0
buffer_load_dwordx4 v17, s[8:11], s24 offen offset:0 lds
buffer_load_dwordx4 v18, s[8:11], s24 offen offset:1024 lds
buffer_load_dwordx4 v19, s[8:11], s24 offen offset:2048 lds
buffer_load_dwordx4 v20, s[8:11], s24 offen offset:3072 lds
s_mov_b32 s12, s38
s_and_b32 s13, s39, 0xffff
s_mov_b32 s14, 2457600
s_mov_b32 s15, 0x20000
s_add_u32 m0, s25, 0
s_add_u32 s32, s23, 0
buffer_load_dwordx4 v12, s[12:15], s32 offen offset:0 lds
buffer_load_dwordx4 v13, s[12:15], s32 offen offset:1024 lds
buffer_load_dwordx4 v14, s[12:15], s32 offen offset:2048 lds
buffer_load_dwordx4 v15, s[12:15], s32 offen offset:3072 lds
s_add_u32 m0, s25, 4096
s_add_u32 s32, s23, 0
buffer_load_dwordx4 v16, s[12:15], s32 offen lds
buffer_load_dwordx2 v[176:177], v237, s[8:11], 0 offen offset:0
buffer_load_dwordx2 v[178:179], v237, s[8:11], 0 offen offset:256
buffer_load_dwordx2 v[180:181], v237, s[8:11], 0 offen offset:512
buffer_load_dwordx2 v[182:183], v237, s[8:11], 0 offen offset:768
buffer_load_dwordx2 v[184:185], v237, s[8:11], 0 offen offset:1024
s_mov_b32 s16, s4
s_and_b32 s17, s5, 0xffff
s_mov_b32 s18, 33554432
s_mov_b32 s19, 0x20000
s_mov_b32 s52, s48
s_and_b32 s53, s49, 0xffff
s_mov_b32 s54, 256
s_mov_b32 s55, 0x20000
s_cmp_ge_u32 s22, 4
s_cbranch_scc1 K1_V
s_add_u32 m0, s60, 0
s_nop 0
buffer_load_dwordx4 v224, s[12:15], 0 offen offset:0 lds
v_and_b32 v32, 31, v1
v_lshrrev_b32 v33, 1, v32
v_and_b32 v33, 7, v33
v_lshrrev_b32 v34, 5, v1
v_lshlrev_b32 v32, 7, v32
v_add_u32 v32, s26, v32
v_add_u32 v35, 0, v34
v_xor_b32 v35, v35, v33
v_lshl_add_u32 v21, v35, 4, v32
v_add_u32 v35, 2, v34
v_xor_b32 v35, v35, v33
buffer_load_dwordx4 v225, s[12:15], 0 offen offset:1024 lds
v_lshl_add_u32 v22, v35, 4, v32
v_add_u32 v35, 4, v34
v_xor_b32 v35, v35, v33
v_lshl_add_u32 v23, v35, 4, v32
v_add_u32 v35, 6, v34
v_xor_b32 v35, v35, v33
v_lshl_add_u32 v24, v35, 4, v32
v_lshrrev_b32 v33, 5, v1
v_bfe_u32 v34, v1, 2, 2
v_lshl_add_u32 v36, v33, 3, v34
v_mul_u32_u24 v36, 320, v36
buffer_load_dwordx4 v226, s[12:15], 0 offen offset:2048 lds
v_bfe_u32 v32, v1, 4, 1
v_and_b32 v35, 3, v1
v_lshl_add_u32 v35, v32, 2, v35
v_lshlrev_b32 v37, 2, v35
s_mov_b32 s28, 1952789008
v_lshrrev_b32 v38, v37, s28
v_and_b32 v38, 15, v38
v_lshl_add_u32 v38, v38, 3, v36
v_add_u32 v2, 0, v38
v_add_u32 v7, 61440, v2
s_mov_b32 s28, 1985229328
buffer_load_dwordx4 v227, s[12:15], 0 offen offset:3072 lds
v_lshrrev_b32 v38, v37, s28
v_and_b32 v38, 15, v38
v_lshl_add_u32 v38, v38, 3, v36
v_add_u32 v3, 64, v38
v_add_u32 v8, 61440, v3
s_mov_b32 s28, 1985229328
v_lshrrev_b32 v38, v37, s28
v_and_b32 v38, 15, v38
v_lshl_add_u32 v38, v38, 3, v36
v_add_u32 v4, 128, v38
v_add_u32 v9, 61440, v4
s_add_u32 m0, s60, 4096
s_nop 0
buffer_load_dwordx4 v228, s[12:15], 0 offen offset:0 lds
s_mov_b32 s28, 1984971553
v_lshrrev_b32 v38, v37, s28
v_and_b32 v38, 15, v38
v_lshl_add_u32 v38, v38, 3, v36
v_add_u32 v5, 192, v38
v_add_u32 v10, 61440, v5
s_mov_b32 s28, 1919238928
v_lshrrev_b32 v38, v37, s28
v_and_b32 v38, 15, v38
v_lshl_add_u32 v38, v38, 3, v36
v_add_u32 v6, 256, v38
buffer_load_dwordx4 v229, s[12:15], 0 offen offset:1024 lds
v_add_u32 v11, 61440, v6
v_lshrrev_b32 v33, 5, v1
v_bfe_u32 v34, v1, 2, 2
v_lshl_add_u32 v34, v33, 3, v34
v_mul_u32_u24 v34, 160, v34
v_bfe_u32 v32, v1, 4, 1
v_and_b32 v35, 3, v1
v_lshl_add_u32 v35, v32, 2, v35
v_lshl_add_u32 v34, v35, 3, v34
s_min_u32 s28, s20, 2
s_lshl_b32 s29, s28, 6
buffer_load_dwordx4 v230, s[12:15], 0 offen offset:2048 lds
s_add_u32 s29, s29, 81920
s_lshl_b32 s28, s20, 5
s_mul_i32 s30, s57, 80
v_add_u32 v232, s29, v34
s_lshl_b32 s31, s22, 2
s_add_u32 s31, s31, s56
s_mul_i32 s31, s31, 384
s_add_u32 s31, s31, s30
v_add_u32 v32, s28, v1
v_add_u32 v33, s31, v32
v_lshlrev_b32 v33, 2, v33
s_add_u32 m0, s26, 4096
s_mov_b32 s24, 128
buffer_load_dwordx4 v17, s[8:11], s24 offen offset:0 lds
v_add_u32 v33, 30408704, v33
v_mov_b32 v34, 2147483648
v_cmp_gt_u32 vcc, 80, v32
s_nop 1
v_cndmask_b32 v33, v34, v33, vcc
v_cmp_gt_u32 vcc, 32, v1
s_nop 1
v_cndmask_b32 v233, v34, v33, vcc
v_mov_b32 v208, 0x3f803f80
v_mov_b32 v209, 0x3f803f80
v_mov_b32 v210, 0x3f803f80
v_mov_b32 v211, 0x3f803f80
s_lshl_b32 s33, s22, 4
buffer_load_dwordx4 v18, s[8:11], s24 offen offset:1024 lds
s_add_u32 s33, s33, s21
v_mov_b32 v32, s33
v_mov_b32 v33, 2147483648
v_cmp_eq_u32 vcc, 0, v0
s_nop 1
v_cndmask_b32 v234, v33, v32, vcc
v_lshlrev_b32 v47, 2, v1
v_lshrrev_b32 v32, 2, v1
v_cmp_eq_u32 vcc, s22, v32
v_mov_b32 v33, 0x01010101
s_nop 0
v_cndmask_b32 v67, 0, v33, vcc
s_and_b32 s33, s21, 3
buffer_load_dwordx4 v19, s[8:11], s24 offen offset:2048 lds
s_lshl_b32 s33, s33, 3
s_lshl_b32 s33, 1, s33
v_and_b32 v32, 3, v1
v_cmp_eq_u32 vcc, s57, v32
v_mov_b32 v33, s33
s_nop 0
v_cndmask_b32 v32, 0, v33, vcc
v_or_b32 v67, v67, v32
v_mov_b32 v32, 2147483648
v_cmp_gt_u32 vcc, 64, v0
s_nop 1
v_cndmask_b32 v47, v32, v47, vcc
v_cndmask_b32 v67, 0, v67, vcc
buffer_load_dwordx4 v20, s[8:11], s24 offen offset:3072 lds
s_lshl_b32 s33, s21, 2
s_add_u32 s33, s33, s20
s_lshl_b32 s33, s33, 9
s_add_u32 s33, s33, 30539776
v_and_b32 v32, 31, v1
v_lshlrev_b32 v32, 4, v32
v_add_u32 v92, s33, v32
s_lshl_b32 s33, s21, 2
s_add_u32 s33, s33, s20
s_lshl_b32 s33, s33, 7
s_add_u32 s33, s33, 30605312
s_add_u32 m0, s25, 20480
s_add_u32 s32, s23, 245760
buffer_load_dwordx4 v12, s[12:15], s32 offen offset:0 lds
v_lshrrev_b32 v32, 5, v1
v_lshlrev_b32 v32, 4, v32
v_add_u32 v66, s33, v32
v_subrev_u32 v33, 96, v0
v_cmp_gt_u32 vcc, 160, v0
s_nop 1
v_cndmask_b32 v32, v33, v0, vcc
v_lshrrev_b32 v34, 5, v32
v_bfe_u32 v35, v32, 2, 3
v_lshlrev_b32 v35, 2, v35
v_mov_b32 v36, 1952789008
v_mov_b32 v37, 1985229328
buffer_load_dwordx4 v13, s[12:15], s32 offen offset:1024 lds
v_cmp_eq_u32 vcc, 1, v34
s_nop 1
v_cndmask_b32 v36, v36, v37, vcc
v_mov_b32 v37, 1985229328
v_cmp_eq_u32 vcc, 2, v34
s_nop 1
v_cndmask_b32 v36, v36, v37, vcc
v_mov_b32 v37, 1984971553
v_cmp_eq_u32 vcc, 3, v34
s_nop 1
v_cndmask_b32 v36, v36, v37, vcc
v_mov_b32 v37, 1919238928
v_cmp_eq_u32 vcc, 4, v34
s_nop 1
v_cndmask_b32 v36, v36, v37, vcc
buffer_load_dwordx4 v14, s[12:15], s32 offen offset:2048 lds
v_lshrrev_b32 v36, v35, v36
v_and_b32 v36, 15, v36
v_lshlrev_b32 v36, 2, v36
v_lshl_add_u32 v36, v34, 5, v36
v_and_b32 v33, 3, v32
v_add_u32 v33, v33, v36
s_mul_i32 s28, s22, 6144
s_add_u32 s28, s28, 30408704
v_lshlrev_b32 v33, 2, v33
v_add_u32 v90, s28, v33
v_lshlrev_b32 v32, 2, v32
buffer_load_dwordx4 v15, s[12:15], s32 offen offset:3072 lds
v_add_u32 v91, 102400, v32
v_and_b32 v32, 31, v1
v_lshlrev_b32 v32, 2, v32
v_add_u32 v95, 102400, v32
s_lshl_b32 s28, s21, 2
s_add_u32 s28, s28, s20
s_lshl_b32 s29, s28, 10
v_lshlrev_b32 v32, 4, v1
v_add_u32 v25, s29, v32
s_lshl_b32 s29, s28, 8
v_and_b32 v32, 31, v1
s_add_u32 m0, s25, 24576
s_add_u32 s32, s23, 245760
buffer_load_dwordx4 v16, s[12:15], s32 offen lds
v_lshlrev_b32 v32, 3, v32
v_lshrrev_b32 v33, 5, v1
v_lshl_add_u32 v32, v33, 14, v32
v_add_u32 v26, s29, v32
s_waitcnt vmcnt(20)
v_lshlrev_b32 v240, 16, v176
v_and_b32 v241, 0xffff0000, v176
v_lshlrev_b32 v242, 16, v177
v_and_b32 v243, 0xffff0000, v177
s_waitcnt vmcnt(19)
v_lshlrev_b32 v244, 16, v178
v_and_b32 v245, 0xffff0000, v178
v_lshlrev_b32 v246, 16, v179
v_and_b32 v247, 0xffff0000, v179
s_waitcnt vmcnt(18)
v_lshlrev_b32 v248, 16, v180
v_and_b32 v249, 0xffff0000, v180
v_add_f32 v250, v240, v241
v_mul_f32 v251, v240, v240
v_fmac_f32 v251, v241, v241
v_add_f32 v250, v250, v242
v_fmac_f32 v251, v242, v242
v_add_f32 v250, v250, v243
v_fmac_f32 v251, v243, v243
v_add_f32 v250, v250, v244
v_fmac_f32 v251, v244, v244
v_add_f32 v250, v250, v245
v_fmac_f32 v251, v245, v245
v_add_f32 v250, v250, v246
v_fmac_f32 v251, v246, v246
v_add_f32 v250, v250, v247
v_fmac_f32 v251, v247, v247
v_add_f32 v250, v250, v248
v_fmac_f32 v251, v248, v248
v_add_f32 v250, v250, v249
v_fmac_f32 v251, v249, v249
v_lshlrev_b32 v240, 16, v181
v_and_b32 v241, 0xffff0000, v181
s_waitcnt vmcnt(17)
v_lshlrev_b32 v242, 16, v182
v_and_b32 v243, 0xffff0000, v182
v_lshlrev_b32 v244, 16, v183
v_and_b32 v245, 0xffff0000, v183
s_waitcnt vmcnt(16)
v_lshlrev_b32 v246, 16, v184
v_and_b32 v247, 0xffff0000, v184
v_lshlrev_b32 v248, 16, v185
v_and_b32 v249, 0xffff0000, v185
v_add_f32 v250, v250, v240
v_fmac_f32 v251, v240, v240
v_add_f32 v250, v250, v241
v_fmac_f32 v251, v241, v241
v_add_f32 v250, v250, v242
v_fmac_f32 v251, v242, v242
v_add_f32 v250, v250, v243
v_fmac_f32 v251, v243, v243
v_add_f32 v250, v250, v244
v_fmac_f32 v251, v244, v244
v_add_f32 v250, v250, v245
v_fmac_f32 v251, v245, v245
v_add_f32 v250, v250, v246
v_fmac_f32 v251, v246, v246
v_add_f32 v250, v250, v247
v_fmac_f32 v251, v247, v247
v_add_f32 v250, v250, v248
v_fmac_f32 v251, v248, v248
v_add_f32 v250, v250, v249
v_fmac_f32 v251, v249, v249
s_nop 0
v_add_f32_dpp v250, v250, v250 row_ror:8 row_mask:0xf bank_mask:0xf
v_add_f32_dpp v251, v251, v251 row_ror:8 row_mask:0xf bank_mask:0xf
s_nop 0
v_add_f32_dpp v250, v250, v250 row_ror:4 row_mask:0xf bank_mask:0xf
v_add_f32_dpp v251, v251, v251 row_ror:4 row_mask:0xf bank_mask:0xf
s_nop 0
v_add_f32_dpp v250, v250, v250 row_ror:2 row_mask:0xf bank_mask:0xf
v_add_f32_dpp v251, v251, v251 row_ror:2 row_mask:0xf bank_mask:0xf
s_nop 0
v_add_f32_dpp v250, v250, v250 row_ror:1 row_mask:0xf bank_mask:0xf
v_add_f32_dpp v251, v251, v251 row_ror:1 row_mask:0xf bank_mask:0xf
ds_swizzle_b32 v252, v250 offset:16415
ds_swizzle_b32 v253, v251 offset:16415
v_and_b32 v254, 31, v1
v_cmp_eq_u32 vcc, 0, v254
v_mov_b32 v254, 2147483648
v_lshlrev_b32 v235, 4, v238
v_add_u32 v235, 30539776, v235
v_cndmask_b32 v235, v254, v235, vcc
v_lshlrev_b32 v236, 2, v238
v_add_u32 v236, 30605312, v236
v_cndmask_b32 v236, v254, v236, vcc
s_waitcnt lgkmcnt(1)
v_add_f32 v250, v250, v252
s_waitcnt lgkmcnt(0)
v_add_f32 v251, v251, v253
v_mul_f32 v240, 0xbacccccd, v250
v_mul_f32 v252, v240, v240
v_mov_b32 v253, 0x3acccccd
v_fma_f32 v252, v251, v253, -v252
v_max_f32 v252, 0, v252
v_add_f32 v252, 0x3727c5ac, v252
v_rsq_f32 v241, v252
v_sqrt_f32 v242, v252
v_mov_b32 v243, 0
buffer_store_dwordx4 v[240:243], v235, s[16:19], 0 offen sc1
buffer_store_dword v241, v236, s[16:19], 0 offen sc1
s_and_b32 s42, s22, 1
s_lshl_b32 s42, s42, 4
s_cmp_lt_u32 s22, 2
s_mov_b32 s45, 8388608
s_cselect_b32 s43, 4194304, s45
s_mov_b32 s45, 10485760
s_cselect_b32 s44, 6291456, s45
s_mov_b32 s45, 1.0
s_cselect_b32 s27, 1051011932, s45
s_lshl_b32 s45, s42, 16
s_add_u32 s43, s43, s45
s_lshl_b32 s45, s42, 14
s_add_u32 s44, s44, s45
s_add_u32 s46, s43, 524288
s_add_u32 s47, s44, 131072
s_barrier
ds_read_b128 a[0:3], v21 offset:0
ds_read_b128 a[4:7], v22 offset:0
ds_read_b128 a[8:11], v23 offset:0
ds_read_b128 a[12:15], v24 offset:0
ds_read_b64_tr_b16 a[160:161], v2 offset:0
ds_read_b64_tr_b16 a[162:163], v2 offset:1280
ds_read_b64_tr_b16 a[164:165], v3 offset:0
ds_read_b64_tr_b16 a[166:167], v3 offset:1280
ds_read_b64_tr_b16 a[168:169], v4 offset:0
ds_read_b64_tr_b16 a[170:171], v4 offset:1280
ds_read_b64_tr_b16 a[172:173], v5 offset:0
ds_read_b64_tr_b16 a[174:175], v5 offset:1280
ds_read_b64_tr_b16 a[176:177], v6 offset:0
ds_read_b64_tr_b16 a[178:179], v6 offset:1280
s_waitcnt lgkmcnt(8)
v_mfma_f32_32x32x16_bf16 v[96:111], a[160:163], a[0:3], 0
ds_read_b64_tr_b16 a[180:181], v2 offset:5120
ds_read_b64_tr_b16 a[182:183], v2 offset:6400
s_waitcnt lgkmcnt(8)
v_mfma_f32_32x32x16_bf16 v[112:127], a[164:167], a[0:3], 0
ds_read_b64_tr_b16 a[184:185], v3 offset:5120
ds_read_b64_tr_b16 a[186:187], v3 offset:6400
s_add_u32 m0, s26, 8192
s_mov_b32 s24, 256
buffer_load_dwordx4 v17, s[8:11], s24 offen offset:0 lds
buffer_load_dwordx4 v18, s[8:11], s24 offen offset:1024 lds
s_waitcnt lgkmcnt(8)
v_mfma_f32_32x32x16_bf16 v[128:143], a[168:171], a[0:3], 0
ds_read_b64_tr_b16 a[188:189], v4 offset:5120
ds_read_b64_tr_b16 a[190:191], v4 offset:6400
buffer_load_dwordx4 v19, s[8:11], s24 offen offset:2048 lds
buffer_load_dwordx4 v20, s[8:11], s24 offen offset:3072 lds
s_waitcnt lgkmcnt(8)
v_mfma_f32_32x32x16_bf16 v[144:159], a[172:175], a[0:3], 0
ds_read_b64_tr_b16 a[192:193], v5 offset:5120
ds_read_b64_tr_b16 a[194:195], v5 offset:6400
s_add_u32 m0, s25, 40960
s_add_u32 s32, s23, 491520
buffer_load_dwordx4 v12, s[12:15], s32 offen offset:0 lds
buffer_load_dwordx4 v13, s[12:15], s32 offen offset:1024 lds
s_waitcnt lgkmcnt(8)
v_mfma_f32_32x32x16_bf16 v[160:175], a[176:179], a[0:3], 0
ds_read_b64_tr_b16 a[196:197], v6 offset:5120
ds_read_b64_tr_b16 a[198:199], v6 offset:6400
buffer_load_dwordx4 v14, s[12:15], s32 offen offset:2048 lds
buffer_load_dwordx4 v15, s[12:15], s32 offen offset:3072 lds
s_waitcnt lgkmcnt(8)
v_mfma_f32_32x32x16_bf16 v[96:111], a[180:183], a[4:7], v[96:111]
ds_read_b64_tr_b16 a[160:161], v2 offset:10240
ds_read_b64_tr_b16 a[162:163], v2 offset:11520
s_add_u32 m0, s25, 45056
s_add_u32 s32, s23, 491520
buffer_load_dwordx4 v16, s[12:15], s32 offen lds
s_add_u32 m0, s26, 0
s_mov_b32 s24, 384
buffer_load_dwordx4 v17, s[8:11], s24 offen offset:0 lds
s_waitcnt lgkmcnt(8)
v_mfma_f32_32x32x16_bf16 v[112:127], a[184:187], a[4:7], v[112:127]
ds_read_b64_tr_b16 a[164:165], v3 offset:10240
ds_read_b64_tr_b16 a[166:167], v3 offset:11520
buffer_load_dwordx4 v18, s[8:11], s24 offen offset:1024 lds
buffer_load_dwordx4 v19, s[8:11], s24 offen offset:2048 lds
s_waitcnt lgkmcnt(8)
v_mfma_f32_32x32x16_bf16 v[128:143], a[188:191], a[4:7], v[128:143]
ds_read_b64_tr_b16 a[168:169], v4 offset:10240
ds_read_b64_tr_b16 a[170:171], v4 offset:11520
buffer_load_dwordx4 v20, s[8:11], s24 offen offset:3072 lds
s_add_u32 m0, s25, 61440
s_add_u32 s32, s23, 737280
buffer_load_dwordx4 v12, s[12:15], s32 offen offset:0 lds
s_waitcnt lgkmcnt(8)
v_mfma_f32_32x32x16_bf16 v[144:159], a[192:195], a[4:7], v[144:159]
ds_read_b64_tr_b16 a[172:173], v5 offset:10240
ds_read_b64_tr_b16 a[174:175], v5 offset:11520
buffer_load_dwordx4 v13, s[12:15], s32 offen offset:1024 lds
buffer_load_dwordx4 v14, s[12:15], s32 offen offset:2048 lds
s_waitcnt lgkmcnt(8)
v_mfma_f32_32x32x16_bf16 v[160:175], a[196:199], a[4:7], v[160:175]
ds_read_b64_tr_b16 a[176:177], v6 offset:10240
ds_read_b64_tr_b16 a[178:179], v6 offset:11520
buffer_load_dwordx4 v15, s[12:15], s32 offen offset:3072 lds
s_add_u32 m0, s25, 65536
s_add_u32 s32, s23, 737280
buffer_load_dwordx4 v16, s[12:15], s32 offen lds
s_waitcnt lgkmcnt(8)
v_mfma_f32_32x32x16_bf16 v[96:111], a[160:163], a[8:11], v[96:111]
ds_read_b64_tr_b16 a[180:181], v2 offset:15360
ds_read_b64_tr_b16 a[182:183], v2 offset:16640
s_waitcnt lgkmcnt(8)
v_mfma_f32_32x32x16_bf16 v[112:127], a[164:167], a[8:11], v[112:127]
ds_read_b64_tr_b16 a[184:185], v3 offset:15360
ds_read_b64_tr_b16 a[186:187], v3 offset:16640
s_waitcnt lgkmcnt(8)
v_mfma_f32_32x32x16_bf16 v[128:143], a[168:171], a[8:11], v[128:143]
ds_read_b64_tr_b16 a[188:189], v4 offset:15360
ds_read_b64_tr_b16 a[190:191], v4 offset:16640
s_waitcnt lgkmcnt(8)
v_mfma_f32_32x32x16_bf16 v[144:159], a[172:175], a[8:11], v[144:159]
ds_read_b64_tr_b16 a[192:193], v5 offset:15360
ds_read_b64_tr_b16 a[194:195], v5 offset:16640
s_waitcnt lgkmcnt(8)
v_mfma_f32_32x32x16_bf16 v[160:175], a[176:179], a[8:11], v[160:175]
ds_read_b64_tr_b16 a[196:197], v6 offset:15360
ds_read_b64_tr_b16 a[198:199], v6 offset:16640
s_waitcnt vmcnt(20)
s_barrier
ds_read_b128 a[16:19], v21 offset:4096
ds_read_b128 a[20:23], v22 offset:4096
ds_read_b128 a[24:27], v23 offset:4096
ds_read_b128 a[28:31], v24 offset:4096
s_waitcnt lgkmcnt(12)
v_mfma_f32_32x32x16_bf16 v[96:111], a[180:183], a[12:15], v[96:111]
ds_read_b64_tr_b16 a[160:161], v2 offset:20480
ds_read_b64_tr_b16 a[162:163], v2 offset:21760
s_waitcnt lgkmcnt(12)
v_mfma_f32_32x32x16_bf16 v[112:127], a[184:187], a[12:15], v[112:127]
ds_read_b64_tr_b16 a[164:165], v3 offset:20480
ds_read_b64_tr_b16 a[166:167], v3 offset:21760
s_waitcnt lgkmcnt(12)
v_mfma_f32_32x32x16_bf16 v[128:143], a[188:191], a[12:15], v[128:143]
ds_read_b64_tr_b16 a[168:169], v4 offset:20480
ds_read_b64_tr_b16 a[170:171], v4 offset:21760
s_waitcnt lgkmcnt(12)
v_mfma_f32_32x32x16_bf16 v[144:159], a[192:195], a[12:15], v[144:159]
ds_read_b64_tr_b16 a[172:173], v5 offset:20480
ds_read_b64_tr_b16 a[174:175], v5 offset:21760
s_waitcnt lgkmcnt(12)
v_mfma_f32_32x32x16_bf16 v[160:175], a[196:199], a[12:15], v[160:175]
ds_read_b64_tr_b16 a[176:177], v6 offset:20480
ds_read_b64_tr_b16 a[178:179], v6 offset:21760
s_waitcnt lgkmcnt(8)
v_mfma_f32_32x32x16_bf16 v[96:111], a[160:163], a[16:19], v[96:111]
ds_read_b64_tr_b16 a[180:181], v2 offset:25600
ds_read_b64_tr_b16 a[182:183], v2 offset:26880
s_waitcnt lgkmcnt(8)
v_mfma_f32_32x32x16_bf16 v[112:127], a[164:167], a[16:19], v[112:127]
ds_read_b64_tr_b16 a[184:185], v3 offset:25600
ds_read_b64_tr_b16 a[186:187], v3 offset:26880
s_add_u32 m0, s26, 4096
s_mov_b32 s24, 512
buffer_load_dwordx4 v17, s[8:11], s24 offen offset:0 lds
s_waitcnt lgkmcnt(8)
v_mfma_f32_32x32x16_bf16 v[128:143], a[168:171], a[16:19], v[128:143]
ds_read_b64_tr_b16 a[188:189], v4 offset:25600
ds_read_b64_tr_b16 a[190:191], v4 offset:26880
buffer_load_dwordx4 v18, s[8:11], s24 offen offset:1024 lds
ds_read_b64_tr_b16 v[212:213], v232 offset:0
ds_read_b64_tr_b16 v[214:215], v232 offset:640
s_waitcnt lgkmcnt(10)
v_mfma_f32_32x32x16_bf16 v[144:159], a[172:175], a[16:19], v[144:159]
ds_read_b64_tr_b16 a[192:193], v5 offset:25600
ds_read_b64_tr_b16 a[194:195], v5 offset:26880
buffer_load_dwordx4 v19, s[8:11], s24 offen offset:2048 lds
ds_read_b64_tr_b16 v[216:217], v232 offset:2560
ds_read_b64_tr_b16 v[218:219], v232 offset:3200
s_waitcnt lgkmcnt(4)
v_mfma_f32_32x32x16_bf16 v[192:207], v[208:211], v[212:215], 0
v_mfma_f32_32x32x16_bf16 v[160:175], a[176:179], a[16:19], v[160:175]
ds_read_b64_tr_b16 a[196:197], v6 offset:25600
ds_read_b64_tr_b16 a[198:199], v6 offset:26880
buffer_load_dwordx4 v20, s[8:11], s24 offen offset:3072 lds
ds_read_b64_tr_b16 v[212:213], v232 offset:5120
ds_read_b64_tr_b16 v[214:215], v232 offset:5760
s_waitcnt lgkmcnt(4)
v_mfma_f32_32x32x16_bf16 v[192:207], v[208:211], v[216:219], v[192:207]
v_mfma_f32_32x32x16_bf16 v[96:111], a[180:183], a[20:23], v[96:111]
ds_read_b64_tr_b16 a[160:161], v2 offset:30720
ds_read_b64_tr_b16 a[162:163], v2 offset:32000
ds_read_b64_tr_b16 v[216:217], v232 offset:7680
ds_read_b64_tr_b16 v[218:219], v232 offset:8320
s_waitcnt lgkmcnt(4)
v_mfma_f32_32x32x16_bf16 v[192:207], v[208:211], v[212:215], v[192:207]
v_mfma_f32_32x32x16_bf16 v[112:127], a[184:187], a[20:23], v[112:127]
ds_read_b64_tr_b16 a[164:165], v3 offset:30720
ds_read_b64_tr_b16 a[166:167], v3 offset:32000
ds_read_b64_tr_b16 v[212:213], v232 offset:10240
ds_read_b64_tr_b16 v[214:215], v232 offset:10880
s_waitcnt lgkmcnt(4)
v_mfma_f32_32x32x16_bf16 v[192:207], v[208:211], v[216:219], v[192:207]
v_mfma_f32_32x32x16_bf16 v[128:143], a[188:191], a[20:23], v[128:143]
ds_read_b64_tr_b16 a[168:169], v4 offset:30720
ds_read_b64_tr_b16 a[170:171], v4 offset:32000
ds_read_b64_tr_b16 v[216:217], v232 offset:12800
ds_read_b64_tr_b16 v[218:219], v232 offset:13440
s_waitcnt lgkmcnt(4)
v_mfma_f32_32x32x16_bf16 v[192:207], v[208:211], v[212:215], v[192:207]
v_mfma_f32_32x32x16_bf16 v[144:159], a[192:195], a[20:23], v[144:159]
ds_read_b64_tr_b16 a[172:173], v5 offset:30720
ds_read_b64_tr_b16 a[174:175], v5 offset:32000
ds_read_b64_tr_b16 v[212:213], v232 offset:15360
ds_read_b64_tr_b16 v[214:215], v232 offset:16000
s_waitcnt lgkmcnt(4)
v_mfma_f32_32x32x16_bf16 v[192:207], v[208:211], v[216:219], v[192:207]
v_mfma_f32_32x32x16_bf16 v[160:175], a[196:199], a[20:23], v[160:175]
ds_read_b64_tr_b16 a[176:177], v6 offset:30720
ds_read_b64_tr_b16 a[178:179], v6 offset:32000
ds_read_b64_tr_b16 v[216:217], v232 offset:17920
ds_read_b64_tr_b16 v[218:219], v232 offset:18560
s_waitcnt lgkmcnt(4)
v_mfma_f32_32x32x16_bf16 v[192:207], v[208:211], v[212:215], v[192:207]
v_mfma_f32_32x32x16_bf16 v[96:111], a[160:163], a[24:27], v[96:111]
ds_read_b64_tr_b16 a[180:181], v2 offset:35840
ds_read_b64_tr_b16 a[182:183], v2 offset:37120
ds_read_b64_tr_b16 v[212:213], v232 offset:20480
ds_read_b64_tr_b16 v[214:215], v232 offset:21120
s_waitcnt lgkmcnt(4)
v_mfma_f32_32x32x16_bf16 v[192:207], v[208:211], v[216:219], v[192:207]
v_mfma_f32_32x32x16_bf16 v[112:127], a[164:167], a[24:27], v[112:127]
ds_read_b64_tr_b16 a[184:185], v3 offset:35840
ds_read_b64_tr_b16 a[186:187], v3 offset:37120
ds_read_b64_tr_b16 v[216:217], v232 offset:23040
ds_read_b64_tr_b16 v[218:219], v232 offset:23680
s_waitcnt lgkmcnt(4)
v_mfma_f32_32x32x16_bf16 v[192:207], v[208:211], v[212:215], v[192:207]
v_mfma_f32_32x32x16_bf16 v[128:143], a[168:171], a[24:27], v[128:143]
ds_read_b64_tr_b16 a[188:189], v4 offset:35840
ds_read_b64_tr_b16 a[190:191], v4 offset:37120
s_waitcnt lgkmcnt(2)
v_mfma_f32_32x32x16_bf16 v[192:207], v[208:211], v[216:219], v[192:207]
v_mfma_f32_32x32x16_bf16 v[144:159], a[172:175], a[24:27], v[144:159]
ds_read_b64_tr_b16 a[192:193], v5 offset:35840
ds_read_b64_tr_b16 a[194:195], v5 offset:37120
v_mfma_f32_32x32x16_bf16 v[160:175], a[176:179], a[24:27], v[160:175]
ds_read_b64_tr_b16 a[196:197], v6 offset:35840
ds_read_b64_tr_b16 a[198:199], v6 offset:37120
s_waitcnt vmcnt(13)
s_barrier
ds_read_b128 a[32:35], v21 offset:8192
ds_read_b128 a[36:39], v22 offset:8192
ds_read_b128 a[40:43], v23 offset:8192
ds_read_b128 a[44:47], v24 offset:8192
v_mfma_f32_32x32x16_bf16 v[96:111], a[180:183], a[28:31], v[96:111]
ds_read_b64_tr_b16 a[160:161], v2 offset:40960
ds_read_b64_tr_b16 a[162:163], v2 offset:42240
v_mfma_f32_32x32x16_bf16 v[112:127], a[184:187], a[28:31], v[112:127]
ds_read_b64_tr_b16 a[164:165], v3 offset:40960
ds_read_b64_tr_b16 a[166:167], v3 offset:42240
s_waitcnt lgkmcnt(12)
v_mfma_f32_32x32x16_bf16 v[128:143], a[188:191], a[28:31], v[128:143]
ds_read_b64_tr_b16 a[168:169], v4 offset:40960
ds_read_b64_tr_b16 a[170:171], v4 offset:42240
s_waitcnt lgkmcnt(12)
v_mfma_f32_32x32x16_bf16 v[144:159], a[192:195], a[28:31], v[144:159]
ds_read_b64_tr_b16 a[172:173], v5 offset:40960
ds_read_b64_tr_b16 a[174:175], v5 offset:42240
s_waitcnt lgkmcnt(12)
v_mfma_f32_32x32x16_bf16 v[160:175], a[196:199], a[28:31], v[160:175]
ds_read_b64_tr_b16 a[176:177], v6 offset:40960
ds_read_b64_tr_b16 a[178:179], v6 offset:42240
buffer_store_dword v192, v233, s[16:19], 0 offen sc1
s_waitcnt lgkmcnt(8)
v_mfma_f32_32x32x16_bf16 v[96:111], a[160:163], a[32:35], v[96:111]
ds_read_b64_tr_b16 a[180:181], v2 offset:46080
ds_read_b64_tr_b16 a[182:183], v2 offset:47360
s_waitcnt lgkmcnt(8)
v_mfma_f32_32x32x16_bf16 v[112:127], a[164:167], a[32:35], v[112:127]
ds_read_b64_tr_b16 a[184:185], v3 offset:46080
ds_read_b64_tr_b16 a[186:187], v3 offset:47360
s_add_u32 m0, s26, 8192
s_mov_b32 s24, 640
buffer_load_dwordx4 v17, s[8:11], s24 offen offset:0 lds
buffer_load_dwordx4 v18, s[8:11], s24 offen offset:1024 lds
s_waitcnt lgkmcnt(8)
v_mfma_f32_32x32x16_bf16 v[128:143], a[168:171], a[32:35], v[128:143]
ds_read_b64_tr_b16 a[188:189], v4 offset:46080
ds_read_b64_tr_b16 a[190:191], v4 offset:47360
buffer_load_dwordx4 v19, s[8:11], s24 offen offset:2048 lds
buffer_load_dwordx4 v20, s[8:11], s24 offen offset:3072 lds
s_waitcnt lgkmcnt(8)
v_mfma_f32_32x32x16_bf16 v[144:159], a[172:175], a[32:35], v[144:159]
ds_read_b64_tr_b16 a[192:193], v5 offset:46080
ds_read_b64_tr_b16 a[194:195], v5 offset:47360
s_add_u32 m0, s25, 81920
s_add_u32 s32, s23, 983040
buffer_load_dwordx4 v12, s[12:15], s32 offen offset:0 lds
buffer_load_dwordx4 v13, s[12:15], s32 offen offset:1024 lds
s_waitcnt lgkmcnt(8)
v_mfma_f32_32x32x16_bf16 v[160:175], a[176:179], a[32:35], v[160:175]
ds_read_b64_tr_b16 a[196:197], v6 offset:46080
ds_read_b64_tr_b16 a[198:199], v6 offset:47360
buffer_load_dwordx4 v14, s[12:15], s32 offen offset:2048 lds
buffer_load_dwordx4 v15, s[12:15], s32 offen offset:3072 lds
s_waitcnt lgkmcnt(8)
v_mfma_f32_32x32x16_bf16 v[96:111], a[180:183], a[36:39], v[96:111]
ds_read_b64_tr_b16 a[160:161], v2 offset:51200
ds_read_b64_tr_b16 a[162:163], v2 offset:52480
s_add_u32 m0, s25, 86016
s_add_u32 s32, s23, 983040
buffer_load_dwordx4 v16, s[12:15], s32 offen lds
s_add_u32 m0, s25, 0
s_add_u32 s32, s23, 1228800
buffer_load_dwordx4 v12, s[12:15], s32 offen offset:0 lds
s_waitcnt lgkmcnt(8)
v_mfma_f32_32x32x16_bf16 v[112:127], a[184:187], a[36:39], v[112:127]
ds_read_b64_tr_b16 a[164:165], v3 offset:51200
ds_read_b64_tr_b16 a[166:167], v3 offset:52480
buffer_load_dwordx4 v13, s[12:15], s32 offen offset:1024 lds
buffer_load_dwordx4 v14, s[12:15], s32 offen offset:2048 lds
s_waitcnt lgkmcnt(8)
v_mfma_f32_32x32x16_bf16 v[128:143], a[188:191], a[36:39], v[128:143]
ds_read_b64_tr_b16 a[168:169], v4 offset:51200
ds_read_b64_tr_b16 a[170:171], v4 offset:52480
buffer_load_dwordx4 v15, s[12:15], s32 offen offset:3072 lds
s_add_u32 m0, s25, 4096
s_add_u32 s32, s23, 1228800
buffer_load_dwordx4 v16, s[12:15], s32 offen lds
s_waitcnt lgkmcnt(8)
v_mfma_f32_32x32x16_bf16 v[144:159], a[192:195], a[36:39], v[144:159]
ds_read_b64_tr_b16 a[172:173], v5 offset:51200
ds_read_b64_tr_b16 a[174:175], v5 offset:52480
s_waitcnt lgkmcnt(8)
v_mfma_f32_32x32x16_bf16 v[160:175], a[196:199], a[36:39], v[160:175]
ds_read_b64_tr_b16 a[176:177], v6 offset:51200
ds_read_b64_tr_b16 a[178:179], v6 offset:52480
s_waitcnt lgkmcnt(8)
v_mfma_f32_32x32x16_bf16 v[96:111], a[160:163], a[40:43], v[96:111]
ds_read_b64_tr_b16 a[180:181], v2 offset:56320
ds_read_b64_tr_b16 a[182:183], v2 offset:57600
s_waitcnt lgkmcnt(8)
v_mfma_f32_32x32x16_bf16 v[112:127], a[164:167], a[40:43], v[112:127]
ds_read_b64_tr_b16 a[184:185], v3 offset:56320
ds_read_b64_tr_b16 a[186:187], v3 offset:57600
s_waitcnt lgkmcnt(8)
v_mfma_f32_32x32x16_bf16 v[128:143], a[168:171], a[40:43], v[128:143]
ds_read_b64_tr_b16 a[188:189], v4 offset:56320
ds_read_b64_tr_b16 a[190:191], v4 offset:57600
s_waitcnt lgkmcnt(8)
v_mfma_f32_32x32x16_bf16 v[144:159], a[172:175], a[40:43], v[144:159]
ds_read_b64_tr_b16 a[192:193], v5 offset:56320
ds_read_b64_tr_b16 a[194:195], v5 offset:57600
s_waitcnt lgkmcnt(8)
v_mfma_f32_32x32x16_bf16 v[160:175], a[176:179], a[40:43], v[160:175]
ds_read_b64_tr_b16 a[196:197], v6 offset:56320
ds_read_b64_tr_b16 a[198:199], v6 offset:57600
s_waitcnt vmcnt(19)
s_barrier
ds_read_b128 a[48:51], v21 offset:0
ds_read_b128 a[52:55], v22 offset:0
ds_read_b128 a[56:59], v23 offset:0
ds_read_b128 a[60:63], v24 offset:0
s_waitcnt lgkmcnt(12)
v_mfma_f32_32x32x16_bf16 v[96:111], a[180:183], a[44:47], v[96:111]
ds_read_b64_tr_b16 a[160:161], v7 offset:0
ds_read_b64_tr_b16 a[162:163], v7 offset:1280
s_waitcnt lgkmcnt(12)
v_mfma_f32_32x32x16_bf16 v[112:127], a[184:187], a[44:47], v[112:127]
ds_read_b64_tr_b16 a[164:165], v8 offset:0
ds_read_b64_tr_b16 a[166:167], v8 offset:1280
s_waitcnt lgkmcnt(12)
v_mfma_f32_32x32x16_bf16 v[128:143], a[188:191], a[44:47], v[128:143]
ds_read_b64_tr_b16 a[168:169], v9 offset:0
ds_read_b64_tr_b16 a[170:171], v9 offset:1280
s_waitcnt lgkmcnt(12)
v_mfma_f32_32x32x16_bf16 v[144:159], a[192:195], a[44:47], v[144:159]
ds_read_b64_tr_b16 a[172:173], v10 offset:0
ds_read_b64_tr_b16 a[174:175], v10 offset:1280
s_waitcnt lgkmcnt(12)
v_mfma_f32_32x32x16_bf16 v[160:175], a[196:199], a[44:47], v[160:175]
ds_read_b64_tr_b16 a[176:177], v11 offset:0
ds_read_b64_tr_b16 a[178:179], v11 offset:1280
s_waitcnt lgkmcnt(8)
v_mfma_f32_32x32x16_bf16 v[96:111], a[160:163], a[48:51], v[96:111]
ds_read_b64_tr_b16 a[180:181], v7 offset:5120
ds_read_b64_tr_b16 a[182:183], v7 offset:6400
s_waitcnt lgkmcnt(8)
v_mfma_f32_32x32x16_bf16 v[112:127], a[164:167], a[48:51], v[112:127]
ds_read_b64_tr_b16 a[184:185], v8 offset:5120
ds_read_b64_tr_b16 a[186:187], v8 offset:6400
s_add_u32 m0, s26, 0
s_mov_b32 s24, 768
buffer_load_dwordx4 v17, s[8:11], s24 offen offset:0 lds
v_mov_b32 v45, 1
s_waitcnt lgkmcnt(8)
v_mfma_f32_32x32x16_bf16 v[128:143], a[168:171], a[48:51], v[128:143]
ds_read_b64_tr_b16 a[188:189], v9 offset:5120
ds_read_b64_tr_b16 a[190:191], v9 offset:6400
buffer_load_dwordx4 v18, s[8:11], s24 offen offset:1024 lds
s_waitcnt lgkmcnt(8)
v_mfma_f32_32x32x16_bf16 v[144:159], a[172:175], a[48:51], v[144:159]
ds_read_b64_tr_b16 a[192:193], v10 offset:5120
ds_read_b64_tr_b16 a[194:195], v10 offset:6400
buffer_load_dwordx4 v19, s[8:11], s24 offen offset:2048 lds
s_waitcnt lgkmcnt(8)
v_mfma_f32_32x32x16_bf16 v[160:175], a[176:179], a[48:51], v[160:175]
ds_read_b64_tr_b16 a[196:197], v11 offset:5120
ds_read_b64_tr_b16 a[198:199], v11 offset:6400
buffer_load_dwordx4 v20, s[8:11], s24 offen offset:3072 lds
s_waitcnt lgkmcnt(8)
v_mfma_f32_32x32x16_bf16 v[96:111], a[180:183], a[52:55], v[96:111]
ds_read_b64_tr_b16 a[160:161], v7 offset:10240
ds_read_b64_tr_b16 a[162:163], v7 offset:11520
s_add_u32 m0, s25, 20480
s_add_u32 s32, s23, 1474560
buffer_load_dwordx4 v12, s[12:15], s32 offen offset:0 lds
s_waitcnt lgkmcnt(8)
v_mfma_f32_32x32x16_bf16 v[112:127], a[184:187], a[52:55], v[112:127]
ds_read_b64_tr_b16 a[164:165], v8 offset:10240
ds_read_b64_tr_b16 a[166:167], v8 offset:11520
buffer_load_dwordx4 v13, s[12:15], s32 offen offset:1024 lds
s_waitcnt lgkmcnt(8)
v_mfma_f32_32x32x16_bf16 v[128:143], a[188:191], a[52:55], v[128:143]
ds_read_b64_tr_b16 a[168:169], v9 offset:10240
ds_read_b64_tr_b16 a[170:171], v9 offset:11520
buffer_load_dwordx4 v14, s[12:15], s32 offen offset:2048 lds
s_waitcnt lgkmcnt(8)
v_mfma_f32_32x32x16_bf16 v[144:159], a[192:195], a[52:55], v[144:159]
ds_read_b64_tr_b16 a[172:173], v10 offset:10240
ds_read_b64_tr_b16 a[174:175], v10 offset:11520
buffer_load_dwordx4 v15, s[12:15], s32 offen offset:3072 lds
s_waitcnt lgkmcnt(8)
v_mfma_f32_32x32x16_bf16 v[160:175], a[196:199], a[52:55], v[160:175]
ds_read_b64_tr_b16 a[176:177], v11 offset:10240
ds_read_b64_tr_b16 a[178:179], v11 offset:11520
s_add_u32 m0, s25, 24576
s_add_u32 s32, s23, 1474560
buffer_load_dwordx4 v16, s[12:15], s32 offen lds
s_waitcnt lgkmcnt(8)
v_mfma_f32_32x32x16_bf16 v[96:111], a[160:163], a[56:59], v[96:111]
ds_read_b64_tr_b16 a[180:181], v7 offset:15360
ds_read_b64_tr_b16 a[182:183], v7 offset:16640
s_waitcnt lgkmcnt(8)
v_mfma_f32_32x32x16_bf16 v[112:127], a[164:167], a[56:59], v[112:127]
ds_read_b64_tr_b16 a[184:185], v8 offset:15360
ds_read_b64_tr_b16 a[186:187], v8 offset:16640
s_waitcnt lgkmcnt(8)
v_mfma_f32_32x32x16_bf16 v[128:143], a[168:171], a[56:59], v[128:143]
ds_read_b64_tr_b16 a[188:189], v9 offset:15360
ds_read_b64_tr_b16 a[190:191], v9 offset:16640
s_waitcnt lgkmcnt(8)
v_mfma_f32_32x32x16_bf16 v[144:159], a[172:175], a[56:59], v[144:159]
ds_read_b64_tr_b16 a[192:193], v10 offset:15360
ds_read_b64_tr_b16 a[194:195], v10 offset:16640
s_waitcnt lgkmcnt(8)
v_mfma_f32_32x32x16_bf16 v[160:175], a[176:179], a[56:59], v[160:175]
ds_read_b64_tr_b16 a[196:197], v11 offset:15360
ds_read_b64_tr_b16 a[198:199], v11 offset:16640
s_waitcnt vmcnt(23)
s_waitcnt vmcnt(14)
s_barrier
ds_read_b128 a[64:67], v21 offset:4096
ds_read_b128 a[68:71], v22 offset:4096
ds_read_b128 a[72:75], v23 offset:4096
ds_read_b128 a[76:79], v24 offset:4096
s_waitcnt lgkmcnt(12)
v_mfma_f32_32x32x16_bf16 v[96:111], a[180:183], a[60:63], v[96:111]
ds_read_b64_tr_b16 a[160:161], v7 offset:20480
ds_read_b64_tr_b16 a[162:163], v7 offset:21760
s_waitcnt lgkmcnt(12)
v_mfma_f32_32x32x16_bf16 v[112:127], a[184:187], a[60:63], v[112:127]
ds_read_b64_tr_b16 a[164:165], v8 offset:20480
ds_read_b64_tr_b16 a[166:167], v8 offset:21760
s_waitcnt lgkmcnt(12)
v_mfma_f32_32x32x16_bf16 v[128:143], a[188:191], a[60:63], v[128:143]
ds_read_b64_tr_b16 a[168:169], v9 offset:20480
ds_read_b64_tr_b16 a[170:171], v9 offset:21760
s_waitcnt lgkmcnt(12)
v_mfma_f32_32x32x16_bf16 v[144:159], a[192:195], a[60:63], v[144:159]
ds_read_b64_tr_b16 a[172:173], v10 offset:20480
ds_read_b64_tr_b16 a[174:175], v10 offset:21760
s_waitcnt lgkmcnt(12)
v_mfma_f32_32x32x16_bf16 v[160:175], a[196:199], a[60:63], v[160:175]
ds_read_b64_tr_b16 a[176:177], v11 offset:20480
ds_read_b64_tr_b16 a[178:179], v11 offset:21760
buffer_store_byte v45, v234, s[52:55], 0 offen sc1
s_waitcnt lgkmcnt(8)
v_mfma_f32_32x32x16_bf16 v[96:111], a[160:163], a[64:67], v[96:111]
ds_read_b64_tr_b16 a[180:181], v7 offset:25600
ds_read_b64_tr_b16 a[182:183], v7 offset:26880
s_waitcnt lgkmcnt(8)
v_mfma_f32_32x32x16_bf16 v[112:127], a[164:167], a[64:67], v[112:127]
ds_read_b64_tr_b16 a[184:185], v8 offset:25600
ds_read_b64_tr_b16 a[186:187], v8 offset:26880
s_add_u32 m0, s26, 4096
s_mov_b32 s24, 896
buffer_load_dwordx4 v17, s[8:11], s24 offen offset:0 lds
s_waitcnt lgkmcnt(8)
v_mfma_f32_32x32x16_bf16 v[128:143], a[168:171], a[64:67], v[128:143]
ds_read_b64_tr_b16 a[188:189], v9 offset:25600
ds_read_b64_tr_b16 a[190:191], v9 offset:26880
buffer_load_dwordx4 v18, s[8:11], s24 offen offset:1024 lds
s_waitcnt lgkmcnt(8)
v_mfma_f32_32x32x16_bf16 v[144:159], a[172:175], a[64:67], v[144:159]
ds_read_b64_tr_b16 a[192:193], v10 offset:25600
ds_read_b64_tr_b16 a[194:195], v10 offset:26880
buffer_load_dwordx4 v19, s[8:11], s24 offen offset:2048 lds
s_waitcnt lgkmcnt(8)
v_mfma_f32_32x32x16_bf16 v[160:175], a[176:179], a[64:67], v[160:175]
ds_read_b64_tr_b16 a[196:197], v11 offset:25600
ds_read_b64_tr_b16 a[198:199], v11 offset:26880
buffer_load_dwordx4 v20, s[8:11], s24 offen offset:3072 lds
s_waitcnt lgkmcnt(8)
v_mfma_f32_32x32x16_bf16 v[96:111], a[180:183], a[68:71], v[96:111]
ds_read_b64_tr_b16 a[160:161], v7 offset:30720
ds_read_b64_tr_b16 a[162:163], v7 offset:32000
s_add_u32 m0, s25, 40960
s_add_u32 s32, s23, 1720320
buffer_load_dwordx4 v12, s[12:15], s32 offen offset:0 lds
s_waitcnt lgkmcnt(8)
v_mfma_f32_32x32x16_bf16 v[112:127], a[184:187], a[68:71], v[112:127]
ds_read_b64_tr_b16 a[164:165], v8 offset:30720
ds_read_b64_tr_b16 a[166:167], v8 offset:32000
buffer_load_dwordx4 v13, s[12:15], s32 offen offset:1024 lds
s_waitcnt lgkmcnt(8)
v_mfma_f32_32x32x16_bf16 v[128:143], a[188:191], a[68:71], v[128:143]
ds_read_b64_tr_b16 a[168:169], v9 offset:30720
ds_read_b64_tr_b16 a[170:171], v9 offset:32000
buffer_load_dwordx4 v14, s[12:15], s32 offen offset:2048 lds
s_waitcnt lgkmcnt(8)
v_mfma_f32_32x32x16_bf16 v[144:159], a[192:195], a[68:71], v[144:159]
ds_read_b64_tr_b16 a[172:173], v10 offset:30720
ds_read_b64_tr_b16 a[174:175], v10 offset:32000
buffer_load_dwordx4 v15, s[12:15], s32 offen offset:3072 lds
s_waitcnt lgkmcnt(8)
v_mfma_f32_32x32x16_bf16 v[160:175], a[196:199], a[68:71], v[160:175]
ds_read_b64_tr_b16 a[176:177], v11 offset:30720
ds_read_b64_tr_b16 a[178:179], v11 offset:32000
s_add_u32 m0, s25, 45056
s_add_u32 s32, s23, 1720320
buffer_load_dwordx4 v16, s[12:15], s32 offen lds
s_waitcnt lgkmcnt(8)
v_mfma_f32_32x32x16_bf16 v[96:111], a[160:163], a[72:75], v[96:111]
ds_read_b64_tr_b16 a[180:181], v7 offset:35840
ds_read_b64_tr_b16 a[182:183], v7 offset:37120
s_waitcnt lgkmcnt(8)
v_mfma_f32_32x32x16_bf16 v[112:127], a[164:167], a[72:75], v[112:127]
ds_read_b64_tr_b16 a[184:185], v8 offset:35840
ds_read_b64_tr_b16 a[186:187], v8 offset:37120
s_waitcnt lgkmcnt(8)
v_mfma_f32_32x32x16_bf16 v[128:143], a[168:171], a[72:75], v[128:143]
ds_read_b64_tr_b16 a[188:189], v9 offset:35840
ds_read_b64_tr_b16 a[190:191], v9 offset:37120
s_waitcnt lgkmcnt(8)
v_mfma_f32_32x32x16_bf16 v[144:159], a[172:175], a[72:75], v[144:159]
ds_read_b64_tr_b16 a[192:193], v10 offset:35840
ds_read_b64_tr_b16 a[194:195], v10 offset:37120
s_waitcnt lgkmcnt(8)
v_mfma_f32_32x32x16_bf16 v[160:175], a[176:179], a[72:75], v[160:175]
ds_read_b64_tr_b16 a[196:197], v11 offset:35840
ds_read_b64_tr_b16 a[198:199], v11 offset:37120
s_waitcnt vmcnt(19)
s_barrier
ds_read_b128 a[80:83], v21 offset:8192
ds_read_b128 a[84:87], v22 offset:8192
ds_read_b128 a[88:91], v23 offset:8192
ds_read_b128 a[92:95], v24 offset:8192
s_waitcnt lgkmcnt(12)
v_mfma_f32_32x32x16_bf16 v[96:111], a[180:183], a[76:79], v[96:111]
ds_read_b64_tr_b16 a[160:161], v2 offset:0
ds_read_b64_tr_b16 a[162:163], v2 offset:1280
s_waitcnt lgkmcnt(12)
v_mfma_f32_32x32x16_bf16 v[112:127], a[184:187], a[76:79], v[112:127]
ds_read_b64_tr_b16 a[164:165], v3 offset:0
ds_read_b64_tr_b16 a[166:167], v3 offset:1280
s_waitcnt lgkmcnt(12)
v_mfma_f32_32x32x16_bf16 v[128:143], a[188:191], a[76:79], v[128:143]
ds_read_b64_tr_b16 a[168:169], v4 offset:0
ds_read_b64_tr_b16 a[170:171], v4 offset:1280
s_waitcnt lgkmcnt(12)
v_mfma_f32_32x32x16_bf16 v[144:159], a[192:195], a[76:79], v[144:159]
ds_read_b64_tr_b16 a[172:173], v5 offset:0
ds_read_b64_tr_b16 a[174:175], v5 offset:1280
s_waitcnt lgkmcnt(12)
v_mfma_f32_32x32x16_bf16 v[160:175], a[196:199], a[76:79], v[160:175]
ds_read_b64_tr_b16 a[176:177], v6 offset:0
ds_read_b64_tr_b16 a[178:179], v6 offset:1280
s_waitcnt lgkmcnt(8)
v_mfma_f32_32x32x16_bf16 v[96:111], a[160:163], a[80:83], v[96:111]
ds_read_b64_tr_b16 a[180:181], v2 offset:5120
ds_read_b64_tr_b16 a[182:183], v2 offset:6400
s_waitcnt lgkmcnt(8)
v_mfma_f32_32x32x16_bf16 v[112:127], a[164:167], a[80:83], v[112:127]
ds_read_b64_tr_b16 a[184:185], v3 offset:5120
ds_read_b64_tr_b16 a[186:187], v3 offset:6400
s_add_u32 m0, s26, 8192
s_mov_b32 s24, 1024
buffer_load_dwordx4 v17, s[8:11], s24 offen offset:0 lds
s_waitcnt lgkmcnt(8)
v_mfma_f32_32x32x16_bf16 v[128:143], a[168:171], a[80:83], v[128:143]
ds_read_b64_tr_b16 a[188:189], v4 offset:5120
ds_read_b64_tr_b16 a[190:191], v4 offset:6400
buffer_load_dwordx4 v18, s[8:11], s24 offen offset:1024 lds
s_waitcnt lgkmcnt(8)
v_mfma_f32_32x32x16_bf16 v[144:159], a[172:175], a[80:83], v[144:159]
ds_read_b64_tr_b16 a[192:193], v5 offset:5120
ds_read_b64_tr_b16 a[194:195], v5 offset:6400
buffer_load_dwordx4 v19, s[8:11], s24 offen offset:2048 lds
s_waitcnt lgkmcnt(8)
v_mfma_f32_32x32x16_bf16 v[160:175], a[176:179], a[80:83], v[160:175]
ds_read_b64_tr_b16 a[196:197], v6 offset:5120
ds_read_b64_tr_b16 a[198:199], v6 offset:6400
buffer_load_dwordx4 v20, s[8:11], s24 offen offset:3072 lds
s_waitcnt lgkmcnt(8)
v_mfma_f32_32x32x16_bf16 v[96:111], a[180:183], a[84:87], v[96:111]
ds_read_b64_tr_b16 a[160:161], v2 offset:10240
ds_read_b64_tr_b16 a[162:163], v2 offset:11520
s_add_u32 m0, s25, 61440
s_add_u32 s32, s23, 1966080
buffer_load_dwordx4 v12, s[12:15], s32 offen offset:0 lds
s_waitcnt lgkmcnt(8)
v_mfma_f32_32x32x16_bf16 v[112:127], a[184:187], a[84:87], v[112:127]
ds_read_b64_tr_b16 a[164:165], v3 offset:10240
ds_read_b64_tr_b16 a[166:167], v3 offset:11520
buffer_load_dwordx4 v13, s[12:15], s32 offen offset:1024 lds
s_waitcnt lgkmcnt(8)
v_mfma_f32_32x32x16_bf16 v[128:143], a[188:191], a[84:87], v[128:143]
ds_read_b64_tr_b16 a[168:169], v4 offset:10240
ds_read_b64_tr_b16 a[170:171], v4 offset:11520
buffer_load_dwordx4 v14, s[12:15], s32 offen offset:2048 lds
s_waitcnt lgkmcnt(8)
v_mfma_f32_32x32x16_bf16 v[144:159], a[192:195], a[84:87], v[144:159]
ds_read_b64_tr_b16 a[172:173], v5 offset:10240
ds_read_b64_tr_b16 a[174:175], v5 offset:11520
buffer_load_dwordx4 v15, s[12:15], s32 offen offset:3072 lds
s_waitcnt lgkmcnt(8)
v_mfma_f32_32x32x16_bf16 v[160:175], a[196:199], a[84:87], v[160:175]
ds_read_b64_tr_b16 a[176:177], v6 offset:10240
ds_read_b64_tr_b16 a[178:179], v6 offset:11520
s_add_u32 m0, s25, 65536
s_add_u32 s32, s23, 1966080
buffer_load_dwordx4 v16, s[12:15], s32 offen lds
s_waitcnt lgkmcnt(8)
v_mfma_f32_32x32x16_bf16 v[96:111], a[160:163], a[88:91], v[96:111]
ds_read_b64_tr_b16 a[180:181], v2 offset:15360
ds_read_b64_tr_b16 a[182:183], v2 offset:16640
s_waitcnt lgkmcnt(8)
v_mfma_f32_32x32x16_bf16 v[112:127], a[164:167], a[88:91], v[112:127]
ds_read_b64_tr_b16 a[184:185], v3 offset:15360
ds_read_b64_tr_b16 a[186:187], v3 offset:16640
s_waitcnt lgkmcnt(8)
v_mfma_f32_32x32x16_bf16 v[128:143], a[168:171], a[88:91], v[128:143]
ds_read_b64_tr_b16 a[188:189], v4 offset:15360
ds_read_b64_tr_b16 a[190:191], v4 offset:16640
s_waitcnt lgkmcnt(8)
v_mfma_f32_32x32x16_bf16 v[144:159], a[172:175], a[88:91], v[144:159]
ds_read_b64_tr_b16 a[192:193], v5 offset:15360
ds_read_b64_tr_b16 a[194:195], v5 offset:16640
s_waitcnt lgkmcnt(8)
v_mfma_f32_32x32x16_bf16 v[160:175], a[176:179], a[88:91], v[160:175]
ds_read_b64_tr_b16 a[196:197], v6 offset:15360
ds_read_b64_tr_b16 a[198:199], v6 offset:16640
s_waitcnt vmcnt(19)
s_barrier
ds_read_b128 a[96:99], v21 offset:0
ds_read_b128 a[100:103], v22 offset:0
ds_read_b128 a[104:107], v23 offset:0
ds_read_b128 a[108:111], v24 offset:0
s_waitcnt lgkmcnt(12)
v_mfma_f32_32x32x16_bf16 v[96:111], a[180:183], a[92:95], v[96:111]
ds_read_b64_tr_b16 a[160:161], v2 offset:20480
ds_read_b64_tr_b16 a[162:163], v2 offset:21760
s_waitcnt lgkmcnt(12)
v_mfma_f32_32x32x16_bf16 v[112:127], a[184:187], a[92:95], v[112:127]
ds_read_b64_tr_b16 a[164:165], v3 offset:20480
ds_read_b64_tr_b16 a[166:167], v3 offset:21760
s_waitcnt lgkmcnt(12)
v_mfma_f32_32x32x16_bf16 v[128:143], a[188:191], a[92:95], v[128:143]
ds_read_b64_tr_b16 a[168:169], v4 offset:20480
ds_read_b64_tr_b16 a[170:171], v4 offset:21760
s_waitcnt lgkmcnt(12)
v_mfma_f32_32x32x16_bf16 v[144:159], a[192:195], a[92:95], v[144:159]
ds_read_b64_tr_b16 a[172:173], v5 offset:20480
ds_read_b64_tr_b16 a[174:175], v5 offset:21760
s_waitcnt lgkmcnt(12)
v_mfma_f32_32x32x16_bf16 v[160:175], a[196:199], a[92:95], v[160:175]
ds_read_b64_tr_b16 a[176:177], v6 offset:20480
ds_read_b64_tr_b16 a[178:179], v6 offset:21760
s_waitcnt lgkmcnt(8)
v_mfma_f32_32x32x16_bf16 v[96:111], a[160:163], a[96:99], v[96:111]
ds_read_b64_tr_b16 a[180:181], v2 offset:25600
ds_read_b64_tr_b16 a[182:183], v2 offset:26880
s_waitcnt lgkmcnt(8)
v_mfma_f32_32x32x16_bf16 v[112:127], a[164:167], a[96:99], v[112:127]
ds_read_b64_tr_b16 a[184:185], v3 offset:25600
ds_read_b64_tr_b16 a[186:187], v3 offset:26880
s_add_u32 m0, s26, 0
s_mov_b32 s24, 1152
buffer_load_dwordx4 v17, s[8:11], s24 offen offset:0 lds
s_waitcnt lgkmcnt(8)
v_mfma_f32_32x32x16_bf16 v[128:143], a[168:171], a[96:99], v[128:143]
ds_read_b64_tr_b16 a[188:189], v4 offset:25600
ds_read_b64_tr_b16 a[190:191], v4 offset:26880
buffer_load_dwordx4 v18, s[8:11], s24 offen offset:1024 lds
s_waitcnt lgkmcnt(8)
v_mfma_f32_32x32x16_bf16 v[144:159], a[172:175], a[96:99], v[144:159]
ds_read_b64_tr_b16 a[192:193], v5 offset:25600
ds_read_b64_tr_b16 a[194:195], v5 offset:26880
buffer_load_dwordx4 v19, s[8:11], s24 offen offset:2048 lds
s_waitcnt lgkmcnt(8)
v_mfma_f32_32x32x16_bf16 v[160:175], a[176:179], a[96:99], v[160:175]
ds_read_b64_tr_b16 a[196:197], v6 offset:25600
ds_read_b64_tr_b16 a[198:199], v6 offset:26880
buffer_load_dwordx4 v20, s[8:11], s24 offen offset:3072 lds
s_waitcnt lgkmcnt(8)
v_mfma_f32_32x32x16_bf16 v[96:111], a[180:183], a[100:103], v[96:111]
ds_read_b64_tr_b16 a[160:161], v2 offset:30720
ds_read_b64_tr_b16 a[162:163], v2 offset:32000
s_add_u32 m0, s25, 81920
s_add_u32 s32, s23, 2211840
buffer_load_dwordx4 v12, s[12:15], s32 offen offset:0 lds
s_waitcnt lgkmcnt(8)
v_mfma_f32_32x32x16_bf16 v[112:127], a[184:187], a[100:103], v[112:127]
ds_read_b64_tr_b16 a[164:165], v3 offset:30720
ds_read_b64_tr_b16 a[166:167], v3 offset:32000
buffer_load_dwordx4 v13, s[12:15], s32 offen offset:1024 lds
s_waitcnt lgkmcnt(8)
v_mfma_f32_32x32x16_bf16 v[128:143], a[188:191], a[100:103], v[128:143]
ds_read_b64_tr_b16 a[168:169], v4 offset:30720
ds_read_b64_tr_b16 a[170:171], v4 offset:32000
buffer_load_dwordx4 v14, s[12:15], s32 offen offset:2048 lds
s_waitcnt lgkmcnt(8)
v_mfma_f32_32x32x16_bf16 v[144:159], a[192:195], a[100:103], v[144:159]
ds_read_b64_tr_b16 a[172:173], v5 offset:30720
ds_read_b64_tr_b16 a[174:175], v5 offset:32000
buffer_load_dwordx4 v15, s[12:15], s32 offen offset:3072 lds
s_waitcnt lgkmcnt(8)
v_mfma_f32_32x32x16_bf16 v[160:175], a[196:199], a[100:103], v[160:175]
ds_read_b64_tr_b16 a[176:177], v6 offset:30720
ds_read_b64_tr_b16 a[178:179], v6 offset:32000
s_add_u32 m0, s25, 86016
s_add_u32 s32, s23, 2211840
buffer_load_dwordx4 v16, s[12:15], s32 offen lds
s_waitcnt lgkmcnt(8)
v_mfma_f32_32x32x16_bf16 v[96:111], a[160:163], a[104:107], v[96:111]
ds_read_b64_tr_b16 a[180:181], v2 offset:35840
ds_read_b64_tr_b16 a[182:183], v2 offset:37120
s_waitcnt lgkmcnt(8)
v_mfma_f32_32x32x16_bf16 v[112:127], a[164:167], a[104:107], v[112:127]
ds_read_b64_tr_b16 a[184:185], v3 offset:35840
ds_read_b64_tr_b16 a[186:187], v3 offset:37120
s_waitcnt lgkmcnt(8)
v_mfma_f32_32x32x16_bf16 v[128:143], a[168:171], a[104:107], v[128:143]
ds_read_b64_tr_b16 a[188:189], v4 offset:35840
ds_read_b64_tr_b16 a[190:191], v4 offset:37120
s_waitcnt lgkmcnt(8)
v_mfma_f32_32x32x16_bf16 v[144:159], a[172:175], a[104:107], v[144:159]
ds_read_b64_tr_b16 a[192:193], v5 offset:35840
ds_read_b64_tr_b16 a[194:195], v5 offset:37120
s_waitcnt lgkmcnt(8)
v_mfma_f32_32x32x16_bf16 v[160:175], a[176:179], a[104:107], v[160:175]
ds_read_b64_tr_b16 a[196:197], v6 offset:35840
ds_read_b64_tr_b16 a[198:199], v6 offset:37120
s_waitcnt vmcnt(18)
s_barrier
ds_read_b128 a[112:115], v21 offset:4096
ds_read_b128 a[116:119], v22 offset:4096
ds_read_b128 a[120:123], v23 offset:4096
ds_read_b128 a[124:127], v24 offset:4096
s_waitcnt lgkmcnt(12)
v_mfma_f32_32x32x16_bf16 v[96:111], a[180:183], a[108:111], v[96:111]
ds_read_b64_tr_b16 a[160:161], v2 offset:40960
ds_read_b64_tr_b16 a[162:163], v2 offset:42240
s_waitcnt lgkmcnt(12)
v_mfma_f32_32x32x16_bf16 v[112:127], a[184:187], a[108:111], v[112:127]
ds_read_b64_tr_b16 a[164:165], v3 offset:40960
ds_read_b64_tr_b16 a[166:167], v3 offset:42240
s_waitcnt lgkmcnt(12)
v_mfma_f32_32x32x16_bf16 v[128:143], a[188:191], a[108:111], v[128:143]
ds_read_b64_tr_b16 a[168:169], v4 offset:40960
ds_read_b64_tr_b16 a[170:171], v4 offset:42240
s_waitcnt lgkmcnt(12)
v_mfma_f32_32x32x16_bf16 v[144:159], a[192:195], a[108:111], v[144:159]
ds_read_b64_tr_b16 a[172:173], v5 offset:40960
ds_read_b64_tr_b16 a[174:175], v5 offset:42240
s_waitcnt lgkmcnt(12)
v_mfma_f32_32x32x16_bf16 v[160:175], a[196:199], a[108:111], v[160:175]
ds_read_b64_tr_b16 a[176:177], v6 offset:40960
ds_read_b64_tr_b16 a[178:179], v6 offset:42240
s_waitcnt lgkmcnt(8)
v_mfma_f32_32x32x16_bf16 v[96:111], a[160:163], a[112:115], v[96:111]
ds_read_b64_tr_b16 a[180:181], v2 offset:46080
ds_read_b64_tr_b16 a[182:183], v2 offset:47360
s_waitcnt lgkmcnt(8)
v_mfma_f32_32x32x16_bf16 v[112:127], a[164:167], a[112:115], v[112:127]
ds_read_b64_tr_b16 a[184:185], v3 offset:46080
ds_read_b64_tr_b16 a[186:187], v3 offset:47360
s_add_u32 m0, s25, 0
s_add_u32 s32, s23, 320
buffer_load_dwordx4 v12, s[12:15], s32 offen offset:0 lds
s_waitcnt lgkmcnt(8)
v_mfma_f32_32x32x16_bf16 v[128:143], a[168:171], a[112:115], v[128:143]
ds_read_b64_tr_b16 a[188:189], v4 offset:46080
ds_read_b64_tr_b16 a[190:191], v4 offset:47360
buffer_load_dwordx4 v13, s[12:15], s32 offen offset:1024 lds
s_waitcnt lgkmcnt(8)
v_mfma_f32_32x32x16_bf16 v[144:159], a[172:175], a[112:115], v[144:159]
ds_read_b64_tr_b16 a[192:193], v5 offset:46080
ds_read_b64_tr_b16 a[194:195], v5 offset:47360
buffer_load_dwordx4 v14, s[12:15], s32 offen offset:2048 lds
s_waitcnt lgkmcnt(8)
v_mfma_f32_32x32x16_bf16 v[160:175], a[176:179], a[112:115], v[160:175]
ds_read_b64_tr_b16 a[196:197], v6 offset:46080
ds_read_b64_tr_b16 a[198:199], v6 offset:47360
buffer_load_dwordx4 v15, s[12:15], s32 offen offset:3072 lds
s_waitcnt lgkmcnt(8)
v_mfma_f32_32x32x16_bf16 v[96:111], a[180:183], a[116:119], v[96:111]
ds_read_b64_tr_b16 a[160:161], v2 offset:51200
ds_read_b64_tr_b16 a[162:163], v2 offset:52480
s_add_u32 m0, s25, 4096
s_add_u32 s32, s23, 320
buffer_load_dwordx4 v16, s[12:15], s32 offen lds
s_waitcnt lgkmcnt(8)
v_mfma_f32_32x32x16_bf16 v[112:127], a[184:187], a[116:119], v[112:127]
ds_read_b64_tr_b16 a[164:165], v3 offset:51200
ds_read_b64_tr_b16 a[166:167], v3 offset:52480
s_waitcnt lgkmcnt(8)
v_mfma_f32_32x32x16_bf16 v[128:143], a[188:191], a[116:119], v[128:143]
ds_read_b64_tr_b16 a[168:169], v4 offset:51200
ds_read_b64_tr_b16 a[170:171], v4 offset:52480
s_waitcnt lgkmcnt(8)
v_mfma_f32_32x32x16_bf16 v[144:159], a[192:195], a[116:119], v[144:159]
ds_read_b64_tr_b16 a[172:173], v5 offset:51200
ds_read_b64_tr_b16 a[174:175], v5 offset:52480
s_waitcnt lgkmcnt(8)
v_mfma_f32_32x32x16_bf16 v[160:175], a[196:199], a[116:119], v[160:175]
ds_read_b64_tr_b16 a[176:177], v6 offset:51200
ds_read_b64_tr_b16 a[178:179], v6 offset:52480
s_waitcnt lgkmcnt(8)
v_mfma_f32_32x32x16_bf16 v[96:111], a[160:163], a[120:123], v[96:111]
ds_read_b64_tr_b16 a[180:181], v2 offset:56320
ds_read_b64_tr_b16 a[182:183], v2 offset:57600
s_waitcnt lgkmcnt(8)
v_mfma_f32_32x32x16_bf16 v[112:127], a[164:167], a[120:123], v[112:127]
ds_read_b64_tr_b16 a[184:185], v3 offset:56320
ds_read_b64_tr_b16 a[186:187], v3 offset:57600
s_waitcnt lgkmcnt(8)
v_mfma_f32_32x32x16_bf16 v[128:143], a[168:171], a[120:123], v[128:143]
ds_read_b64_tr_b16 a[188:189], v4 offset:56320
ds_read_b64_tr_b16 a[190:191], v4 offset:57600
s_waitcnt lgkmcnt(8)
v_mfma_f32_32x32x16_bf16 v[144:159], a[172:175], a[120:123], v[144:159]
ds_read_b64_tr_b16 a[192:193], v5 offset:56320
ds_read_b64_tr_b16 a[194:195], v5 offset:57600
s_waitcnt lgkmcnt(8)
v_mfma_f32_32x32x16_bf16 v[160:175], a[176:179], a[120:123], v[160:175]
ds_read_b64_tr_b16 a[196:197], v6 offset:56320
ds_read_b64_tr_b16 a[198:199], v6 offset:57600
s_waitcnt vmcnt(14)
s_barrier
ds_read_b128 a[128:131], v21 offset:8192
ds_read_b128 a[132:135], v22 offset:8192
ds_read_b128 a[136:139], v23 offset:8192
ds_read_b128 a[140:143], v24 offset:8192
s_waitcnt lgkmcnt(12)
v_mfma_f32_32x32x16_bf16 v[96:111], a[180:183], a[124:127], v[96:111]
ds_read_b64_tr_b16 a[160:161], v7 offset:0
ds_read_b64_tr_b16 a[162:163], v7 offset:1280
s_waitcnt lgkmcnt(12)
v_mfma_f32_32x32x16_bf16 v[112:127], a[184:187], a[124:127], v[112:127]
ds_read_b64_tr_b16 a[164:165], v8 offset:0
ds_read_b64_tr_b16 a[166:167], v8 offset:1280
s_waitcnt lgkmcnt(12)
v_mfma_f32_32x32x16_bf16 v[128:143], a[188:191], a[124:127], v[128:143]
ds_read_b64_tr_b16 a[168:169], v9 offset:0
ds_read_b64_tr_b16 a[170:171], v9 offset:1280
s_waitcnt lgkmcnt(12)
v_mfma_f32_32x32x16_bf16 v[144:159], a[192:195], a[124:127], v[144:159]
ds_read_b64_tr_b16 a[172:173], v10 offset:0
ds_read_b64_tr_b16 a[174:175], v10 offset:1280
s_waitcnt lgkmcnt(12)
v_mfma_f32_32x32x16_bf16 v[160:175], a[196:199], a[124:127], v[160:175]
ds_read_b64_tr_b16 a[176:177], v11 offset:0
ds_read_b64_tr_b16 a[178:179], v11 offset:1280
s_waitcnt lgkmcnt(8)
v_mfma_f32_32x32x16_bf16 v[96:111], a[160:163], a[128:131], v[96:111]
ds_read_b64_tr_b16 a[180:181], v7 offset:5120
ds_read_b64_tr_b16 a[182:183], v7 offset:6400
s_waitcnt lgkmcnt(8)
v_mfma_f32_32x32x16_bf16 v[112:127], a[164:167], a[128:131], v[112:127]
ds_read_b64_tr_b16 a[184:185], v8 offset:5120
ds_read_b64_tr_b16 a[186:187], v8 offset:6400
s_add_u32 m0, s25, 20480
s_add_u32 s32, s23, 246080
buffer_load_dwordx4 v12, s[12:15], s32 offen offset:0 lds
s_waitcnt lgkmcnt(8)
v_mfma_f32_32x32x16_bf16 v[128:143], a[168:171], a[128:131], v[128:143]
ds_read_b64_tr_b16 a[188:189], v9 offset:5120
ds_read_b64_tr_b16 a[190:191], v9 offset:6400
buffer_load_dwordx4 v13, s[12:15], s32 offen offset:1024 lds
s_waitcnt lgkmcnt(8)
v_mfma_f32_32x32x16_bf16 v[144:159], a[172:175], a[128:131], v[144:159]
ds_read_b64_tr_b16 a[192:193], v10 offset:5120
ds_read_b64_tr_b16 a[194:195], v10 offset:6400
buffer_load_dwordx4 v14, s[12:15], s32 offen offset:2048 lds
s_waitcnt lgkmcnt(8)
v_mfma_f32_32x32x16_bf16 v[160:175], a[176:179], a[128:131], v[160:175]
ds_read_b64_tr_b16 a[196:197], v11 offset:5120
ds_read_b64_tr_b16 a[198:199], v11 offset:6400
buffer_load_dwordx4 v15, s[12:15], s32 offen offset:3072 lds
s_waitcnt lgkmcnt(8)
v_mfma_f32_32x32x16_bf16 v[96:111], a[180:183], a[132:135], v[96:111]
ds_read_b64_tr_b16 a[160:161], v7 offset:10240
ds_read_b64_tr_b16 a[162:163], v7 offset:11520
s_add_u32 m0, s25, 24576
s_add_u32 s32, s23, 246080
buffer_load_dwordx4 v16, s[12:15], s32 offen lds
s_waitcnt lgkmcnt(8)
v_mfma_f32_32x32x16_bf16 v[112:127], a[184:187], a[132:135], v[112:127]
ds_read_b64_tr_b16 a[164:165], v8 offset:10240
ds_read_b64_tr_b16 a[166:167], v8 offset:11520
s_waitcnt lgkmcnt(8)
v_mfma_f32_32x32x16_bf16 v[128:143], a[188:191], a[132:135], v[128:143]
ds_read_b64_tr_b16 a[168:169], v9 offset:10240
ds_read_b64_tr_b16 a[170:171], v9 offset:11520
s_waitcnt lgkmcnt(8)
v_mfma_f32_32x32x16_bf16 v[144:159], a[192:195], a[132:135], v[144:159]
ds_read_b64_tr_b16 a[172:173], v10 offset:10240
ds_read_b64_tr_b16 a[174:175], v10 offset:11520
s_waitcnt lgkmcnt(8)
v_mfma_f32_32x32x16_bf16 v[160:175], a[196:199], a[132:135], v[160:175]
ds_read_b64_tr_b16 a[176:177], v11 offset:10240
ds_read_b64_tr_b16 a[178:179], v11 offset:11520
s_waitcnt lgkmcnt(8)
v_mfma_f32_32x32x16_bf16 v[96:111], a[160:163], a[136:139], v[96:111]
ds_read_b64_tr_b16 a[180:181], v7 offset:15360
ds_read_b64_tr_b16 a[182:183], v7 offset:16640
s_waitcnt lgkmcnt(8)
v_mfma_f32_32x32x16_bf16 v[112:127], a[164:167], a[136:139], v[112:127]
ds_read_b64_tr_b16 a[184:185], v8 offset:15360
ds_read_b64_tr_b16 a[186:187], v8 offset:16640
s_waitcnt lgkmcnt(8)
v_mfma_f32_32x32x16_bf16 v[128:143], a[168:171], a[136:139], v[128:143]
ds_read_b64_tr_b16 a[188:189], v9 offset:15360
ds_read_b64_tr_b16 a[190:191], v9 offset:16640
s_waitcnt lgkmcnt(8)
v_mfma_f32_32x32x16_bf16 v[144:159], a[172:175], a[136:139], v[144:159]
ds_read_b64_tr_b16 a[192:193], v10 offset:15360
ds_read_b64_tr_b16 a[194:195], v10 offset:16640
s_waitcnt lgkmcnt(8)
v_mfma_f32_32x32x16_bf16 v[160:175], a[176:179], a[136:139], v[160:175]
ds_read_b64_tr_b16 a[196:197], v11 offset:15360
ds_read_b64_tr_b16 a[198:199], v11 offset:16640
s_waitcnt vmcnt(10)
s_barrier
ds_read_b128 a[144:147], v21 offset:0
ds_read_b128 a[148:151], v22 offset:0
ds_read_b128 a[152:155], v23 offset:0
ds_read_b128 a[156:159], v24 offset:0
s_waitcnt lgkmcnt(12)
v_mfma_f32_32x32x16_bf16 v[96:111], a[180:183], a[140:143], v[96:111]
ds_read_b64_tr_b16 a[160:161], v7 offset:20480
ds_read_b64_tr_b16 a[162:163], v7 offset:21760
s_waitcnt lgkmcnt(12)
v_mfma_f32_32x32x16_bf16 v[112:127], a[184:187], a[140:143], v[112:127]
ds_read_b64_tr_b16 a[164:165], v8 offset:20480
ds_read_b64_tr_b16 a[166:167], v8 offset:21760
s_waitcnt lgkmcnt(12)
v_mfma_f32_32x32x16_bf16 v[128:143], a[188:191], a[140:143], v[128:143]
ds_read_b64_tr_b16 a[168:169], v9 offset:20480
ds_read_b64_tr_b16 a[170:171], v9 offset:21760
s_waitcnt lgkmcnt(12)
v_mfma_f32_32x32x16_bf16 v[144:159], a[192:195], a[140:143], v[144:159]
ds_read_b64_tr_b16 a[172:173], v10 offset:20480
ds_read_b64_tr_b16 a[174:175], v10 offset:21760
s_waitcnt lgkmcnt(12)
v_mfma_f32_32x32x16_bf16 v[160:175], a[196:199], a[140:143], v[160:175]
ds_read_b64_tr_b16 a[176:177], v11 offset:20480
ds_read_b64_tr_b16 a[178:179], v11 offset:21760
buffer_load_dword v46, v47, s[52:55], 0 offen
s_waitcnt lgkmcnt(8)
v_mfma_f32_32x32x16_bf16 v[96:111], a[160:163], a[144:147], v[96:111]
ds_read_b64_tr_b16 a[180:181], v7 offset:25600
ds_read_b64_tr_b16 a[182:183], v7 offset:26880
s_waitcnt lgkmcnt(8)
v_mfma_f32_32x32x16_bf16 v[112:127], a[164:167], a[144:147], v[112:127]
ds_read_b64_tr_b16 a[184:185], v8 offset:25600
ds_read_b64_tr_b16 a[186:187], v8 offset:26880
s_add_u32 m0, s25, 40960
s_add_u32 s32, s23, 491840
buffer_load_dwordx4 v12, s[12:15], s32 offen offset:0 lds
s_waitcnt lgkmcnt(8)
v_mfma_f32_32x32x16_bf16 v[128:143], a[168:171], a[144:147], v[128:143]
ds_read_b64_tr_b16 a[188:189], v9 offset:25600
ds_read_b64_tr_b16 a[190:191], v9 offset:26880
buffer_load_dwordx4 v13, s[12:15], s32 offen offset:1024 lds
s_waitcnt lgkmcnt(8)
v_mfma_f32_32x32x16_bf16 v[144:159], a[172:175], a[144:147], v[144:159]
ds_read_b64_tr_b16 a[192:193], v10 offset:25600
ds_read_b64_tr_b16 a[194:195], v10 offset:26880
buffer_load_dwordx4 v14, s[12:15], s32 offen offset:2048 lds
s_waitcnt lgkmcnt(8)
v_mfma_f32_32x32x16_bf16 v[160:175], a[176:179], a[144:147], v[160:175]
ds_read_b64_tr_b16 a[196:197], v11 offset:25600
ds_read_b64_tr_b16 a[198:199], v11 offset:26880
buffer_load_dwordx4 v15, s[12:15], s32 offen offset:3072 lds
s_waitcnt lgkmcnt(8)
v_mfma_f32_32x32x16_bf16 v[96:111], a[180:183], a[148:151], v[96:111]
ds_read_b64_tr_b16 a[160:161], v7 offset:30720
ds_read_b64_tr_b16 a[162:163], v7 offset:32000
s_add_u32 m0, s25, 45056
s_add_u32 s32, s23, 491840
buffer_load_dwordx4 v16, s[12:15], s32 offen lds
s_waitcnt lgkmcnt(8)
v_mfma_f32_32x32x16_bf16 v[112:127], a[184:187], a[148:151], v[112:127]
ds_read_b64_tr_b16 a[164:165], v8 offset:30720
ds_read_b64_tr_b16 a[166:167], v8 offset:32000
s_waitcnt lgkmcnt(8)
v_mfma_f32_32x32x16_bf16 v[128:143], a[188:191], a[148:151], v[128:143]
ds_read_b64_tr_b16 a[168:169], v9 offset:30720
ds_read_b64_tr_b16 a[170:171], v9 offset:32000
s_waitcnt lgkmcnt(8)
v_mfma_f32_32x32x16_bf16 v[144:159], a[192:195], a[148:151], v[144:159]
ds_read_b64_tr_b16 a[172:173], v10 offset:30720
ds_read_b64_tr_b16 a[174:175], v10 offset:32000
s_waitcnt lgkmcnt(8)
v_mfma_f32_32x32x16_bf16 v[160:175], a[196:199], a[148:151], v[160:175]
ds_read_b64_tr_b16 a[176:177], v11 offset:30720
ds_read_b64_tr_b16 a[178:179], v11 offset:32000
s_waitcnt lgkmcnt(8)
v_mfma_f32_32x32x16_bf16 v[96:111], a[160:163], a[152:155], v[96:111]
ds_read_b64_tr_b16 a[180:181], v7 offset:35840
ds_read_b64_tr_b16 a[182:183], v7 offset:37120
s_waitcnt lgkmcnt(8)
v_mfma_f32_32x32x16_bf16 v[112:127], a[164:167], a[152:155], v[112:127]
ds_read_b64_tr_b16 a[184:185], v8 offset:35840
ds_read_b64_tr_b16 a[186:187], v8 offset:37120
s_waitcnt lgkmcnt(8)
v_mfma_f32_32x32x16_bf16 v[128:143], a[168:171], a[152:155], v[128:143]
ds_read_b64_tr_b16 a[188:189], v9 offset:35840
ds_read_b64_tr_b16 a[190:191], v9 offset:37120
s_waitcnt lgkmcnt(8)
v_mfma_f32_32x32x16_bf16 v[144:159], a[172:175], a[152:155], v[144:159]
ds_read_b64_tr_b16 a[192:193], v10 offset:35840
ds_read_b64_tr_b16 a[194:195], v10 offset:37120
s_waitcnt lgkmcnt(8)
v_mfma_f32_32x32x16_bf16 v[160:175], a[176:179], a[152:155], v[160:175]
ds_read_b64_tr_b16 a[196:197], v11 offset:35840
ds_read_b64_tr_b16 a[198:199], v11 offset:37120
s_waitcnt vmcnt(11)
s_barrier
s_waitcnt lgkmcnt(8)
v_mfma_f32_32x32x16_bf16 v[96:111], a[180:183], a[156:159], v[96:111]
ds_read_b64_tr_b16 a[160:161], v2 offset:0
ds_read_b64_tr_b16 a[162:163], v2 offset:1280
s_waitcnt lgkmcnt(8)
v_mfma_f32_32x32x16_bf16 v[112:127], a[184:187], a[156:159], v[112:127]
ds_read_b64_tr_b16 a[164:165], v3 offset:0
ds_read_b64_tr_b16 a[166:167], v3 offset:1280
s_waitcnt lgkmcnt(8)
v_mfma_f32_32x32x16_bf16 v[128:143], a[188:191], a[156:159], v[128:143]
ds_read_b64_tr_b16 a[168:169], v4 offset:0
ds_read_b64_tr_b16 a[170:171], v4 offset:1280
s_waitcnt lgkmcnt(8)
v_mfma_f32_32x32x16_bf16 v[144:159], a[192:195], a[156:159], v[144:159]
ds_read_b64_tr_b16 a[172:173], v5 offset:0
ds_read_b64_tr_b16 a[174:175], v5 offset:1280
s_waitcnt lgkmcnt(8)
v_mfma_f32_32x32x16_bf16 v[160:175], a[196:199], a[156:159], v[160:175]
ds_read_b64_tr_b16 a[176:177], v6 offset:0
ds_read_b64_tr_b16 a[178:179], v6 offset:1280
s_waitcnt lgkmcnt(8)
v_mfma_f32_32x32x16_bf16 v[176:191], a[160:163], a[0:3], 0
ds_read_b64_tr_b16 a[180:181], v2 offset:5120
ds_read_b64_tr_b16 a[182:183], v2 offset:6400
s_waitcnt lgkmcnt(8)
v_mfma_f32_32x32x16_bf16 v[192:207], a[164:167], a[0:3], 0
ds_read_b64_tr_b16 a[184:185], v3 offset:5120
ds_read_b64_tr_b16 a[186:187], v3 offset:6400
s_add_u32 m0, s25, 61440
s_add_u32 s32, s23, 737600
buffer_load_dwordx4 v12, s[12:15], s32 offen offset:0 lds
s_waitcnt lgkmcnt(8)
v_mfma_f32_32x32x16_bf16 v[208:223], a[168:171], a[0:3], 0
ds_read_b64_tr_b16 a[188:189], v4 offset:5120
ds_read_b64_tr_b16 a[190:191], v4 offset:6400
buffer_load_dwordx4 v13, s[12:15], s32 offen offset:1024 lds
s_waitcnt lgkmcnt(8)
v_mfma_f32_32x32x16_bf16 v[224:239], a[172:175], a[0:3], 0
ds_read_b64_tr_b16 a[192:193], v5 offset:5120
ds_read_b64_tr_b16 a[194:195], v5 offset:6400
buffer_load_dwordx4 v14, s[12:15], s32 offen offset:2048 lds
s_waitcnt lgkmcnt(8)
v_mfma_f32_32x32x16_bf16 v[240:255], a[176:179], a[0:3], 0
ds_read_b64_tr_b16 a[196:197], v6 offset:5120
ds_read_b64_tr_b16 a[198:199], v6 offset:6400
buffer_load_dwordx4 v15, s[12:15], s32 offen offset:3072 lds
s_waitcnt lgkmcnt(8)
v_mfma_f32_32x32x16_bf16 v[176:191], a[180:183], a[4:7], v[176:191]
ds_read_b64_tr_b16 a[160:161], v2 offset:10240
ds_read_b64_tr_b16 a[162:163], v2 offset:11520
s_add_u32 m0, s25, 65536
s_add_u32 s32, s23, 737600
buffer_load_dwordx4 v16, s[12:15], s32 offen lds
s_waitcnt lgkmcnt(8)
v_mfma_f32_32x32x16_bf16 v[192:207], a[184:187], a[4:7], v[192:207]
ds_read_b64_tr_b16 a[164:165], v3 offset:10240
ds_read_b64_tr_b16 a[166:167], v3 offset:11520
s_waitcnt lgkmcnt(8)
v_mfma_f32_32x32x16_bf16 v[208:223], a[188:191], a[4:7], v[208:223]
ds_read_b64_tr_b16 a[168:169], v4 offset:10240
ds_read_b64_tr_b16 a[170:171], v4 offset:11520
s_waitcnt lgkmcnt(8)
v_mfma_f32_32x32x16_bf16 v[224:239], a[192:195], a[4:7], v[224:239]
ds_read_b64_tr_b16 a[172:173], v5 offset:10240
ds_read_b64_tr_b16 a[174:175], v5 offset:11520
s_waitcnt lgkmcnt(8)
v_mfma_f32_32x32x16_bf16 v[240:255], a[196:199], a[4:7], v[240:255]
ds_read_b64_tr_b16 a[176:177], v6 offset:10240
ds_read_b64_tr_b16 a[178:179], v6 offset:11520
s_waitcnt lgkmcnt(8)
v_mfma_f32_32x32x16_bf16 v[176:191], a[160:163], a[8:11], v[176:191]
ds_read_b64_tr_b16 a[180:181], v2 offset:15360
ds_read_b64_tr_b16 a[182:183], v2 offset:16640
s_waitcnt lgkmcnt(8)
v_mfma_f32_32x32x16_bf16 v[192:207], a[164:167], a[8:11], v[192:207]
ds_read_b64_tr_b16 a[184:185], v3 offset:15360
ds_read_b64_tr_b16 a[186:187], v3 offset:16640
s_waitcnt lgkmcnt(8)
v_mfma_f32_32x32x16_bf16 v[208:223], a[168:171], a[8:11], v[208:223]
ds_read_b64_tr_b16 a[188:189], v4 offset:15360
ds_read_b64_tr_b16 a[190:191], v4 offset:16640
s_waitcnt lgkmcnt(8)
v_mfma_f32_32x32x16_bf16 v[224:239], a[172:175], a[8:11], v[224:239]
ds_read_b64_tr_b16 a[192:193], v5 offset:15360
ds_read_b64_tr_b16 a[194:195], v5 offset:16640
s_waitcnt lgkmcnt(8)
v_mfma_f32_32x32x16_bf16 v[240:255], a[176:179], a[8:11], v[240:255]
ds_read_b64_tr_b16 a[196:197], v6 offset:15360
ds_read_b64_tr_b16 a[198:199], v6 offset:16640
s_waitcnt vmcnt(10)
v_and_b32 v46, v46, v67
v_cmp_ne_u32 vcc, v46, v67
s_nop 4
s_cbranch_vccnz K1_SPIN_Q
K1_GO_Q:
s_barrier
s_waitcnt lgkmcnt(8)
v_mfma_f32_32x32x16_bf16 v[176:191], a[180:183], a[12:15], v[176:191]
ds_read_b64_tr_b16 a[160:161], v2 offset:20480
ds_read_b64_tr_b16 a[162:163], v2 offset:21760
s_waitcnt lgkmcnt(8)
v_mfma_f32_32x32x16_bf16 v[192:207], a[184:187], a[12:15], v[192:207]
ds_read_b64_tr_b16 a[164:165], v3 offset:20480
ds_read_b64_tr_b16 a[166:167], v3 offset:21760
s_waitcnt lgkmcnt(8)
v_mfma_f32_32x32x16_bf16 v[208:223], a[188:191], a[12:15], v[208:223]
ds_read_b64_tr_b16 a[168:169], v4 offset:20480
ds_read_b64_tr_b16 a[170:171], v4 offset:21760
s_waitcnt lgkmcnt(8)
v_mfma_f32_32x32x16_bf16 v[224:239], a[192:195], a[12:15], v[224:239]
ds_read_b64_tr_b16 a[172:173], v5 offset:20480
ds_read_b64_tr_b16 a[174:175], v5 offset:21760
s_waitcnt lgkmcnt(8)
v_mfma_f32_32x32x16_bf16 v[240:255], a[196:199], a[12:15], v[240:255]
ds_read_b64_tr_b16 a[176:177], v6 offset:20480
ds_read_b64_tr_b16 a[178:179], v6 offset:21760
buffer_load_dword v32, v90, s[16:19], 0 offen offset:0
buffer_load_dword v33, v90, s[16:19], 0 offen offset:1536
buffer_load_dword v34, v90, s[16:19], s59 offen offset:0
buffer_load_dword v35, v90, s[16:19], s59 offen offset:1536
buffer_load_dword v36, v90, s[16:19], 0 offen offset:640
buffer_load_dword v37, v90, s[16:19], 0 offen offset:2176
buffer_load_dword v38, v90, s[16:19], s59 offen offset:640
buffer_load_dword v39, v90, s[16:19], s59 offen offset:2176
buffer_load_dwordx4 v[84:87], v92, s[16:19], 0 offen
s_waitcnt lgkmcnt(8)
v_mfma_f32_32x32x16_bf16 v[176:191], a[160:163], a[16:19], v[176:191]
ds_read_b64_tr_b16 a[180:181], v2 offset:25600
ds_read_b64_tr_b16 a[182:183], v2 offset:26880
s_waitcnt lgkmcnt(8)
v_mfma_f32_32x32x16_bf16 v[192:207], a[164:167], a[16:19], v[192:207]
ds_read_b64_tr_b16 a[184:185], v3 offset:25600
ds_read_b64_tr_b16 a[186:187], v3 offset:26880
s_add_u32 m0, s25, 81920
s_add_u32 s32, s23, 983360
buffer_load_dwordx4 v12, s[12:15], s32 offen offset:0 lds
s_waitcnt lgkmcnt(8)
v_mfma_f32_32x32x16_bf16 v[208:223], a[168:171], a[16:19], v[208:223]
ds_read_b64_tr_b16 a[188:189], v4 offset:25600
ds_read_b64_tr_b16 a[190:191], v4 offset:26880
buffer_load_dwordx4 v13, s[12:15], s32 offen offset:1024 lds
s_waitcnt lgkmcnt(8)
v_mfma_f32_32x32x16_bf16 v[224:239], a[172:175], a[16:19], v[224:239]
ds_read_b64_tr_b16 a[192:193], v5 offset:25600
ds_read_b64_tr_b16 a[194:195], v5 offset:26880
buffer_load_dwordx4 v14, s[12:15], s32 offen offset:2048 lds
s_waitcnt lgkmcnt(8)
v_mfma_f32_32x32x16_bf16 v[240:255], a[176:179], a[16:19], v[240:255]
ds_read_b64_tr_b16 a[196:197], v6 offset:25600
ds_read_b64_tr_b16 a[198:199], v6 offset:26880
buffer_load_dwordx4 v15, s[12:15], s32 offen offset:3072 lds
s_waitcnt lgkmcnt(8)
v_mfma_f32_32x32x16_bf16 v[176:191], a[180:183], a[20:23], v[176:191]
ds_read_b64_tr_b16 a[160:161], v2 offset:30720
ds_read_b64_tr_b16 a[162:163], v2 offset:32000
s_add_u32 m0, s25, 86016
s_add_u32 s32, s23, 983360
buffer_load_dwordx4 v16, s[12:15], s32 offen lds
s_waitcnt lgkmcnt(8)
v_mfma_f32_32x32x16_bf16 v[192:207], a[184:187], a[20:23], v[192:207]
ds_read_b64_tr_b16 a[164:165], v3 offset:30720
ds_read_b64_tr_b16 a[166:167], v3 offset:32000
s_waitcnt lgkmcnt(8)
v_mfma_f32_32x32x16_bf16 v[208:223], a[188:191], a[20:23], v[208:223]
ds_read_b64_tr_b16 a[168:169], v4 offset:30720
ds_read_b64_tr_b16 a[170:171], v4 offset:32000
s_waitcnt lgkmcnt(8)
v_mfma_f32_32x32x16_bf16 v[224:239], a[192:195], a[20:23], v[224:239]
ds_read_b64_tr_b16 a[172:173], v5 offset:30720
ds_read_b64_tr_b16 a[174:175], v5 offset:32000
s_waitcnt lgkmcnt(8)
v_mfma_f32_32x32x16_bf16 v[240:255], a[196:199], a[20:23], v[240:255]
ds_read_b64_tr_b16 a[176:177], v6 offset:30720
ds_read_b64_tr_b16 a[178:179], v6 offset:32000
s_waitcnt lgkmcnt(8)
v_mfma_f32_32x32x16_bf16 v[176:191], a[160:163], a[24:27], v[176:191]
ds_read_b64_tr_b16 a[180:181], v2 offset:35840
ds_read_b64_tr_b16 a[182:183], v2 offset:37120
s_waitcnt lgkmcnt(8)
v_mfma_f32_32x32x16_bf16 v[192:207], a[164:167], a[24:27], v[192:207]
ds_read_b64_tr_b16 a[184:185], v3 offset:35840
ds_read_b64_tr_b16 a[186:187], v3 offset:37120
s_waitcnt lgkmcnt(8)
v_mfma_f32_32x32x16_bf16 v[208:223], a[168:171], a[24:27], v[208:223]
ds_read_b64_tr_b16 a[188:189], v4 offset:35840
ds_read_b64_tr_b16 a[190:191], v4 offset:37120
s_waitcnt lgkmcnt(8)
v_mfma_f32_32x32x16_bf16 v[224:239], a[172:175], a[24:27], v[224:239]
ds_read_b64_tr_b16 a[192:193], v5 offset:35840
ds_read_b64_tr_b16 a[194:195], v5 offset:37120
s_waitcnt lgkmcnt(8)
v_mfma_f32_32x32x16_bf16 v[240:255], a[176:179], a[24:27], v[240:255]
ds_read_b64_tr_b16 a[196:197], v6 offset:35840
ds_read_b64_tr_b16 a[198:199], v6 offset:37120
s_waitcnt vmcnt(19)
s_barrier
s_waitcnt lgkmcnt(8)
v_mfma_f32_32x32x16_bf16 v[176:191], a[180:183], a[28:31], v[176:191]
ds_read_b64_tr_b16 a[160:161], v2 offset:40960
ds_read_b64_tr_b16 a[162:163], v2 offset:42240
s_waitcnt lgkmcnt(8)
v_mfma_f32_32x32x16_bf16 v[192:207], a[184:187], a[28:31], v[192:207]
ds_read_b64_tr_b16 a[164:165], v3 offset:40960
ds_read_b64_tr_b16 a[166:167], v3 offset:42240
s_waitcnt lgkmcnt(8)
v_mfma_f32_32x32x16_bf16 v[208:223], a[188:191], a[28:31], v[208:223]
ds_read_b64_tr_b16 a[168:169], v4 offset:40960
ds_read_b64_tr_b16 a[170:171], v4 offset:42240
s_waitcnt lgkmcnt(8)
v_mfma_f32_32x32x16_bf16 v[224:239], a[192:195], a[28:31], v[224:239]
ds_read_b64_tr_b16 a[172:173], v5 offset:40960
ds_read_b64_tr_b16 a[174:175], v5 offset:42240
s_waitcnt lgkmcnt(8)
v_mfma_f32_32x32x16_bf16 v[240:255], a[196:199], a[28:31], v[240:255]
ds_read_b64_tr_b16 a[176:177], v6 offset:40960
ds_read_b64_tr_b16 a[178:179], v6 offset:42240
s_waitcnt lgkmcnt(8)
v_mfma_f32_32x32x16_bf16 v[176:191], a[160:163], a[32:35], v[176:191]
ds_read_b64_tr_b16 a[180:181], v2 offset:46080
ds_read_b64_tr_b16 a[182:183], v2 offset:47360
s_waitcnt lgkmcnt(8)
v_mfma_f32_32x32x16_bf16 v[192:207], a[164:167], a[32:35], v[192:207]
ds_read_b64_tr_b16 a[184:185], v3 offset:46080
ds_read_b64_tr_b16 a[186:187], v3 offset:47360
s_add_u32 m0, s25, 0
s_add_u32 s32, s23, 1229120
buffer_load_dwordx4 v12, s[12:15], s32 offen offset:0 lds
s_waitcnt lgkmcnt(8)
v_mfma_f32_32x32x16_bf16 v[208:223], a[168:171], a[32:35], v[208:223]
ds_read_b64_tr_b16 a[188:189], v4 offset:46080
ds_read_b64_tr_b16 a[190:191], v4 offset:47360
buffer_load_dwordx4 v13, s[12:15], s32 offen offset:1024 lds
s_waitcnt lgkmcnt(8)
v_mfma_f32_32x32x16_bf16 v[224:239], a[172:175], a[32:35], v[224:239]
ds_read_b64_tr_b16 a[192:193], v5 offset:46080
ds_read_b64_tr_b16 a[194:195], v5 offset:47360
buffer_load_dwordx4 v14, s[12:15], s32 offen offset:2048 lds
s_waitcnt lgkmcnt(8)
v_mfma_f32_32x32x16_bf16 v[240:255], a[176:179], a[32:35], v[240:255]
ds_read_b64_tr_b16 a[196:197], v6 offset:46080
ds_read_b64_tr_b16 a[198:199], v6 offset:47360
buffer_load_dwordx4 v15, s[12:15], s32 offen offset:3072 lds
s_waitcnt vmcnt(16)
v_add_f32 v32, v32, v33
s_waitcnt vmcnt(14)
v_add_f32 v34, v34, v35
s_waitcnt lgkmcnt(8)
v_mfma_f32_32x32x16_bf16 v[176:191], a[180:183], a[36:39], v[176:191]
ds_read_b64_tr_b16 a[160:161], v2 offset:51200
ds_read_b64_tr_b16 a[162:163], v2 offset:52480
s_add_u32 m0, s25, 4096
s_add_u32 s32, s23, 1229120
buffer_load_dwordx4 v16, s[12:15], s32 offen lds
v_add_f32 v32, v32, v34
ds_write_b32 v91, v32 offset:0
s_waitcnt lgkmcnt(9)
v_mfma_f32_32x32x16_bf16 v[192:207], a[184:187], a[36:39], v[192:207]
ds_read_b64_tr_b16 a[164:165], v3 offset:51200
ds_read_b64_tr_b16 a[166:167], v3 offset:52480
s_waitcnt vmcnt(13)
v_add_f32 v36, v36, v37
s_waitcnt vmcnt(11)
v_add_f32 v38, v38, v39
s_waitcnt lgkmcnt(9)
v_mfma_f32_32x32x16_bf16 v[208:223], a[188:191], a[36:39], v[208:223]
ds_read_b64_tr_b16 a[168:169], v4 offset:51200
ds_read_b64_tr_b16 a[170:171], v4 offset:52480
v_add_f32 v36, v36, v38
ds_write_b32 v91, v36 offset:640
s_waitcnt lgkmcnt(10)
v_mfma_f32_32x32x16_bf16 v[224:239], a[192:195], a[36:39], v[224:239]
ds_read_b64_tr_b16 a[172:173], v5 offset:51200
ds_read_b64_tr_b16 a[174:175], v5 offset:52480
s_waitcnt lgkmcnt(10)
v_mfma_f32_32x32x16_bf16 v[240:255], a[196:199], a[36:39], v[240:255]
ds_read_b64_tr_b16 a[176:177], v6 offset:51200
ds_read_b64_tr_b16 a[178:179], v6 offset:52480
s_waitcnt lgkmcnt(10)
v_mfma_f32_32x32x16_bf16 v[176:191], a[160:163], a[40:43], v[176:191]
ds_read_b64_tr_b16 a[180:181], v2 offset:56320
ds_read_b64_tr_b16 a[182:183], v2 offset:57600
s_waitcnt vmcnt(10)
v_cvt_pk_bf16_f32 v44, v84, v84
v_and_b32 v45, 0xffff0000, v44
s_waitcnt lgkmcnt(9)
v_mfma_f32_32x32x16_bf16 v[192:207], a[164:167], a[40:43], v[192:207]
ds_read_b64_tr_b16 a[184:185], v3 offset:56320
ds_read_b64_tr_b16 a[186:187], v3 offset:57600
v_sub_f32 v45, v84, v45
v_cvt_pk_bf16_f32 v45, v45, v45
s_waitcnt lgkmcnt(9)
v_mfma_f32_32x32x16_bf16 v[208:223], a[168:171], a[40:43], v[208:223]
ds_read_b64_tr_b16 a[188:189], v4 offset:56320
ds_read_b64_tr_b16 a[190:191], v4 offset:57600
s_mov_b32 s33, 0xffff
v_bfi_b32 v44, s33, v44, v45
s_waitcnt lgkmcnt(8)
v_mfma_f32_32x32x16_bf16 v[224:239], a[172:175], a[40:43], v[224:239]
ds_read_b64_tr_b16 a[192:193], v5 offset:56320
ds_read_b64_tr_b16 a[194:195], v5 offset:57600
v_cmp_gt_u32 vcc, 32, v1
s_nop 1
v_cndmask_b32 v88, 0, v44, vcc
s_waitcnt lgkmcnt(8)
v_mfma_f32_32x32x16_bf16 v[240:255], a[176:179], a[40:43], v[240:255]
ds_read_b64_tr_b16 a[196:197], v6 offset:56320
ds_read_b64_tr_b16 a[198:199], v6 offset:57600
v_mov_b32 v89, v88
v_mul_f32 v93, s27, v85
s_waitcnt lgkmcnt(0)
s_barrier
v_mfma_f32_32x32x16_bf16 v[176:191], a[180:183], a[44:47], v[176:191]
ds_read_b64_tr_b16 a[160:161], v7 offset:0
ds_read_b64_tr_b16 a[162:163], v7 offset:1280
v_mfma_f32_32x32x16_bf16 v[192:207], a[184:187], a[44:47], v[192:207]
ds_read_b64_tr_b16 a[164:165], v8 offset:0
ds_read_b64_tr_b16 a[166:167], v8 offset:1280
v_mfma_f32_32x32x16_bf16 v[208:223], a[188:191], a[44:47], v[208:223]
ds_read_b64_tr_b16 a[168:169], v9 offset:0
ds_read_b64_tr_b16 a[170:171], v9 offset:1280
v_mfma_f32_32x32x16_bf16 v[224:239], a[192:195], a[44:47], v[224:239]
ds_read_b64_tr_b16 a[172:173], v10 offset:0
ds_read_b64_tr_b16 a[174:175], v10 offset:1280
v_mfma_f32_32x32x16_bf16 v[240:255], a[196:199], a[44:47], v[240:255]
ds_read_b64_tr_b16 a[176:177], v11 offset:0
ds_read_b64_tr_b16 a[178:179], v11 offset:1280
s_waitcnt lgkmcnt(8)
v_mfma_f32_32x32x16_bf16 v[176:191], a[160:163], a[48:51], v[176:191]
ds_read_b64_tr_b16 a[180:181], v7 offset:5120
ds_read_b64_tr_b16 a[182:183], v7 offset:6400
s_waitcnt lgkmcnt(8)
v_mfma_f32_32x32x16_bf16 v[192:207], a[164:167], a[48:51], v[192:207]
ds_read_b64_tr_b16 a[184:185], v8 offset:5120
ds_read_b64_tr_b16 a[186:187], v8 offset:6400
s_add_u32 m0, s25, 20480
s_add_u32 s32, s23, 1474880
buffer_load_dwordx4 v12, s[12:15], s32 offen offset:0 lds
ds_read_b32 v62, v95 offset:0
ds_read_b32 v63, v95 offset:128
s_waitcnt lgkmcnt(10)
v_mfma_f32_32x32x16_bf16 v[208:223], a[168:171], a[48:51], v[208:223]
ds_read_b64_tr_b16 a[188:189], v9 offset:5120
ds_read_b64_tr_b16 a[190:191], v9 offset:6400
buffer_load_dwordx4 v13, s[12:15], s32 offen offset:1024 lds
ds_read_b32 v64, v95 offset:256
ds_read_b32 v65, v95 offset:384
s_waitcnt lgkmcnt(12)
v_mfma_f32_32x32x16_bf16 v[224:239], a[172:175], a[48:51], v[224:239]
ds_read_b64_tr_b16 a[192:193], v10 offset:5120
ds_read_b64_tr_b16 a[194:195], v10 offset:6400
buffer_load_dwordx4 v14, s[12:15], s32 offen offset:2048 lds
ds_read_b32 v66, v95 offset:512
s_waitcnt lgkmcnt(8)
v_cvt_pk_bf16_f32 v52, v62, v62
v_mfma_f32_32x32x16_bf16 v[240:255], a[176:179], a[48:51], v[240:255]
ds_read_b64_tr_b16 a[196:197], v11 offset:5120
ds_read_b64_tr_b16 a[198:199], v11 offset:6400
buffer_load_dwordx4 v15, s[12:15], s32 offen offset:3072 lds
v_and_b32 v53, 0xffff0000, v52
v_sub_f32 v53, v62, v53
v_mfma_f32_32x32x16_bf16 v[176:191], a[180:183], a[52:55], v[176:191]
ds_read_b64_tr_b16 a[160:161], v7 offset:10240
ds_read_b64_tr_b16 a[162:163], v7 offset:11520
s_add_u32 m0, s25, 24576
s_add_u32 s32, s23, 1474880
buffer_load_dwordx4 v16, s[12:15], s32 offen lds
v_cvt_pk_bf16_f32 v53, v53, v53
s_waitcnt lgkmcnt(11)
v_cvt_pk_bf16_f32 v54, v63, v63
v_mfma_f32_32x32x16_bf16 v[192:207], a[184:187], a[52:55], v[192:207]
ds_read_b64_tr_b16 a[164:165], v8 offset:10240
ds_read_b64_tr_b16 a[166:167], v8 offset:11520
v_and_b32 v55, 0xffff0000, v54
v_sub_f32 v55, v63, v55
s_waitcnt lgkmcnt(11)
v_mfma_f32_32x32x16_bf16 v[208:223], a[188:191], a[52:55], v[208:223]
ds_read_b64_tr_b16 a[168:169], v9 offset:10240
ds_read_b64_tr_b16 a[170:171], v9 offset:11520
v_cvt_pk_bf16_f32 v55, v55, v55
s_waitcnt lgkmcnt(12)
v_cvt_pk_bf16_f32 v56, v64, v64
s_waitcnt lgkmcnt(9)
v_mfma_f32_32x32x16_bf16 v[224:239], a[192:195], a[52:55], v[224:239]
ds_read_b64_tr_b16 a[172:173], v10 offset:10240
ds_read_b64_tr_b16 a[174:175], v10 offset:11520
v_and_b32 v57, 0xffff0000, v56
v_sub_f32 v57, v64, v57
s_waitcnt lgkmcnt(8)
v_mfma_f32_32x32x16_bf16 v[240:255], a[196:199], a[52:55], v[240:255]
ds_read_b64_tr_b16 a[176:177], v11 offset:10240
ds_read_b64_tr_b16 a[178:179], v11 offset:11520
v_cvt_pk_bf16_f32 v57, v57, v57
v_cvt_pk_bf16_f32 v58, v65, v65
s_waitcnt lgkmcnt(8)
v_mfma_f32_32x32x16_bf16 v[176:191], a[160:163], a[56:59], v[176:191]
ds_read_b64_tr_b16 a[180:181], v7 offset:15360
ds_read_b64_tr_b16 a[182:183], v7 offset:16640
v_and_b32 v59, 0xffff0000, v58
v_sub_f32 v59, v65, v59
s_waitcnt lgkmcnt(8)
v_mfma_f32_32x32x16_bf16 v[192:207], a[164:167], a[56:59], v[192:207]
ds_read_b64_tr_b16 a[184:185], v8 offset:15360
ds_read_b64_tr_b16 a[186:187], v8 offset:16640
v_cvt_pk_bf16_f32 v59, v59, v59
v_cvt_pk_bf16_f32 v60, v66, v66
s_waitcnt lgkmcnt(8)
v_mfma_f32_32x32x16_bf16 v[208:223], a[168:171], a[56:59], v[208:223]
ds_read_b64_tr_b16 a[188:189], v9 offset:15360
ds_read_b64_tr_b16 a[190:191], v9 offset:16640
v_and_b32 v61, 0xffff0000, v60
v_sub_f32 v61, v66, v61
s_waitcnt lgkmcnt(8)
v_mfma_f32_32x32x16_bf16 v[224:239], a[172:175], a[56:59], v[224:239]
ds_read_b64_tr_b16 a[192:193], v10 offset:15360
ds_read_b64_tr_b16 a[194:195], v10 offset:16640
v_cvt_pk_bf16_f32 v61, v61, v61
v_mfma_f32_32x32x8_bf16 v[96:111], v[52:53], v[88:89], v[96:111]
s_waitcnt lgkmcnt(8)
v_mfma_f32_32x32x16_bf16 v[240:255], a[176:179], a[56:59], v[240:255]
ds_read_b64_tr_b16 a[196:197], v11 offset:15360
ds_read_b64_tr_b16 a[198:199], v11 offset:16640
v_mfma_f32_32x32x8_bf16 v[112:127], v[54:55], v[88:89], v[112:127]
v_mfma_f32_32x32x8_bf16 v[128:143], v[56:57], v[88:89], v[128:143]
s_waitcnt vmcnt(10)
s_barrier
s_waitcnt lgkmcnt(8)
v_mfma_f32_32x32x16_bf16 v[176:191], a[180:183], a[60:63], v[176:191]
ds_read_b64_tr_b16 a[160:161], v7 offset:20480
ds_read_b64_tr_b16 a[162:163], v7 offset:21760
v_mfma_f32_32x32x8_bf16 v[144:159], v[58:59], v[88:89], v[144:159]
v_mfma_f32_32x32x8_bf16 v[160:175], v[60:61], v[88:89], v[160:175]
s_waitcnt lgkmcnt(8)
v_mfma_f32_32x32x16_bf16 v[192:207], a[184:187], a[60:63], v[192:207]
ds_read_b64_tr_b16 a[164:165], v8 offset:20480
ds_read_b64_tr_b16 a[166:167], v8 offset:21760
v_mul_f32 v96, v93, v96
v_mul_f32 v97, v93, v97
s_waitcnt lgkmcnt(8)
v_mfma_f32_32x32x16_bf16 v[208:223], a[188:191], a[60:63], v[208:223]
ds_read_b64_tr_b16 a[168:169], v9 offset:20480
ds_read_b64_tr_b16 a[170:171], v9 offset:21760
v_mul_f32 v98, v93, v98
v_mul_f32 v99, v93, v99
s_waitcnt lgkmcnt(8)
v_mfma_f32_32x32x16_bf16 v[224:239], a[192:195], a[60:63], v[224:239]
ds_read_b64_tr_b16 a[172:173], v10 offset:20480
ds_read_b64_tr_b16 a[174:175], v10 offset:21760
v_mul_f32 v100, v93, v100
v_mul_f32 v101, v93, v101
s_waitcnt lgkmcnt(8)
v_mfma_f32_32x32x16_bf16 v[240:255], a[196:199], a[60:63], v[240:255]
ds_read_b64_tr_b16 a[176:177], v11 offset:20480
ds_read_b64_tr_b16 a[178:179], v11 offset:21760
v_mul_f32 v102, v93, v102
v_mul_f32 v103, v93, v103
s_waitcnt lgkmcnt(8)
v_mfma_f32_32x32x16_bf16 v[176:191], a[160:163], a[64:67], v[176:191]
ds_read_b64_tr_b16 a[180:181], v7 offset:25600
ds_read_b64_tr_b16 a[182:183], v7 offset:26880
v_cvt_pk_bf16_f32 v32, v96, v97
v_cvt_pk_bf16_f32 v33, v98, v99
s_waitcnt lgkmcnt(8)
v_mfma_f32_32x32x16_bf16 v[192:207], a[164:167], a[64:67], v[192:207]
ds_read_b64_tr_b16 a[184:185], v8 offset:25600
ds_read_b64_tr_b16 a[186:187], v8 offset:26880
s_add_u32 m0, s25, 40960
s_add_u32 s32, s23, 1720640
buffer_load_dwordx4 v12, s[12:15], s32 offen offset:0 lds
v_cvt_pk_bf16_f32 v34, v100, v101
v_cvt_pk_bf16_f32 v35, v102, v103
s_waitcnt lgkmcnt(8)
v_mfma_f32_32x32x16_bf16 v[208:223], a[168:171], a[64:67], v[208:223]
ds_read_b64_tr_b16 a[188:189], v9 offset:25600
ds_read_b64_tr_b16 a[190:191], v9 offset:26880
buffer_load_dwordx4 v13, s[12:15], s32 offen offset:1024 lds
s_add_u32 s28, s43, 0
buffer_store_dwordx4 v[32:35], v25, s[16:19], s28 offen sc1
s_waitcnt lgkmcnt(8)
v_mfma_f32_32x32x16_bf16 v[224:239], a[172:175], a[64:67], v[224:239]
ds_read_b64_tr_b16 a[192:193], v10 offset:25600
ds_read_b64_tr_b16 a[194:195], v10 offset:26880
buffer_load_dwordx4 v14, s[12:15], s32 offen offset:2048 lds
v_mul_f32 v104, v93, v104
v_mul_f32 v105, v93, v105
s_waitcnt lgkmcnt(8)
v_mfma_f32_32x32x16_bf16 v[240:255], a[176:179], a[64:67], v[240:255]
ds_read_b64_tr_b16 a[196:197], v11 offset:25600
ds_read_b64_tr_b16 a[198:199], v11 offset:26880
buffer_load_dwordx4 v15, s[12:15], s32 offen offset:3072 lds
v_mul_f32 v106, v93, v106
v_mul_f32 v107, v93, v107
s_waitcnt lgkmcnt(8)
v_mfma_f32_32x32x16_bf16 v[176:191], a[180:183], a[68:71], v[176:191]
ds_read_b64_tr_b16 a[160:161], v7 offset:30720
ds_read_b64_tr_b16 a[162:163], v7 offset:32000
s_add_u32 m0, s25, 45056
s_add_u32 s32, s23, 1720640
buffer_load_dwordx4 v16, s[12:15], s32 offen lds
v_mul_f32 v112, v93, v112
v_mul_f32 v113, v93, v113
s_waitcnt lgkmcnt(8)
v_mfma_f32_32x32x16_bf16 v[192:207], a[184:187], a[68:71], v[192:207]
ds_read_b64_tr_b16 a[164:165], v8 offset:30720
ds_read_b64_tr_b16 a[166:167], v8 offset:32000
v_mul_f32 v114, v93, v114
v_mul_f32 v115, v93, v115
s_waitcnt lgkmcnt(8)
v_mfma_f32_32x32x16_bf16 v[208:223], a[188:191], a[68:71], v[208:223]
ds_read_b64_tr_b16 a[168:169], v9 offset:30720
ds_read_b64_tr_b16 a[170:171], v9 offset:32000
v_cvt_pk_bf16_f32 v36, v104, v105
v_cvt_pk_bf16_f32 v37, v106, v107
s_waitcnt lgkmcnt(8)
v_mfma_f32_32x32x16_bf16 v[224:239], a[192:195], a[68:71], v[224:239]
ds_read_b64_tr_b16 a[172:173], v10 offset:30720
ds_read_b64_tr_b16 a[174:175], v10 offset:32000
v_cvt_pk_bf16_f32 v38, v112, v113
v_cvt_pk_bf16_f32 v39, v114, v115
s_waitcnt lgkmcnt(8)
v_mfma_f32_32x32x16_bf16 v[240:255], a[196:199], a[68:71], v[240:255]
ds_read_b64_tr_b16 a[176:177], v11 offset:30720
ds_read_b64_tr_b16 a[178:179], v11 offset:32000
s_add_u32 s28, s43, 65536
buffer_store_dwordx4 v[36:39], v25, s[16:19], s28 offen sc1
s_waitcnt lgkmcnt(8)
v_mfma_f32_32x32x16_bf16 v[176:191], a[160:163], a[72:75], v[176:191]
ds_read_b64_tr_b16 a[180:181], v7 offset:35840
ds_read_b64_tr_b16 a[182:183], v7 offset:37120
v_mul_f32 v116, v93, v116
v_mul_f32 v117, v93, v117
s_waitcnt lgkmcnt(8)
v_mfma_f32_32x32x16_bf16 v[192:207], a[164:167], a[72:75], v[192:207]
ds_read_b64_tr_b16 a[184:185], v8 offset:35840
ds_read_b64_tr_b16 a[186:187], v8 offset:37120
v_mul_f32 v118, v93, v118
v_mul_f32 v119, v93, v119
s_waitcnt lgkmcnt(8)
v_mfma_f32_32x32x16_bf16 v[208:223], a[168:171], a[72:75], v[208:223]
ds_read_b64_tr_b16 a[188:189], v9 offset:35840
ds_read_b64_tr_b16 a[190:191], v9 offset:37120
v_mul_f32 v120, v93, v120
v_mul_f32 v121, v93, v121
s_waitcnt lgkmcnt(8)
v_mfma_f32_32x32x16_bf16 v[224:239], a[172:175], a[72:75], v[224:239]
ds_read_b64_tr_b16 a[192:193], v10 offset:35840
ds_read_b64_tr_b16 a[194:195], v10 offset:37120
v_mul_f32 v122, v93, v122
v_mul_f32 v123, v93, v123
s_waitcnt lgkmcnt(8)
v_mfma_f32_32x32x16_bf16 v[240:255], a[176:179], a[72:75], v[240:255]
ds_read_b64_tr_b16 a[196:197], v11 offset:35840
ds_read_b64_tr_b16 a[198:199], v11 offset:37120
v_cvt_pk_bf16_f32 v40, v116, v117
v_cvt_pk_bf16_f32 v41, v118, v119
s_waitcnt vmcnt(12)
s_barrier
s_waitcnt lgkmcnt(8)
v_mfma_f32_32x32x16_bf16 v[176:191], a[180:183], a[76:79], v[176:191]
ds_read_b64_tr_b16 a[160:161], v2 offset:0
ds_read_b64_tr_b16 a[162:163], v2 offset:1280
v_cvt_pk_bf16_f32 v42, v120, v121
v_cvt_pk_bf16_f32 v43, v122, v123
s_waitcnt lgkmcnt(8)
v_mfma_f32_32x32x16_bf16 v[192:207], a[184:187], a[76:79], v[192:207]
ds_read_b64_tr_b16 a[164:165], v3 offset:0
ds_read_b64_tr_b16 a[166:167], v3 offset:1280
s_add_u32 s28, s43, 131072
buffer_store_dwordx4 v[40:43], v25, s[16:19], s28 offen sc1
s_waitcnt lgkmcnt(8)
v_mfma_f32_32x32x16_bf16 v[208:223], a[188:191], a[76:79], v[208:223]
ds_read_b64_tr_b16 a[168:169], v4 offset:0
ds_read_b64_tr_b16 a[170:171], v4 offset:1280
v_mul_f32 v128, v93, v128
v_mul_f32 v129, v93, v129
s_waitcnt lgkmcnt(8)
v_mfma_f32_32x32x16_bf16 v[224:239], a[192:195], a[76:79], v[224:239]
ds_read_b64_tr_b16 a[172:173], v5 offset:0
ds_read_b64_tr_b16 a[174:175], v5 offset:1280
v_mul_f32 v130, v93, v130
v_mul_f32 v131, v93, v131
s_waitcnt lgkmcnt(8)
v_mfma_f32_32x32x16_bf16 v[240:255], a[196:199], a[76:79], v[240:255]
ds_read_b64_tr_b16 a[176:177], v6 offset:0
ds_read_b64_tr_b16 a[178:179], v6 offset:1280
v_mul_f32 v132, v93, v132
v_mul_f32 v133, v93, v133
s_waitcnt lgkmcnt(8)
v_mfma_f32_32x32x16_bf16 v[176:191], a[160:163], a[80:83], v[176:191]
ds_read_b64_tr_b16 a[180:181], v2 offset:5120
ds_read_b64_tr_b16 a[182:183], v2 offset:6400
v_mul_f32 v134, v93, v134
s_waitcnt lgkmcnt(8)
v_mfma_f32_32x32x16_bf16 v[192:207], a[164:167], a[80:83], v[192:207]
ds_read_b64_tr_b16 a[184:185], v3 offset:5120
ds_read_b64_tr_b16 a[186:187], v3 offset:6400
s_add_u32 m0, s25, 61440
s_add_u32 s32, s23, 1966400
buffer_load_dwordx4 v12, s[12:15], s32 offen offset:0 lds
v_mul_f32 v135, v93, v135
s_waitcnt lgkmcnt(8)
v_mfma_f32_32x32x16_bf16 v[208:223], a[168:171], a[80:83], v[208:223]
ds_read_b64_tr_b16 a[188:189], v4 offset:5120
ds_read_b64_tr_b16 a[190:191], v4 offset:6400
buffer_load_dwordx4 v13, s[12:15], s32 offen offset:1024 lds
v_cvt_pk_bf16_f32 v44, v128, v129
s_waitcnt lgkmcnt(8)
v_mfma_f32_32x32x16_bf16 v[224:239], a[172:175], a[80:83], v[224:239]
ds_read_b64_tr_b16 a[192:193], v5 offset:5120
ds_read_b64_tr_b16 a[194:195], v5 offset:6400
buffer_load_dwordx4 v14, s[12:15], s32 offen offset:2048 lds
v_cvt_pk_bf16_f32 v45, v130, v131
s_waitcnt lgkmcnt(8)
v_mfma_f32_32x32x16_bf16 v[240:255], a[176:179], a[80:83], v[240:255]
ds_read_b64_tr_b16 a[196:197], v6 offset:5120
ds_read_b64_tr_b16 a[198:199], v6 offset:6400
buffer_load_dwordx4 v15, s[12:15], s32 offen offset:3072 lds
v_cvt_pk_bf16_f32 v46, v132, v133
s_waitcnt lgkmcnt(8)
v_mfma_f32_32x32x16_bf16 v[176:191], a[180:183], a[84:87], v[176:191]
ds_read_b64_tr_b16 a[160:161], v2 offset:10240
ds_read_b64_tr_b16 a[162:163], v2 offset:11520
s_add_u32 m0, s25, 65536
s_add_u32 s32, s23, 1966400
buffer_load_dwordx4 v16, s[12:15], s32 offen lds
v_cvt_pk_bf16_f32 v47, v134, v135
s_waitcnt lgkmcnt(8)
v_mfma_f32_32x32x16_bf16 v[192:207], a[184:187], a[84:87], v[192:207]
ds_read_b64_tr_b16 a[164:165], v3 offset:10240
ds_read_b64_tr_b16 a[166:167], v3 offset:11520
s_add_u32 s28, s43, 196608
s_waitcnt lgkmcnt(8)
v_mfma_f32_32x32x16_bf16 v[208:223], a[188:191], a[84:87], v[208:223]
ds_read_b64_tr_b16 a[168:169], v4 offset:10240
ds_read_b64_tr_b16 a[170:171], v4 offset:11520
buffer_store_dwordx4 v[44:47], v25, s[16:19], s28 offen sc1
s_waitcnt lgkmcnt(8)
v_mfma_f32_32x32x16_bf16 v[224:239], a[192:195], a[84:87], v[224:239]
ds_read_b64_tr_b16 a[172:173], v5 offset:10240
ds_read_b64_tr_b16 a[174:175], v5 offset:11520
v_mul_f32 v136, v93, v136
s_waitcnt lgkmcnt(8)
v_mfma_f32_32x32x16_bf16 v[240:255], a[196:199], a[84:87], v[240:255]
ds_read_b64_tr_b16 a[176:177], v6 offset:10240
ds_read_b64_tr_b16 a[178:179], v6 offset:11520
v_mul_f32 v137, v93, v137
s_waitcnt lgkmcnt(8)
v_mfma_f32_32x32x16_bf16 v[176:191], a[160:163], a[88:91], v[176:191]
ds_read_b64_tr_b16 a[180:181], v2 offset:15360
ds_read_b64_tr_b16 a[182:183], v2 offset:16640
v_mul_f32 v138, v93, v138
s_waitcnt lgkmcnt(8)
v_mfma_f32_32x32x16_bf16 v[192:207], a[164:167], a[88:91], v[192:207]
ds_read_b64_tr_b16 a[184:185], v3 offset:15360
ds_read_b64_tr_b16 a[186:187], v3 offset:16640
v_mul_f32 v139, v93, v139
s_waitcnt lgkmcnt(8)
v_mfma_f32_32x32x16_bf16 v[208:223], a[168:171], a[88:91], v[208:223]
ds_read_b64_tr_b16 a[188:189], v4 offset:15360
ds_read_b64_tr_b16 a[190:191], v4 offset:16640
v_mul_f32 v140, v93, v140
s_waitcnt lgkmcnt(8)
v_mfma_f32_32x32x16_bf16 v[224:239], a[172:175], a[88:91], v[224:239]
ds_read_b64_tr_b16 a[192:193], v5 offset:15360
ds_read_b64_tr_b16 a[194:195], v5 offset:16640
v_mul_f32 v141, v93, v141
s_waitcnt lgkmcnt(8)
v_mfma_f32_32x32x16_bf16 v[240:255], a[176:179], a[88:91], v[240:255]
ds_read_b64_tr_b16 a[196:197], v6 offset:15360
ds_read_b64_tr_b16 a[198:199], v6 offset:16640
v_mul_f32 v142, v93, v142
s_waitcnt vmcnt(14)
s_barrier
s_waitcnt lgkmcnt(8)
v_mfma_f32_32x32x16_bf16 v[176:191], a[180:183], a[92:95], v[176:191]
ds_read_b64_tr_b16 a[160:161], v2 offset:20480
ds_read_b64_tr_b16 a[162:163], v2 offset:21760
v_mul_f32 v143, v93, v143
s_waitcnt lgkmcnt(8)
v_mfma_f32_32x32x16_bf16 v[192:207], a[184:187], a[92:95], v[192:207]
ds_read_b64_tr_b16 a[164:165], v3 offset:20480
ds_read_b64_tr_b16 a[166:167], v3 offset:21760
v_cvt_pk_bf16_f32 v32, v136, v137
s_waitcnt lgkmcnt(8)
v_mfma_f32_32x32x16_bf16 v[208:223], a[188:191], a[92:95], v[208:223]
ds_read_b64_tr_b16 a[168:169], v4 offset:20480
ds_read_b64_tr_b16 a[170:171], v4 offset:21760
v_cvt_pk_bf16_f32 v33, v138, v139
s_waitcnt lgkmcnt(8)
v_mfma_f32_32x32x16_bf16 v[224:239], a[192:195], a[92:95], v[224:239]
ds_read_b64_tr_b16 a[172:173], v5 offset:20480
ds_read_b64_tr_b16 a[174:175], v5 offset:21760
v_cvt_pk_bf16_f32 v34, v140, v141
s_waitcnt lgkmcnt(8)
v_mfma_f32_32x32x16_bf16 v[240:255], a[196:199], a[92:95], v[240:255]
ds_read_b64_tr_b16 a[176:177], v6 offset:20480
ds_read_b64_tr_b16 a[178:179], v6 offset:21760
v_cvt_pk_bf16_f32 v35, v142, v143
s_waitcnt lgkmcnt(8)
v_mfma_f32_32x32x16_bf16 v[176:191], a[160:163], a[96:99], v[176:191]
ds_read_b64_tr_b16 a[180:181], v2 offset:25600
ds_read_b64_tr_b16 a[182:183], v2 offset:26880
s_add_u32 s28, s43, 262144
s_waitcnt lgkmcnt(8)
v_mfma_f32_32x32x16_bf16 v[192:207], a[164:167], a[96:99], v[192:207]
ds_read_b64_tr_b16 a[184:185], v3 offset:25600
ds_read_b64_tr_b16 a[186:187], v3 offset:26880
s_add_u32 m0, s25, 81920
s_add_u32 s32, s23, 2212160
buffer_load_dwordx4 v12, s[12:15], s32 offen offset:0 lds
buffer_store_dwordx4 v[32:35], v25, s[16:19], s28 offen sc1
s_waitcnt lgkmcnt(8)
v_mfma_f32_32x32x16_bf16 v[208:223], a[168:171], a[96:99], v[208:223]
ds_read_b64_tr_b16 a[188:189], v4 offset:25600
ds_read_b64_tr_b16 a[190:191], v4 offset:26880
buffer_load_dwordx4 v13, s[12:15], s32 offen offset:1024 lds
v_mul_f32 v144, v93, v144
s_waitcnt lgkmcnt(8)
v_mfma_f32_32x32x16_bf16 v[224:239], a[172:175], a[96:99], v[224:239]
ds_read_b64_tr_b16 a[192:193], v5 offset:25600
ds_read_b64_tr_b16 a[194:195], v5 offset:26880
buffer_load_dwordx4 v14, s[12:15], s32 offen offset:2048 lds
v_mul_f32 v145, v93, v145
s_waitcnt lgkmcnt(8)
v_mfma_f32_32x32x16_bf16 v[240:255], a[176:179], a[96:99], v[240:255]
ds_read_b64_tr_b16 a[196:197], v6 offset:25600
ds_read_b64_tr_b16 a[198:199], v6 offset:26880
buffer_load_dwordx4 v15, s[12:15], s32 offen offset:3072 lds
v_mul_f32 v146, v93, v146
s_waitcnt lgkmcnt(8)
v_mfma_f32_32x32x16_bf16 v[176:191], a[180:183], a[100:103], v[176:191]
ds_read_b64_tr_b16 a[160:161], v2 offset:30720
ds_read_b64_tr_b16 a[162:163], v2 offset:32000
s_add_u32 m0, s25, 86016
s_add_u32 s32, s23, 2212160
buffer_load_dwordx4 v16, s[12:15], s32 offen lds
v_mul_f32 v147, v93, v147
s_waitcnt lgkmcnt(8)
v_mfma_f32_32x32x16_bf16 v[192:207], a[184:187], a[100:103], v[192:207]
ds_read_b64_tr_b16 a[164:165], v3 offset:30720
ds_read_b64_tr_b16 a[166:167], v3 offset:32000
v_mul_f32 v148, v93, v148
s_waitcnt lgkmcnt(8)
v_mfma_f32_32x32x16_bf16 v[208:223], a[188:191], a[100:103], v[208:223]
ds_read_b64_tr_b16 a[168:169], v4 offset:30720
ds_read_b64_tr_b16 a[170:171], v4 offset:32000
v_mul_f32 v149, v93, v149
s_waitcnt lgkmcnt(8)
v_mfma_f32_32x32x16_bf16 v[224:239], a[192:195], a[100:103], v[224:239]
ds_read_b64_tr_b16 a[172:173], v5 offset:30720
ds_read_b64_tr_b16 a[174:175], v5 offset:32000
v_mul_f32 v150, v93, v150
s_waitcnt lgkmcnt(8)
v_mfma_f32_32x32x16_bf16 v[240:255], a[196:199], a[100:103], v[240:255]
ds_read_b64_tr_b16 a[176:177], v6 offset:30720
ds_read_b64_tr_b16 a[178:179], v6 offset:32000
v_mul_f32 v151, v93, v151
s_waitcnt lgkmcnt(8)
v_mfma_f32_32x32x16_bf16 v[176:191], a[160:163], a[104:107], v[176:191]
ds_read_b64_tr_b16 a[180:181], v2 offset:35840
ds_read_b64_tr_b16 a[182:183], v2 offset:37120
v_cvt_pk_bf16_f32 v36, v144, v145
s_waitcnt lgkmcnt(8)
v_mfma_f32_32x32x16_bf16 v[192:207], a[164:167], a[104:107], v[192:207]
ds_read_b64_tr_b16 a[184:185], v3 offset:35840
ds_read_b64_tr_b16 a[186:187], v3 offset:37120
v_cvt_pk_bf16_f32 v37, v146, v147
s_waitcnt lgkmcnt(8)
v_mfma_f32_32x32x16_bf16 v[208:223], a[168:171], a[104:107], v[208:223]
ds_read_b64_tr_b16 a[188:189], v4 offset:35840
ds_read_b64_tr_b16 a[190:191], v4 offset:37120
v_cvt_pk_bf16_f32 v38, v148, v149
s_waitcnt lgkmcnt(8)
v_mfma_f32_32x32x16_bf16 v[224:239], a[172:175], a[104:107], v[224:239]
ds_read_b64_tr_b16 a[192:193], v5 offset:35840
ds_read_b64_tr_b16 a[194:195], v5 offset:37120
v_cvt_pk_bf16_f32 v39, v150, v151
s_waitcnt lgkmcnt(8)
v_mfma_f32_32x32x16_bf16 v[240:255], a[176:179], a[104:107], v[240:255]
ds_read_b64_tr_b16 a[196:197], v6 offset:35840
ds_read_b64_tr_b16 a[198:199], v6 offset:37120
s_add_u32 s28, s43, 327680
s_waitcnt vmcnt(14)
s_barrier
s_waitcnt lgkmcnt(8)
v_mfma_f32_32x32x16_bf16 v[176:191], a[180:183], a[108:111], v[176:191]
ds_read_b64_tr_b16 a[160:161], v2 offset:40960
ds_read_b64_tr_b16 a[162:163], v2 offset:42240
buffer_store_dwordx4 v[36:39], v25, s[16:19], s28 offen sc1
s_waitcnt lgkmcnt(8)
v_mfma_f32_32x32x16_bf16 v[192:207], a[184:187], a[108:111], v[192:207]
ds_read_b64_tr_b16 a[164:165], v3 offset:40960
ds_read_b64_tr_b16 a[166:167], v3 offset:42240
v_mul_f32 v156, v93, v156
s_waitcnt lgkmcnt(8)
v_mfma_f32_32x32x16_bf16 v[208:223], a[188:191], a[108:111], v[208:223]
ds_read_b64_tr_b16 a[168:169], v4 offset:40960
ds_read_b64_tr_b16 a[170:171], v4 offset:42240
v_mul_f32 v157, v93, v157
s_waitcnt lgkmcnt(8)
v_mfma_f32_32x32x16_bf16 v[224:239], a[192:195], a[108:111], v[224:239]
ds_read_b64_tr_b16 a[172:173], v5 offset:40960
ds_read_b64_tr_b16 a[174:175], v5 offset:42240
v_mul_f32 v158, v93, v158
s_waitcnt lgkmcnt(8)
v_mfma_f32_32x32x16_bf16 v[240:255], a[196:199], a[108:111], v[240:255]
ds_read_b64_tr_b16 a[176:177], v6 offset:40960
ds_read_b64_tr_b16 a[178:179], v6 offset:42240
v_mul_f32 v159, v93, v159
s_waitcnt lgkmcnt(8)
v_mfma_f32_32x32x16_bf16 v[176:191], a[160:163], a[112:115], v[176:191]
ds_read_b64_tr_b16 a[180:181], v2 offset:46080
ds_read_b64_tr_b16 a[182:183], v2 offset:47360
v_mul_f32 v160, v93, v160
s_waitcnt lgkmcnt(8)
v_mfma_f32_32x32x16_bf16 v[192:207], a[164:167], a[112:115], v[192:207]
ds_read_b64_tr_b16 a[184:185], v3 offset:46080
ds_read_b64_tr_b16 a[186:187], v3 offset:47360
v_mul_f32 v161, v93, v161
s_waitcnt lgkmcnt(8)
v_mfma_f32_32x32x16_bf16 v[208:223], a[168:171], a[112:115], v[208:223]
ds_read_b64_tr_b16 a[188:189], v4 offset:46080
ds_read_b64_tr_b16 a[190:191], v4 offset:47360
v_mul_f32 v162, v93, v162
s_waitcnt lgkmcnt(8)
v_mfma_f32_32x32x16_bf16 v[224:239], a[172:175], a[112:115], v[224:239]
ds_read_b64_tr_b16 a[192:193], v5 offset:46080
ds_read_b64_tr_b16 a[194:195], v5 offset:47360
v_mul_f32 v163, v93, v163
s_waitcnt lgkmcnt(8)
v_mfma_f32_32x32x16_bf16 v[240:255], a[176:179], a[112:115], v[240:255]
ds_read_b64_tr_b16 a[196:197], v6 offset:46080
ds_read_b64_tr_b16 a[198:199], v6 offset:47360
v_cvt_pk_bf16_f32 v40, v156, v157
s_waitcnt lgkmcnt(8)
v_mfma_f32_32x32x16_bf16 v[176:191], a[180:183], a[116:119], v[176:191]
ds_read_b64_tr_b16 a[160:161], v2 offset:51200
ds_read_b64_tr_b16 a[162:163], v2 offset:52480
v_cvt_pk_bf16_f32 v41, v158, v159
s_waitcnt lgkmcnt(8)
v_mfma_f32_32x32x16_bf16 v[192:207], a[184:187], a[116:119], v[192:207]
ds_read_b64_tr_b16 a[164:165], v3 offset:51200
ds_read_b64_tr_b16 a[166:167], v3 offset:52480
v_cvt_pk_bf16_f32 v42, v160, v161
s_waitcnt lgkmcnt(8)
v_mfma_f32_32x32x16_bf16 v[208:223], a[188:191], a[116:119], v[208:223]
ds_read_b64_tr_b16 a[168:169], v4 offset:51200
ds_read_b64_tr_b16 a[170:171], v4 offset:52480
v_cvt_pk_bf16_f32 v43, v162, v163
s_waitcnt lgkmcnt(8)
v_mfma_f32_32x32x16_bf16 v[224:239], a[192:195], a[116:119], v[224:239]
ds_read_b64_tr_b16 a[172:173], v5 offset:51200
ds_read_b64_tr_b16 a[174:175], v5 offset:52480
s_add_u32 s28, s43, 393216
s_waitcnt lgkmcnt(8)
v_mfma_f32_32x32x16_bf16 v[240:255], a[196:199], a[116:119], v[240:255]
ds_read_b64_tr_b16 a[176:177], v6 offset:51200
ds_read_b64_tr_b16 a[178:179], v6 offset:52480
buffer_store_dwordx4 v[40:43], v25, s[16:19], s28 offen sc1
s_waitcnt lgkmcnt(8)
v_mfma_f32_32x32x16_bf16 v[176:191], a[160:163], a[120:123], v[176:191]
ds_read_b64_tr_b16 a[180:181], v2 offset:56320
ds_read_b64_tr_b16 a[182:183], v2 offset:57600
v_mul_f32 v164, v93, v164
s_waitcnt lgkmcnt(8)
v_mfma_f32_32x32x16_bf16 v[192:207], a[164:167], a[120:123], v[192:207]
ds_read_b64_tr_b16 a[184:185], v3 offset:56320
ds_read_b64_tr_b16 a[186:187], v3 offset:57600
v_mul_f32 v165, v93, v165
s_waitcnt lgkmcnt(8)
v_mfma_f32_32x32x16_bf16 v[208:223], a[168:171], a[120:123], v[208:223]
ds_read_b64_tr_b16 a[188:189], v4 offset:56320
ds_read_b64_tr_b16 a[190:191], v4 offset:57600
v_mul_f32 v166, v93, v166
s_waitcnt lgkmcnt(8)
v_mfma_f32_32x32x16_bf16 v[224:239], a[172:175], a[120:123], v[224:239]
ds_read_b64_tr_b16 a[192:193], v5 offset:56320
ds_read_b64_tr_b16 a[194:195], v5 offset:57600
v_mul_f32 v167, v93, v167
s_waitcnt lgkmcnt(8)
v_mfma_f32_32x32x16_bf16 v[240:255], a[176:179], a[120:123], v[240:255]
ds_read_b64_tr_b16 a[196:197], v6 offset:56320
ds_read_b64_tr_b16 a[198:199], v6 offset:57600
v_mul_f32 v168, v93, v168
s_waitcnt vmcnt(9)
s_barrier
s_waitcnt lgkmcnt(8)
v_mfma_f32_32x32x16_bf16 v[176:191], a[180:183], a[124:127], v[176:191]
ds_read_b64_tr_b16 a[160:161], v7 offset:0
ds_read_b64_tr_b16 a[162:163], v7 offset:1280
v_mul_f32 v169, v93, v169
s_waitcnt lgkmcnt(8)
v_mfma_f32_32x32x16_bf16 v[192:207], a[184:187], a[124:127], v[192:207]
ds_read_b64_tr_b16 a[164:165], v8 offset:0
ds_read_b64_tr_b16 a[166:167], v8 offset:1280
v_mul_f32 v170, v93, v170
s_waitcnt lgkmcnt(8)
v_mfma_f32_32x32x16_bf16 v[208:223], a[188:191], a[124:127], v[208:223]
ds_read_b64_tr_b16 a[168:169], v9 offset:0
ds_read_b64_tr_b16 a[170:171], v9 offset:1280
v_mul_f32 v171, v93, v171
s_waitcnt lgkmcnt(8)
v_mfma_f32_32x32x16_bf16 v[224:239], a[192:195], a[124:127], v[224:239]
ds_read_b64_tr_b16 a[172:173], v10 offset:0
ds_read_b64_tr_b16 a[174:175], v10 offset:1280
v_cvt_pk_bf16_f32 v44, v164, v165
s_waitcnt lgkmcnt(8)
v_mfma_f32_32x32x16_bf16 v[240:255], a[196:199], a[124:127], v[240:255]
ds_read_b64_tr_b16 a[176:177], v11 offset:0
ds_read_b64_tr_b16 a[178:179], v11 offset:1280
v_cvt_pk_bf16_f32 v45, v166, v167
s_waitcnt lgkmcnt(8)
v_mfma_f32_32x32x16_bf16 v[176:191], a[160:163], a[128:131], v[176:191]
ds_read_b64_tr_b16 a[180:181], v7 offset:5120
ds_read_b64_tr_b16 a[182:183], v7 offset:6400
v_cvt_pk_bf16_f32 v46, v168, v169
s_waitcnt lgkmcnt(8)
v_mfma_f32_32x32x16_bf16 v[192:207], a[164:167], a[128:131], v[192:207]
ds_read_b64_tr_b16 a[184:185], v8 offset:5120
ds_read_b64_tr_b16 a[186:187], v8 offset:6400
ds_read_b32 v62, v95 offset:640
ds_read_b32 v63, v95 offset:768
v_cvt_pk_bf16_f32 v47, v170, v171
s_waitcnt lgkmcnt(10)
v_mfma_f32_32x32x16_bf16 v[208:223], a[168:171], a[128:131], v[208:223]
ds_read_b64_tr_b16 a[188:189], v9 offset:5120
ds_read_b64_tr_b16 a[190:191], v9 offset:6400
ds_read_b32 v64, v95 offset:896
ds_read_b32 v65, v95 offset:1024
s_add_u32 s28, s43, 458752
s_waitcnt lgkmcnt(12)
v_mfma_f32_32x32x16_bf16 v[224:239], a[172:175], a[128:131], v[224:239]
ds_read_b64_tr_b16 a[192:193], v10 offset:5120
ds_read_b64_tr_b16 a[194:195], v10 offset:6400
ds_read_b32 v66, v95 offset:1152
s_waitcnt lgkmcnt(8)
v_cvt_pk_bf16_f32 v52, v62, v62
buffer_store_dwordx4 v[44:47], v25, s[16:19], s28 offen sc1
v_mfma_f32_32x32x16_bf16 v[240:255], a[176:179], a[128:131], v[240:255]
ds_read_b64_tr_b16 a[196:197], v11 offset:5120
ds_read_b64_tr_b16 a[198:199], v11 offset:6400
v_and_b32 v53, 0xffff0000, v52
v_sub_f32 v53, v62, v53
v_mul_f32 v108, v93, v108
v_mfma_f32_32x32x16_bf16 v[176:191], a[180:183], a[132:135], v[176:191]
ds_read_b64_tr_b16 a[160:161], v7 offset:10240
ds_read_b64_tr_b16 a[162:163], v7 offset:11520
v_cvt_pk_bf16_f32 v53, v53, v53
s_waitcnt lgkmcnt(11)
v_cvt_pk_bf16_f32 v54, v63, v63
v_mul_f32 v109, v93, v109
v_mfma_f32_32x32x16_bf16 v[192:207], a[184:187], a[132:135], v[192:207]
ds_read_b64_tr_b16 a[164:165], v8 offset:10240
ds_read_b64_tr_b16 a[166:167], v8 offset:11520
v_and_b32 v55, 0xffff0000, v54
v_sub_f32 v55, v63, v55
v_mul_f32 v110, v93, v110
s_waitcnt lgkmcnt(11)
v_mfma_f32_32x32x16_bf16 v[208:223], a[188:191], a[132:135], v[208:223]
ds_read_b64_tr_b16 a[168:169], v9 offset:10240
ds_read_b64_tr_b16 a[170:171], v9 offset:11520
v_cvt_pk_bf16_f32 v55, v55, v55
s_waitcnt lgkmcnt(12)
v_cvt_pk_bf16_f32 v56, v64, v64
v_mul_f32 v111, v93, v111
s_waitcnt lgkmcnt(9)
v_mfma_f32_32x32x16_bf16 v[224:239], a[192:195], a[132:135], v[224:239]
ds_read_b64_tr_b16 a[172:173], v10 offset:10240
ds_read_b64_tr_b16 a[174:175], v10 offset:11520
v_and_b32 v57, 0xffff0000, v56
v_sub_f32 v57, v64, v57
v_cvt_pk_bf16_f32 v32, v108, v109
s_waitcnt lgkmcnt(8)
v_mfma_f32_32x32x16_bf16 v[240:255], a[196:199], a[132:135], v[240:255]
ds_read_b64_tr_b16 a[176:177], v11 offset:10240
ds_read_b64_tr_b16 a[178:179], v11 offset:11520
v_cvt_pk_bf16_f32 v57, v57, v57
v_cvt_pk_bf16_f32 v58, v65, v65
v_cvt_pk_bf16_f32 v33, v110, v111
s_waitcnt lgkmcnt(8)
v_mfma_f32_32x32x16_bf16 v[176:191], a[160:163], a[136:139], v[176:191]
ds_read_b64_tr_b16 a[180:181], v7 offset:15360
ds_read_b64_tr_b16 a[182:183], v7 offset:16640
v_and_b32 v59, 0xffff0000, v58
v_sub_f32 v59, v65, v59
s_add_u32 s28, s44, 0
s_waitcnt lgkmcnt(8)
v_mfma_f32_32x32x16_bf16 v[192:207], a[164:167], a[136:139], v[192:207]
ds_read_b64_tr_b16 a[184:185], v8 offset:15360
ds_read_b64_tr_b16 a[186:187], v8 offset:16640
v_cvt_pk_bf16_f32 v59, v59, v59
v_cvt_pk_bf16_f32 v60, v66, v66
buffer_store_dwordx2 v[32:33], v26, s[16:19], s28 offen sc1
s_waitcnt lgkmcnt(8)
v_mfma_f32_32x32x16_bf16 v[208:223], a[168:171], a[136:139], v[208:223]
ds_read_b64_tr_b16 a[188:189], v9 offset:15360
ds_read_b64_tr_b16 a[190:191], v9 offset:16640
v_and_b32 v61, 0xffff0000, v60
v_sub_f32 v61, v66, v61
v_mul_f32 v124, v93, v124
s_waitcnt lgkmcnt(8)
v_mfma_f32_32x32x16_bf16 v[224:239], a[172:175], a[136:139], v[224:239]
ds_read_b64_tr_b16 a[192:193], v10 offset:15360
ds_read_b64_tr_b16 a[194:195], v10 offset:16640
v_cvt_pk_bf16_f32 v61, v61, v61
v_mfma_f32_32x32x8_bf16 v[176:191], v[52:53], v[88:89], v[176:191]
v_mul_f32 v125, v93, v125
s_waitcnt lgkmcnt(8)
v_mfma_f32_32x32x16_bf16 v[240:255], a[176:179], a[136:139], v[240:255]
ds_read_b64_tr_b16 a[196:197], v11 offset:15360
ds_read_b64_tr_b16 a[198:199], v11 offset:16640
v_mfma_f32_32x32x8_bf16 v[192:207], v[54:55], v[88:89], v[192:207]
v_mfma_f32_32x32x8_bf16 v[208:223], v[56:57], v[88:89], v[208:223]
v_mul_f32 v126, v93, v126
s_waitcnt vmcnt(4)
s_barrier
s_waitcnt lgkmcnt(8)
v_mfma_f32_32x32x16_bf16 v[176:191], a[180:183], a[140:143], v[176:191]
ds_read_b64_tr_b16 a[160:161], v7 offset:20480
ds_read_b64_tr_b16 a[162:163], v7 offset:21760
v_mfma_f32_32x32x8_bf16 v[224:239], v[58:59], v[88:89], v[224:239]
v_mfma_f32_32x32x8_bf16 v[240:255], v[60:61], v[88:89], v[240:255]
v_mul_f32 v127, v93, v127
s_waitcnt lgkmcnt(8)
v_mfma_f32_32x32x16_bf16 v[192:207], a[184:187], a[140:143], v[192:207]
ds_read_b64_tr_b16 a[164:165], v8 offset:20480
ds_read_b64_tr_b16 a[166:167], v8 offset:21760
v_cvt_pk_bf16_f32 v36, v124, v125
s_waitcnt lgkmcnt(8)
v_mfma_f32_32x32x16_bf16 v[208:223], a[188:191], a[140:143], v[208:223]
ds_read_b64_tr_b16 a[168:169], v9 offset:20480
ds_read_b64_tr_b16 a[170:171], v9 offset:21760
v_cvt_pk_bf16_f32 v37, v126, v127
s_waitcnt lgkmcnt(8)
v_mfma_f32_32x32x16_bf16 v[224:239], a[192:195], a[140:143], v[224:239]
ds_read_b64_tr_b16 a[172:173], v10 offset:20480
ds_read_b64_tr_b16 a[174:175], v10 offset:21760
s_add_u32 s28, s44, 32768
s_waitcnt lgkmcnt(8)
v_mfma_f32_32x32x16_bf16 v[240:255], a[196:199], a[140:143], v[240:255]
ds_read_b64_tr_b16 a[176:177], v11 offset:20480
ds_read_b64_tr_b16 a[178:179], v11 offset:21760
buffer_store_dwordx2 v[36:37], v26, s[16:19], s28 offen sc1
s_waitcnt lgkmcnt(8)
v_mfma_f32_32x32x16_bf16 v[176:191], a[160:163], a[144:147], v[176:191]
ds_read_b64_tr_b16 a[180:181], v7 offset:25600
ds_read_b64_tr_b16 a[182:183], v7 offset:26880
v_mul_f32 v152, v93, v152
s_waitcnt lgkmcnt(8)
v_mfma_f32_32x32x16_bf16 v[192:207], a[164:167], a[144:147], v[192:207]
ds_read_b64_tr_b16 a[184:185], v8 offset:25600
ds_read_b64_tr_b16 a[186:187], v8 offset:26880
v_mul_f32 v153, v93, v153
s_waitcnt lgkmcnt(8)
v_mfma_f32_32x32x16_bf16 v[208:223], a[168:171], a[144:147], v[208:223]
ds_read_b64_tr_b16 a[188:189], v9 offset:25600
ds_read_b64_tr_b16 a[190:191], v9 offset:26880
v_mul_f32 v154, v93, v154
s_waitcnt lgkmcnt(8)
v_mfma_f32_32x32x16_bf16 v[224:239], a[172:175], a[144:147], v[224:239]
ds_read_b64_tr_b16 a[192:193], v10 offset:25600
ds_read_b64_tr_b16 a[194:195], v10 offset:26880
v_mul_f32 v155, v93, v155
s_waitcnt lgkmcnt(8)
v_mfma_f32_32x32x16_bf16 v[240:255], a[176:179], a[144:147], v[240:255]
ds_read_b64_tr_b16 a[196:197], v11 offset:25600
ds_read_b64_tr_b16 a[198:199], v11 offset:26880
v_cvt_pk_bf16_f32 v40, v152, v153
s_waitcnt lgkmcnt(8)
v_mfma_f32_32x32x16_bf16 v[176:191], a[180:183], a[148:151], v[176:191]
ds_read_b64_tr_b16 a[160:161], v7 offset:30720
ds_read_b64_tr_b16 a[162:163], v7 offset:32000
v_cvt_pk_bf16_f32 v41, v154, v155
s_waitcnt lgkmcnt(8)
v_mfma_f32_32x32x16_bf16 v[192:207], a[184:187], a[148:151], v[192:207]
ds_read_b64_tr_b16 a[164:165], v8 offset:30720
ds_read_b64_tr_b16 a[166:167], v8 offset:32000
s_add_u32 s28, s44, 65536
s_waitcnt lgkmcnt(8)
v_mfma_f32_32x32x16_bf16 v[208:223], a[188:191], a[148:151], v[208:223]
ds_read_b64_tr_b16 a[168:169], v9 offset:30720
ds_read_b64_tr_b16 a[170:171], v9 offset:32000
buffer_store_dwordx2 v[40:41], v26, s[16:19], s28 offen sc1
s_waitcnt lgkmcnt(8)
v_mfma_f32_32x32x16_bf16 v[224:239], a[192:195], a[148:151], v[224:239]
ds_read_b64_tr_b16 a[172:173], v10 offset:30720
ds_read_b64_tr_b16 a[174:175], v10 offset:32000
v_mul_f32 v172, v93, v172
s_waitcnt lgkmcnt(8)
v_mfma_f32_32x32x16_bf16 v[240:255], a[196:199], a[148:151], v[240:255]
ds_read_b64_tr_b16 a[176:177], v11 offset:30720
ds_read_b64_tr_b16 a[178:179], v11 offset:32000
v_mul_f32 v173, v93, v173
s_waitcnt lgkmcnt(8)
v_mfma_f32_32x32x16_bf16 v[176:191], a[160:163], a[152:155], v[176:191]
ds_read_b64_tr_b16 a[180:181], v7 offset:35840
ds_read_b64_tr_b16 a[182:183], v7 offset:37120
v_mul_f32 v174, v93, v174
s_waitcnt lgkmcnt(8)
v_mfma_f32_32x32x16_bf16 v[192:207], a[164:167], a[152:155], v[192:207]
ds_read_b64_tr_b16 a[184:185], v8 offset:35840
ds_read_b64_tr_b16 a[186:187], v8 offset:37120
v_mul_f32 v175, v93, v175
s_waitcnt lgkmcnt(8)
v_mfma_f32_32x32x16_bf16 v[208:223], a[168:171], a[152:155], v[208:223]
ds_read_b64_tr_b16 a[188:189], v9 offset:35840
ds_read_b64_tr_b16 a[190:191], v9 offset:37120
v_cvt_pk_bf16_f32 v44, v172, v173
s_waitcnt lgkmcnt(8)
v_mfma_f32_32x32x16_bf16 v[224:239], a[172:175], a[152:155], v[224:239]
ds_read_b64_tr_b16 a[192:193], v10 offset:35840
ds_read_b64_tr_b16 a[194:195], v10 offset:37120
v_cvt_pk_bf16_f32 v45, v174, v175
s_waitcnt lgkmcnt(8)
v_mfma_f32_32x32x16_bf16 v[240:255], a[176:179], a[152:155], v[240:255]
ds_read_b64_tr_b16 a[196:197], v11 offset:35840
ds_read_b64_tr_b16 a[198:199], v11 offset:37120
s_add_u32 s28, s44, 98304
s_waitcnt lgkmcnt(8)
v_mfma_f32_32x32x16_bf16 v[176:191], a[180:183], a[156:159], v[176:191]
buffer_store_dwordx2 v[44:45], v26, s[16:19], s28 offen sc1
s_waitcnt lgkmcnt(6)
v_mfma_f32_32x32x16_bf16 v[192:207], a[184:187], a[156:159], v[192:207]
s_waitcnt lgkmcnt(4)
v_mfma_f32_32x32x16_bf16 v[208:223], a[188:191], a[156:159], v[208:223]
s_waitcnt lgkmcnt(2)
v_mfma_f32_32x32x16_bf16 v[224:239], a[192:195], a[156:159], v[224:239]
s_waitcnt lgkmcnt(0)
v_mfma_f32_32x32x16_bf16 v[240:255], a[196:199], a[156:159], v[240:255]
s_nop 2
v_mul_f32 v176, v93, v176
v_mul_f32 v177, v93, v177
v_mul_f32 v178, v93, v178
v_mul_f32 v179, v93, v179
v_mul_f32 v180, v93, v180
v_mul_f32 v181, v93, v181
v_mul_f32 v182, v93, v182
v_mul_f32 v183, v93, v183
v_cvt_pk_bf16_f32 v32, v176, v177
v_cvt_pk_bf16_f32 v33, v178, v179
v_cvt_pk_bf16_f32 v34, v180, v181
v_cvt_pk_bf16_f32 v35, v182, v183
s_add_u32 s28, s46, 0
buffer_store_dwordx4 v[32:35], v25, s[16:19], s28 offen sc1
v_mul_f32 v184, v93, v184
v_mul_f32 v185, v93, v185
v_mul_f32 v186, v93, v186
v_mul_f32 v187, v93, v187
v_mul_f32 v192, v93, v192
v_mul_f32 v193, v93, v193
v_mul_f32 v194, v93, v194
v_mul_f32 v195, v93, v195
v_cvt_pk_bf16_f32 v36, v184, v185
v_cvt_pk_bf16_f32 v37, v186, v187
v_cvt_pk_bf16_f32 v38, v192, v193
v_cvt_pk_bf16_f32 v39, v194, v195
s_add_u32 s28, s46, 65536
buffer_store_dwordx4 v[36:39], v25, s[16:19], s28 offen sc1
v_mul_f32 v196, v93, v196
v_mul_f32 v197, v93, v197
v_mul_f32 v198, v93, v198
v_mul_f32 v199, v93, v199
v_mul_f32 v200, v93, v200
v_mul_f32 v201, v93, v201
v_mul_f32 v202, v93, v202
v_mul_f32 v203, v93, v203
v_cvt_pk_bf16_f32 v40, v196, v197
v_cvt_pk_bf16_f32 v41, v198, v199
v_cvt_pk_bf16_f32 v42, v200, v201
v_cvt_pk_bf16_f32 v43, v202, v203
s_add_u32 s28, s46, 131072
buffer_store_dwordx4 v[40:43], v25, s[16:19], s28 offen sc1
v_mul_f32 v208, v93, v208
v_mul_f32 v209, v93, v209
v_mul_f32 v210, v93, v210
v_mul_f32 v211, v93, v211
v_mul_f32 v212, v93, v212
v_mul_f32 v213, v93, v213
v_mul_f32 v214, v93, v214
v_mul_f32 v215, v93, v215
v_cvt_pk_bf16_f32 v44, v208, v209
v_cvt_pk_bf16_f32 v45, v210, v211
v_cvt_pk_bf16_f32 v46, v212, v213
v_cvt_pk_bf16_f32 v47, v214, v215
s_add_u32 s28, s46, 196608
buffer_store_dwordx4 v[44:47], v25, s[16:19], s28 offen sc1
v_mul_f32 v216, v93, v216
v_mul_f32 v217, v93, v217
v_mul_f32 v218, v93, v218
v_mul_f32 v219, v93, v219
v_mul_f32 v220, v93, v220
v_mul_f32 v221, v93, v221
v_mul_f32 v222, v93, v222
v_mul_f32 v223, v93, v223
v_cvt_pk_bf16_f32 v32, v216, v217
v_cvt_pk_bf16_f32 v33, v218, v219
v_cvt_pk_bf16_f32 v34, v220, v221
v_cvt_pk_bf16_f32 v35, v222, v223
s_add_u32 s28, s46, 262144
buffer_store_dwordx4 v[32:35], v25, s[16:19], s28 offen sc1
v_mul_f32 v224, v93, v224
v_mul_f32 v225, v93, v225
v_mul_f32 v226, v93, v226
v_mul_f32 v227, v93, v227
v_mul_f32 v228, v93, v228
v_mul_f32 v229, v93, v229
v_mul_f32 v230, v93, v230
v_mul_f32 v231, v93, v231
v_cvt_pk_bf16_f32 v36, v224, v225
v_cvt_pk_bf16_f32 v37, v226, v227
v_cvt_pk_bf16_f32 v38, v228, v229
v_cvt_pk_bf16_f32 v39, v230, v231
s_add_u32 s28, s46, 327680
buffer_store_dwordx4 v[36:39], v25, s[16:19], s28 offen sc1
v_mul_f32 v236, v93, v236
v_mul_f32 v237, v93, v237
v_mul_f32 v238, v93, v238
v_mul_f32 v239, v93, v239
v_mul_f32 v240, v93, v240
v_mul_f32 v241, v93, v241
v_mul_f32 v242, v93, v242
v_mul_f32 v243, v93, v243
v_cvt_pk_bf16_f32 v40, v236, v237
v_cvt_pk_bf16_f32 v41, v238, v239
v_cvt_pk_bf16_f32 v42, v240, v241
v_cvt_pk_bf16_f32 v43, v242, v243
s_add_u32 s28, s46, 393216
buffer_store_dwordx4 v[40:43], v25, s[16:19], s28 offen sc1
v_mul_f32 v244, v93, v244
v_mul_f32 v245, v93, v245
v_mul_f32 v246, v93, v246
v_mul_f32 v247, v93, v247
v_mul_f32 v248, v93, v248
v_mul_f32 v249, v93, v249
v_mul_f32 v250, v93, v250
v_mul_f32 v251, v93, v251
v_cvt_pk_bf16_f32 v44, v244, v245
v_cvt_pk_bf16_f32 v45, v246, v247
v_cvt_pk_bf16_f32 v46, v248, v249
v_cvt_pk_bf16_f32 v47, v250, v251
s_add_u32 s28, s46, 458752
buffer_store_dwordx4 v[44:47], v25, s[16:19], s28 offen sc1
v_mul_f32 v188, v93, v188
v_mul_f32 v189, v93, v189
v_mul_f32 v190, v93, v190
v_mul_f32 v191, v93, v191
v_cvt_pk_bf16_f32 v32, v188, v189
v_cvt_pk_bf16_f32 v33, v190, v191
s_add_u32 s28, s47, 0
buffer_store_dwordx2 v[32:33], v26, s[16:19], s28 offen sc1
v_mul_f32 v204, v93, v204
v_mul_f32 v205, v93, v205
v_mul_f32 v206, v93, v206
v_mul_f32 v207, v93, v207
v_cvt_pk_bf16_f32 v36, v204, v205
v_cvt_pk_bf16_f32 v37, v206, v207
s_add_u32 s28, s47, 32768
buffer_store_dwordx2 v[36:37], v26, s[16:19], s28 offen sc1
v_mul_f32 v232, v93, v232
v_mul_f32 v233, v93, v233
v_mul_f32 v234, v93, v234
v_mul_f32 v235, v93, v235
v_cvt_pk_bf16_f32 v40, v232, v233
v_cvt_pk_bf16_f32 v41, v234, v235
s_add_u32 s28, s47, 65536
buffer_store_dwordx2 v[40:41], v26, s[16:19], s28 offen sc1
v_mul_f32 v252, v93, v252
v_mul_f32 v253, v93, v253
v_mul_f32 v254, v93, v254
v_mul_f32 v255, v93, v255
v_cvt_pk_bf16_f32 v44, v252, v253
v_cvt_pk_bf16_f32 v45, v254, v255
s_add_u32 s28, s47, 98304
buffer_store_dwordx2 v[44:45], v26, s[16:19], s28 offen sc1
s_endpgm
K1_V:
s_nop 4
s_add_u32 m0, s60, 0
s_nop 0
buffer_load_dwordx4 v224, s[12:15], 0 offen offset:0 lds
v_and_b32 v32, 31, v1
v_lshrrev_b32 v33, 1, v32
v_and_b32 v33, 7, v33
v_lshrrev_b32 v34, 5, v1
v_lshlrev_b32 v32, 7, v32
v_add_u32 v32, s26, v32
v_add_u32 v35, 0, v34
v_xor_b32 v35, v35, v33
v_lshl_add_u32 v21, v35, 4, v32
v_add_u32 v35, 2, v34
v_xor_b32 v35, v35, v33
v_lshl_add_u32 v22, v35, 4, v32
v_add_u32 v35, 4, v34
buffer_load_dwordx4 v225, s[12:15], 0 offen offset:1024 lds
v_xor_b32 v35, v35, v33
v_lshl_add_u32 v23, v35, 4, v32
v_add_u32 v35, 6, v34
v_xor_b32 v35, v35, v33
v_lshl_add_u32 v24, v35, 4, v32
v_lshrrev_b32 v33, 5, v1
v_bfe_u32 v34, v1, 2, 2
v_lshl_add_u32 v36, v33, 3, v34
v_mul_u32_u24 v36, 320, v36
v_bfe_u32 v32, v1, 4, 1
v_and_b32 v35, 3, v1
v_lshl_add_u32 v35, v32, 2, v35
v_lshlrev_b32 v37, 2, v35
buffer_load_dwordx4 v226, s[12:15], 0 offen offset:2048 lds
s_mov_b32 s28, 1985229328
v_lshrrev_b32 v38, v37, s28
v_and_b32 v38, 15, v38
v_lshl_add_u32 v38, v38, 3, v36
v_add_u32 v2, 0, v38
v_add_u32 v7, 61440, v2
s_mov_b32 s28, 1985229328
v_lshrrev_b32 v38, v37, s28
v_and_b32 v38, 15, v38
v_lshl_add_u32 v38, v38, 3, v36
v_add_u32 v3, 64, v38
v_add_u32 v8, 61440, v3
s_mov_b32 s28, 1985229328
buffer_load_dwordx4 v227, s[12:15], 0 offen offset:3072 lds
v_lshrrev_b32 v38, v37, s28
v_and_b32 v38, 15, v38
v_lshl_add_u32 v38, v38, 3, v36
v_add_u32 v4, 128, v38
v_add_u32 v9, 61440, v4
s_mov_b32 s28, 1985229328
v_lshrrev_b32 v38, v37, s28
v_and_b32 v38, 15, v38
v_lshl_add_u32 v38, v38, 3, v36
v_add_u32 v5, 192, v38
v_add_u32 v10, 61440, v5
s_mov_b32 s28, 1985229328
v_lshrrev_b32 v38, v37, s28
s_add_u32 m0, s60, 4096
s_nop 0
buffer_load_dwordx4 v228, s[12:15], 0 offen offset:0 lds
v_and_b32 v38, 15, v38
v_lshl_add_u32 v38, v38, 3, v36
v_add_u32 v6, 256, v38
v_add_u32 v11, 61440, v6
v_lshrrev_b32 v33, 5, v1
v_bfe_u32 v34, v1, 2, 2
v_lshl_add_u32 v34, v33, 3, v34
v_mul_u32_u24 v34, 160, v34
v_bfe_u32 v32, v1, 4, 1
v_and_b32 v35, 3, v1
v_lshl_add_u32 v35, v32, 2, v35
v_lshl_add_u32 v34, v35, 3, v34
s_min_u32 s28, s20, 2
buffer_load_dwordx4 v229, s[12:15], 0 offen offset:1024 lds
s_lshl_b32 s29, s28, 6
s_add_u32 s29, s29, 81920
s_lshl_b32 s28, s20, 5
s_mul_i32 s30, s57, 80
v_add_u32 v232, s29, v34
s_lshl_b32 s31, s22, 2
s_add_u32 s31, s31, s56
s_mul_i32 s31, s31, 384
s_add_u32 s31, s31, s30
v_add_u32 v32, s28, v1
v_add_u32 v33, s31, v32
v_lshlrev_b32 v33, 2, v33
v_add_u32 v33, 30408704, v33
buffer_load_dwordx4 v230, s[12:15], 0 offen offset:2048 lds
v_mov_b32 v34, 2147483648
v_cmp_gt_u32 vcc, 80, v32
s_nop 1
v_cndmask_b32 v33, v34, v33, vcc
v_cmp_gt_u32 vcc, 32, v1
s_nop 1
v_cndmask_b32 v233, v34, v33, vcc
v_mov_b32 v208, 0x3f803f80
v_mov_b32 v209, 0x3f803f80
v_mov_b32 v210, 0x3f803f80
v_mov_b32 v211, 0x3f803f80
s_lshl_b32 s33, s22, 4
s_add_u32 s33, s33, s21
v_mov_b32 v32, s33
v_mov_b32 v33, 2147483648
s_add_u32 m0, s26, 4096
s_mov_b32 s24, 128
buffer_load_dwordx4 v17, s[8:11], s24 offen offset:0 lds
v_cmp_eq_u32 vcc, 0, v0
s_nop 1
v_cndmask_b32 v234, v33, v32, vcc
v_lshlrev_b32 v47, 2, v1
v_lshrrev_b32 v32, 2, v1
v_cmp_eq_u32 vcc, s22, v32
v_mov_b32 v33, 0x01010101
s_nop 0
v_cndmask_b32 v67, 0, v33, vcc
s_and_b32 s33, s21, 3
s_lshl_b32 s33, s33, 3
s_lshl_b32 s33, 1, s33
v_and_b32 v32, 3, v1
v_cmp_eq_u32 vcc, s57, v32
v_mov_b32 v33, s33
buffer_load_dwordx4 v18, s[8:11], s24 offen offset:1024 lds
v_cndmask_b32 v32, 0, v33, vcc
v_or_b32 v67, v67, v32
v_mov_b32 v32, 2147483648
v_cmp_gt_u32 vcc, 64, v0
s_nop 1
v_cndmask_b32 v47, v32, v47, vcc
v_cndmask_b32 v67, 0, v67, vcc
s_lshl_b32 s33, s21, 2
s_add_u32 s33, s33, s20
s_lshl_b32 s33, s33, 9
s_add_u32 s33, s33, 30539776
v_and_b32 v32, 31, v1
v_lshlrev_b32 v32, 4, v32
v_add_u32 v92, s33, v32
buffer_load_dwordx4 v19, s[8:11], s24 offen offset:2048 lds
s_lshl_b32 s33, s21, 2
s_add_u32 s33, s33, s20
s_lshl_b32 s33, s33, 7
s_add_u32 s33, s33, 30605312
v_lshrrev_b32 v32, 5, v1
v_lshlrev_b32 v32, 4, v32
v_add_u32 v66, s33, v32
v_subrev_u32 v33, 96, v0
v_cmp_gt_u32 vcc, 160, v0
s_nop 1
v_cndmask_b32 v32, v33, v0, vcc
v_mov_b32 v33, v32
s_mul_i32 s28, s22, 6144
s_add_u32 s28, s28, 30408704
buffer_load_dwordx4 v20, s[8:11], s24 offen offset:3072 lds
v_lshlrev_b32 v33, 2, v33
v_add_u32 v90, s28, v33
v_lshlrev_b32 v32, 2, v32
v_add_u32 v91, 102400, v32
v_and_b32 v32, 31, v1
v_lshlrev_b32 v32, 2, v32
v_add_u32 v95, 102400, v32
s_lshl_b32 s28, s21, 2
s_add_u32 s28, s28, s20
s_mul_i32 s29, s28, 1344
v_lshrrev_b32 v35, 5, v1
v_mul_u32_u24 v35, 336, v35
v_add_u32 v35, s29, v35
s_add_u32 m0, s25, 20480
s_add_u32 s32, s23, 245760
buffer_load_dwordx4 v12, s[12:15], s32 offen offset:0 lds
s_mov_b32 s30, 86016
v_bfe_u32 v32, v1, 2, 3
v_mul_lo_u32 v32, v32, s30
v_and_b32 v33, 3, v1
v_mul_u32_u24 v33, 336, v33
v_add_u32 v32, v32, v33
v_add_u32 v32, s29, v32
v_add_u32 v30, 320, v32
v_mov_b32 v48, 0x3f803f80
v_mov_b32 v49, 0x3f803f80
v_mov_b32 v50, 0x3f803f80
v_mov_b32 v51, 0x3f803f80
v_and_b32 v32, 31, v1
buffer_load_dwordx4 v13, s[12:15], s32 offen offset:1024 lds
v_add_u32 v32, 0, v32
v_mul_u32_u24 v33, 3277, v32
v_lshrrev_b32 v33, 16, v33
v_mul_u32_u24 v34, 20, v33
v_sub_u32 v34, v32, v34
v_mul_lo_u32 v33, v33, s30
v_lshl_add_u32 v33, v34, 4, v33
v_add_u32 v25, v33, v35
v_and_b32 v32, 31, v1
v_add_u32 v32, 32, v32
v_mul_u32_u24 v33, 3277, v32
v_lshrrev_b32 v33, 16, v33
v_mul_u32_u24 v34, 20, v33
buffer_load_dwordx4 v14, s[12:15], s32 offen offset:2048 lds
v_sub_u32 v34, v32, v34
v_mul_lo_u32 v33, v33, s30
v_lshl_add_u32 v33, v34, 4, v33
v_add_u32 v26, v33, v35
v_and_b32 v32, 31, v1
v_add_u32 v32, 64, v32
v_mul_u32_u24 v33, 3277, v32
v_lshrrev_b32 v33, 16, v33
v_mul_u32_u24 v34, 20, v33
v_sub_u32 v34, v32, v34
v_mul_lo_u32 v33, v33, s30
v_lshl_add_u32 v33, v34, 4, v33
v_add_u32 v27, v33, v35
buffer_load_dwordx4 v15, s[12:15], s32 offen offset:3072 lds
v_and_b32 v32, 31, v1
v_add_u32 v32, 96, v32
v_mul_u32_u24 v33, 3277, v32
v_lshrrev_b32 v33, 16, v33
v_mul_u32_u24 v34, 20, v33
v_sub_u32 v34, v32, v34
v_mul_lo_u32 v33, v33, s30
v_lshl_add_u32 v33, v34, 4, v33
v_add_u32 v28, v33, v35
v_and_b32 v32, 31, v1
v_add_u32 v32, 128, v32
v_mul_u32_u24 v33, 3277, v32
v_lshrrev_b32 v33, 16, v33
s_add_u32 m0, s25, 24576
s_add_u32 s32, s23, 245760
buffer_load_dwordx4 v16, s[12:15], s32 offen lds
v_mul_u32_u24 v34, 20, v33
v_sub_u32 v34, v32, v34
v_mul_lo_u32 v33, v33, s30
v_lshl_add_u32 v33, v34, 4, v33
v_add_u32 v29, v33, v35
s_waitcnt vmcnt(20)
v_lshlrev_b32 v240, 16, v176
v_and_b32 v241, 0xffff0000, v176
v_lshlrev_b32 v242, 16, v177
v_and_b32 v243, 0xffff0000, v177
s_waitcnt vmcnt(19)
v_lshlrev_b32 v244, 16, v178
v_and_b32 v245, 0xffff0000, v178
v_lshlrev_b32 v246, 16, v179
v_and_b32 v247, 0xffff0000, v179
s_waitcnt vmcnt(18)
v_lshlrev_b32 v248, 16, v180
v_and_b32 v249, 0xffff0000, v180
v_add_f32 v250, v240, v241
v_mul_f32 v251, v240, v240
v_fmac_f32 v251, v241, v241
v_add_f32 v250, v250, v242
v_fmac_f32 v251, v242, v242
v_add_f32 v250, v250, v243
v_fmac_f32 v251, v243, v243
v_add_f32 v250, v250, v244
v_fmac_f32 v251, v244, v244
v_add_f32 v250, v250, v245
v_fmac_f32 v251, v245, v245
v_add_f32 v250, v250, v246
v_fmac_f32 v251, v246, v246
v_add_f32 v250, v250, v247
v_fmac_f32 v251, v247, v247
v_add_f32 v250, v250, v248
v_fmac_f32 v251, v248, v248
v_add_f32 v250, v250, v249
v_fmac_f32 v251, v249, v249
v_lshlrev_b32 v240, 16, v181
v_and_b32 v241, 0xffff0000, v181
s_waitcnt vmcnt(17)
v_lshlrev_b32 v242, 16, v182
v_and_b32 v243, 0xffff0000, v182
v_lshlrev_b32 v244, 16, v183
v_and_b32 v245, 0xffff0000, v183
s_waitcnt vmcnt(16)
v_lshlrev_b32 v246, 16, v184
v_and_b32 v247, 0xffff0000, v184
v_lshlrev_b32 v248, 16, v185
v_and_b32 v249, 0xffff0000, v185
v_add_f32 v250, v250, v240
v_fmac_f32 v251, v240, v240
v_add_f32 v250, v250, v241
v_fmac_f32 v251, v241, v241
v_add_f32 v250, v250, v242
v_fmac_f32 v251, v242, v242
v_add_f32 v250, v250, v243
v_fmac_f32 v251, v243, v243
v_add_f32 v250, v250, v244
v_fmac_f32 v251, v244, v244
v_add_f32 v250, v250, v245
v_fmac_f32 v251, v245, v245
v_add_f32 v250, v250, v246
v_fmac_f32 v251, v246, v246
v_add_f32 v250, v250, v247
v_fmac_f32 v251, v247, v247
v_add_f32 v250, v250, v248
v_fmac_f32 v251, v248, v248
v_add_f32 v250, v250, v249
v_fmac_f32 v251, v249, v249
s_nop 0
v_add_f32_dpp v250, v250, v250 row_ror:8 row_mask:0xf bank_mask:0xf
v_add_f32_dpp v251, v251, v251 row_ror:8 row_mask:0xf bank_mask:0xf
s_nop 0
v_add_f32_dpp v250, v250, v250 row_ror:4 row_mask:0xf bank_mask:0xf
v_add_f32_dpp v251, v251, v251 row_ror:4 row_mask:0xf bank_mask:0xf
s_nop 0
v_add_f32_dpp v250, v250, v250 row_ror:2 row_mask:0xf bank_mask:0xf
v_add_f32_dpp v251, v251, v251 row_ror:2 row_mask:0xf bank_mask:0xf
s_nop 0
v_add_f32_dpp v250, v250, v250 row_ror:1 row_mask:0xf bank_mask:0xf
v_add_f32_dpp v251, v251, v251 row_ror:1 row_mask:0xf bank_mask:0xf
ds_swizzle_b32 v252, v250 offset:16415
ds_swizzle_b32 v253, v251 offset:16415
v_and_b32 v254, 31, v1
v_cmp_eq_u32 vcc, 0, v254
v_mov_b32 v254, 2147483648
v_lshlrev_b32 v235, 4, v238
v_add_u32 v235, 30539776, v235
v_cndmask_b32 v235, v254, v235, vcc
v_lshlrev_b32 v236, 2, v238
v_add_u32 v236, 30605312, v236
v_cndmask_b32 v236, v254, v236, vcc
s_waitcnt lgkmcnt(1)
v_add_f32 v250, v250, v252
s_waitcnt lgkmcnt(0)
v_add_f32 v251, v251, v253
v_mul_f32 v240, 0xbacccccd, v250
v_mul_f32 v252, v240, v240
v_mov_b32 v253, 0x3acccccd
v_fma_f32 v252, v251, v253, -v252
v_max_f32 v252, 0, v252
v_add_f32 v252, 0x3727c5ac, v252
v_rsq_f32 v241, v252
v_sqrt_f32 v242, v252
v_mov_b32 v243, 0
buffer_store_dwordx4 v[240:243], v235, s[16:19], 0 offen sc1
buffer_store_dword v241, v236, s[16:19], 0 offen sc1
s_and_b32 s42, s22, 1
s_lshl_b32 s42, s42, 4
s_mul_i32 s43, s42, 86016
s_add_u32 s43, s43, 12582912
s_add_u32 s44, s43, 688128
s_barrier
ds_read_b128 a[0:3], v21 offset:0
ds_read_b128 a[4:7], v22 offset:0
ds_read_b128 a[8:11], v23 offset:0
ds_read_b128 a[12:15], v24 offset:0
ds_read_b64_tr_b16 a[160:161], v2 offset:0
ds_read_b64_tr_b16 a[162:163], v2 offset:1280
ds_read_b64_tr_b16 a[164:165], v3 offset:0
ds_read_b64_tr_b16 a[166:167], v3 offset:1280
ds_read_b64_tr_b16 a[168:169], v4 offset:0
ds_read_b64_tr_b16 a[170:171], v4 offset:1280
ds_read_b64_tr_b16 a[172:173], v5 offset:0
ds_read_b64_tr_b16 a[174:175], v5 offset:1280
ds_read_b64_tr_b16 a[176:177], v6 offset:0
ds_read_b64_tr_b16 a[178:179], v6 offset:1280
s_waitcnt lgkmcnt(8)
v_mfma_f32_32x32x16_bf16 v[96:111], a[0:3], a[160:163], 0
ds_read_b64_tr_b16 a[180:181], v2 offset:5120
ds_read_b64_tr_b16 a[182:183], v2 offset:6400
s_waitcnt lgkmcnt(8)
v_mfma_f32_32x32x16_bf16 v[112:127], a[0:3], a[164:167], 0
ds_read_b64_tr_b16 a[184:185], v3 offset:5120
ds_read_b64_tr_b16 a[186:187], v3 offset:6400
s_add_u32 m0, s26, 8192
s_mov_b32 s24, 256
buffer_load_dwordx4 v17, s[8:11], s24 offen offset:0 lds
buffer_load_dwordx4 v18, s[8:11], s24 offen offset:1024 lds
s_waitcnt lgkmcnt(8)
v_mfma_f32_32x32x16_bf16 v[128:143], a[0:3], a[168:171], 0
ds_read_b64_tr_b16 a[188:189], v4 offset:5120
ds_read_b64_tr_b16 a[190:191], v4 offset:6400
buffer_load_dwordx4 v19, s[8:11], s24 offen offset:2048 lds
buffer_load_dwordx4 v20, s[8:11], s24 offen offset:3072 lds
s_waitcnt lgkmcnt(8)
v_mfma_f32_32x32x16_bf16 v[144:159], a[0:3], a[172:175], 0
ds_read_b64_tr_b16 a[192:193], v5 offset:5120
ds_read_b64_tr_b16 a[194:195], v5 offset:6400
s_add_u32 m0, s25, 40960
s_add_u32 s32, s23, 491520
buffer_load_dwordx4 v12, s[12:15], s32 offen offset:0 lds
buffer_load_dwordx4 v13, s[12:15], s32 offen offset:1024 lds
s_waitcnt lgkmcnt(8)
v_mfma_f32_32x32x16_bf16 v[160:175], a[0:3], a[176:179], 0
ds_read_b64_tr_b16 a[196:197], v6 offset:5120
ds_read_b64_tr_b16 a[198:199], v6 offset:6400
buffer_load_dwordx4 v14, s[12:15], s32 offen offset:2048 lds
buffer_load_dwordx4 v15, s[12:15], s32 offen offset:3072 lds
s_waitcnt lgkmcnt(8)
v_mfma_f32_32x32x16_bf16 v[96:111], a[4:7], a[180:183], v[96:111]
ds_read_b64_tr_b16 a[160:161], v2 offset:10240
ds_read_b64_tr_b16 a[162:163], v2 offset:11520
s_add_u32 m0, s25, 45056
s_add_u32 s32, s23, 491520
buffer_load_dwordx4 v16, s[12:15], s32 offen lds
s_add_u32 m0, s26, 0
s_mov_b32 s24, 384
buffer_load_dwordx4 v17, s[8:11], s24 offen offset:0 lds
s_waitcnt lgkmcnt(8)
v_mfma_f32_32x32x16_bf16 v[112:127], a[4:7], a[184:187], v[112:127]
ds_read_b64_tr_b16 a[164:165], v3 offset:10240
ds_read_b64_tr_b16 a[166:167], v3 offset:11520
buffer_load_dwordx4 v18, s[8:11], s24 offen offset:1024 lds
buffer_load_dwordx4 v19, s[8:11], s24 offen offset:2048 lds
s_waitcnt lgkmcnt(8)
v_mfma_f32_32x32x16_bf16 v[128:143], a[4:7], a[188:191], v[128:143]
ds_read_b64_tr_b16 a[168:169], v4 offset:10240
ds_read_b64_tr_b16 a[170:171], v4 offset:11520
buffer_load_dwordx4 v20, s[8:11], s24 offen offset:3072 lds
s_add_u32 m0, s25, 61440
s_add_u32 s32, s23, 737280
buffer_load_dwordx4 v12, s[12:15], s32 offen offset:0 lds
s_waitcnt lgkmcnt(8)
v_mfma_f32_32x32x16_bf16 v[144:159], a[4:7], a[192:195], v[144:159]
ds_read_b64_tr_b16 a[172:173], v5 offset:10240
ds_read_b64_tr_b16 a[174:175], v5 offset:11520
buffer_load_dwordx4 v13, s[12:15], s32 offen offset:1024 lds
buffer_load_dwordx4 v14, s[12:15], s32 offen offset:2048 lds
s_waitcnt lgkmcnt(8)
v_mfma_f32_32x32x16_bf16 v[160:175], a[4:7], a[196:199], v[160:175]
ds_read_b64_tr_b16 a[176:177], v6 offset:10240
ds_read_b64_tr_b16 a[178:179], v6 offset:11520
buffer_load_dwordx4 v15, s[12:15], s32 offen offset:3072 lds
s_add_u32 m0, s25, 65536
s_add_u32 s32, s23, 737280
buffer_load_dwordx4 v16, s[12:15], s32 offen lds
s_waitcnt lgkmcnt(8)
v_mfma_f32_32x32x16_bf16 v[96:111], a[8:11], a[160:163], v[96:111]
ds_read_b64_tr_b16 a[180:181], v2 offset:15360
ds_read_b64_tr_b16 a[182:183], v2 offset:16640
s_waitcnt lgkmcnt(8)
v_mfma_f32_32x32x16_bf16 v[112:127], a[8:11], a[164:167], v[112:127]
ds_read_b64_tr_b16 a[184:185], v3 offset:15360
ds_read_b64_tr_b16 a[186:187], v3 offset:16640
s_waitcnt lgkmcnt(8)
v_mfma_f32_32x32x16_bf16 v[128:143], a[8:11], a[168:171], v[128:143]
ds_read_b64_tr_b16 a[188:189], v4 offset:15360
ds_read_b64_tr_b16 a[190:191], v4 offset:16640
s_waitcnt lgkmcnt(8)
v_mfma_f32_32x32x16_bf16 v[144:159], a[8:11], a[172:175], v[144:159]
ds_read_b64_tr_b16 a[192:193], v5 offset:15360
ds_read_b64_tr_b16 a[194:195], v5 offset:16640
s_waitcnt lgkmcnt(8)
v_mfma_f32_32x32x16_bf16 v[160:175], a[8:11], a[176:179], v[160:175]
ds_read_b64_tr_b16 a[196:197], v6 offset:15360
ds_read_b64_tr_b16 a[198:199], v6 offset:16640
s_waitcnt vmcnt(20)
s_barrier
ds_read_b128 a[16:19], v21 offset:4096
ds_read_b128 a[20:23], v22 offset:4096
ds_read_b128 a[24:27], v23 offset:4096
ds_read_b128 a[28:31], v24 offset:4096
s_waitcnt lgkmcnt(12)
v_mfma_f32_32x32x16_bf16 v[96:111], a[12:15], a[180:183], v[96:111]
ds_read_b64_tr_b16 a[160:161], v2 offset:20480
ds_read_b64_tr_b16 a[162:163], v2 offset:21760
s_waitcnt lgkmcnt(12)
v_mfma_f32_32x32x16_bf16 v[112:127], a[12:15], a[184:187], v[112:127]
ds_read_b64_tr_b16 a[164:165], v3 offset:20480
ds_read_b64_tr_b16 a[166:167], v3 offset:21760
s_waitcnt lgkmcnt(12)
v_mfma_f32_32x32x16_bf16 v[128:143], a[12:15], a[188:191], v[128:143]
ds_read_b64_tr_b16 a[168:169], v4 offset:20480
ds_read_b64_tr_b16 a[170:171], v4 offset:21760
s_waitcnt lgkmcnt(12)
v_mfma_f32_32x32x16_bf16 v[144:159], a[12:15], a[192:195], v[144:159]
ds_read_b64_tr_b16 a[172:173], v5 offset:20480
ds_read_b64_tr_b16 a[174:175], v5 offset:21760
s_waitcnt lgkmcnt(12)
v_mfma_f32_32x32x16_bf16 v[160:175], a[12:15], a[196:199], v[160:175]
ds_read_b64_tr_b16 a[176:177], v6 offset:20480
ds_read_b64_tr_b16 a[178:179], v6 offset:21760
s_waitcnt lgkmcnt(8)
v_mfma_f32_32x32x16_bf16 v[96:111], a[16:19], a[160:163], v[96:111]
ds_read_b64_tr_b16 a[180:181], v2 offset:25600
ds_read_b64_tr_b16 a[182:183], v2 offset:26880
s_waitcnt lgkmcnt(8)
v_mfma_f32_32x32x16_bf16 v[112:127], a[16:19], a[164:167], v[112:127]
ds_read_b64_tr_b16 a[184:185], v3 offset:25600
ds_read_b64_tr_b16 a[186:187], v3 offset:26880
s_add_u32 m0, s26, 4096
s_mov_b32 s24, 512
buffer_load_dwordx4 v17, s[8:11], s24 offen offset:0 lds
s_waitcnt lgkmcnt(8)
v_mfma_f32_32x32x16_bf16 v[128:143], a[16:19], a[168:171], v[128:143]
ds_read_b64_tr_b16 a[188:189], v4 offset:25600
ds_read_b64_tr_b16 a[190:191], v4 offset:26880
buffer_load_dwordx4 v18, s[8:11], s24 offen offset:1024 lds
ds_read_b64_tr_b16 v[212:213], v232 offset:0
ds_read_b64_tr_b16 v[214:215], v232 offset:640
s_waitcnt lgkmcnt(10)
v_mfma_f32_32x32x16_bf16 v[144:159], a[16:19], a[172:175], v[144:159]
ds_read_b64_tr_b16 a[192:193], v5 offset:25600
ds_read_b64_tr_b16 a[194:195], v5 offset:26880
buffer_load_dwordx4 v19, s[8:11], s24 offen offset:2048 lds
ds_read_b64_tr_b16 v[216:217], v232 offset:2560
ds_read_b64_tr_b16 v[218:219], v232 offset:3200
s_waitcnt lgkmcnt(4)
v_mfma_f32_32x32x16_bf16 v[192:207], v[208:211], v[212:215], 0
v_mfma_f32_32x32x16_bf16 v[160:175], a[16:19], a[176:179], v[160:175]
ds_read_b64_tr_b16 a[196:197], v6 offset:25600
ds_read_b64_tr_b16 a[198:199], v6 offset:26880
buffer_load_dwordx4 v20, s[8:11], s24 offen offset:3072 lds
ds_read_b64_tr_b16 v[212:213], v232 offset:5120
ds_read_b64_tr_b16 v[214:215], v232 offset:5760
s_waitcnt lgkmcnt(4)
v_mfma_f32_32x32x16_bf16 v[192:207], v[208:211], v[216:219], v[192:207]
v_mfma_f32_32x32x16_bf16 v[96:111], a[20:23], a[180:183], v[96:111]
ds_read_b64_tr_b16 a[160:161], v2 offset:30720
ds_read_b64_tr_b16 a[162:163], v2 offset:32000
ds_read_b64_tr_b16 v[216:217], v232 offset:7680
ds_read_b64_tr_b16 v[218:219], v232 offset:8320
s_waitcnt lgkmcnt(4)
v_mfma_f32_32x32x16_bf16 v[192:207], v[208:211], v[212:215], v[192:207]
v_mfma_f32_32x32x16_bf16 v[112:127], a[20:23], a[184:187], v[112:127]
ds_read_b64_tr_b16 a[164:165], v3 offset:30720
ds_read_b64_tr_b16 a[166:167], v3 offset:32000
ds_read_b64_tr_b16 v[212:213], v232 offset:10240
ds_read_b64_tr_b16 v[214:215], v232 offset:10880
s_waitcnt lgkmcnt(4)
v_mfma_f32_32x32x16_bf16 v[192:207], v[208:211], v[216:219], v[192:207]
v_mfma_f32_32x32x16_bf16 v[128:143], a[20:23], a[188:191], v[128:143]
ds_read_b64_tr_b16 a[168:169], v4 offset:30720
ds_read_b64_tr_b16 a[170:171], v4 offset:32000
ds_read_b64_tr_b16 v[216:217], v232 offset:12800
ds_read_b64_tr_b16 v[218:219], v232 offset:13440
s_waitcnt lgkmcnt(4)
v_mfma_f32_32x32x16_bf16 v[192:207], v[208:211], v[212:215], v[192:207]
v_mfma_f32_32x32x16_bf16 v[144:159], a[20:23], a[192:195], v[144:159]
ds_read_b64_tr_b16 a[172:173], v5 offset:30720
ds_read_b64_tr_b16 a[174:175], v5 offset:32000
ds_read_b64_tr_b16 v[212:213], v232 offset:15360
ds_read_b64_tr_b16 v[214:215], v232 offset:16000
s_waitcnt lgkmcnt(4)
v_mfma_f32_32x32x16_bf16 v[192:207], v[208:211], v[216:219], v[192:207]
v_mfma_f32_32x32x16_bf16 v[160:175], a[20:23], a[196:199], v[160:175]
ds_read_b64_tr_b16 a[176:177], v6 offset:30720
ds_read_b64_tr_b16 a[178:179], v6 offset:32000
ds_read_b64_tr_b16 v[216:217], v232 offset:17920
ds_read_b64_tr_b16 v[218:219], v232 offset:18560
s_waitcnt lgkmcnt(4)
v_mfma_f32_32x32x16_bf16 v[192:207], v[208:211], v[212:215], v[192:207]
v_mfma_f32_32x32x16_bf16 v[96:111], a[24:27], a[160:163], v[96:111]
ds_read_b64_tr_b16 a[180:181], v2 offset:35840
ds_read_b64_tr_b16 a[182:183], v2 offset:37120
ds_read_b64_tr_b16 v[212:213], v232 offset:20480
ds_read_b64_tr_b16 v[214:215], v232 offset:21120
s_waitcnt lgkmcnt(4)
v_mfma_f32_32x32x16_bf16 v[192:207], v[208:211], v[216:219], v[192:207]
v_mfma_f32_32x32x16_bf16 v[112:127], a[24:27], a[164:167], v[112:127]
ds_read_b64_tr_b16 a[184:185], v3 offset:35840
ds_read_b64_tr_b16 a[186:187], v3 offset:37120
ds_read_b64_tr_b16 v[216:217], v232 offset:23040
ds_read_b64_tr_b16 v[218:219], v232 offset:23680
s_waitcnt lgkmcnt(4)
v_mfma_f32_32x32x16_bf16 v[192:207], v[208:211], v[212:215], v[192:207]
v_mfma_f32_32x32x16_bf16 v[128:143], a[24:27], a[168:171], v[128:143]
ds_read_b64_tr_b16 a[188:189], v4 offset:35840
ds_read_b64_tr_b16 a[190:191], v4 offset:37120
s_waitcnt lgkmcnt(2)
v_mfma_f32_32x32x16_bf16 v[192:207], v[208:211], v[216:219], v[192:207]
v_mfma_f32_32x32x16_bf16 v[144:159], a[24:27], a[172:175], v[144:159]
ds_read_b64_tr_b16 a[192:193], v5 offset:35840
ds_read_b64_tr_b16 a[194:195], v5 offset:37120
v_mfma_f32_32x32x16_bf16 v[160:175], a[24:27], a[176:179], v[160:175]
ds_read_b64_tr_b16 a[196:197], v6 offset:35840
ds_read_b64_tr_b16 a[198:199], v6 offset:37120
s_waitcnt vmcnt(13)
s_barrier
ds_read_b128 a[32:35], v21 offset:8192
ds_read_b128 a[36:39], v22 offset:8192
ds_read_b128 a[40:43], v23 offset:8192
ds_read_b128 a[44:47], v24 offset:8192
v_mfma_f32_32x32x16_bf16 v[96:111], a[28:31], a[180:183], v[96:111]
ds_read_b64_tr_b16 a[160:161], v2 offset:40960
ds_read_b64_tr_b16 a[162:163], v2 offset:42240
v_mfma_f32_32x32x16_bf16 v[112:127], a[28:31], a[184:187], v[112:127]
ds_read_b64_tr_b16 a[164:165], v3 offset:40960
ds_read_b64_tr_b16 a[166:167], v3 offset:42240
s_waitcnt lgkmcnt(12)
v_mfma_f32_32x32x16_bf16 v[128:143], a[28:31], a[188:191], v[128:143]
ds_read_b64_tr_b16 a[168:169], v4 offset:40960
ds_read_b64_tr_b16 a[170:171], v4 offset:42240
s_waitcnt lgkmcnt(12)
v_mfma_f32_32x32x16_bf16 v[144:159], a[28:31], a[192:195], v[144:159]
ds_read_b64_tr_b16 a[172:173], v5 offset:40960
ds_read_b64_tr_b16 a[174:175], v5 offset:42240
s_waitcnt lgkmcnt(12)
v_mfma_f32_32x32x16_bf16 v[160:175], a[28:31], a[196:199], v[160:175]
ds_read_b64_tr_b16 a[176:177], v6 offset:40960
ds_read_b64_tr_b16 a[178:179], v6 offset:42240
buffer_store_dword v192, v233, s[16:19], 0 offen sc1
s_waitcnt lgkmcnt(8)
v_mfma_f32_32x32x16_bf16 v[96:111], a[32:35], a[160:163], v[96:111]
ds_read_b64_tr_b16 a[180:181], v2 offset:46080
ds_read_b64_tr_b16 a[182:183], v2 offset:47360
s_waitcnt lgkmcnt(8)
v_mfma_f32_32x32x16_bf16 v[112:127], a[32:35], a[164:167], v[112:127]
ds_read_b64_tr_b16 a[184:185], v3 offset:46080
ds_read_b64_tr_b16 a[186:187], v3 offset:47360
s_add_u32 m0, s26, 8192
s_mov_b32 s24, 640
buffer_load_dwordx4 v17, s[8:11], s24 offen offset:0 lds
buffer_load_dwordx4 v18, s[8:11], s24 offen offset:1024 lds
s_waitcnt lgkmcnt(8)
v_mfma_f32_32x32x16_bf16 v[128:143], a[32:35], a[168:171], v[128:143]
ds_read_b64_tr_b16 a[188:189], v4 offset:46080
ds_read_b64_tr_b16 a[190:191], v4 offset:47360
buffer_load_dwordx4 v19, s[8:11], s24 offen offset:2048 lds
buffer_load_dwordx4 v20, s[8:11], s24 offen offset:3072 lds
s_waitcnt lgkmcnt(8)
v_mfma_f32_32x32x16_bf16 v[144:159], a[32:35], a[172:175], v[144:159]
ds_read_b64_tr_b16 a[192:193], v5 offset:46080
ds_read_b64_tr_b16 a[194:195], v5 offset:47360
s_add_u32 m0, s25, 81920
s_add_u32 s32, s23, 983040
buffer_load_dwordx4 v12, s[12:15], s32 offen offset:0 lds
buffer_load_dwordx4 v13, s[12:15], s32 offen offset:1024 lds
s_waitcnt lgkmcnt(8)
v_mfma_f32_32x32x16_bf16 v[160:175], a[32:35], a[176:179], v[160:175]
ds_read_b64_tr_b16 a[196:197], v6 offset:46080
ds_read_b64_tr_b16 a[198:199], v6 offset:47360
buffer_load_dwordx4 v14, s[12:15], s32 offen offset:2048 lds
buffer_load_dwordx4 v15, s[12:15], s32 offen offset:3072 lds
s_waitcnt lgkmcnt(8)
v_mfma_f32_32x32x16_bf16 v[96:111], a[36:39], a[180:183], v[96:111]
ds_read_b64_tr_b16 a[160:161], v2 offset:51200
ds_read_b64_tr_b16 a[162:163], v2 offset:52480
s_add_u32 m0, s25, 86016
s_add_u32 s32, s23, 983040
buffer_load_dwordx4 v16, s[12:15], s32 offen lds
s_add_u32 m0, s25, 0
s_add_u32 s32, s23, 1228800
buffer_load_dwordx4 v12, s[12:15], s32 offen offset:0 lds
s_waitcnt lgkmcnt(8)
v_mfma_f32_32x32x16_bf16 v[112:127], a[36:39], a[184:187], v[112:127]
ds_read_b64_tr_b16 a[164:165], v3 offset:51200
ds_read_b64_tr_b16 a[166:167], v3 offset:52480
buffer_load_dwordx4 v13, s[12:15], s32 offen offset:1024 lds
buffer_load_dwordx4 v14, s[12:15], s32 offen offset:2048 lds
s_waitcnt lgkmcnt(8)
v_mfma_f32_32x32x16_bf16 v[128:143], a[36:39], a[188:191], v[128:143]
ds_read_b64_tr_b16 a[168:169], v4 offset:51200
ds_read_b64_tr_b16 a[170:171], v4 offset:52480
buffer_load_dwordx4 v15, s[12:15], s32 offen offset:3072 lds
s_add_u32 m0, s25, 4096
s_add_u32 s32, s23, 1228800
buffer_load_dwordx4 v16, s[12:15], s32 offen lds
s_waitcnt lgkmcnt(8)
v_mfma_f32_32x32x16_bf16 v[144:159], a[36:39], a[192:195], v[144:159]
ds_read_b64_tr_b16 a[172:173], v5 offset:51200
ds_read_b64_tr_b16 a[174:175], v5 offset:52480
s_waitcnt lgkmcnt(8)
v_mfma_f32_32x32x16_bf16 v[160:175], a[36:39], a[196:199], v[160:175]
ds_read_b64_tr_b16 a[176:177], v6 offset:51200
ds_read_b64_tr_b16 a[178:179], v6 offset:52480
s_waitcnt lgkmcnt(8)
v_mfma_f32_32x32x16_bf16 v[96:111], a[40:43], a[160:163], v[96:111]
ds_read_b64_tr_b16 a[180:181], v2 offset:56320
ds_read_b64_tr_b16 a[182:183], v2 offset:57600
s_waitcnt lgkmcnt(8)
v_mfma_f32_32x32x16_bf16 v[112:127], a[40:43], a[164:167], v[112:127]
ds_read_b64_tr_b16 a[184:185], v3 offset:56320
ds_read_b64_tr_b16 a[186:187], v3 offset:57600
s_waitcnt lgkmcnt(8)
v_mfma_f32_32x32x16_bf16 v[128:143], a[40:43], a[168:171], v[128:143]
ds_read_b64_tr_b16 a[188:189], v4 offset:56320
ds_read_b64_tr_b16 a[190:191], v4 offset:57600
s_waitcnt lgkmcnt(8)
v_mfma_f32_32x32x16_bf16 v[144:159], a[40:43], a[172:175], v[144:159]
ds_read_b64_tr_b16 a[192:193], v5 offset:56320
ds_read_b64_tr_b16 a[194:195], v5 offset:57600
s_waitcnt lgkmcnt(8)
v_mfma_f32_32x32x16_bf16 v[160:175], a[40:43], a[176:179], v[160:175]
ds_read_b64_tr_b16 a[196:197], v6 offset:56320
ds_read_b64_tr_b16 a[198:199], v6 offset:57600
s_waitcnt vmcnt(19)
s_barrier
ds_read_b128 a[48:51], v21 offset:0
ds_read_b128 a[52:55], v22 offset:0
ds_read_b128 a[56:59], v23 offset:0
ds_read_b128 a[60:63], v24 offset:0
s_waitcnt lgkmcnt(12)
v_mfma_f32_32x32x16_bf16 v[96:111], a[44:47], a[180:183], v[96:111]
ds_read_b64_tr_b16 a[160:161], v7 offset:0
ds_read_b64_tr_b16 a[162:163], v7 offset:1280
s_waitcnt lgkmcnt(12)
v_mfma_f32_32x32x16_bf16 v[112:127], a[44:47], a[184:187], v[112:127]
ds_read_b64_tr_b16 a[164:165], v8 offset:0
ds_read_b64_tr_b16 a[166:167], v8 offset:1280
s_waitcnt lgkmcnt(12)
v_mfma_f32_32x32x16_bf16 v[128:143], a[44:47], a[188:191], v[128:143]
ds_read_b64_tr_b16 a[168:169], v9 offset:0
ds_read_b64_tr_b16 a[170:171], v9 offset:1280
s_waitcnt lgkmcnt(12)
v_mfma_f32_32x32x16_bf16 v[144:159], a[44:47], a[192:195], v[144:159]
ds_read_b64_tr_b16 a[172:173], v10 offset:0
ds_read_b64_tr_b16 a[174:175], v10 offset:1280
s_waitcnt lgkmcnt(12)
v_mfma_f32_32x32x16_bf16 v[160:175], a[44:47], a[196:199], v[160:175]
ds_read_b64_tr_b16 a[176:177], v11 offset:0
ds_read_b64_tr_b16 a[178:179], v11 offset:1280
s_waitcnt lgkmcnt(8)
v_mfma_f32_32x32x16_bf16 v[96:111], a[48:51], a[160:163], v[96:111]
ds_read_b64_tr_b16 a[180:181], v7 offset:5120
ds_read_b64_tr_b16 a[182:183], v7 offset:6400
s_waitcnt lgkmcnt(8)
v_mfma_f32_32x32x16_bf16 v[112:127], a[48:51], a[164:167], v[112:127]
ds_read_b64_tr_b16 a[184:185], v8 offset:5120
ds_read_b64_tr_b16 a[186:187], v8 offset:6400
s_add_u32 m0, s26, 0
s_mov_b32 s24, 768
buffer_load_dwordx4 v17, s[8:11], s24 offen offset:0 lds
v_mov_b32 v45, 1
s_waitcnt lgkmcnt(8)
v_mfma_f32_32x32x16_bf16 v[128:143], a[48:51], a[168:171], v[128:143]
ds_read_b64_tr_b16 a[188:189], v9 offset:5120
ds_read_b64_tr_b16 a[190:191], v9 offset:6400
buffer_load_dwordx4 v18, s[8:11], s24 offen offset:1024 lds
s_waitcnt lgkmcnt(8)
v_mfma_f32_32x32x16_bf16 v[144:159], a[48:51], a[172:175], v[144:159]
ds_read_b64_tr_b16 a[192:193], v10 offset:5120
ds_read_b64_tr_b16 a[194:195], v10 offset:6400
buffer_load_dwordx4 v19, s[8:11], s24 offen offset:2048 lds
s_waitcnt lgkmcnt(8)
v_mfma_f32_32x32x16_bf16 v[160:175], a[48:51], a[176:179], v[160:175]
ds_read_b64_tr_b16 a[196:197], v11 offset:5120
ds_read_b64_tr_b16 a[198:199], v11 offset:6400
buffer_load_dwordx4 v20, s[8:11], s24 offen offset:3072 lds
s_waitcnt lgkmcnt(8)
v_mfma_f32_32x32x16_bf16 v[96:111], a[52:55], a[180:183], v[96:111]
ds_read_b64_tr_b16 a[160:161], v7 offset:10240
ds_read_b64_tr_b16 a[162:163], v7 offset:11520
s_add_u32 m0, s25, 20480
s_add_u32 s32, s23, 1474560
buffer_load_dwordx4 v12, s[12:15], s32 offen offset:0 lds
s_waitcnt lgkmcnt(8)
v_mfma_f32_32x32x16_bf16 v[112:127], a[52:55], a[184:187], v[112:127]
ds_read_b64_tr_b16 a[164:165], v8 offset:10240
ds_read_b64_tr_b16 a[166:167], v8 offset:11520
buffer_load_dwordx4 v13, s[12:15], s32 offen offset:1024 lds
s_waitcnt lgkmcnt(8)
v_mfma_f32_32x32x16_bf16 v[128:143], a[52:55], a[188:191], v[128:143]
ds_read_b64_tr_b16 a[168:169], v9 offset:10240
ds_read_b64_tr_b16 a[170:171], v9 offset:11520
buffer_load_dwordx4 v14, s[12:15], s32 offen offset:2048 lds
s_waitcnt lgkmcnt(8)
v_mfma_f32_32x32x16_bf16 v[144:159], a[52:55], a[192:195], v[144:159]
ds_read_b64_tr_b16 a[172:173], v10 offset:10240
ds_read_b64_tr_b16 a[174:175], v10 offset:11520
buffer_load_dwordx4 v15, s[12:15], s32 offen offset:3072 lds
s_waitcnt lgkmcnt(8)
v_mfma_f32_32x32x16_bf16 v[160:175], a[52:55], a[196:199], v[160:175]
ds_read_b64_tr_b16 a[176:177], v11 offset:10240
ds_read_b64_tr_b16 a[178:179], v11 offset:11520
s_add_u32 m0, s25, 24576
s_add_u32 s32, s23, 1474560
buffer_load_dwordx4 v16, s[12:15], s32 offen lds
s_waitcnt lgkmcnt(8)
v_mfma_f32_32x32x16_bf16 v[96:111], a[56:59], a[160:163], v[96:111]
ds_read_b64_tr_b16 a[180:181], v7 offset:15360
ds_read_b64_tr_b16 a[182:183], v7 offset:16640
s_waitcnt lgkmcnt(8)
v_mfma_f32_32x32x16_bf16 v[112:127], a[56:59], a[164:167], v[112:127]
ds_read_b64_tr_b16 a[184:185], v8 offset:15360
ds_read_b64_tr_b16 a[186:187], v8 offset:16640
s_waitcnt lgkmcnt(8)
v_mfma_f32_32x32x16_bf16 v[128:143], a[56:59], a[168:171], v[128:143]
ds_read_b64_tr_b16 a[188:189], v9 offset:15360
ds_read_b64_tr_b16 a[190:191], v9 offset:16640
s_waitcnt lgkmcnt(8)
v_mfma_f32_32x32x16_bf16 v[144:159], a[56:59], a[172:175], v[144:159]
ds_read_b64_tr_b16 a[192:193], v10 offset:15360
ds_read_b64_tr_b16 a[194:195], v10 offset:16640
s_waitcnt lgkmcnt(8)
v_mfma_f32_32x32x16_bf16 v[160:175], a[56:59], a[176:179], v[160:175]
ds_read_b64_tr_b16 a[196:197], v11 offset:15360
ds_read_b64_tr_b16 a[198:199], v11 offset:16640
s_waitcnt vmcnt(23)
s_waitcnt vmcnt(14)
s_barrier
ds_read_b128 a[64:67], v21 offset:4096
ds_read_b128 a[68:71], v22 offset:4096
ds_read_b128 a[72:75], v23 offset:4096
ds_read_b128 a[76:79], v24 offset:4096
s_waitcnt lgkmcnt(12)
v_mfma_f32_32x32x16_bf16 v[96:111], a[60:63], a[180:183], v[96:111]
ds_read_b64_tr_b16 a[160:161], v7 offset:20480
ds_read_b64_tr_b16 a[162:163], v7 offset:21760
s_waitcnt lgkmcnt(12)
v_mfma_f32_32x32x16_bf16 v[112:127], a[60:63], a[184:187], v[112:127]
ds_read_b64_tr_b16 a[164:165], v8 offset:20480
ds_read_b64_tr_b16 a[166:167], v8 offset:21760
s_waitcnt lgkmcnt(12)
v_mfma_f32_32x32x16_bf16 v[128:143], a[60:63], a[188:191], v[128:143]
ds_read_b64_tr_b16 a[168:169], v9 offset:20480
ds_read_b64_tr_b16 a[170:171], v9 offset:21760
s_waitcnt lgkmcnt(12)
v_mfma_f32_32x32x16_bf16 v[144:159], a[60:63], a[192:195], v[144:159]
ds_read_b64_tr_b16 a[172:173], v10 offset:20480
ds_read_b64_tr_b16 a[174:175], v10 offset:21760
s_waitcnt lgkmcnt(12)
v_mfma_f32_32x32x16_bf16 v[160:175], a[60:63], a[196:199], v[160:175]
ds_read_b64_tr_b16 a[176:177], v11 offset:20480
ds_read_b64_tr_b16 a[178:179], v11 offset:21760
buffer_store_byte v45, v234, s[52:55], 0 offen sc1
s_waitcnt lgkmcnt(8)
v_mfma_f32_32x32x16_bf16 v[96:111], a[64:67], a[160:163], v[96:111]
ds_read_b64_tr_b16 a[180:181], v7 offset:25600
ds_read_b64_tr_b16 a[182:183], v7 offset:26880
s_waitcnt lgkmcnt(8)
v_mfma_f32_32x32x16_bf16 v[112:127], a[64:67], a[164:167], v[112:127]
ds_read_b64_tr_b16 a[184:185], v8 offset:25600
ds_read_b64_tr_b16 a[186:187], v8 offset:26880
s_add_u32 m0, s26, 4096
s_mov_b32 s24, 896
buffer_load_dwordx4 v17, s[8:11], s24 offen offset:0 lds
s_waitcnt lgkmcnt(8)
v_mfma_f32_32x32x16_bf16 v[128:143], a[64:67], a[168:171], v[128:143]
ds_read_b64_tr_b16 a[188:189], v9 offset:25600
ds_read_b64_tr_b16 a[190:191], v9 offset:26880
buffer_load_dwordx4 v18, s[8:11], s24 offen offset:1024 lds
s_waitcnt lgkmcnt(8)
v_mfma_f32_32x32x16_bf16 v[144:159], a[64:67], a[172:175], v[144:159]
ds_read_b64_tr_b16 a[192:193], v10 offset:25600
ds_read_b64_tr_b16 a[194:195], v10 offset:26880
buffer_load_dwordx4 v19, s[8:11], s24 offen offset:2048 lds
s_waitcnt lgkmcnt(8)
v_mfma_f32_32x32x16_bf16 v[160:175], a[64:67], a[176:179], v[160:175]
ds_read_b64_tr_b16 a[196:197], v11 offset:25600
ds_read_b64_tr_b16 a[198:199], v11 offset:26880
buffer_load_dwordx4 v20, s[8:11], s24 offen offset:3072 lds
s_waitcnt lgkmcnt(8)
v_mfma_f32_32x32x16_bf16 v[96:111], a[68:71], a[180:183], v[96:111]
ds_read_b64_tr_b16 a[160:161], v7 offset:30720
ds_read_b64_tr_b16 a[162:163], v7 offset:32000
s_add_u32 m0, s25, 40960
s_add_u32 s32, s23, 1720320
buffer_load_dwordx4 v12, s[12:15], s32 offen offset:0 lds
s_waitcnt lgkmcnt(8)
v_mfma_f32_32x32x16_bf16 v[112:127], a[68:71], a[184:187], v[112:127]
ds_read_b64_tr_b16 a[164:165], v8 offset:30720
ds_read_b64_tr_b16 a[166:167], v8 offset:32000
buffer_load_dwordx4 v13, s[12:15], s32 offen offset:1024 lds
s_waitcnt lgkmcnt(8)
v_mfma_f32_32x32x16_bf16 v[128:143], a[68:71], a[188:191], v[128:143]
ds_read_b64_tr_b16 a[168:169], v9 offset:30720
ds_read_b64_tr_b16 a[170:171], v9 offset:32000
buffer_load_dwordx4 v14, s[12:15], s32 offen offset:2048 lds
s_waitcnt lgkmcnt(8)
v_mfma_f32_32x32x16_bf16 v[144:159], a[68:71], a[192:195], v[144:159]
ds_read_b64_tr_b16 a[172:173], v10 offset:30720
ds_read_b64_tr_b16 a[174:175], v10 offset:32000
buffer_load_dwordx4 v15, s[12:15], s32 offen offset:3072 lds
s_waitcnt lgkmcnt(8)
v_mfma_f32_32x32x16_bf16 v[160:175], a[68:71], a[196:199], v[160:175]
ds_read_b64_tr_b16 a[176:177], v11 offset:30720
ds_read_b64_tr_b16 a[178:179], v11 offset:32000
s_add_u32 m0, s25, 45056
s_add_u32 s32, s23, 1720320
buffer_load_dwordx4 v16, s[12:15], s32 offen lds
s_waitcnt lgkmcnt(8)
v_mfma_f32_32x32x16_bf16 v[96:111], a[72:75], a[160:163], v[96:111]
ds_read_b64_tr_b16 a[180:181], v7 offset:35840
ds_read_b64_tr_b16 a[182:183], v7 offset:37120
s_waitcnt lgkmcnt(8)
v_mfma_f32_32x32x16_bf16 v[112:127], a[72:75], a[164:167], v[112:127]
ds_read_b64_tr_b16 a[184:185], v8 offset:35840
ds_read_b64_tr_b16 a[186:187], v8 offset:37120
s_waitcnt lgkmcnt(8)
v_mfma_f32_32x32x16_bf16 v[128:143], a[72:75], a[168:171], v[128:143]
ds_read_b64_tr_b16 a[188:189], v9 offset:35840
ds_read_b64_tr_b16 a[190:191], v9 offset:37120
s_waitcnt lgkmcnt(8)
v_mfma_f32_32x32x16_bf16 v[144:159], a[72:75], a[172:175], v[144:159]
ds_read_b64_tr_b16 a[192:193], v10 offset:35840
ds_read_b64_tr_b16 a[194:195], v10 offset:37120
s_waitcnt lgkmcnt(8)
v_mfma_f32_32x32x16_bf16 v[160:175], a[72:75], a[176:179], v[160:175]
ds_read_b64_tr_b16 a[196:197], v11 offset:35840
ds_read_b64_tr_b16 a[198:199], v11 offset:37120
s_waitcnt vmcnt(19)
s_barrier
ds_read_b128 a[80:83], v21 offset:8192
ds_read_b128 a[84:87], v22 offset:8192
ds_read_b128 a[88:91], v23 offset:8192
ds_read_b128 a[92:95], v24 offset:8192
s_waitcnt lgkmcnt(12)
v_mfma_f32_32x32x16_bf16 v[96:111], a[76:79], a[180:183], v[96:111]
ds_read_b64_tr_b16 a[160:161], v2 offset:0
ds_read_b64_tr_b16 a[162:163], v2 offset:1280
s_waitcnt lgkmcnt(12)
v_mfma_f32_32x32x16_bf16 v[112:127], a[76:79], a[184:187], v[112:127]
ds_read_b64_tr_b16 a[164:165], v3 offset:0
ds_read_b64_tr_b16 a[166:167], v3 offset:1280
s_waitcnt lgkmcnt(12)
v_mfma_f32_32x32x16_bf16 v[128:143], a[76:79], a[188:191], v[128:143]
ds_read_b64_tr_b16 a[168:169], v4 offset:0
ds_read_b64_tr_b16 a[170:171], v4 offset:1280
s_waitcnt lgkmcnt(12)
v_mfma_f32_32x32x16_bf16 v[144:159], a[76:79], a[192:195], v[144:159]
ds_read_b64_tr_b16 a[172:173], v5 offset:0
ds_read_b64_tr_b16 a[174:175], v5 offset:1280
s_waitcnt lgkmcnt(12)
v_mfma_f32_32x32x16_bf16 v[160:175], a[76:79], a[196:199], v[160:175]
ds_read_b64_tr_b16 a[176:177], v6 offset:0
ds_read_b64_tr_b16 a[178:179], v6 offset:1280
s_waitcnt lgkmcnt(8)
v_mfma_f32_32x32x16_bf16 v[96:111], a[80:83], a[160:163], v[96:111]
ds_read_b64_tr_b16 a[180:181], v2 offset:5120
ds_read_b64_tr_b16 a[182:183], v2 offset:6400
s_waitcnt lgkmcnt(8)
v_mfma_f32_32x32x16_bf16 v[112:127], a[80:83], a[164:167], v[112:127]
ds_read_b64_tr_b16 a[184:185], v3 offset:5120
ds_read_b64_tr_b16 a[186:187], v3 offset:6400
s_add_u32 m0, s26, 8192
s_mov_b32 s24, 1024
buffer_load_dwordx4 v17, s[8:11], s24 offen offset:0 lds
s_waitcnt lgkmcnt(8)
v_mfma_f32_32x32x16_bf16 v[128:143], a[80:83], a[168:171], v[128:143]
ds_read_b64_tr_b16 a[188:189], v4 offset:5120
ds_read_b64_tr_b16 a[190:191], v4 offset:6400
buffer_load_dwordx4 v18, s[8:11], s24 offen offset:1024 lds
s_waitcnt lgkmcnt(8)
v_mfma_f32_32x32x16_bf16 v[144:159], a[80:83], a[172:175], v[144:159]
ds_read_b64_tr_b16 a[192:193], v5 offset:5120
ds_read_b64_tr_b16 a[194:195], v5 offset:6400
buffer_load_dwordx4 v19, s[8:11], s24 offen offset:2048 lds
s_waitcnt lgkmcnt(8)
v_mfma_f32_32x32x16_bf16 v[160:175], a[80:83], a[176:179], v[160:175]
ds_read_b64_tr_b16 a[196:197], v6 offset:5120
ds_read_b64_tr_b16 a[198:199], v6 offset:6400
buffer_load_dwordx4 v20, s[8:11], s24 offen offset:3072 lds
s_waitcnt lgkmcnt(8)
v_mfma_f32_32x32x16_bf16 v[96:111], a[84:87], a[180:183], v[96:111]
ds_read_b64_tr_b16 a[160:161], v2 offset:10240
ds_read_b64_tr_b16 a[162:163], v2 offset:11520
s_add_u32 m0, s25, 61440
s_add_u32 s32, s23, 1966080
buffer_load_dwordx4 v12, s[12:15], s32 offen offset:0 lds
s_waitcnt lgkmcnt(8)
v_mfma_f32_32x32x16_bf16 v[112:127], a[84:87], a[184:187], v[112:127]
ds_read_b64_tr_b16 a[164:165], v3 offset:10240
ds_read_b64_tr_b16 a[166:167], v3 offset:11520
buffer_load_dwordx4 v13, s[12:15], s32 offen offset:1024 lds
s_waitcnt lgkmcnt(8)
v_mfma_f32_32x32x16_bf16 v[128:143], a[84:87], a[188:191], v[128:143]
ds_read_b64_tr_b16 a[168:169], v4 offset:10240
ds_read_b64_tr_b16 a[170:171], v4 offset:11520
buffer_load_dwordx4 v14, s[12:15], s32 offen offset:2048 lds
s_waitcnt lgkmcnt(8)
v_mfma_f32_32x32x16_bf16 v[144:159], a[84:87], a[192:195], v[144:159]
ds_read_b64_tr_b16 a[172:173], v5 offset:10240
ds_read_b64_tr_b16 a[174:175], v5 offset:11520
buffer_load_dwordx4 v15, s[12:15], s32 offen offset:3072 lds
s_waitcnt lgkmcnt(8)
v_mfma_f32_32x32x16_bf16 v[160:175], a[84:87], a[196:199], v[160:175]
ds_read_b64_tr_b16 a[176:177], v6 offset:10240
ds_read_b64_tr_b16 a[178:179], v6 offset:11520
s_add_u32 m0, s25, 65536
s_add_u32 s32, s23, 1966080
buffer_load_dwordx4 v16, s[12:15], s32 offen lds
s_waitcnt lgkmcnt(8)
v_mfma_f32_32x32x16_bf16 v[96:111], a[88:91], a[160:163], v[96:111]
ds_read_b64_tr_b16 a[180:181], v2 offset:15360
ds_read_b64_tr_b16 a[182:183], v2 offset:16640
s_waitcnt lgkmcnt(8)
v_mfma_f32_32x32x16_bf16 v[112:127], a[88:91], a[164:167], v[112:127]
ds_read_b64_tr_b16 a[184:185], v3 offset:15360
ds_read_b64_tr_b16 a[186:187], v3 offset:16640
s_waitcnt lgkmcnt(8)
v_mfma_f32_32x32x16_bf16 v[128:143], a[88:91], a[168:171], v[128:143]
ds_read_b64_tr_b16 a[188:189], v4 offset:15360
ds_read_b64_tr_b16 a[190:191], v4 offset:16640
s_waitcnt lgkmcnt(8)
v_mfma_f32_32x32x16_bf16 v[144:159], a[88:91], a[172:175], v[144:159]
ds_read_b64_tr_b16 a[192:193], v5 offset:15360
ds_read_b64_tr_b16 a[194:195], v5 offset:16640
s_waitcnt lgkmcnt(8)
v_mfma_f32_32x32x16_bf16 v[160:175], a[88:91], a[176:179], v[160:175]
ds_read_b64_tr_b16 a[196:197], v6 offset:15360
ds_read_b64_tr_b16 a[198:199], v6 offset:16640
s_waitcnt vmcnt(19)
s_barrier
ds_read_b128 a[96:99], v21 offset:0
ds_read_b128 a[100:103], v22 offset:0
ds_read_b128 a[104:107], v23 offset:0
ds_read_b128 a[108:111], v24 offset:0
s_waitcnt lgkmcnt(12)
v_mfma_f32_32x32x16_bf16 v[96:111], a[92:95], a[180:183], v[96:111]
ds_read_b64_tr_b16 a[160:161], v2 offset:20480
ds_read_b64_tr_b16 a[162:163], v2 offset:21760
s_waitcnt lgkmcnt(12)
v_mfma_f32_32x32x16_bf16 v[112:127], a[92:95], a[184:187], v[112:127]
ds_read_b64_tr_b16 a[164:165], v3 offset:20480
ds_read_b64_tr_b16 a[166:167], v3 offset:21760
s_waitcnt lgkmcnt(12)
v_mfma_f32_32x32x16_bf16 v[128:143], a[92:95], a[188:191], v[128:143]
ds_read_b64_tr_b16 a[168:169], v4 offset:20480
ds_read_b64_tr_b16 a[170:171], v4 offset:21760
s_waitcnt lgkmcnt(12)
v_mfma_f32_32x32x16_bf16 v[144:159], a[92:95], a[192:195], v[144:159]
ds_read_b64_tr_b16 a[172:173], v5 offset:20480
ds_read_b64_tr_b16 a[174:175], v5 offset:21760
s_waitcnt lgkmcnt(12)
v_mfma_f32_32x32x16_bf16 v[160:175], a[92:95], a[196:199], v[160:175]
ds_read_b64_tr_b16 a[176:177], v6 offset:20480
ds_read_b64_tr_b16 a[178:179], v6 offset:21760
s_waitcnt lgkmcnt(8)
v_mfma_f32_32x32x16_bf16 v[96:111], a[96:99], a[160:163], v[96:111]
ds_read_b64_tr_b16 a[180:181], v2 offset:25600
ds_read_b64_tr_b16 a[182:183], v2 offset:26880
s_waitcnt lgkmcnt(8)
v_mfma_f32_32x32x16_bf16 v[112:127], a[96:99], a[164:167], v[112:127]
ds_read_b64_tr_b16 a[184:185], v3 offset:25600
ds_read_b64_tr_b16 a[186:187], v3 offset:26880
s_add_u32 m0, s26, 0
s_mov_b32 s24, 1152
buffer_load_dwordx4 v17, s[8:11], s24 offen offset:0 lds
s_waitcnt lgkmcnt(8)
v_mfma_f32_32x32x16_bf16 v[128:143], a[96:99], a[168:171], v[128:143]
ds_read_b64_tr_b16 a[188:189], v4 offset:25600
ds_read_b64_tr_b16 a[190:191], v4 offset:26880
buffer_load_dwordx4 v18, s[8:11], s24 offen offset:1024 lds
s_waitcnt lgkmcnt(8)
v_mfma_f32_32x32x16_bf16 v[144:159], a[96:99], a[172:175], v[144:159]
ds_read_b64_tr_b16 a[192:193], v5 offset:25600
ds_read_b64_tr_b16 a[194:195], v5 offset:26880
buffer_load_dwordx4 v19, s[8:11], s24 offen offset:2048 lds
s_waitcnt lgkmcnt(8)
v_mfma_f32_32x32x16_bf16 v[160:175], a[96:99], a[176:179], v[160:175]
ds_read_b64_tr_b16 a[196:197], v6 offset:25600
ds_read_b64_tr_b16 a[198:199], v6 offset:26880
buffer_load_dwordx4 v20, s[8:11], s24 offen offset:3072 lds
s_waitcnt lgkmcnt(8)
v_mfma_f32_32x32x16_bf16 v[96:111], a[100:103], a[180:183], v[96:111]
ds_read_b64_tr_b16 a[160:161], v2 offset:30720
ds_read_b64_tr_b16 a[162:163], v2 offset:32000
s_add_u32 m0, s25, 81920
s_add_u32 s32, s23, 2211840
buffer_load_dwordx4 v12, s[12:15], s32 offen offset:0 lds
s_waitcnt lgkmcnt(8)
v_mfma_f32_32x32x16_bf16 v[112:127], a[100:103], a[184:187], v[112:127]
ds_read_b64_tr_b16 a[164:165], v3 offset:30720
ds_read_b64_tr_b16 a[166:167], v3 offset:32000
buffer_load_dwordx4 v13, s[12:15], s32 offen offset:1024 lds
s_waitcnt lgkmcnt(8)
v_mfma_f32_32x32x16_bf16 v[128:143], a[100:103], a[188:191], v[128:143]
ds_read_b64_tr_b16 a[168:169], v4 offset:30720
ds_read_b64_tr_b16 a[170:171], v4 offset:32000
buffer_load_dwordx4 v14, s[12:15], s32 offen offset:2048 lds
s_waitcnt lgkmcnt(8)
v_mfma_f32_32x32x16_bf16 v[144:159], a[100:103], a[192:195], v[144:159]
ds_read_b64_tr_b16 a[172:173], v5 offset:30720
ds_read_b64_tr_b16 a[174:175], v5 offset:32000
buffer_load_dwordx4 v15, s[12:15], s32 offen offset:3072 lds
s_waitcnt lgkmcnt(8)
v_mfma_f32_32x32x16_bf16 v[160:175], a[100:103], a[196:199], v[160:175]
ds_read_b64_tr_b16 a[176:177], v6 offset:30720
ds_read_b64_tr_b16 a[178:179], v6 offset:32000
s_add_u32 m0, s25, 86016
s_add_u32 s32, s23, 2211840
buffer_load_dwordx4 v16, s[12:15], s32 offen lds
s_waitcnt lgkmcnt(8)
v_mfma_f32_32x32x16_bf16 v[96:111], a[104:107], a[160:163], v[96:111]
ds_read_b64_tr_b16 a[180:181], v2 offset:35840
ds_read_b64_tr_b16 a[182:183], v2 offset:37120
s_waitcnt lgkmcnt(8)
v_mfma_f32_32x32x16_bf16 v[112:127], a[104:107], a[164:167], v[112:127]
ds_read_b64_tr_b16 a[184:185], v3 offset:35840
ds_read_b64_tr_b16 a[186:187], v3 offset:37120
s_waitcnt lgkmcnt(8)
v_mfma_f32_32x32x16_bf16 v[128:143], a[104:107], a[168:171], v[128:143]
ds_read_b64_tr_b16 a[188:189], v4 offset:35840
ds_read_b64_tr_b16 a[190:191], v4 offset:37120
s_waitcnt lgkmcnt(8)
v_mfma_f32_32x32x16_bf16 v[144:159], a[104:107], a[172:175], v[144:159]
ds_read_b64_tr_b16 a[192:193], v5 offset:35840
ds_read_b64_tr_b16 a[194:195], v5 offset:37120
s_waitcnt lgkmcnt(8)
v_mfma_f32_32x32x16_bf16 v[160:175], a[104:107], a[176:179], v[160:175]
ds_read_b64_tr_b16 a[196:197], v6 offset:35840
ds_read_b64_tr_b16 a[198:199], v6 offset:37120
s_waitcnt vmcnt(18)
s_barrier
ds_read_b128 a[112:115], v21 offset:4096
ds_read_b128 a[116:119], v22 offset:4096
ds_read_b128 a[120:123], v23 offset:4096
ds_read_b128 a[124:127], v24 offset:4096
s_waitcnt lgkmcnt(12)
v_mfma_f32_32x32x16_bf16 v[96:111], a[108:111], a[180:183], v[96:111]
ds_read_b64_tr_b16 a[160:161], v2 offset:40960
ds_read_b64_tr_b16 a[162:163], v2 offset:42240
s_waitcnt lgkmcnt(12)
v_mfma_f32_32x32x16_bf16 v[112:127], a[108:111], a[184:187], v[112:127]
ds_read_b64_tr_b16 a[164:165], v3 offset:40960
ds_read_b64_tr_b16 a[166:167], v3 offset:42240
s_waitcnt lgkmcnt(12)
v_mfma_f32_32x32x16_bf16 v[128:143], a[108:111], a[188:191], v[128:143]
ds_read_b64_tr_b16 a[168:169], v4 offset:40960
ds_read_b64_tr_b16 a[170:171], v4 offset:42240
s_waitcnt lgkmcnt(12)
v_mfma_f32_32x32x16_bf16 v[144:159], a[108:111], a[192:195], v[144:159]
ds_read_b64_tr_b16 a[172:173], v5 offset:40960
ds_read_b64_tr_b16 a[174:175], v5 offset:42240
s_waitcnt lgkmcnt(12)
v_mfma_f32_32x32x16_bf16 v[160:175], a[108:111], a[196:199], v[160:175]
ds_read_b64_tr_b16 a[176:177], v6 offset:40960
ds_read_b64_tr_b16 a[178:179], v6 offset:42240
s_waitcnt lgkmcnt(8)
v_mfma_f32_32x32x16_bf16 v[96:111], a[112:115], a[160:163], v[96:111]
ds_read_b64_tr_b16 a[180:181], v2 offset:46080
ds_read_b64_tr_b16 a[182:183], v2 offset:47360
s_waitcnt lgkmcnt(8)
v_mfma_f32_32x32x16_bf16 v[112:127], a[112:115], a[164:167], v[112:127]
ds_read_b64_tr_b16 a[184:185], v3 offset:46080
ds_read_b64_tr_b16 a[186:187], v3 offset:47360
s_add_u32 m0, s25, 0
s_add_u32 s32, s23, 320
buffer_load_dwordx4 v12, s[12:15], s32 offen offset:0 lds
s_waitcnt lgkmcnt(8)
v_mfma_f32_32x32x16_bf16 v[128:143], a[112:115], a[168:171], v[128:143]
ds_read_b64_tr_b16 a[188:189], v4 offset:46080
ds_read_b64_tr_b16 a[190:191], v4 offset:47360
buffer_load_dwordx4 v13, s[12:15], s32 offen offset:1024 lds
s_waitcnt lgkmcnt(8)
v_mfma_f32_32x32x16_bf16 v[144:159], a[112:115], a[172:175], v[144:159]
ds_read_b64_tr_b16 a[192:193], v5 offset:46080
ds_read_b64_tr_b16 a[194:195], v5 offset:47360
buffer_load_dwordx4 v14, s[12:15], s32 offen offset:2048 lds
s_waitcnt lgkmcnt(8)
v_mfma_f32_32x32x16_bf16 v[160:175], a[112:115], a[176:179], v[160:175]
ds_read_b64_tr_b16 a[196:197], v6 offset:46080
ds_read_b64_tr_b16 a[198:199], v6 offset:47360
buffer_load_dwordx4 v15, s[12:15], s32 offen offset:3072 lds
s_waitcnt lgkmcnt(8)
v_mfma_f32_32x32x16_bf16 v[96:111], a[116:119], a[180:183], v[96:111]
ds_read_b64_tr_b16 a[160:161], v2 offset:51200
ds_read_b64_tr_b16 a[162:163], v2 offset:52480
s_add_u32 m0, s25, 4096
s_add_u32 s32, s23, 320
buffer_load_dwordx4 v16, s[12:15], s32 offen lds
s_waitcnt lgkmcnt(8)
v_mfma_f32_32x32x16_bf16 v[112:127], a[116:119], a[184:187], v[112:127]
ds_read_b64_tr_b16 a[164:165], v3 offset:51200
ds_read_b64_tr_b16 a[166:167], v3 offset:52480
s_waitcnt lgkmcnt(8)
v_mfma_f32_32x32x16_bf16 v[128:143], a[116:119], a[188:191], v[128:143]
ds_read_b64_tr_b16 a[168:169], v4 offset:51200
ds_read_b64_tr_b16 a[170:171], v4 offset:52480
s_waitcnt lgkmcnt(8)
v_mfma_f32_32x32x16_bf16 v[144:159], a[116:119], a[192:195], v[144:159]
ds_read_b64_tr_b16 a[172:173], v5 offset:51200
ds_read_b64_tr_b16 a[174:175], v5 offset:52480
s_waitcnt lgkmcnt(8)
v_mfma_f32_32x32x16_bf16 v[160:175], a[116:119], a[196:199], v[160:175]
ds_read_b64_tr_b16 a[176:177], v6 offset:51200
ds_read_b64_tr_b16 a[178:179], v6 offset:52480
s_waitcnt lgkmcnt(8)
v_mfma_f32_32x32x16_bf16 v[96:111], a[120:123], a[160:163], v[96:111]
ds_read_b64_tr_b16 a[180:181], v2 offset:56320
ds_read_b64_tr_b16 a[182:183], v2 offset:57600
s_waitcnt lgkmcnt(8)
v_mfma_f32_32x32x16_bf16 v[112:127], a[120:123], a[164:167], v[112:127]
ds_read_b64_tr_b16 a[184:185], v3 offset:56320
ds_read_b64_tr_b16 a[186:187], v3 offset:57600
s_waitcnt lgkmcnt(8)
v_mfma_f32_32x32x16_bf16 v[128:143], a[120:123], a[168:171], v[128:143]
ds_read_b64_tr_b16 a[188:189], v4 offset:56320
ds_read_b64_tr_b16 a[190:191], v4 offset:57600
s_waitcnt lgkmcnt(8)
v_mfma_f32_32x32x16_bf16 v[144:159], a[120:123], a[172:175], v[144:159]
ds_read_b64_tr_b16 a[192:193], v5 offset:56320
ds_read_b64_tr_b16 a[194:195], v5 offset:57600
s_waitcnt lgkmcnt(8)
v_mfma_f32_32x32x16_bf16 v[160:175], a[120:123], a[176:179], v[160:175]
ds_read_b64_tr_b16 a[196:197], v6 offset:56320
ds_read_b64_tr_b16 a[198:199], v6 offset:57600
s_waitcnt vmcnt(14)
s_barrier
ds_read_b128 a[128:131], v21 offset:8192
ds_read_b128 a[132:135], v22 offset:8192
ds_read_b128 a[136:139], v23 offset:8192
ds_read_b128 a[140:143], v24 offset:8192
s_waitcnt lgkmcnt(12)
v_mfma_f32_32x32x16_bf16 v[96:111], a[124:127], a[180:183], v[96:111]
ds_read_b64_tr_b16 a[160:161], v7 offset:0
ds_read_b64_tr_b16 a[162:163], v7 offset:1280
s_waitcnt lgkmcnt(12)
v_mfma_f32_32x32x16_bf16 v[112:127], a[124:127], a[184:187], v[112:127]
ds_read_b64_tr_b16 a[164:165], v8 offset:0
ds_read_b64_tr_b16 a[166:167], v8 offset:1280
s_waitcnt lgkmcnt(12)
v_mfma_f32_32x32x16_bf16 v[128:143], a[124:127], a[188:191], v[128:143]
ds_read_b64_tr_b16 a[168:169], v9 offset:0
ds_read_b64_tr_b16 a[170:171], v9 offset:1280
s_waitcnt lgkmcnt(12)
v_mfma_f32_32x32x16_bf16 v[144:159], a[124:127], a[192:195], v[144:159]
ds_read_b64_tr_b16 a[172:173], v10 offset:0
ds_read_b64_tr_b16 a[174:175], v10 offset:1280
s_waitcnt lgkmcnt(12)
v_mfma_f32_32x32x16_bf16 v[160:175], a[124:127], a[196:199], v[160:175]
ds_read_b64_tr_b16 a[176:177], v11 offset:0
ds_read_b64_tr_b16 a[178:179], v11 offset:1280
s_waitcnt lgkmcnt(8)
v_mfma_f32_32x32x16_bf16 v[96:111], a[128:131], a[160:163], v[96:111]
ds_read_b64_tr_b16 a[180:181], v7 offset:5120
ds_read_b64_tr_b16 a[182:183], v7 offset:6400
s_waitcnt lgkmcnt(8)
v_mfma_f32_32x32x16_bf16 v[112:127], a[128:131], a[164:167], v[112:127]
ds_read_b64_tr_b16 a[184:185], v8 offset:5120
ds_read_b64_tr_b16 a[186:187], v8 offset:6400
s_add_u32 m0, s25, 20480
s_add_u32 s32, s23, 246080
buffer_load_dwordx4 v12, s[12:15], s32 offen offset:0 lds
s_waitcnt lgkmcnt(8)
v_mfma_f32_32x32x16_bf16 v[128:143], a[128:131], a[168:171], v[128:143]
ds_read_b64_tr_b16 a[188:189], v9 offset:5120
ds_read_b64_tr_b16 a[190:191], v9 offset:6400
buffer_load_dwordx4 v13, s[12:15], s32 offen offset:1024 lds
s_waitcnt lgkmcnt(8)
v_mfma_f32_32x32x16_bf16 v[144:159], a[128:131], a[172:175], v[144:159]
ds_read_b64_tr_b16 a[192:193], v10 offset:5120
ds_read_b64_tr_b16 a[194:195], v10 offset:6400
buffer_load_dwordx4 v14, s[12:15], s32 offen offset:2048 lds
s_waitcnt lgkmcnt(8)
v_mfma_f32_32x32x16_bf16 v[160:175], a[128:131], a[176:179], v[160:175]
ds_read_b64_tr_b16 a[196:197], v11 offset:5120
ds_read_b64_tr_b16 a[198:199], v11 offset:6400
buffer_load_dwordx4 v15, s[12:15], s32 offen offset:3072 lds
s_waitcnt lgkmcnt(8)
v_mfma_f32_32x32x16_bf16 v[96:111], a[132:135], a[180:183], v[96:111]
ds_read_b64_tr_b16 a[160:161], v7 offset:10240
ds_read_b64_tr_b16 a[162:163], v7 offset:11520
s_add_u32 m0, s25, 24576
s_add_u32 s32, s23, 246080
buffer_load_dwordx4 v16, s[12:15], s32 offen lds
s_waitcnt lgkmcnt(8)
v_mfma_f32_32x32x16_bf16 v[112:127], a[132:135], a[184:187], v[112:127]
ds_read_b64_tr_b16 a[164:165], v8 offset:10240
ds_read_b64_tr_b16 a[166:167], v8 offset:11520
s_waitcnt lgkmcnt(8)
v_mfma_f32_32x32x16_bf16 v[128:143], a[132:135], a[188:191], v[128:143]
ds_read_b64_tr_b16 a[168:169], v9 offset:10240
ds_read_b64_tr_b16 a[170:171], v9 offset:11520
s_waitcnt lgkmcnt(8)
v_mfma_f32_32x32x16_bf16 v[144:159], a[132:135], a[192:195], v[144:159]
ds_read_b64_tr_b16 a[172:173], v10 offset:10240
ds_read_b64_tr_b16 a[174:175], v10 offset:11520
s_waitcnt lgkmcnt(8)
v_mfma_f32_32x32x16_bf16 v[160:175], a[132:135], a[196:199], v[160:175]
ds_read_b64_tr_b16 a[176:177], v11 offset:10240
ds_read_b64_tr_b16 a[178:179], v11 offset:11520
s_waitcnt lgkmcnt(8)
v_mfma_f32_32x32x16_bf16 v[96:111], a[136:139], a[160:163], v[96:111]
ds_read_b64_tr_b16 a[180:181], v7 offset:15360
ds_read_b64_tr_b16 a[182:183], v7 offset:16640
s_waitcnt lgkmcnt(8)
v_mfma_f32_32x32x16_bf16 v[112:127], a[136:139], a[164:167], v[112:127]
ds_read_b64_tr_b16 a[184:185], v8 offset:15360
ds_read_b64_tr_b16 a[186:187], v8 offset:16640
s_waitcnt lgkmcnt(8)
v_mfma_f32_32x32x16_bf16 v[128:143], a[136:139], a[168:171], v[128:143]
ds_read_b64_tr_b16 a[188:189], v9 offset:15360
ds_read_b64_tr_b16 a[190:191], v9 offset:16640
s_waitcnt lgkmcnt(8)
v_mfma_f32_32x32x16_bf16 v[144:159], a[136:139], a[172:175], v[144:159]
ds_read_b64_tr_b16 a[192:193], v10 offset:15360
ds_read_b64_tr_b16 a[194:195], v10 offset:16640
s_waitcnt lgkmcnt(8)
v_mfma_f32_32x32x16_bf16 v[160:175], a[136:139], a[176:179], v[160:175]
ds_read_b64_tr_b16 a[196:197], v11 offset:15360
ds_read_b64_tr_b16 a[198:199], v11 offset:16640
s_waitcnt vmcnt(10)
s_barrier
ds_read_b128 a[144:147], v21 offset:0
ds_read_b128 a[148:151], v22 offset:0
ds_read_b128 a[152:155], v23 offset:0
ds_read_b128 a[156:159], v24 offset:0
s_waitcnt lgkmcnt(12)
v_mfma_f32_32x32x16_bf16 v[96:111], a[140:143], a[180:183], v[96:111]
ds_read_b64_tr_b16 a[160:161], v7 offset:20480
ds_read_b64_tr_b16 a[162:163], v7 offset:21760
s_waitcnt lgkmcnt(12)
v_mfma_f32_32x32x16_bf16 v[112:127], a[140:143], a[184:187], v[112:127]
ds_read_b64_tr_b16 a[164:165], v8 offset:20480
ds_read_b64_tr_b16 a[166:167], v8 offset:21760
s_waitcnt lgkmcnt(12)
v_mfma_f32_32x32x16_bf16 v[128:143], a[140:143], a[188:191], v[128:143]
ds_read_b64_tr_b16 a[168:169], v9 offset:20480
ds_read_b64_tr_b16 a[170:171], v9 offset:21760
s_waitcnt lgkmcnt(12)
v_mfma_f32_32x32x16_bf16 v[144:159], a[140:143], a[192:195], v[144:159]
ds_read_b64_tr_b16 a[172:173], v10 offset:20480
ds_read_b64_tr_b16 a[174:175], v10 offset:21760
s_waitcnt lgkmcnt(12)
v_mfma_f32_32x32x16_bf16 v[160:175], a[140:143], a[196:199], v[160:175]
ds_read_b64_tr_b16 a[176:177], v11 offset:20480
ds_read_b64_tr_b16 a[178:179], v11 offset:21760
buffer_load_dword v46, v47, s[52:55], 0 offen
s_waitcnt lgkmcnt(8)
v_mfma_f32_32x32x16_bf16 v[96:111], a[144:147], a[160:163], v[96:111]
ds_read_b64_tr_b16 a[180:181], v7 offset:25600
ds_read_b64_tr_b16 a[182:183], v7 offset:26880
s_waitcnt lgkmcnt(8)
v_mfma_f32_32x32x16_bf16 v[112:127], a[144:147], a[164:167], v[112:127]
ds_read_b64_tr_b16 a[184:185], v8 offset:25600
ds_read_b64_tr_b16 a[186:187], v8 offset:26880
s_add_u32 m0, s25, 40960
s_add_u32 s32, s23, 491840
buffer_load_dwordx4 v12, s[12:15], s32 offen offset:0 lds
s_waitcnt lgkmcnt(8)
v_mfma_f32_32x32x16_bf16 v[128:143], a[144:147], a[168:171], v[128:143]
ds_read_b64_tr_b16 a[188:189], v9 offset:25600
ds_read_b64_tr_b16 a[190:191], v9 offset:26880
buffer_load_dwordx4 v13, s[12:15], s32 offen offset:1024 lds
s_waitcnt lgkmcnt(8)
v_mfma_f32_32x32x16_bf16 v[144:159], a[144:147], a[172:175], v[144:159]
ds_read_b64_tr_b16 a[192:193], v10 offset:25600
ds_read_b64_tr_b16 a[194:195], v10 offset:26880
buffer_load_dwordx4 v14, s[12:15], s32 offen offset:2048 lds
s_waitcnt lgkmcnt(8)
v_mfma_f32_32x32x16_bf16 v[160:175], a[144:147], a[176:179], v[160:175]
ds_read_b64_tr_b16 a[196:197], v11 offset:25600
ds_read_b64_tr_b16 a[198:199], v11 offset:26880
buffer_load_dwordx4 v15, s[12:15], s32 offen offset:3072 lds
s_waitcnt lgkmcnt(8)
v_mfma_f32_32x32x16_bf16 v[96:111], a[148:151], a[180:183], v[96:111]
ds_read_b64_tr_b16 a[160:161], v7 offset:30720
ds_read_b64_tr_b16 a[162:163], v7 offset:32000
s_add_u32 m0, s25, 45056
s_add_u32 s32, s23, 491840
buffer_load_dwordx4 v16, s[12:15], s32 offen lds
s_waitcnt lgkmcnt(8)
v_mfma_f32_32x32x16_bf16 v[112:127], a[148:151], a[184:187], v[112:127]
ds_read_b64_tr_b16 a[164:165], v8 offset:30720
ds_read_b64_tr_b16 a[166:167], v8 offset:32000
s_waitcnt lgkmcnt(8)
v_mfma_f32_32x32x16_bf16 v[128:143], a[148:151], a[188:191], v[128:143]
ds_read_b64_tr_b16 a[168:169], v9 offset:30720
ds_read_b64_tr_b16 a[170:171], v9 offset:32000
s_waitcnt lgkmcnt(8)
v_mfma_f32_32x32x16_bf16 v[144:159], a[148:151], a[192:195], v[144:159]
ds_read_b64_tr_b16 a[172:173], v10 offset:30720
ds_read_b64_tr_b16 a[174:175], v10 offset:32000
s_waitcnt lgkmcnt(8)
v_mfma_f32_32x32x16_bf16 v[160:175], a[148:151], a[196:199], v[160:175]
ds_read_b64_tr_b16 a[176:177], v11 offset:30720
ds_read_b64_tr_b16 a[178:179], v11 offset:32000
s_waitcnt lgkmcnt(8)
v_mfma_f32_32x32x16_bf16 v[96:111], a[152:155], a[160:163], v[96:111]
ds_read_b64_tr_b16 a[180:181], v7 offset:35840
ds_read_b64_tr_b16 a[182:183], v7 offset:37120
s_waitcnt lgkmcnt(8)
v_mfma_f32_32x32x16_bf16 v[112:127], a[152:155], a[164:167], v[112:127]
ds_read_b64_tr_b16 a[184:185], v8 offset:35840
ds_read_b64_tr_b16 a[186:187], v8 offset:37120
s_waitcnt lgkmcnt(8)
v_mfma_f32_32x32x16_bf16 v[128:143], a[152:155], a[168:171], v[128:143]
ds_read_b64_tr_b16 a[188:189], v9 offset:35840
ds_read_b64_tr_b16 a[190:191], v9 offset:37120
s_waitcnt lgkmcnt(8)
v_mfma_f32_32x32x16_bf16 v[144:159], a[152:155], a[172:175], v[144:159]
ds_read_b64_tr_b16 a[192:193], v10 offset:35840
ds_read_b64_tr_b16 a[194:195], v10 offset:37120
s_waitcnt lgkmcnt(8)
v_mfma_f32_32x32x16_bf16 v[160:175], a[152:155], a[176:179], v[160:175]
ds_read_b64_tr_b16 a[196:197], v11 offset:35840
ds_read_b64_tr_b16 a[198:199], v11 offset:37120
s_waitcnt vmcnt(11)
s_barrier
s_waitcnt lgkmcnt(8)
v_mfma_f32_32x32x16_bf16 v[96:111], a[156:159], a[180:183], v[96:111]
ds_read_b64_tr_b16 a[160:161], v2 offset:0
ds_read_b64_tr_b16 a[162:163], v2 offset:1280
s_waitcnt lgkmcnt(8)
v_mfma_f32_32x32x16_bf16 v[112:127], a[156:159], a[184:187], v[112:127]
ds_read_b64_tr_b16 a[164:165], v3 offset:0
ds_read_b64_tr_b16 a[166:167], v3 offset:1280
s_waitcnt lgkmcnt(8)
v_mfma_f32_32x32x16_bf16 v[128:143], a[156:159], a[188:191], v[128:143]
ds_read_b64_tr_b16 a[168:169], v4 offset:0
ds_read_b64_tr_b16 a[170:171], v4 offset:1280
s_waitcnt lgkmcnt(8)
v_mfma_f32_32x32x16_bf16 v[144:159], a[156:159], a[192:195], v[144:159]
ds_read_b64_tr_b16 a[172:173], v5 offset:0
ds_read_b64_tr_b16 a[174:175], v5 offset:1280
s_waitcnt lgkmcnt(8)
v_mfma_f32_32x32x16_bf16 v[160:175], a[156:159], a[196:199], v[160:175]
ds_read_b64_tr_b16 a[176:177], v6 offset:0
ds_read_b64_tr_b16 a[178:179], v6 offset:1280
s_waitcnt lgkmcnt(8)
v_mfma_f32_32x32x16_bf16 v[176:191], a[0:3], a[160:163], 0
ds_read_b64_tr_b16 a[180:181], v2 offset:5120
ds_read_b64_tr_b16 a[182:183], v2 offset:6400
s_waitcnt lgkmcnt(8)
v_mfma_f32_32x32x16_bf16 v[192:207], a[0:3], a[164:167], 0
ds_read_b64_tr_b16 a[184:185], v3 offset:5120
ds_read_b64_tr_b16 a[186:187], v3 offset:6400
s_add_u32 m0, s25, 61440
s_add_u32 s32, s23, 737600
buffer_load_dwordx4 v12, s[12:15], s32 offen offset:0 lds
s_waitcnt lgkmcnt(8)
v_mfma_f32_32x32x16_bf16 v[208:223], a[0:3], a[168:171], 0
ds_read_b64_tr_b16 a[188:189], v4 offset:5120
ds_read_b64_tr_b16 a[190:191], v4 offset:6400
buffer_load_dwordx4 v13, s[12:15], s32 offen offset:1024 lds
s_waitcnt lgkmcnt(8)
v_mfma_f32_32x32x16_bf16 v[224:239], a[0:3], a[172:175], 0
ds_read_b64_tr_b16 a[192:193], v5 offset:5120
ds_read_b64_tr_b16 a[194:195], v5 offset:6400
buffer_load_dwordx4 v14, s[12:15], s32 offen offset:2048 lds
s_waitcnt lgkmcnt(8)
v_mfma_f32_32x32x16_bf16 v[240:255], a[0:3], a[176:179], 0
ds_read_b64_tr_b16 a[196:197], v6 offset:5120
ds_read_b64_tr_b16 a[198:199], v6 offset:6400
buffer_load_dwordx4 v15, s[12:15], s32 offen offset:3072 lds
s_waitcnt lgkmcnt(8)
v_mfma_f32_32x32x16_bf16 v[176:191], a[4:7], a[180:183], v[176:191]
ds_read_b64_tr_b16 a[160:161], v2 offset:10240
ds_read_b64_tr_b16 a[162:163], v2 offset:11520
s_add_u32 m0, s25, 65536
s_add_u32 s32, s23, 737600
buffer_load_dwordx4 v16, s[12:15], s32 offen lds
s_waitcnt lgkmcnt(8)
v_mfma_f32_32x32x16_bf16 v[192:207], a[4:7], a[184:187], v[192:207]
ds_read_b64_tr_b16 a[164:165], v3 offset:10240
ds_read_b64_tr_b16 a[166:167], v3 offset:11520
s_waitcnt lgkmcnt(8)
v_mfma_f32_32x32x16_bf16 v[208:223], a[4:7], a[188:191], v[208:223]
ds_read_b64_tr_b16 a[168:169], v4 offset:10240
ds_read_b64_tr_b16 a[170:171], v4 offset:11520
s_waitcnt lgkmcnt(8)
v_mfma_f32_32x32x16_bf16 v[224:239], a[4:7], a[192:195], v[224:239]
ds_read_b64_tr_b16 a[172:173], v5 offset:10240
ds_read_b64_tr_b16 a[174:175], v5 offset:11520
s_waitcnt lgkmcnt(8)
v_mfma_f32_32x32x16_bf16 v[240:255], a[4:7], a[196:199], v[240:255]
ds_read_b64_tr_b16 a[176:177], v6 offset:10240
ds_read_b64_tr_b16 a[178:179], v6 offset:11520
s_waitcnt lgkmcnt(8)
v_mfma_f32_32x32x16_bf16 v[176:191], a[8:11], a[160:163], v[176:191]
ds_read_b64_tr_b16 a[180:181], v2 offset:15360
ds_read_b64_tr_b16 a[182:183], v2 offset:16640
s_waitcnt lgkmcnt(8)
v_mfma_f32_32x32x16_bf16 v[192:207], a[8:11], a[164:167], v[192:207]
ds_read_b64_tr_b16 a[184:185], v3 offset:15360
ds_read_b64_tr_b16 a[186:187], v3 offset:16640
s_waitcnt lgkmcnt(8)
v_mfma_f32_32x32x16_bf16 v[208:223], a[8:11], a[168:171], v[208:223]
ds_read_b64_tr_b16 a[188:189], v4 offset:15360
ds_read_b64_tr_b16 a[190:191], v4 offset:16640
s_waitcnt lgkmcnt(8)
v_mfma_f32_32x32x16_bf16 v[224:239], a[8:11], a[172:175], v[224:239]
ds_read_b64_tr_b16 a[192:193], v5 offset:15360
ds_read_b64_tr_b16 a[194:195], v5 offset:16640
s_waitcnt lgkmcnt(8)
v_mfma_f32_32x32x16_bf16 v[240:255], a[8:11], a[176:179], v[240:255]
ds_read_b64_tr_b16 a[196:197], v6 offset:15360
ds_read_b64_tr_b16 a[198:199], v6 offset:16640
s_waitcnt vmcnt(10)
v_and_b32 v46, v46, v67
v_cmp_ne_u32 vcc, v46, v67
s_nop 4
s_cbranch_vccnz K1_SPIN_V
K1_GO_V:
s_barrier
s_waitcnt lgkmcnt(8)
v_mfma_f32_32x32x16_bf16 v[176:191], a[12:15], a[180:183], v[176:191]
ds_read_b64_tr_b16 a[160:161], v2 offset:20480
ds_read_b64_tr_b16 a[162:163], v2 offset:21760
s_waitcnt lgkmcnt(8)
v_mfma_f32_32x32x16_bf16 v[192:207], a[12:15], a[184:187], v[192:207]
ds_read_b64_tr_b16 a[164:165], v3 offset:20480
ds_read_b64_tr_b16 a[166:167], v3 offset:21760
s_waitcnt lgkmcnt(8)
v_mfma_f32_32x32x16_bf16 v[208:223], a[12:15], a[188:191], v[208:223]
ds_read_b64_tr_b16 a[168:169], v4 offset:20480
ds_read_b64_tr_b16 a[170:171], v4 offset:21760
s_waitcnt lgkmcnt(8)
v_mfma_f32_32x32x16_bf16 v[224:239], a[12:15], a[192:195], v[224:239]
ds_read_b64_tr_b16 a[172:173], v5 offset:20480
ds_read_b64_tr_b16 a[174:175], v5 offset:21760
s_waitcnt lgkmcnt(8)
v_mfma_f32_32x32x16_bf16 v[240:255], a[12:15], a[196:199], v[240:255]
ds_read_b64_tr_b16 a[176:177], v6 offset:20480
ds_read_b64_tr_b16 a[178:179], v6 offset:21760
buffer_load_dword v32, v90, s[16:19], 0 offen offset:0
buffer_load_dword v33, v90, s[16:19], 0 offen offset:1536
buffer_load_dword v34, v90, s[16:19], s59 offen offset:0
buffer_load_dword v35, v90, s[16:19], s59 offen offset:1536
buffer_load_dword v36, v90, s[16:19], 0 offen offset:640
buffer_load_dword v37, v90, s[16:19], 0 offen offset:2176
buffer_load_dword v38, v90, s[16:19], s59 offen offset:640
buffer_load_dword v39, v90, s[16:19], s59 offen offset:2176
buffer_load_dwordx4 v[84:87], v92, s[16:19], 0 offen
buffer_load_dwordx4 v[68:71], v66, s[16:19], 0 offen offset:0
buffer_load_dwordx4 v[72:75], v66, s[16:19], 0 offen offset:32
buffer_load_dwordx4 v[76:79], v66, s[16:19], 0 offen offset:64
buffer_load_dwordx4 v[80:83], v66, s[16:19], 0 offen offset:96
s_waitcnt lgkmcnt(8)
v_mfma_f32_32x32x16_bf16 v[176:191], a[16:19], a[160:163], v[176:191]
ds_read_b64_tr_b16 a[180:181], v2 offset:25600
ds_read_b64_tr_b16 a[182:183], v2 offset:26880
s_waitcnt lgkmcnt(8)
v_mfma_f32_32x32x16_bf16 v[192:207], a[16:19], a[164:167], v[192:207]
ds_read_b64_tr_b16 a[184:185], v3 offset:25600
ds_read_b64_tr_b16 a[186:187], v3 offset:26880
s_add_u32 m0, s25, 81920
s_add_u32 s32, s23, 983360
buffer_load_dwordx4 v12, s[12:15], s32 offen offset:0 lds
s_waitcnt lgkmcnt(8)
v_mfma_f32_32x32x16_bf16 v[208:223], a[16:19], a[168:171], v[208:223]
ds_read_b64_tr_b16 a[188:189], v4 offset:25600
ds_read_b64_tr_b16 a[190:191], v4 offset:26880
buffer_load_dwordx4 v13, s[12:15], s32 offen offset:1024 lds
s_waitcnt lgkmcnt(8)
v_mfma_f32_32x32x16_bf16 v[224:239], a[16:19], a[172:175], v[224:239]
ds_read_b64_tr_b16 a[192:193], v5 offset:25600
ds_read_b64_tr_b16 a[194:195], v5 offset:26880
buffer_load_dwordx4 v14, s[12:15], s32 offen offset:2048 lds
s_waitcnt lgkmcnt(8)
v_mfma_f32_32x32x16_bf16 v[240:255], a[16:19], a[176:179], v[240:255]
ds_read_b64_tr_b16 a[196:197], v6 offset:25600
ds_read_b64_tr_b16 a[198:199], v6 offset:26880
buffer_load_dwordx4 v15, s[12:15], s32 offen offset:3072 lds
s_waitcnt lgkmcnt(8)
v_mfma_f32_32x32x16_bf16 v[176:191], a[20:23], a[180:183], v[176:191]
ds_read_b64_tr_b16 a[160:161], v2 offset:30720
ds_read_b64_tr_b16 a[162:163], v2 offset:32000
s_add_u32 m0, s25, 86016
s_add_u32 s32, s23, 983360
buffer_load_dwordx4 v16, s[12:15], s32 offen lds
s_waitcnt lgkmcnt(8)
v_mfma_f32_32x32x16_bf16 v[192:207], a[20:23], a[184:187], v[192:207]
ds_read_b64_tr_b16 a[164:165], v3 offset:30720
ds_read_b64_tr_b16 a[166:167], v3 offset:32000
s_waitcnt lgkmcnt(8)
v_mfma_f32_32x32x16_bf16 v[208:223], a[20:23], a[188:191], v[208:223]
ds_read_b64_tr_b16 a[168:169], v4 offset:30720
ds_read_b64_tr_b16 a[170:171], v4 offset:32000
s_waitcnt lgkmcnt(8)
v_mfma_f32_32x32x16_bf16 v[224:239], a[20:23], a[192:195], v[224:239]
ds_read_b64_tr_b16 a[172:173], v5 offset:30720
ds_read_b64_tr_b16 a[174:175], v5 offset:32000
s_waitcnt lgkmcnt(8)
v_mfma_f32_32x32x16_bf16 v[240:255], a[20:23], a[196:199], v[240:255]
ds_read_b64_tr_b16 a[176:177], v6 offset:30720
ds_read_b64_tr_b16 a[178:179], v6 offset:32000
s_waitcnt lgkmcnt(8)
v_mfma_f32_32x32x16_bf16 v[176:191], a[24:27], a[160:163], v[176:191]
ds_read_b64_tr_b16 a[180:181], v2 offset:35840
ds_read_b64_tr_b16 a[182:183], v2 offset:37120
s_waitcnt lgkmcnt(8)
v_mfma_f32_32x32x16_bf16 v[192:207], a[24:27], a[164:167], v[192:207]
ds_read_b64_tr_b16 a[184:185], v3 offset:35840
ds_read_b64_tr_b16 a[186:187], v3 offset:37120
s_waitcnt lgkmcnt(8)
v_mfma_f32_32x32x16_bf16 v[208:223], a[24:27], a[168:171], v[208:223]
ds_read_b64_tr_b16 a[188:189], v4 offset:35840
ds_read_b64_tr_b16 a[190:191], v4 offset:37120
s_waitcnt lgkmcnt(8)
v_mfma_f32_32x32x16_bf16 v[224:239], a[24:27], a[172:175], v[224:239]
ds_read_b64_tr_b16 a[192:193], v5 offset:35840
ds_read_b64_tr_b16 a[194:195], v5 offset:37120
s_waitcnt lgkmcnt(8)
v_mfma_f32_32x32x16_bf16 v[240:255], a[24:27], a[176:179], v[240:255]
ds_read_b64_tr_b16 a[196:197], v6 offset:35840
ds_read_b64_tr_b16 a[198:199], v6 offset:37120
s_waitcnt vmcnt(23)
s_barrier
s_waitcnt lgkmcnt(8)
v_mfma_f32_32x32x16_bf16 v[176:191], a[28:31], a[180:183], v[176:191]
ds_read_b64_tr_b16 a[160:161], v2 offset:40960
ds_read_b64_tr_b16 a[162:163], v2 offset:42240
s_waitcnt lgkmcnt(8)
v_mfma_f32_32x32x16_bf16 v[192:207], a[28:31], a[184:187], v[192:207]
ds_read_b64_tr_b16 a[164:165], v3 offset:40960
ds_read_b64_tr_b16 a[166:167], v3 offset:42240
s_waitcnt lgkmcnt(8)
v_mfma_f32_32x32x16_bf16 v[208:223], a[28:31], a[188:191], v[208:223]
ds_read_b64_tr_b16 a[168:169], v4 offset:40960
ds_read_b64_tr_b16 a[170:171], v4 offset:42240
s_waitcnt lgkmcnt(8)
v_mfma_f32_32x32x16_bf16 v[224:239], a[28:31], a[192:195], v[224:239]
ds_read_b64_tr_b16 a[172:173], v5 offset:40960
ds_read_b64_tr_b16 a[174:175], v5 offset:42240
s_waitcnt lgkmcnt(8)
v_mfma_f32_32x32x16_bf16 v[240:255], a[28:31], a[196:199], v[240:255]
ds_read_b64_tr_b16 a[176:177], v6 offset:40960
ds_read_b64_tr_b16 a[178:179], v6 offset:42240
s_waitcnt lgkmcnt(8)
v_mfma_f32_32x32x16_bf16 v[176:191], a[32:35], a[160:163], v[176:191]
ds_read_b64_tr_b16 a[180:181], v2 offset:46080
ds_read_b64_tr_b16 a[182:183], v2 offset:47360
s_waitcnt lgkmcnt(8)
v_mfma_f32_32x32x16_bf16 v[192:207], a[32:35], a[164:167], v[192:207]
ds_read_b64_tr_b16 a[184:185], v3 offset:46080
ds_read_b64_tr_b16 a[186:187], v3 offset:47360
s_add_u32 m0, s25, 0
s_add_u32 s32, s23, 1229120
buffer_load_dwordx4 v12, s[12:15], s32 offen offset:0 lds
s_waitcnt lgkmcnt(8)
v_mfma_f32_32x32x16_bf16 v[208:223], a[32:35], a[168:171], v[208:223]
ds_read_b64_tr_b16 a[188:189], v4 offset:46080
ds_read_b64_tr_b16 a[190:191], v4 offset:47360
buffer_load_dwordx4 v13, s[12:15], s32 offen offset:1024 lds
s_waitcnt lgkmcnt(8)
v_mfma_f32_32x32x16_bf16 v[224:239], a[32:35], a[172:175], v[224:239]
ds_read_b64_tr_b16 a[192:193], v5 offset:46080
ds_read_b64_tr_b16 a[194:195], v5 offset:47360
buffer_load_dwordx4 v14, s[12:15], s32 offen offset:2048 lds
s_waitcnt lgkmcnt(8)
v_mfma_f32_32x32x16_bf16 v[240:255], a[32:35], a[176:179], v[240:255]
ds_read_b64_tr_b16 a[196:197], v6 offset:46080
ds_read_b64_tr_b16 a[198:199], v6 offset:47360
buffer_load_dwordx4 v15, s[12:15], s32 offen offset:3072 lds
s_waitcnt vmcnt(20)
v_add_f32 v32, v32, v33
s_waitcnt vmcnt(18)
v_add_f32 v34, v34, v35
s_waitcnt lgkmcnt(8)
v_mfma_f32_32x32x16_bf16 v[176:191], a[36:39], a[180:183], v[176:191]
ds_read_b64_tr_b16 a[160:161], v2 offset:51200
ds_read_b64_tr_b16 a[162:163], v2 offset:52480
s_add_u32 m0, s25, 4096
s_add_u32 s32, s23, 1229120
buffer_load_dwordx4 v16, s[12:15], s32 offen lds
v_add_f32 v32, v32, v34
ds_write_b32 v91, v32 offset:0
s_waitcnt lgkmcnt(9)
v_mfma_f32_32x32x16_bf16 v[192:207], a[36:39], a[184:187], v[192:207]
ds_read_b64_tr_b16 a[164:165], v3 offset:51200
ds_read_b64_tr_b16 a[166:167], v3 offset:52480
s_waitcnt vmcnt(17)
v_add_f32 v36, v36, v37
s_waitcnt vmcnt(15)
v_add_f32 v38, v38, v39
s_waitcnt lgkmcnt(9)
v_mfma_f32_32x32x16_bf16 v[208:223], a[36:39], a[188:191], v[208:223]
ds_read_b64_tr_b16 a[168:169], v4 offset:51200
ds_read_b64_tr_b16 a[170:171], v4 offset:52480
v_add_f32 v36, v36, v38
ds_write_b32 v91, v36 offset:640
s_waitcnt lgkmcnt(10)
v_mfma_f32_32x32x16_bf16 v[224:239], a[36:39], a[192:195], v[224:239]
ds_read_b64_tr_b16 a[172:173], v5 offset:51200
ds_read_b64_tr_b16 a[174:175], v5 offset:52480
s_waitcnt lgkmcnt(10)
v_mfma_f32_32x32x16_bf16 v[240:255], a[36:39], a[196:199], v[240:255]
ds_read_b64_tr_b16 a[176:177], v6 offset:51200
ds_read_b64_tr_b16 a[178:179], v6 offset:52480
s_waitcnt lgkmcnt(10)
v_mfma_f32_32x32x16_bf16 v[176:191], a[40:43], a[160:163], v[176:191]
ds_read_b64_tr_b16 a[180:181], v2 offset:56320
ds_read_b64_tr_b16 a[182:183], v2 offset:57600
s_waitcnt vmcnt(14)
v_cvt_pk_bf16_f32 v44, v84, v84
v_and_b32 v45, 0xffff0000, v44
s_waitcnt lgkmcnt(9)
v_mfma_f32_32x32x16_bf16 v[192:207], a[40:43], a[164:167], v[192:207]
ds_read_b64_tr_b16 a[184:185], v3 offset:56320
ds_read_b64_tr_b16 a[186:187], v3 offset:57600
v_sub_f32 v45, v84, v45
v_cvt_pk_bf16_f32 v45, v45, v45
s_waitcnt lgkmcnt(9)
v_mfma_f32_32x32x16_bf16 v[208:223], a[40:43], a[168:171], v[208:223]
ds_read_b64_tr_b16 a[188:189], v4 offset:56320
ds_read_b64_tr_b16 a[190:191], v4 offset:57600
s_mov_b32 s33, 0xffff
v_bfi_b32 v44, s33, v44, v45
s_waitcnt lgkmcnt(8)
v_mfma_f32_32x32x16_bf16 v[224:239], a[40:43], a[172:175], v[224:239]
ds_read_b64_tr_b16 a[192:193], v5 offset:56320
ds_read_b64_tr_b16 a[194:195], v5 offset:57600
v_cmp_gt_u32 vcc, 32, v1
s_nop 1
v_cndmask_b32 v88, 0, v44, vcc
s_waitcnt lgkmcnt(8)
v_mfma_f32_32x32x16_bf16 v[240:255], a[40:43], a[176:179], v[240:255]
ds_read_b64_tr_b16 a[196:197], v6 offset:56320
ds_read_b64_tr_b16 a[198:199], v6 offset:57600
v_mov_b32 v89, v88
s_waitcnt lgkmcnt(0)
s_barrier
v_mfma_f32_32x32x16_bf16 v[176:191], a[44:47], a[180:183], v[176:191]
ds_read_b64_tr_b16 a[160:161], v7 offset:0
ds_read_b64_tr_b16 a[162:163], v7 offset:1280
v_mfma_f32_32x32x16_bf16 v[192:207], a[44:47], a[184:187], v[192:207]
ds_read_b64_tr_b16 a[164:165], v8 offset:0
ds_read_b64_tr_b16 a[166:167], v8 offset:1280
v_mfma_f32_32x32x16_bf16 v[208:223], a[44:47], a[188:191], v[208:223]
ds_read_b64_tr_b16 a[168:169], v9 offset:0
ds_read_b64_tr_b16 a[170:171], v9 offset:1280
v_mfma_f32_32x32x16_bf16 v[224:239], a[44:47], a[192:195], v[224:239]
ds_read_b64_tr_b16 a[172:173], v10 offset:0
ds_read_b64_tr_b16 a[174:175], v10 offset:1280
v_mfma_f32_32x32x16_bf16 v[240:255], a[44:47], a[196:199], v[240:255]
ds_read_b64_tr_b16 a[176:177], v11 offset:0
ds_read_b64_tr_b16 a[178:179], v11 offset:1280
s_waitcnt lgkmcnt(8)
v_mfma_f32_32x32x16_bf16 v[176:191], a[48:51], a[160:163], v[176:191]
ds_read_b64_tr_b16 a[180:181], v7 offset:5120
ds_read_b64_tr_b16 a[182:183], v7 offset:6400
s_waitcnt lgkmcnt(8)
v_mfma_f32_32x32x16_bf16 v[192:207], a[48:51], a[164:167], v[192:207]
ds_read_b64_tr_b16 a[184:185], v8 offset:5120
ds_read_b64_tr_b16 a[186:187], v8 offset:6400
s_add_u32 m0, s25, 20480
s_add_u32 s32, s23, 1474880
buffer_load_dwordx4 v12, s[12:15], s32 offen offset:0 lds
ds_read_b32 v62, v95 offset:0
ds_read_b32 v63, v95 offset:128
s_waitcnt lgkmcnt(10)
v_mfma_f32_32x32x16_bf16 v[208:223], a[48:51], a[168:171], v[208:223]
ds_read_b64_tr_b16 a[188:189], v9 offset:5120
ds_read_b64_tr_b16 a[190:191], v9 offset:6400
buffer_load_dwordx4 v13, s[12:15], s32 offen offset:1024 lds
ds_read_b32 v64, v95 offset:256
ds_read_b32 v65, v95 offset:384
s_waitcnt lgkmcnt(12)
v_mfma_f32_32x32x16_bf16 v[224:239], a[48:51], a[172:175], v[224:239]
ds_read_b64_tr_b16 a[192:193], v10 offset:5120
ds_read_b64_tr_b16 a[194:195], v10 offset:6400
buffer_load_dwordx4 v14, s[12:15], s32 offen offset:2048 lds
ds_read_b32 v66, v95 offset:512
s_waitcnt lgkmcnt(8)
v_cvt_pk_bf16_f32 v52, v62, v62
v_mfma_f32_32x32x16_bf16 v[240:255], a[48:51], a[176:179], v[240:255]
ds_read_b64_tr_b16 a[196:197], v11 offset:5120
ds_read_b64_tr_b16 a[198:199], v11 offset:6400
buffer_load_dwordx4 v15, s[12:15], s32 offen offset:3072 lds
v_and_b32 v53, 0xffff0000, v52
v_sub_f32 v53, v62, v53
v_mfma_f32_32x32x16_bf16 v[176:191], a[52:55], a[180:183], v[176:191]
ds_read_b64_tr_b16 a[160:161], v7 offset:10240
ds_read_b64_tr_b16 a[162:163], v7 offset:11520
s_add_u32 m0, s25, 24576
s_add_u32 s32, s23, 1474880
buffer_load_dwordx4 v16, s[12:15], s32 offen lds
v_cvt_pk_bf16_f32 v53, v53, v53
s_waitcnt lgkmcnt(11)
v_cvt_pk_bf16_f32 v54, v63, v63
v_mfma_f32_32x32x16_bf16 v[192:207], a[52:55], a[184:187], v[192:207]
ds_read_b64_tr_b16 a[164:165], v8 offset:10240
ds_read_b64_tr_b16 a[166:167], v8 offset:11520
v_and_b32 v55, 0xffff0000, v54
v_sub_f32 v55, v63, v55
s_waitcnt lgkmcnt(11)
v_mfma_f32_32x32x16_bf16 v[208:223], a[52:55], a[188:191], v[208:223]
ds_read_b64_tr_b16 a[168:169], v9 offset:10240
ds_read_b64_tr_b16 a[170:171], v9 offset:11520
v_cvt_pk_bf16_f32 v55, v55, v55
s_waitcnt lgkmcnt(12)
v_cvt_pk_bf16_f32 v56, v64, v64
s_waitcnt lgkmcnt(9)
v_mfma_f32_32x32x16_bf16 v[224:239], a[52:55], a[192:195], v[224:239]
ds_read_b64_tr_b16 a[172:173], v10 offset:10240
ds_read_b64_tr_b16 a[174:175], v10 offset:11520
v_and_b32 v57, 0xffff0000, v56
v_sub_f32 v57, v64, v57
s_waitcnt lgkmcnt(8)
v_mfma_f32_32x32x16_bf16 v[240:255], a[52:55], a[196:199], v[240:255]
ds_read_b64_tr_b16 a[176:177], v11 offset:10240
ds_read_b64_tr_b16 a[178:179], v11 offset:11520
v_cvt_pk_bf16_f32 v57, v57, v57
v_cvt_pk_bf16_f32 v58, v65, v65
s_waitcnt lgkmcnt(8)
v_mfma_f32_32x32x16_bf16 v[176:191], a[56:59], a[160:163], v[176:191]
ds_read_b64_tr_b16 a[180:181], v7 offset:15360
ds_read_b64_tr_b16 a[182:183], v7 offset:16640
v_and_b32 v59, 0xffff0000, v58
v_sub_f32 v59, v65, v59
s_waitcnt lgkmcnt(8)
v_mfma_f32_32x32x16_bf16 v[192:207], a[56:59], a[164:167], v[192:207]
ds_read_b64_tr_b16 a[184:185], v8 offset:15360
ds_read_b64_tr_b16 a[186:187], v8 offset:16640
v_cvt_pk_bf16_f32 v59, v59, v59
v_cvt_pk_bf16_f32 v60, v66, v66
s_waitcnt lgkmcnt(8)
v_mfma_f32_32x32x16_bf16 v[208:223], a[56:59], a[168:171], v[208:223]
ds_read_b64_tr_b16 a[188:189], v9 offset:15360
ds_read_b64_tr_b16 a[190:191], v9 offset:16640
v_and_b32 v61, 0xffff0000, v60
v_sub_f32 v61, v66, v61
s_waitcnt lgkmcnt(8)
v_mfma_f32_32x32x16_bf16 v[224:239], a[56:59], a[172:175], v[224:239]
ds_read_b64_tr_b16 a[192:193], v10 offset:15360
ds_read_b64_tr_b16 a[194:195], v10 offset:16640
v_cvt_pk_bf16_f32 v61, v61, v61
v_mfma_f32_32x32x8_bf16 v[96:111], v[88:89], v[52:53], v[96:111]
s_waitcnt lgkmcnt(8)
v_mfma_f32_32x32x16_bf16 v[240:255], a[56:59], a[176:179], v[240:255]
ds_read_b64_tr_b16 a[196:197], v11 offset:15360
ds_read_b64_tr_b16 a[198:199], v11 offset:16640
v_mfma_f32_32x32x8_bf16 v[112:127], v[88:89], v[54:55], v[112:127]
v_mfma_f32_32x32x8_bf16 v[128:143], v[88:89], v[56:57], v[128:143]
s_waitcnt vmcnt(10)
s_barrier
s_waitcnt lgkmcnt(8)
v_mfma_f32_32x32x16_bf16 v[176:191], a[60:63], a[180:183], v[176:191]
ds_read_b64_tr_b16 a[160:161], v7 offset:20480
ds_read_b64_tr_b16 a[162:163], v7 offset:21760
v_mfma_f32_32x32x8_bf16 v[144:159], v[88:89], v[58:59], v[144:159]
v_mfma_f32_32x32x8_bf16 v[160:175], v[88:89], v[60:61], v[160:175]
s_waitcnt lgkmcnt(8)
v_mfma_f32_32x32x16_bf16 v[192:207], a[60:63], a[184:187], v[192:207]
ds_read_b64_tr_b16 a[164:165], v8 offset:20480
ds_read_b64_tr_b16 a[166:167], v8 offset:21760
v_mul_f32 v96, v68, v96
v_mul_f32 v97, v69, v97
s_waitcnt lgkmcnt(8)
v_mfma_f32_32x32x16_bf16 v[208:223], a[60:63], a[188:191], v[208:223]
ds_read_b64_tr_b16 a[168:169], v9 offset:20480
ds_read_b64_tr_b16 a[170:171], v9 offset:21760
v_mul_f32 v98, v70, v98
v_mul_f32 v99, v71, v99
s_waitcnt lgkmcnt(8)
v_mfma_f32_32x32x16_bf16 v[224:239], a[60:63], a[192:195], v[224:239]
ds_read_b64_tr_b16 a[172:173], v10 offset:20480
ds_read_b64_tr_b16 a[174:175], v10 offset:21760
v_mul_f32 v100, v72, v100
v_mul_f32 v101, v73, v101
s_waitcnt lgkmcnt(8)
v_mfma_f32_32x32x16_bf16 v[240:255], a[60:63], a[196:199], v[240:255]
ds_read_b64_tr_b16 a[176:177], v11 offset:20480
ds_read_b64_tr_b16 a[178:179], v11 offset:21760
v_mul_f32 v102, v74, v102
v_mul_f32 v103, v75, v103
s_waitcnt lgkmcnt(8)
v_mfma_f32_32x32x16_bf16 v[176:191], a[64:67], a[160:163], v[176:191]
ds_read_b64_tr_b16 a[180:181], v7 offset:25600
ds_read_b64_tr_b16 a[182:183], v7 offset:26880
v_mul_f32 v104, v76, v104
v_mul_f32 v105, v77, v105
s_waitcnt lgkmcnt(8)
v_mfma_f32_32x32x16_bf16 v[192:207], a[64:67], a[164:167], v[192:207]
ds_read_b64_tr_b16 a[184:185], v8 offset:25600
ds_read_b64_tr_b16 a[186:187], v8 offset:26880
s_add_u32 m0, s25, 40960
s_add_u32 s32, s23, 1720640
buffer_load_dwordx4 v12, s[12:15], s32 offen offset:0 lds
v_mul_f32 v106, v78, v106
v_mul_f32 v107, v79, v107
s_waitcnt lgkmcnt(8)
v_mfma_f32_32x32x16_bf16 v[208:223], a[64:67], a[168:171], v[208:223]
ds_read_b64_tr_b16 a[188:189], v9 offset:25600
ds_read_b64_tr_b16 a[190:191], v9 offset:26880
buffer_load_dwordx4 v13, s[12:15], s32 offen offset:1024 lds
v_mul_f32 v108, v80, v108
v_mul_f32 v109, v81, v109
s_waitcnt lgkmcnt(8)
v_mfma_f32_32x32x16_bf16 v[224:239], a[64:67], a[172:175], v[224:239]
ds_read_b64_tr_b16 a[192:193], v10 offset:25600
ds_read_b64_tr_b16 a[194:195], v10 offset:26880
buffer_load_dwordx4 v14, s[12:15], s32 offen offset:2048 lds
v_mul_f32 v110, v82, v110
v_mul_f32 v111, v83, v111
s_waitcnt lgkmcnt(8)
v_mfma_f32_32x32x16_bf16 v[240:255], a[64:67], a[176:179], v[240:255]
ds_read_b64_tr_b16 a[196:197], v11 offset:25600
ds_read_b64_tr_b16 a[198:199], v11 offset:26880
buffer_load_dwordx4 v15, s[12:15], s32 offen offset:3072 lds
v_cvt_pk_bf16_f32 v32, v96, v97
v_cvt_pk_bf16_f32 v33, v98, v99
s_waitcnt lgkmcnt(8)
v_mfma_f32_32x32x16_bf16 v[176:191], a[68:71], a[180:183], v[176:191]
ds_read_b64_tr_b16 a[160:161], v7 offset:30720
ds_read_b64_tr_b16 a[162:163], v7 offset:32000
s_add_u32 m0, s25, 45056
s_add_u32 s32, s23, 1720640
buffer_load_dwordx4 v16, s[12:15], s32 offen lds
v_cvt_pk_bf16_f32 v34, v100, v101
v_cvt_pk_bf16_f32 v35, v102, v103
s_waitcnt lgkmcnt(8)
v_mfma_f32_32x32x16_bf16 v[192:207], a[68:71], a[184:187], v[192:207]
ds_read_b64_tr_b16 a[164:165], v8 offset:30720
ds_read_b64_tr_b16 a[166:167], v8 offset:32000
buffer_store_dwordx4 v[32:35], v25, s[16:19], s43 offen offset:0 sc1
v_cvt_pk_bf16_f32 v36, v104, v105
s_waitcnt lgkmcnt(8)
v_mfma_f32_32x32x16_bf16 v[208:223], a[68:71], a[188:191], v[208:223]
ds_read_b64_tr_b16 a[168:169], v9 offset:30720
ds_read_b64_tr_b16 a[170:171], v9 offset:32000
v_cvt_pk_bf16_f32 v37, v106, v107
s_waitcnt lgkmcnt(8)
v_mfma_f32_32x32x16_bf16 v[224:239], a[68:71], a[192:195], v[224:239]
ds_read_b64_tr_b16 a[172:173], v10 offset:30720
ds_read_b64_tr_b16 a[174:175], v10 offset:32000
v_cvt_pk_bf16_f32 v38, v108, v109
s_waitcnt lgkmcnt(8)
v_mfma_f32_32x32x16_bf16 v[240:255], a[68:71], a[196:199], v[240:255]
ds_read_b64_tr_b16 a[176:177], v11 offset:30720
ds_read_b64_tr_b16 a[178:179], v11 offset:32000
v_cvt_pk_bf16_f32 v39, v110, v111
s_waitcnt lgkmcnt(8)
v_mfma_f32_32x32x16_bf16 v[176:191], a[72:75], a[160:163], v[176:191]
ds_read_b64_tr_b16 a[180:181], v7 offset:35840
ds_read_b64_tr_b16 a[182:183], v7 offset:37120
buffer_store_dwordx4 v[36:39], v25, s[16:19], s43 offen offset:672 sc1
s_waitcnt lgkmcnt(8)
v_mfma_f32_32x32x16_bf16 v[192:207], a[72:75], a[164:167], v[192:207]
ds_read_b64_tr_b16 a[184:185], v8 offset:35840
ds_read_b64_tr_b16 a[186:187], v8 offset:37120
v_mul_f32 v112, v68, v112
s_waitcnt lgkmcnt(8)
v_mfma_f32_32x32x16_bf16 v[208:223], a[72:75], a[168:171], v[208:223]
ds_read_b64_tr_b16 a[188:189], v9 offset:35840
ds_read_b64_tr_b16 a[190:191], v9 offset:37120
v_mul_f32 v113, v69, v113
s_waitcnt lgkmcnt(8)
v_mfma_f32_32x32x16_bf16 v[224:239], a[72:75], a[172:175], v[224:239]
ds_read_b64_tr_b16 a[192:193], v10 offset:35840
ds_read_b64_tr_b16 a[194:195], v10 offset:37120
v_mul_f32 v114, v70, v114
s_waitcnt lgkmcnt(8)
v_mfma_f32_32x32x16_bf16 v[240:255], a[72:75], a[176:179], v[240:255]
ds_read_b64_tr_b16 a[196:197], v11 offset:35840
ds_read_b64_tr_b16 a[198:199], v11 offset:37120
v_mul_f32 v115, v71, v115
s_waitcnt vmcnt(12)
s_barrier
s_waitcnt lgkmcnt(8)
v_mfma_f32_32x32x16_bf16 v[176:191], a[76:79], a[180:183], v[176:191]
ds_read_b64_tr_b16 a[160:161], v2 offset:0
ds_read_b64_tr_b16 a[162:163], v2 offset:1280
v_mul_f32 v116, v72, v116
s_waitcnt lgkmcnt(8)
v_mfma_f32_32x32x16_bf16 v[192:207], a[76:79], a[184:187], v[192:207]
ds_read_b64_tr_b16 a[164:165], v3 offset:0
ds_read_b64_tr_b16 a[166:167], v3 offset:1280
v_mul_f32 v117, v73, v117
s_waitcnt lgkmcnt(8)
v_mfma_f32_32x32x16_bf16 v[208:223], a[76:79], a[188:191], v[208:223]
ds_read_b64_tr_b16 a[168:169], v4 offset:0
ds_read_b64_tr_b16 a[170:171], v4 offset:1280
v_mul_f32 v118, v74, v118
s_waitcnt lgkmcnt(8)
v_mfma_f32_32x32x16_bf16 v[224:239], a[76:79], a[192:195], v[224:239]
ds_read_b64_tr_b16 a[172:173], v5 offset:0
ds_read_b64_tr_b16 a[174:175], v5 offset:1280
v_mul_f32 v119, v75, v119
s_waitcnt lgkmcnt(8)
v_mfma_f32_32x32x16_bf16 v[240:255], a[76:79], a[196:199], v[240:255]
ds_read_b64_tr_b16 a[176:177], v6 offset:0
ds_read_b64_tr_b16 a[178:179], v6 offset:1280
v_mul_f32 v120, v76, v120
s_waitcnt lgkmcnt(8)
v_mfma_f32_32x32x16_bf16 v[176:191], a[80:83], a[160:163], v[176:191]
ds_read_b64_tr_b16 a[180:181], v2 offset:5120
ds_read_b64_tr_b16 a[182:183], v2 offset:6400
v_mul_f32 v121, v77, v121
s_waitcnt lgkmcnt(8)
v_mfma_f32_32x32x16_bf16 v[192:207], a[80:83], a[164:167], v[192:207]
ds_read_b64_tr_b16 a[184:185], v3 offset:5120
ds_read_b64_tr_b16 a[186:187], v3 offset:6400
s_add_u32 m0, s25, 61440
s_add_u32 s32, s23, 1966400
buffer_load_dwordx4 v12, s[12:15], s32 offen offset:0 lds
v_mul_f32 v122, v78, v122
s_waitcnt lgkmcnt(8)
v_mfma_f32_32x32x16_bf16 v[208:223], a[80:83], a[168:171], v[208:223]
ds_read_b64_tr_b16 a[188:189], v4 offset:5120
ds_read_b64_tr_b16 a[190:191], v4 offset:6400
buffer_load_dwordx4 v13, s[12:15], s32 offen offset:1024 lds
v_mul_f32 v123, v79, v123
s_waitcnt lgkmcnt(8)
v_mfma_f32_32x32x16_bf16 v[224:239], a[80:83], a[172:175], v[224:239]
ds_read_b64_tr_b16 a[192:193], v5 offset:5120
ds_read_b64_tr_b16 a[194:195], v5 offset:6400
buffer_load_dwordx4 v14, s[12:15], s32 offen offset:2048 lds
v_mul_f32 v124, v80, v124
s_waitcnt lgkmcnt(8)
v_mfma_f32_32x32x16_bf16 v[240:255], a[80:83], a[176:179], v[240:255]
ds_read_b64_tr_b16 a[196:197], v6 offset:5120
ds_read_b64_tr_b16 a[198:199], v6 offset:6400
buffer_load_dwordx4 v15, s[12:15], s32 offen offset:3072 lds
v_mul_f32 v125, v81, v125
s_waitcnt lgkmcnt(8)
v_mfma_f32_32x32x16_bf16 v[176:191], a[84:87], a[180:183], v[176:191]
ds_read_b64_tr_b16 a[160:161], v2 offset:10240
ds_read_b64_tr_b16 a[162:163], v2 offset:11520
s_add_u32 m0, s25, 65536
s_add_u32 s32, s23, 1966400
buffer_load_dwordx4 v16, s[12:15], s32 offen lds
v_mul_f32 v126, v82, v126
s_waitcnt lgkmcnt(8)
v_mfma_f32_32x32x16_bf16 v[192:207], a[84:87], a[184:187], v[192:207]
ds_read_b64_tr_b16 a[164:165], v3 offset:10240
ds_read_b64_tr_b16 a[166:167], v3 offset:11520
v_mul_f32 v127, v83, v127
s_waitcnt lgkmcnt(8)
v_mfma_f32_32x32x16_bf16 v[208:223], a[84:87], a[188:191], v[208:223]
ds_read_b64_tr_b16 a[168:169], v4 offset:10240
ds_read_b64_tr_b16 a[170:171], v4 offset:11520
v_cvt_pk_bf16_f32 v40, v112, v113
s_waitcnt lgkmcnt(8)
v_mfma_f32_32x32x16_bf16 v[224:239], a[84:87], a[192:195], v[224:239]
ds_read_b64_tr_b16 a[172:173], v5 offset:10240
ds_read_b64_tr_b16 a[174:175], v5 offset:11520
v_cvt_pk_bf16_f32 v41, v114, v115
s_waitcnt lgkmcnt(8)
v_mfma_f32_32x32x16_bf16 v[240:255], a[84:87], a[196:199], v[240:255]
ds_read_b64_tr_b16 a[176:177], v6 offset:10240
ds_read_b64_tr_b16 a[178:179], v6 offset:11520
v_cvt_pk_bf16_f32 v42, v116, v117
s_waitcnt lgkmcnt(8)
v_mfma_f32_32x32x16_bf16 v[176:191], a[88:91], a[160:163], v[176:191]
ds_read_b64_tr_b16 a[180:181], v2 offset:15360
ds_read_b64_tr_b16 a[182:183], v2 offset:16640
v_cvt_pk_bf16_f32 v43, v118, v119
s_waitcnt lgkmcnt(8)
v_mfma_f32_32x32x16_bf16 v[192:207], a[88:91], a[164:167], v[192:207]
ds_read_b64_tr_b16 a[184:185], v3 offset:15360
ds_read_b64_tr_b16 a[186:187], v3 offset:16640
buffer_store_dwordx4 v[40:43], v26, s[16:19], s43 offen offset:0 sc1
s_waitcnt lgkmcnt(8)
v_mfma_f32_32x32x16_bf16 v[208:223], a[88:91], a[168:171], v[208:223]
ds_read_b64_tr_b16 a[188:189], v4 offset:15360
ds_read_b64_tr_b16 a[190:191], v4 offset:16640
v_cvt_pk_bf16_f32 v44, v120, v121
s_waitcnt lgkmcnt(8)
v_mfma_f32_32x32x16_bf16 v[224:239], a[88:91], a[172:175], v[224:239]
ds_read_b64_tr_b16 a[192:193], v5 offset:15360
ds_read_b64_tr_b16 a[194:195], v5 offset:16640
v_cvt_pk_bf16_f32 v45, v122, v123
s_waitcnt lgkmcnt(8)
v_mfma_f32_32x32x16_bf16 v[240:255], a[88:91], a[176:179], v[240:255]
ds_read_b64_tr_b16 a[196:197], v6 offset:15360
ds_read_b64_tr_b16 a[198:199], v6 offset:16640
v_cvt_pk_bf16_f32 v46, v124, v125
s_waitcnt vmcnt(13)
s_barrier
s_waitcnt lgkmcnt(8)
v_mfma_f32_32x32x16_bf16 v[176:191], a[92:95], a[180:183], v[176:191]
ds_read_b64_tr_b16 a[160:161], v2 offset:20480
ds_read_b64_tr_b16 a[162:163], v2 offset:21760
v_cvt_pk_bf16_f32 v47, v126, v127
s_waitcnt lgkmcnt(8)
v_mfma_f32_32x32x16_bf16 v[192:207], a[92:95], a[184:187], v[192:207]
ds_read_b64_tr_b16 a[164:165], v3 offset:20480
ds_read_b64_tr_b16 a[166:167], v3 offset:21760
buffer_store_dwordx4 v[44:47], v26, s[16:19], s43 offen offset:672 sc1
s_waitcnt lgkmcnt(8)
v_mfma_f32_32x32x16_bf16 v[208:223], a[92:95], a[188:191], v[208:223]
ds_read_b64_tr_b16 a[168:169], v4 offset:20480
ds_read_b64_tr_b16 a[170:171], v4 offset:21760
v_mul_f32 v128, v68, v128
s_waitcnt lgkmcnt(8)
v_mfma_f32_32x32x16_bf16 v[224:239], a[92:95], a[192:195], v[224:239]
ds_read_b64_tr_b16 a[172:173], v5 offset:20480
ds_read_b64_tr_b16 a[174:175], v5 offset:21760
v_mul_f32 v129, v69, v129
s_waitcnt lgkmcnt(8)
v_mfma_f32_32x32x16_bf16 v[240:255], a[92:95], a[196:199], v[240:255]
ds_read_b64_tr_b16 a[176:177], v6 offset:20480
ds_read_b64_tr_b16 a[178:179], v6 offset:21760
v_mul_f32 v130, v70, v130
s_waitcnt lgkmcnt(8)
v_mfma_f32_32x32x16_bf16 v[176:191], a[96:99], a[160:163], v[176:191]
ds_read_b64_tr_b16 a[180:181], v2 offset:25600
ds_read_b64_tr_b16 a[182:183], v2 offset:26880
v_mul_f32 v131, v71, v131
s_waitcnt lgkmcnt(8)
v_mfma_f32_32x32x16_bf16 v[192:207], a[96:99], a[164:167], v[192:207]
ds_read_b64_tr_b16 a[184:185], v3 offset:25600
ds_read_b64_tr_b16 a[186:187], v3 offset:26880
s_add_u32 m0, s25, 81920
s_add_u32 s32, s23, 2212160
buffer_load_dwordx4 v12, s[12:15], s32 offen offset:0 lds
v_mul_f32 v132, v72, v132
s_waitcnt lgkmcnt(8)
v_mfma_f32_32x32x16_bf16 v[208:223], a[96:99], a[168:171], v[208:223]
ds_read_b64_tr_b16 a[188:189], v4 offset:25600
ds_read_b64_tr_b16 a[190:191], v4 offset:26880
buffer_load_dwordx4 v13, s[12:15], s32 offen offset:1024 lds
v_mul_f32 v133, v73, v133
s_waitcnt lgkmcnt(8)
v_mfma_f32_32x32x16_bf16 v[224:239], a[96:99], a[172:175], v[224:239]
ds_read_b64_tr_b16 a[192:193], v5 offset:25600
ds_read_b64_tr_b16 a[194:195], v5 offset:26880
buffer_load_dwordx4 v14, s[12:15], s32 offen offset:2048 lds
v_mul_f32 v134, v74, v134
s_waitcnt lgkmcnt(8)
v_mfma_f32_32x32x16_bf16 v[240:255], a[96:99], a[176:179], v[240:255]
ds_read_b64_tr_b16 a[196:197], v6 offset:25600
ds_read_b64_tr_b16 a[198:199], v6 offset:26880
buffer_load_dwordx4 v15, s[12:15], s32 offen offset:3072 lds
v_mul_f32 v135, v75, v135
s_waitcnt lgkmcnt(8)
v_mfma_f32_32x32x16_bf16 v[176:191], a[100:103], a[180:183], v[176:191]
ds_read_b64_tr_b16 a[160:161], v2 offset:30720
ds_read_b64_tr_b16 a[162:163], v2 offset:32000
s_add_u32 m0, s25, 86016
s_add_u32 s32, s23, 2212160
buffer_load_dwordx4 v16, s[12:15], s32 offen lds
v_mul_f32 v136, v76, v136
s_waitcnt lgkmcnt(8)
v_mfma_f32_32x32x16_bf16 v[192:207], a[100:103], a[184:187], v[192:207]
ds_read_b64_tr_b16 a[164:165], v3 offset:30720
ds_read_b64_tr_b16 a[166:167], v3 offset:32000
v_mul_f32 v137, v77, v137
s_waitcnt lgkmcnt(8)
v_mfma_f32_32x32x16_bf16 v[208:223], a[100:103], a[188:191], v[208:223]
ds_read_b64_tr_b16 a[168:169], v4 offset:30720
ds_read_b64_tr_b16 a[170:171], v4 offset:32000
v_mul_f32 v138, v78, v138
s_waitcnt lgkmcnt(8)
v_mfma_f32_32x32x16_bf16 v[224:239], a[100:103], a[192:195], v[224:239]
ds_read_b64_tr_b16 a[172:173], v5 offset:30720
ds_read_b64_tr_b16 a[174:175], v5 offset:32000
v_mul_f32 v139, v79, v139
s_waitcnt lgkmcnt(8)
v_mfma_f32_32x32x16_bf16 v[240:255], a[100:103], a[196:199], v[240:255]
ds_read_b64_tr_b16 a[176:177], v6 offset:30720
ds_read_b64_tr_b16 a[178:179], v6 offset:32000
v_mul_f32 v140, v80, v140
s_waitcnt lgkmcnt(8)
v_mfma_f32_32x32x16_bf16 v[176:191], a[104:107], a[160:163], v[176:191]
ds_read_b64_tr_b16 a[180:181], v2 offset:35840
ds_read_b64_tr_b16 a[182:183], v2 offset:37120
v_mul_f32 v141, v81, v141
s_waitcnt lgkmcnt(8)
v_mfma_f32_32x32x16_bf16 v[192:207], a[104:107], a[164:167], v[192:207]
ds_read_b64_tr_b16 a[184:185], v3 offset:35840
ds_read_b64_tr_b16 a[186:187], v3 offset:37120
v_mul_f32 v142, v82, v142
s_waitcnt lgkmcnt(8)
v_mfma_f32_32x32x16_bf16 v[208:223], a[104:107], a[168:171], v[208:223]
ds_read_b64_tr_b16 a[188:189], v4 offset:35840
ds_read_b64_tr_b16 a[190:191], v4 offset:37120
v_mul_f32 v143, v83, v143
s_waitcnt lgkmcnt(8)
v_mfma_f32_32x32x16_bf16 v[224:239], a[104:107], a[172:175], v[224:239]
ds_read_b64_tr_b16 a[192:193], v5 offset:35840
ds_read_b64_tr_b16 a[194:195], v5 offset:37120
v_cvt_pk_bf16_f32 v32, v128, v129
s_waitcnt lgkmcnt(8)
v_mfma_f32_32x32x16_bf16 v[240:255], a[104:107], a[176:179], v[240:255]
ds_read_b64_tr_b16 a[196:197], v6 offset:35840
ds_read_b64_tr_b16 a[198:199], v6 offset:37120
v_cvt_pk_bf16_f32 v33, v130, v131
s_waitcnt vmcnt(14)
s_barrier
s_waitcnt lgkmcnt(8)
v_mfma_f32_32x32x16_bf16 v[176:191], a[108:111], a[180:183], v[176:191]
ds_read_b64_tr_b16 a[160:161], v2 offset:40960
ds_read_b64_tr_b16 a[162:163], v2 offset:42240
v_cvt_pk_bf16_f32 v34, v132, v133
s_waitcnt lgkmcnt(8)
v_mfma_f32_32x32x16_bf16 v[192:207], a[108:111], a[184:187], v[192:207]
ds_read_b64_tr_b16 a[164:165], v3 offset:40960
ds_read_b64_tr_b16 a[166:167], v3 offset:42240
v_cvt_pk_bf16_f32 v35, v134, v135
s_waitcnt lgkmcnt(8)
v_mfma_f32_32x32x16_bf16 v[208:223], a[108:111], a[188:191], v[208:223]
ds_read_b64_tr_b16 a[168:169], v4 offset:40960
ds_read_b64_tr_b16 a[170:171], v4 offset:42240
buffer_store_dwordx4 v[32:35], v27, s[16:19], s43 offen offset:0 sc1
s_waitcnt lgkmcnt(8)
v_mfma_f32_32x32x16_bf16 v[224:239], a[108:111], a[192:195], v[224:239]
ds_read_b64_tr_b16 a[172:173], v5 offset:40960
ds_read_b64_tr_b16 a[174:175], v5 offset:42240
v_cvt_pk_bf16_f32 v36, v136, v137
s_waitcnt lgkmcnt(8)
v_mfma_f32_32x32x16_bf16 v[240:255], a[108:111], a[196:199], v[240:255]
ds_read_b64_tr_b16 a[176:177], v6 offset:40960
ds_read_b64_tr_b16 a[178:179], v6 offset:42240
v_cvt_pk_bf16_f32 v37, v138, v139
s_waitcnt lgkmcnt(8)
v_mfma_f32_32x32x16_bf16 v[176:191], a[112:115], a[160:163], v[176:191]
ds_read_b64_tr_b16 a[180:181], v2 offset:46080
ds_read_b64_tr_b16 a[182:183], v2 offset:47360
v_cvt_pk_bf16_f32 v38, v140, v141
s_waitcnt lgkmcnt(8)
v_mfma_f32_32x32x16_bf16 v[192:207], a[112:115], a[164:167], v[192:207]
ds_read_b64_tr_b16 a[184:185], v3 offset:46080
ds_read_b64_tr_b16 a[186:187], v3 offset:47360
v_cvt_pk_bf16_f32 v39, v142, v143
s_waitcnt lgkmcnt(8)
v_mfma_f32_32x32x16_bf16 v[208:223], a[112:115], a[168:171], v[208:223]
ds_read_b64_tr_b16 a[188:189], v4 offset:46080
ds_read_b64_tr_b16 a[190:191], v4 offset:47360
buffer_store_dwordx4 v[36:39], v27, s[16:19], s43 offen offset:672 sc1
s_waitcnt lgkmcnt(8)
v_mfma_f32_32x32x16_bf16 v[224:239], a[112:115], a[172:175], v[224:239]
ds_read_b64_tr_b16 a[192:193], v5 offset:46080
ds_read_b64_tr_b16 a[194:195], v5 offset:47360
v_mul_f32 v144, v68, v144
s_waitcnt lgkmcnt(8)
v_mfma_f32_32x32x16_bf16 v[240:255], a[112:115], a[176:179], v[240:255]
ds_read_b64_tr_b16 a[196:197], v6 offset:46080
ds_read_b64_tr_b16 a[198:199], v6 offset:47360
v_mul_f32 v145, v69, v145
s_waitcnt lgkmcnt(8)
v_mfma_f32_32x32x16_bf16 v[176:191], a[116:119], a[180:183], v[176:191]
ds_read_b64_tr_b16 a[160:161], v2 offset:51200
ds_read_b64_tr_b16 a[162:163], v2 offset:52480
v_mul_f32 v146, v70, v146
s_waitcnt lgkmcnt(8)
v_mfma_f32_32x32x16_bf16 v[192:207], a[116:119], a[184:187], v[192:207]
ds_read_b64_tr_b16 a[164:165], v3 offset:51200
ds_read_b64_tr_b16 a[166:167], v3 offset:52480
v_mul_f32 v147, v71, v147
s_waitcnt lgkmcnt(8)
v_mfma_f32_32x32x16_bf16 v[208:223], a[116:119], a[188:191], v[208:223]
ds_read_b64_tr_b16 a[168:169], v4 offset:51200
ds_read_b64_tr_b16 a[170:171], v4 offset:52480
v_mul_f32 v148, v72, v148
s_waitcnt lgkmcnt(8)
v_mfma_f32_32x32x16_bf16 v[224:239], a[116:119], a[192:195], v[224:239]
ds_read_b64_tr_b16 a[172:173], v5 offset:51200
ds_read_b64_tr_b16 a[174:175], v5 offset:52480
v_mul_f32 v149, v73, v149
s_waitcnt lgkmcnt(8)
v_mfma_f32_32x32x16_bf16 v[240:255], a[116:119], a[196:199], v[240:255]
ds_read_b64_tr_b16 a[176:177], v6 offset:51200
ds_read_b64_tr_b16 a[178:179], v6 offset:52480
v_mul_f32 v150, v74, v150
s_waitcnt lgkmcnt(8)
v_mfma_f32_32x32x16_bf16 v[176:191], a[120:123], a[160:163], v[176:191]
ds_read_b64_tr_b16 a[180:181], v2 offset:56320
ds_read_b64_tr_b16 a[182:183], v2 offset:57600
v_mul_f32 v151, v75, v151
s_waitcnt lgkmcnt(8)
v_mfma_f32_32x32x16_bf16 v[192:207], a[120:123], a[164:167], v[192:207]
ds_read_b64_tr_b16 a[184:185], v3 offset:56320
ds_read_b64_tr_b16 a[186:187], v3 offset:57600
v_mul_f32 v152, v76, v152
s_waitcnt lgkmcnt(8)
v_mfma_f32_32x32x16_bf16 v[208:223], a[120:123], a[168:171], v[208:223]
ds_read_b64_tr_b16 a[188:189], v4 offset:56320
ds_read_b64_tr_b16 a[190:191], v4 offset:57600
v_mul_f32 v153, v77, v153
s_waitcnt lgkmcnt(8)
v_mfma_f32_32x32x16_bf16 v[224:239], a[120:123], a[172:175], v[224:239]
ds_read_b64_tr_b16 a[192:193], v5 offset:56320
ds_read_b64_tr_b16 a[194:195], v5 offset:57600
v_mul_f32 v154, v78, v154
s_waitcnt lgkmcnt(8)
v_mfma_f32_32x32x16_bf16 v[240:255], a[120:123], a[176:179], v[240:255]
ds_read_b64_tr_b16 a[196:197], v6 offset:56320
ds_read_b64_tr_b16 a[198:199], v6 offset:57600
v_mul_f32 v155, v79, v155
s_waitcnt vmcnt(9)
s_barrier
s_waitcnt lgkmcnt(8)
v_mfma_f32_32x32x16_bf16 v[176:191], a[124:127], a[180:183], v[176:191]
ds_read_b64_tr_b16 a[160:161], v7 offset:0
ds_read_b64_tr_b16 a[162:163], v7 offset:1280
v_mul_f32 v156, v80, v156
s_waitcnt lgkmcnt(8)
v_mfma_f32_32x32x16_bf16 v[192:207], a[124:127], a[184:187], v[192:207]
ds_read_b64_tr_b16 a[164:165], v8 offset:0
ds_read_b64_tr_b16 a[166:167], v8 offset:1280
v_mul_f32 v157, v81, v157
s_waitcnt lgkmcnt(8)
v_mfma_f32_32x32x16_bf16 v[208:223], a[124:127], a[188:191], v[208:223]
ds_read_b64_tr_b16 a[168:169], v9 offset:0
ds_read_b64_tr_b16 a[170:171], v9 offset:1280
v_mul_f32 v158, v82, v158
s_waitcnt lgkmcnt(8)
v_mfma_f32_32x32x16_bf16 v[224:239], a[124:127], a[192:195], v[224:239]
ds_read_b64_tr_b16 a[172:173], v10 offset:0
ds_read_b64_tr_b16 a[174:175], v10 offset:1280
v_mul_f32 v159, v83, v159
s_waitcnt lgkmcnt(8)
v_mfma_f32_32x32x16_bf16 v[240:255], a[124:127], a[196:199], v[240:255]
ds_read_b64_tr_b16 a[176:177], v11 offset:0
ds_read_b64_tr_b16 a[178:179], v11 offset:1280
v_cvt_pk_bf16_f32 v40, v144, v145
s_waitcnt lgkmcnt(8)
v_mfma_f32_32x32x16_bf16 v[176:191], a[128:131], a[160:163], v[176:191]
ds_read_b64_tr_b16 a[180:181], v7 offset:5120
ds_read_b64_tr_b16 a[182:183], v7 offset:6400
v_cvt_pk_bf16_f32 v41, v146, v147
s_waitcnt lgkmcnt(8)
v_mfma_f32_32x32x16_bf16 v[192:207], a[128:131], a[164:167], v[192:207]
ds_read_b64_tr_b16 a[184:185], v8 offset:5120
ds_read_b64_tr_b16 a[186:187], v8 offset:6400
ds_read_b32 v62, v95 offset:640
ds_read_b32 v63, v95 offset:768
v_cvt_pk_bf16_f32 v42, v148, v149
s_waitcnt lgkmcnt(10)
v_mfma_f32_32x32x16_bf16 v[208:223], a[128:131], a[168:171], v[208:223]
ds_read_b64_tr_b16 a[188:189], v9 offset:5120
ds_read_b64_tr_b16 a[190:191], v9 offset:6400
ds_read_b32 v64, v95 offset:896
ds_read_b32 v65, v95 offset:1024
v_cvt_pk_bf16_f32 v43, v150, v151
s_waitcnt lgkmcnt(12)
v_mfma_f32_32x32x16_bf16 v[224:239], a[128:131], a[172:175], v[224:239]
ds_read_b64_tr_b16 a[192:193], v10 offset:5120
ds_read_b64_tr_b16 a[194:195], v10 offset:6400
ds_read_b32 v66, v95 offset:1152
s_waitcnt lgkmcnt(8)
v_cvt_pk_bf16_f32 v52, v62, v62
buffer_store_dwordx4 v[40:43], v28, s[16:19], s43 offen offset:0 sc1
v_mfma_f32_32x32x16_bf16 v[240:255], a[128:131], a[176:179], v[240:255]
ds_read_b64_tr_b16 a[196:197], v11 offset:5120
ds_read_b64_tr_b16 a[198:199], v11 offset:6400
v_and_b32 v53, 0xffff0000, v52
v_sub_f32 v53, v62, v53
v_cvt_pk_bf16_f32 v44, v152, v153
v_mfma_f32_32x32x16_bf16 v[176:191], a[132:135], a[180:183], v[176:191]
ds_read_b64_tr_b16 a[160:161], v7 offset:10240
ds_read_b64_tr_b16 a[162:163], v7 offset:11520
v_cvt_pk_bf16_f32 v53, v53, v53
s_waitcnt lgkmcnt(11)
v_cvt_pk_bf16_f32 v54, v63, v63
v_cvt_pk_bf16_f32 v45, v154, v155
v_mfma_f32_32x32x16_bf16 v[192:207], a[132:135], a[184:187], v[192:207]
ds_read_b64_tr_b16 a[164:165], v8 offset:10240
ds_read_b64_tr_b16 a[166:167], v8 offset:11520
v_and_b32 v55, 0xffff0000, v54
v_sub_f32 v55, v63, v55
v_cvt_pk_bf16_f32 v46, v156, v157
s_waitcnt lgkmcnt(11)
v_mfma_f32_32x32x16_bf16 v[208:223], a[132:135], a[188:191], v[208:223]
ds_read_b64_tr_b16 a[168:169], v9 offset:10240
ds_read_b64_tr_b16 a[170:171], v9 offset:11520
v_cvt_pk_bf16_f32 v55, v55, v55
s_waitcnt lgkmcnt(12)
v_cvt_pk_bf16_f32 v56, v64, v64
v_cvt_pk_bf16_f32 v47, v158, v159
s_waitcnt lgkmcnt(9)
v_mfma_f32_32x32x16_bf16 v[224:239], a[132:135], a[192:195], v[224:239]
ds_read_b64_tr_b16 a[172:173], v10 offset:10240
ds_read_b64_tr_b16 a[174:175], v10 offset:11520
v_and_b32 v57, 0xffff0000, v56
v_sub_f32 v57, v64, v57
buffer_store_dwordx4 v[44:47], v28, s[16:19], s43 offen offset:672 sc1
s_waitcnt lgkmcnt(8)
v_mfma_f32_32x32x16_bf16 v[240:255], a[132:135], a[196:199], v[240:255]
ds_read_b64_tr_b16 a[176:177], v11 offset:10240
ds_read_b64_tr_b16 a[178:179], v11 offset:11520
v_cvt_pk_bf16_f32 v57, v57, v57
v_cvt_pk_bf16_f32 v58, v65, v65
v_mul_f32 v160, v68, v160
s_waitcnt lgkmcnt(8)
v_mfma_f32_32x32x16_bf16 v[176:191], a[136:139], a[160:163], v[176:191]
ds_read_b64_tr_b16 a[180:181], v7 offset:15360
ds_read_b64_tr_b16 a[182:183], v7 offset:16640
v_and_b32 v59, 0xffff0000, v58
v_sub_f32 v59, v65, v59
v_mul_f32 v161, v69, v161
s_waitcnt lgkmcnt(8)
v_mfma_f32_32x32x16_bf16 v[192:207], a[136:139], a[164:167], v[192:207]
ds_read_b64_tr_b16 a[184:185], v8 offset:15360
ds_read_b64_tr_b16 a[186:187], v8 offset:16640
v_cvt_pk_bf16_f32 v59, v59, v59
v_cvt_pk_bf16_f32 v60, v66, v66
v_mul_f32 v162, v70, v162
s_waitcnt lgkmcnt(8)
v_mfma_f32_32x32x16_bf16 v[208:223], a[136:139], a[168:171], v[208:223]
ds_read_b64_tr_b16 a[188:189], v9 offset:15360
ds_read_b64_tr_b16 a[190:191], v9 offset:16640
v_and_b32 v61, 0xffff0000, v60
v_sub_f32 v61, v66, v61
v_mul_f32 v163, v71, v163
s_waitcnt lgkmcnt(8)
v_mfma_f32_32x32x16_bf16 v[224:239], a[136:139], a[172:175], v[224:239]
ds_read_b64_tr_b16 a[192:193], v10 offset:15360
ds_read_b64_tr_b16 a[194:195], v10 offset:16640
v_cvt_pk_bf16_f32 v61, v61, v61
v_mfma_f32_32x32x8_bf16 v[176:191], v[88:89], v[52:53], v[176:191]
v_mul_f32 v164, v72, v164
s_waitcnt lgkmcnt(8)
v_mfma_f32_32x32x16_bf16 v[240:255], a[136:139], a[176:179], v[240:255]
ds_read_b64_tr_b16 a[196:197], v11 offset:15360
ds_read_b64_tr_b16 a[198:199], v11 offset:16640
v_mfma_f32_32x32x8_bf16 v[192:207], v[88:89], v[54:55], v[192:207]
v_mfma_f32_32x32x8_bf16 v[208:223], v[88:89], v[56:57], v[208:223]
v_mul_f32 v165, v73, v165
s_waitcnt vmcnt(4)
s_barrier
s_waitcnt lgkmcnt(8)
v_mfma_f32_32x32x16_bf16 v[176:191], a[140:143], a[180:183], v[176:191]
ds_read_b64_tr_b16 a[160:161], v7 offset:20480
ds_read_b64_tr_b16 a[162:163], v7 offset:21760
v_mfma_f32_32x32x8_bf16 v[224:239], v[88:89], v[58:59], v[224:239]
v_mfma_f32_32x32x8_bf16 v[240:255], v[88:89], v[60:61], v[240:255]
v_mul_f32 v166, v74, v166
s_waitcnt lgkmcnt(8)
v_mfma_f32_32x32x16_bf16 v[192:207], a[140:143], a[184:187], v[192:207]
ds_read_b64_tr_b16 a[164:165], v8 offset:20480
ds_read_b64_tr_b16 a[166:167], v8 offset:21760
v_mul_f32 v167, v75, v167
s_waitcnt lgkmcnt(8)
v_mfma_f32_32x32x16_bf16 v[208:223], a[140:143], a[188:191], v[208:223]
ds_read_b64_tr_b16 a[168:169], v9 offset:20480
ds_read_b64_tr_b16 a[170:171], v9 offset:21760
v_mul_f32 v168, v76, v168
s_waitcnt lgkmcnt(8)
v_mfma_f32_32x32x16_bf16 v[224:239], a[140:143], a[192:195], v[224:239]
ds_read_b64_tr_b16 a[172:173], v10 offset:20480
ds_read_b64_tr_b16 a[174:175], v10 offset:21760
v_mul_f32 v169, v77, v169
s_waitcnt lgkmcnt(8)
v_mfma_f32_32x32x16_bf16 v[240:255], a[140:143], a[196:199], v[240:255]
ds_read_b64_tr_b16 a[176:177], v11 offset:20480
ds_read_b64_tr_b16 a[178:179], v11 offset:21760
v_mul_f32 v170, v78, v170
s_waitcnt lgkmcnt(8)
v_mfma_f32_32x32x16_bf16 v[176:191], a[144:147], a[160:163], v[176:191]
ds_read_b64_tr_b16 a[180:181], v7 offset:25600
ds_read_b64_tr_b16 a[182:183], v7 offset:26880
v_mul_f32 v171, v79, v171
s_waitcnt lgkmcnt(8)
v_mfma_f32_32x32x16_bf16 v[192:207], a[144:147], a[164:167], v[192:207]
ds_read_b64_tr_b16 a[184:185], v8 offset:25600
ds_read_b64_tr_b16 a[186:187], v8 offset:26880
v_mul_f32 v172, v80, v172
s_waitcnt lgkmcnt(8)
v_mfma_f32_32x32x16_bf16 v[208:223], a[144:147], a[168:171], v[208:223]
ds_read_b64_tr_b16 a[188:189], v9 offset:25600
ds_read_b64_tr_b16 a[190:191], v9 offset:26880
v_mul_f32 v173, v81, v173
s_waitcnt lgkmcnt(8)
v_mfma_f32_32x32x16_bf16 v[224:239], a[144:147], a[172:175], v[224:239]
ds_read_b64_tr_b16 a[192:193], v10 offset:25600
ds_read_b64_tr_b16 a[194:195], v10 offset:26880
v_mul_f32 v174, v82, v174
s_waitcnt lgkmcnt(8)
v_mfma_f32_32x32x16_bf16 v[240:255], a[144:147], a[176:179], v[240:255]
ds_read_b64_tr_b16 a[196:197], v11 offset:25600
ds_read_b64_tr_b16 a[198:199], v11 offset:26880
v_mul_f32 v175, v83, v175
s_waitcnt lgkmcnt(8)
v_mfma_f32_32x32x16_bf16 v[176:191], a[148:151], a[180:183], v[176:191]
ds_read_b64_tr_b16 a[160:161], v7 offset:30720
ds_read_b64_tr_b16 a[162:163], v7 offset:32000
v_cvt_pk_bf16_f32 v32, v160, v161
s_waitcnt lgkmcnt(8)
v_mfma_f32_32x32x16_bf16 v[192:207], a[148:151], a[184:187], v[192:207]
ds_read_b64_tr_b16 a[164:165], v8 offset:30720
ds_read_b64_tr_b16 a[166:167], v8 offset:32000
v_cvt_pk_bf16_f32 v33, v162, v163
s_waitcnt lgkmcnt(8)
v_mfma_f32_32x32x16_bf16 v[208:223], a[148:151], a[188:191], v[208:223]
ds_read_b64_tr_b16 a[168:169], v9 offset:30720
ds_read_b64_tr_b16 a[170:171], v9 offset:32000
v_cvt_pk_bf16_f32 v34, v164, v165
s_waitcnt lgkmcnt(8)
v_mfma_f32_32x32x16_bf16 v[224:239], a[148:151], a[192:195], v[224:239]
ds_read_b64_tr_b16 a[172:173], v10 offset:30720
ds_read_b64_tr_b16 a[174:175], v10 offset:32000
v_cvt_pk_bf16_f32 v35, v166, v167
s_waitcnt lgkmcnt(8)
v_mfma_f32_32x32x16_bf16 v[240:255], a[148:151], a[196:199], v[240:255]
ds_read_b64_tr_b16 a[176:177], v11 offset:30720
ds_read_b64_tr_b16 a[178:179], v11 offset:32000
buffer_store_dwordx4 v[32:35], v29, s[16:19], s43 offen offset:0 sc1
s_waitcnt lgkmcnt(8)
v_mfma_f32_32x32x16_bf16 v[176:191], a[152:155], a[160:163], v[176:191]
ds_read_b64_tr_b16 a[180:181], v7 offset:35840
ds_read_b64_tr_b16 a[182:183], v7 offset:37120
v_cvt_pk_bf16_f32 v36, v168, v169
s_waitcnt lgkmcnt(8)
v_mfma_f32_32x32x16_bf16 v[192:207], a[152:155], a[164:167], v[192:207]
ds_read_b64_tr_b16 a[184:185], v8 offset:35840
ds_read_b64_tr_b16 a[186:187], v8 offset:37120
v_cvt_pk_bf16_f32 v37, v170, v171
s_waitcnt lgkmcnt(8)
v_mfma_f32_32x32x16_bf16 v[208:223], a[152:155], a[168:171], v[208:223]
ds_read_b64_tr_b16 a[188:189], v9 offset:35840
ds_read_b64_tr_b16 a[190:191], v9 offset:37120
v_cvt_pk_bf16_f32 v38, v172, v173
s_waitcnt lgkmcnt(8)
v_mfma_f32_32x32x16_bf16 v[224:239], a[152:155], a[172:175], v[224:239]
ds_read_b64_tr_b16 a[192:193], v10 offset:35840
ds_read_b64_tr_b16 a[194:195], v10 offset:37120
v_cvt_pk_bf16_f32 v39, v174, v175
s_waitcnt lgkmcnt(8)
v_mfma_f32_32x32x16_bf16 v[240:255], a[152:155], a[176:179], v[240:255]
ds_read_b64_tr_b16 a[196:197], v11 offset:35840
ds_read_b64_tr_b16 a[198:199], v11 offset:37120
buffer_store_dwordx4 v[36:39], v29, s[16:19], s43 offen offset:672 sc1
s_waitcnt lgkmcnt(8)
v_mfma_f32_32x32x16_bf16 v[176:191], a[156:159], a[180:183], v[176:191]
buffer_store_dwordx4 v[48:51], v30, s[16:19], s43 offen sc1
s_waitcnt lgkmcnt(6)
v_mfma_f32_32x32x16_bf16 v[192:207], a[156:159], a[184:187], v[192:207]
s_waitcnt lgkmcnt(4)
v_mfma_f32_32x32x16_bf16 v[208:223], a[156:159], a[188:191], v[208:223]
s_waitcnt lgkmcnt(2)
v_mfma_f32_32x32x16_bf16 v[224:239], a[156:159], a[192:195], v[224:239]
s_waitcnt lgkmcnt(0)
v_mfma_f32_32x32x16_bf16 v[240:255], a[156:159], a[196:199], v[240:255]
s_nop 2
v_mul_f32 v176, v68, v176
v_mul_f32 v177, v69, v177
v_mul_f32 v178, v70, v178
v_mul_f32 v179, v71, v179
v_mul_f32 v180, v72, v180
v_mul_f32 v181, v73, v181
v_mul_f32 v182, v74, v182
v_mul_f32 v183, v75, v183
v_mul_f32 v184, v76, v184
v_mul_f32 v185, v77, v185
v_mul_f32 v186, v78, v186
v_mul_f32 v187, v79, v187
v_mul_f32 v188, v80, v188
v_mul_f32 v189, v81, v189
v_mul_f32 v190, v82, v190
v_mul_f32 v191, v83, v191
v_cvt_pk_bf16_f32 v32, v176, v177
v_cvt_pk_bf16_f32 v33, v178, v179
v_cvt_pk_bf16_f32 v34, v180, v181
v_cvt_pk_bf16_f32 v35, v182, v183
buffer_store_dwordx4 v[32:35], v25, s[16:19], s44 offen offset:0 sc1
v_cvt_pk_bf16_f32 v36, v184, v185
v_cvt_pk_bf16_f32 v37, v186, v187
v_cvt_pk_bf16_f32 v38, v188, v189
v_cvt_pk_bf16_f32 v39, v190, v191
buffer_store_dwordx4 v[36:39], v25, s[16:19], s44 offen offset:672 sc1
v_mul_f32 v192, v68, v192
v_mul_f32 v193, v69, v193
v_mul_f32 v194, v70, v194
v_mul_f32 v195, v71, v195
v_mul_f32 v196, v72, v196
v_mul_f32 v197, v73, v197
v_mul_f32 v198, v74, v198
v_mul_f32 v199, v75, v199
v_mul_f32 v200, v76, v200
v_mul_f32 v201, v77, v201
v_mul_f32 v202, v78, v202
v_mul_f32 v203, v79, v203
v_mul_f32 v204, v80, v204
v_mul_f32 v205, v81, v205
v_mul_f32 v206, v82, v206
v_mul_f32 v207, v83, v207
v_cvt_pk_bf16_f32 v40, v192, v193
v_cvt_pk_bf16_f32 v41, v194, v195
v_cvt_pk_bf16_f32 v42, v196, v197
v_cvt_pk_bf16_f32 v43, v198, v199
buffer_store_dwordx4 v[40:43], v26, s[16:19], s44 offen offset:0 sc1
v_cvt_pk_bf16_f32 v44, v200, v201
v_cvt_pk_bf16_f32 v45, v202, v203
v_cvt_pk_bf16_f32 v46, v204, v205
v_cvt_pk_bf16_f32 v47, v206, v207
buffer_store_dwordx4 v[44:47], v26, s[16:19], s44 offen offset:672 sc1
v_mul_f32 v208, v68, v208
v_mul_f32 v209, v69, v209
v_mul_f32 v210, v70, v210
v_mul_f32 v211, v71, v211
v_mul_f32 v212, v72, v212
v_mul_f32 v213, v73, v213
v_mul_f32 v214, v74, v214
v_mul_f32 v215, v75, v215
v_mul_f32 v216, v76, v216
v_mul_f32 v217, v77, v217
v_mul_f32 v218, v78, v218
v_mul_f32 v219, v79, v219
v_mul_f32 v220, v80, v220
v_mul_f32 v221, v81, v221
v_mul_f32 v222, v82, v222
v_mul_f32 v223, v83, v223
v_cvt_pk_bf16_f32 v32, v208, v209
v_cvt_pk_bf16_f32 v33, v210, v211
v_cvt_pk_bf16_f32 v34, v212, v213
v_cvt_pk_bf16_f32 v35, v214, v215
buffer_store_dwordx4 v[32:35], v27, s[16:19], s44 offen offset:0 sc1
v_cvt_pk_bf16_f32 v36, v216, v217
v_cvt_pk_bf16_f32 v37, v218, v219
v_cvt_pk_bf16_f32 v38, v220, v221
v_cvt_pk_bf16_f32 v39, v222, v223
buffer_store_dwordx4 v[36:39], v27, s[16:19], s44 offen offset:672 sc1
v_mul_f32 v224, v68, v224
v_mul_f32 v225, v69, v225
v_mul_f32 v226, v70, v226
v_mul_f32 v227, v71, v227
v_mul_f32 v228, v72, v228
v_mul_f32 v229, v73, v229
v_mul_f32 v230, v74, v230
v_mul_f32 v231, v75, v231
v_mul_f32 v232, v76, v232
v_mul_f32 v233, v77, v233
v_mul_f32 v234, v78, v234
v_mul_f32 v235, v79, v235
v_mul_f32 v236, v80, v236
v_mul_f32 v237, v81, v237
v_mul_f32 v238, v82, v238
v_mul_f32 v239, v83, v239
v_cvt_pk_bf16_f32 v40, v224, v225
v_cvt_pk_bf16_f32 v41, v226, v227
v_cvt_pk_bf16_f32 v42, v228, v229
v_cvt_pk_bf16_f32 v43, v230, v231
buffer_store_dwordx4 v[40:43], v28, s[16:19], s44 offen offset:0 sc1
v_cvt_pk_bf16_f32 v44, v232, v233
v_cvt_pk_bf16_f32 v45, v234, v235
v_cvt_pk_bf16_f32 v46, v236, v237
v_cvt_pk_bf16_f32 v47, v238, v239
buffer_store_dwordx4 v[44:47], v28, s[16:19], s44 offen offset:672 sc1
v_mul_f32 v240, v68, v240
v_mul_f32 v241, v69, v241
v_mul_f32 v242, v70, v242
v_mul_f32 v243, v71, v243
v_mul_f32 v244, v72, v244
v_mul_f32 v245, v73, v245
v_mul_f32 v246, v74, v246
v_mul_f32 v247, v75, v247
v_mul_f32 v248, v76, v248
v_mul_f32 v249, v77, v249
v_mul_f32 v250, v78, v250
v_mul_f32 v251, v79, v251
v_mul_f32 v252, v80, v252
v_mul_f32 v253, v81, v253
v_mul_f32 v254, v82, v254
v_mul_f32 v255, v83, v255
v_cvt_pk_bf16_f32 v32, v240, v241
v_cvt_pk_bf16_f32 v33, v242, v243
v_cvt_pk_bf16_f32 v34, v244, v245
v_cvt_pk_bf16_f32 v35, v246, v247
buffer_store_dwordx4 v[32:35], v29, s[16:19], s44 offen offset:0 sc1
v_cvt_pk_bf16_f32 v36, v248, v249
v_cvt_pk_bf16_f32 v37, v250, v251
v_cvt_pk_bf16_f32 v38, v252, v253
v_cvt_pk_bf16_f32 v39, v254, v255
buffer_store_dwordx4 v[36:39], v29, s[16:19], s44 offen offset:672 sc1
buffer_store_dwordx4 v[48:51], v30, s[16:19], s44 offen sc1
s_endpgm
K1_GLU:
s_nop 4
s_and_b32 s28, s20, 1
s_lshl_b32 s28, s28, 5
s_lshr_b32 s29, s20, 1
s_lshl_b32 s29, s29, 1
v_lshrrev_b32 v32, 3, v1
v_bfe_u32 v33, v1, 4, 1
v_or_b32 v33, s29, v33
v_bfe_u32 v34, v1, 1, 2
v_xor_b32 v34, v34, v33
v_lshlrev_b32 v34, 5, v34
v_and_b32 v35, 1, v1
v_lshl_add_u32 v34, v35, 4, v34
v_add_u32 v32, s28, v32
v_mul_u32_u24 v32, 3456, v32
v_add_u32 v12, v32, v34
v_add_u32 v13, 26624, v12
v_add_u32 v14, 53248, v12
v_add_u32 v15, 79872, v12
s_lshl_b32 s25, s20, 12
s_sub_u32 s42, s22, 6
s_mul_i32 s42, s42, 3
s_lshl_b32 s23, s42, 7
s_and_b32 s28, s20, 1
s_lshl_b32 s28, s28, 9
s_sub_u32 s29, s22, 6
s_mul_i32 s29, s29, 384
s_mul_i32 s30, s57, 96
s_lshr_b32 s60, s20, 1
s_lshl_b32 s60, s60, 14
s_lshl_b32 s31, s28, 4
s_add_u32 s60, s60, s31
s_cmp_lg_u32 s28, 0
s_cselect_b32 s31, 2147483648, 0
s_add_u32 s60, s60, 81920
s_add_u32 s29, s29, s30
s_mul_i32 s30, s56, 552960
s_add_u32 s29, s29, s30
v_add_u32 v32, s28, v1
v_lshlrev_b32 v33, 4, v32
v_add_u32 v33, s29, v33
v_add_u32 v34, 4096, v33
s_mov_b32 s28, 10923
s_mov_b32 s30, 3360
v_mul_u32_u24 v35, s28, v32
v_lshrrev_b32 v35, 16, v35
v_mad_u32_u24 v224, v35, s30, v33
v_add_u32 v32, 64, v32
v_mul_u32_u24 v35, s28, v32
v_lshrrev_b32 v35, 16, v35
v_mad_u32_u24 v225, v35, s30, v33
v_add_u32 v32, 64, v32
v_mul_u32_u24 v35, s28, v32
v_lshrrev_b32 v35, 16, v35
v_mad_u32_u24 v226, v35, s30, v33
v_add_u32 v32, 64, v32
v_mul_u32_u24 v35, s28, v32
v_lshrrev_b32 v35, 16, v35
v_mad_u32_u24 v227, v35, s30, v33
v_add_u32 v32, 64, v32
v_mul_u32_u24 v35, s28, v32
v_lshrrev_b32 v35, 16, v35
v_mad_u32_u24 v228, v35, s30, v34
v_add_u32 v32, 64, v32
v_mul_u32_u24 v35, s28, v32
v_lshrrev_b32 v35, 16, v35
v_mad_u32_u24 v229, v35, s30, v34
v_add_u32 v32, 64, v32
v_mul_u32_u24 v35, s28, v32
v_lshrrev_b32 v35, 16, v35
v_mad_u32_u24 v230, v35, s30, v34
v_add_u32 v32, 64, v32
v_mul_u32_u24 v35, s28, v32
v_lshrrev_b32 v35, 16, v35
v_mad_u32_u24 v231, v35, s30, v34
v_or_b32 v231, s31, v231
s_waitcnt lgkmcnt(0)
s_mov_b32 s8, s36
s_and_b32 s9, s37, 0xffff
s_mov_b32 s10, 2621440
s_mov_b32 s11, 0x20000
s_add_u32 m0, s26, 0
s_mov_b32 s24, 0
buffer_load_dwordx4 v17, s[8:11], s24 offen offset:0 lds
buffer_load_dwordx4 v18, s[8:11], s24 offen offset:1024 lds
buffer_load_dwordx4 v19, s[8:11], s24 offen offset:2048 lds
buffer_load_dwordx4 v20, s[8:11], s24 offen offset:3072 lds
s_cmp_lt_u32 s20, 2
s_cselect_b32 s40, s32, s34
s_cselect_b32 s41, s33, s35
s_mov_b32 s12, s40
s_and_b32 s13, s41, 0xffff
s_mov_b32 s14, 2211840
s_mov_b32 s15, 0x20000
s_add_u32 m0, s25, 0
s_add_u32 s32, s23, 0
buffer_load_dwordx4 v12, s[12:15], s32 offen offset:0 lds
buffer_load_dwordx4 v13, s[12:15], s32 offen offset:1024 lds
buffer_load_dwordx4 v14, s[12:15], s32 offen offset:2048 lds
buffer_load_dwordx4 v15, s[12:15], s32 offen offset:3072 lds
buffer_load_dwordx2 v[176:177], v237, s[8:11], 0 offen offset:0
buffer_load_dwordx2 v[178:179], v237, s[8:11], 0 offen offset:256
buffer_load_dwordx2 v[180:181], v237, s[8:11], 0 offen offset:512
buffer_load_dwordx2 v[182:183], v237, s[8:11], 0 offen offset:768
buffer_load_dwordx2 v[184:185], v237, s[8:11], 0 offen offset:1024
s_mov_b32 s16, s4
s_and_b32 s17, s5, 0xffff
s_mov_b32 s18, 33554432
s_mov_b32 s19, 0x20000
s_mov_b32 s52, s48
s_and_b32 s53, s49, 0xffff
s_mov_b32 s54, 256
s_mov_b32 s55, 0x20000
s_add_u32 m0, s60, 0
s_nop 0
buffer_load_dwordx4 v224, s[12:15], 0 offen offset:0 lds
v_and_b32 v32, 31, v1
v_lshrrev_b32 v33, 1, v32
v_and_b32 v33, 7, v33
v_lshrrev_b32 v34, 5, v1
v_lshlrev_b32 v32, 7, v32
v_add_u32 v32, s26, v32
v_add_u32 v35, 0, v34
v_xor_b32 v35, v35, v33
v_lshl_add_u32 v21, v35, 4, v32
v_add_u32 v35, 2, v34
buffer_load_dwordx4 v225, s[12:15], 0 offen offset:1024 lds
v_xor_b32 v35, v35, v33
v_lshl_add_u32 v22, v35, 4, v32
v_add_u32 v35, 4, v34
v_xor_b32 v35, v35, v33
v_lshl_add_u32 v23, v35, 4, v32
v_add_u32 v35, 6, v34
v_xor_b32 v35, v35, v33
v_lshl_add_u32 v24, v35, 4, v32
v_bfe_u32 v32, v1, 4, 1
v_lshrrev_b32 v33, 5, v1
buffer_load_dwordx4 v226, s[12:15], 0 offen offset:2048 lds
v_bfe_u32 v34, v1, 2, 2
v_and_b32 v35, 3, v1
v_lshl_add_u32 v36, v33, 3, v34
v_lshlrev_b32 v36, 7, v36
v_lshl_add_u32 v36, v32, 13, v36
v_and_b32 v37, 1, v35
v_lshlrev_b32 v37, 1, v37
v_lshrrev_b32 v38, 1, v35
v_add_u32 v37, v37, v38
v_lshl_add_u32 v36, v37, 3, v36
buffer_load_dwordx4 v227, s[12:15], 0 offen offset:3072 lds
v_lshrrev_b32 v37, 1, v34
v_lshl_add_u32 v37, v32, 1, v37
v_xor_b32 v38, 0, v37
v_lshl_add_u32 v2, v38, 5, v36
v_add_u32 v7, 65536, v2
v_xor_b32 v38, 1, v37
v_lshl_add_u32 v3, v38, 5, v36
v_add_u32 v8, 65536, v3
v_xor_b32 v38, 2, v37
v_lshl_add_u32 v4, v38, 5, v36
s_add_u32 m0, s60, 4096
s_nop 0
buffer_load_dwordx4 v228, s[12:15], 0 offen offset:0 lds
v_add_u32 v9, 65536, v4
v_xor_b32 v38, 3, v37
v_lshl_add_u32 v5, v38, 5, v36
v_add_u32 v10, 65536, v5
v_lshrrev_b32 v33, 5, v1
v_bfe_u32 v34, v1, 2, 2
v_lshl_add_u32 v34, v33, 3, v34
v_mul_u32_u24 v34, 96, v34
v_bfe_u32 v32, v1, 4, 1
v_and_b32 v35, 3, v1
buffer_load_dwordx4 v229, s[12:15], 0 offen offset:1024 lds
v_lshl_add_u32 v35, v32, 2, v35
v_lshl_add_u32 v34, v35, 3, v34
s_and_b32 s28, s20, 1
s_lshl_b32 s29, s28, 6
s_lshr_b32 s30, s20, 1
s_lshl_b32 s31, s30, 14
s_add_u32 s29, s29, s31
s_add_u32 s29, s29, 81920
s_lshl_b32 s28, s28, 5
s_mul_i32 s30, s30, 192
buffer_load_dwordx4 v230, s[12:15], 0 offen offset:2048 lds
s_mul_i32 s31, s57, 48
s_add_u32 s30, s30, s31
v_add_u32 v232, s29, v34
s_lshl_b32 s31, s22, 2
s_add_u32 s31, s31, s56
s_mul_i32 s31, s31, 384
s_add_u32 s31, s31, s30
v_add_u32 v32, s28, v1
v_add_u32 v33, s31, v32
v_lshlrev_b32 v33, 2, v33
buffer_load_dwordx4 v231, s[12:15], 0 offen offset:3072 lds
v_add_u32 v33, 30408704, v33
v_mov_b32 v34, 2147483648
v_cmp_gt_u32 vcc, 48, v32
s_nop 1
v_cndmask_b32 v33, v34, v33, vcc
v_cmp_gt_u32 vcc, 32, v1
s_nop 1
v_cndmask_b32 v233, v34, v33, vcc
v_mov_b32 v208, 0x3f803f80
v_mov_b32 v209, 0x3f803f80
v_mov_b32 v210, 0x3f803f80
v_mov_b32 v211, 0x3f803f80
s_add_u32 m0, s26, 4096
s_mov_b32 s24, 128
buffer_load_dwordx4 v17, s[8:11], s24 offen offset:0 lds
s_lshl_b32 s33, s22, 4
s_add_u32 s33, s33, s21
v_mov_b32 v32, s33
v_mov_b32 v33, 2147483648
v_cmp_eq_u32 vcc, 0, v0
s_nop 1
v_cndmask_b32 v234, v33, v32, vcc
v_lshlrev_b32 v47, 2, v1
v_lshrrev_b32 v32, 2, v1
v_cmp_eq_u32 vcc, s22, v32
v_mov_b32 v33, 0x01010101
buffer_load_dwordx4 v18, s[8:11], s24 offen offset:1024 lds
v_cndmask_b32 v67, 0, v33, vcc
s_and_b32 s33, s21, 3
s_lshl_b32 s33, s33, 3
s_lshl_b32 s33, 1, s33
v_and_b32 v32, 3, v1
v_cmp_eq_u32 vcc, s57, v32
v_mov_b32 v33, s33
s_nop 0
v_cndmask_b32 v32, 0, v33, vcc
v_or_b32 v67, v67, v32
v_mov_b32 v32, 2147483648
buffer_load_dwordx4 v19, s[8:11], s24 offen offset:2048 lds
v_cmp_gt_u32 vcc, 64, v0
s_nop 1
v_cndmask_b32 v47, v32, v47, vcc
v_cndmask_b32 v67, 0, v67, vcc
s_lshl_b32 s33, s21, 2
s_add_u32 s33, s33, s20
s_lshl_b32 s33, s33, 9
s_add_u32 s33, s33, 30539776
v_and_b32 v32, 31, v1
v_lshlrev_b32 v32, 4, v32
v_add_u32 v92, s33, v32
buffer_load_dwordx4 v20, s[8:11], s24 offen offset:3072 lds
s_lshl_b32 s33, s21, 2
s_add_u32 s33, s33, s20
s_lshl_b32 s33, s33, 7
s_add_u32 s33, s33, 30605312
v_lshrrev_b32 v32, 5, v1
v_lshlrev_b32 v32, 4, v32
v_add_u32 v66, s33, v32
v_and_b32 v32, 127, v0
v_lshrrev_b32 v33, 5, v32
v_lshlrev_b32 v33, 4, v33
s_add_u32 m0, s25, 16384
s_add_u32 s32, s23, 128
buffer_load_dwordx4 v12, s[12:15], s32 offen offset:0 lds
v_bfe_u32 v34, v32, 2, 1
v_lshl_add_u32 v33, v34, 3, v33
v_bfe_u32 v34, v32, 3, 1
v_lshl_add_u32 v33, v34, 2, v33
v_and_b32 v34, 3, v32
v_add_u32 v33, v33, v34
v_bfe_u32 v34, v32, 4, 1
v_mul_u32_u24 v34, 192, v34
v_add_u32 v33, v33, v34
s_mul_i32 s28, s22, 6144
buffer_load_dwordx4 v13, s[12:15], s32 offen offset:1024 lds
s_add_u32 s28, s28, 30408704
v_lshlrev_b32 v33, 2, v33
v_add_u32 v90, s28, v33
v_lshlrev_b32 v32, 2, v32
v_add_u32 v91, 102400, v32
v_and_b32 v32, 31, v1
v_lshlrev_b32 v32, 2, v32
v_add_u32 v95, 102400, v32
s_lshl_b32 s28, s21, 1
s_lshr_b32 s29, s20, 1
buffer_load_dwordx4 v14, s[12:15], s32 offen offset:2048 lds
s_add_u32 s28, s28, s29
s_mul_i32 s28, s28, 303104
s_and_b32 s29, s20, 1
s_lshl_b32 s29, s29, 11
s_add_u32 s28, s28, s29
s_add_u32 s28, s28, 16777216
v_bfe_u32 v32, v1, 4, 1
v_lshlrev_b32 v32, 10, v32
v_lshrrev_b32 v33, 5, v1
v_lshl_add_u32 v32, v33, 8, v32
buffer_load_dwordx4 v15, s[12:15], s32 offen offset:3072 lds
v_and_b32 v33, 15, v1
v_lshl_add_u32 v32, v33, 4, v32
v_add_u32 v25, s28, v32
s_waitcnt vmcnt(20)
v_lshlrev_b32 v240, 16, v176
v_and_b32 v241, 0xffff0000, v176
v_lshlrev_b32 v242, 16, v177
v_and_b32 v243, 0xffff0000, v177
s_waitcnt vmcnt(19)
v_lshlrev_b32 v244, 16, v178
v_and_b32 v245, 0xffff0000, v178
v_lshlrev_b32 v246, 16, v179
v_and_b32 v247, 0xffff0000, v179
s_waitcnt vmcnt(18)
v_lshlrev_b32 v248, 16, v180
v_and_b32 v249, 0xffff0000, v180
v_add_f32 v250, v240, v241
v_mul_f32 v251, v240, v240
v_fmac_f32 v251, v241, v241
v_add_f32 v250, v250, v242
v_fmac_f32 v251, v242, v242
v_add_f32 v250, v250, v243
v_fmac_f32 v251, v243, v243
v_add_f32 v250, v250, v244
v_fmac_f32 v251, v244, v244
v_add_f32 v250, v250, v245
v_fmac_f32 v251, v245, v245
v_add_f32 v250, v250, v246
v_fmac_f32 v251, v246, v246
v_add_f32 v250, v250, v247
v_fmac_f32 v251, v247, v247
v_add_f32 v250, v250, v248
v_fmac_f32 v251, v248, v248
v_add_f32 v250, v250, v249
v_fmac_f32 v251, v249, v249
v_lshlrev_b32 v240, 16, v181
v_and_b32 v241, 0xffff0000, v181
s_waitcnt vmcnt(17)
v_lshlrev_b32 v242, 16, v182
v_and_b32 v243, 0xffff0000, v182
v_lshlrev_b32 v244, 16, v183
v_and_b32 v245, 0xffff0000, v183
s_waitcnt vmcnt(16)
v_lshlrev_b32 v246, 16, v184
v_and_b32 v247, 0xffff0000, v184
v_lshlrev_b32 v248, 16, v185
v_and_b32 v249, 0xffff0000, v185
v_add_f32 v250, v250, v240
v_fmac_f32 v251, v240, v240
v_add_f32 v250, v250, v241
v_fmac_f32 v251, v241, v241
v_add_f32 v250, v250, v242
v_fmac_f32 v251, v242, v242
v_add_f32 v250, v250, v243
v_fmac_f32 v251, v243, v243
v_add_f32 v250, v250, v244
v_fmac_f32 v251, v244, v244
v_add_f32 v250, v250, v245
v_fmac_f32 v251, v245, v245
v_add_f32 v250, v250, v246
v_fmac_f32 v251, v246, v246
v_add_f32 v250, v250, v247
v_fmac_f32 v251, v247, v247
v_add_f32 v250, v250, v248
v_fmac_f32 v251, v248, v248
v_add_f32 v250, v250, v249
v_fmac_f32 v251, v249, v249
s_nop 0
v_add_f32_dpp v250, v250, v250 row_ror:8 row_mask:0xf bank_mask:0xf
v_add_f32_dpp v251, v251, v251 row_ror:8 row_mask:0xf bank_mask:0xf
s_nop 0
v_add_f32_dpp v250, v250, v250 row_ror:4 row_mask:0xf bank_mask:0xf
v_add_f32_dpp v251, v251, v251 row_ror:4 row_mask:0xf bank_mask:0xf
s_nop 0
v_add_f32_dpp v250, v250, v250 row_ror:2 row_mask:0xf bank_mask:0xf
v_add_f32_dpp v251, v251, v251 row_ror:2 row_mask:0xf bank_mask:0xf
s_nop 0
v_add_f32_dpp v250, v250, v250 row_ror:1 row_mask:0xf bank_mask:0xf
v_add_f32_dpp v251, v251, v251 row_ror:1 row_mask:0xf bank_mask:0xf
ds_swizzle_b32 v252, v250 offset:16415
ds_swizzle_b32 v253, v251 offset:16415
v_and_b32 v254, 31, v1
v_cmp_eq_u32 vcc, 0, v254
v_mov_b32 v254, 2147483648
v_lshlrev_b32 v235, 4, v238
v_add_u32 v235, 30539776, v235
v_cndmask_b32 v235, v254, v235, vcc
v_lshlrev_b32 v236, 2, v238
v_add_u32 v236, 30605312, v236
v_cndmask_b32 v236, v254, v236, vcc
s_waitcnt lgkmcnt(1)
v_add_f32 v250, v250, v252
s_waitcnt lgkmcnt(0)
v_add_f32 v251, v251, v253
v_mul_f32 v240, 0xbacccccd, v250
v_mul_f32 v252, v240, v240
v_mov_b32 v253, 0x3acccccd
v_fma_f32 v252, v251, v253, -v252
v_max_f32 v252, 0, v252
v_add_f32 v252, 0x3727c5ac, v252
v_rsq_f32 v241, v252
v_sqrt_f32 v242, v252
v_mov_b32 v243, 0
buffer_store_dwordx4 v[240:243], v235, s[16:19], 0 offen sc1
buffer_store_dword v241, v236, s[16:19], 0 offen sc1
s_add_u32 s45, s42, 0
s_lshl_b32 s45, s45, 1
s_add_u32 s45, s45, 20
s_lshl_b32 s46, s45, 12
s_add_u32 s47, s46, 4096
s_add_u32 s45, s42, 1
s_lshl_b32 s45, s45, 1
s_add_u32 s45, s45, 20
s_lshl_b32 s48, s45, 12
s_add_u32 s49, s48, 4096
s_add_u32 s45, s42, 2
s_lshl_b32 s45, s45, 1
s_add_u32 s45, s45, 20
s_lshl_b32 s50, s45, 12
s_add_u32 s51, s50, 4096
s_barrier
ds_read_b128 a[0:3], v21 offset:0
ds_read_b128 a[4:7], v22 offset:0
ds_read_b128 a[8:11], v23 offset:0
ds_read_b128 a[12:15], v24 offset:0
ds_read_b64_tr_b16 a[160:161], v2 offset:0
ds_read_b64_tr_b16 a[162:163], v2 offset:512
ds_read_b64_tr_b16 a[164:165], v3 offset:0
ds_read_b64_tr_b16 a[166:167], v3 offset:512
ds_read_b64_tr_b16 a[168:169], v4 offset:0
ds_read_b64_tr_b16 a[170:171], v4 offset:512
ds_read_b64_tr_b16 a[172:173], v5 offset:0
ds_read_b64_tr_b16 a[174:175], v5 offset:512
s_waitcnt lgkmcnt(6)
v_mfma_f32_32x32x16_bf16 a[192:207], a[160:163], a[0:3], 0
ds_read_b64_tr_b16 a[176:177], v2 offset:2048
ds_read_b64_tr_b16 a[178:179], v2 offset:2560
s_waitcnt lgkmcnt(6)
v_mfma_f32_32x32x16_bf16 a[208:223], a[164:167], a[0:3], 0
ds_read_b64_tr_b16 a[180:181], v3 offset:2048
ds_read_b64_tr_b16 a[182:183], v3 offset:2560
s_add_u32 m0, s26, 8192
s_mov_b32 s24, 256
buffer_load_dwordx4 v17, s[8:11], s24 offen offset:0 lds
buffer_load_dwordx4 v18, s[8:11], s24 offen offset:1024 lds
s_waitcnt lgkmcnt(6)
v_mfma_f32_32x32x16_bf16 a[224:239], a[168:171], a[0:3], 0
ds_read_b64_tr_b16 a[184:185], v4 offset:2048
ds_read_b64_tr_b16 a[186:187], v4 offset:2560
buffer_load_dwordx4 v19, s[8:11], s24 offen offset:2048 lds
buffer_load_dwordx4 v20, s[8:11], s24 offen offset:3072 lds
s_waitcnt lgkmcnt(6)
v_mfma_f32_32x32x16_bf16 a[240:255], a[172:175], a[0:3], 0
ds_read_b64_tr_b16 a[188:189], v5 offset:2048
ds_read_b64_tr_b16 a[190:191], v5 offset:2560
s_add_u32 m0, s25, 32768
s_add_u32 s32, s23, 221184
buffer_load_dwordx4 v12, s[12:15], s32 offen offset:0 lds
buffer_load_dwordx4 v13, s[12:15], s32 offen offset:1024 lds
s_waitcnt lgkmcnt(6)
v_mfma_f32_32x32x16_bf16 a[192:207], a[176:179], a[4:7], a[192:207]
ds_read_b64_tr_b16 a[160:161], v2 offset:4096
ds_read_b64_tr_b16 a[162:163], v2 offset:4608
buffer_load_dwordx4 v14, s[12:15], s32 offen offset:2048 lds
buffer_load_dwordx4 v15, s[12:15], s32 offen offset:3072 lds
s_waitcnt lgkmcnt(6)
v_mfma_f32_32x32x16_bf16 a[208:223], a[180:183], a[4:7], a[208:223]
ds_read_b64_tr_b16 a[164:165], v3 offset:4096
ds_read_b64_tr_b16 a[166:167], v3 offset:4608
s_add_u32 m0, s25, 49152
s_add_u32 s32, s23, 221312
buffer_load_dwordx4 v12, s[12:15], s32 offen offset:0 lds
buffer_load_dwordx4 v13, s[12:15], s32 offen offset:1024 lds
s_waitcnt lgkmcnt(6)
v_mfma_f32_32x32x16_bf16 a[224:239], a[184:187], a[4:7], a[224:239]
ds_read_b64_tr_b16 a[168:169], v4 offset:4096
ds_read_b64_tr_b16 a[170:171], v4 offset:4608
buffer_load_dwordx4 v14, s[12:15], s32 offen offset:2048 lds
buffer_load_dwordx4 v15, s[12:15], s32 offen offset:3072 lds
s_waitcnt lgkmcnt(6)
v_mfma_f32_32x32x16_bf16 a[240:255], a[188:191], a[4:7], a[240:255]
ds_read_b64_tr_b16 a[172:173], v5 offset:4096
ds_read_b64_tr_b16 a[174:175], v5 offset:4608
s_add_u32 m0, s25, 65536
s_add_u32 s32, s23, 442368
buffer_load_dwordx4 v12, s[12:15], s32 offen offset:0 lds
buffer_load_dwordx4 v13, s[12:15], s32 offen offset:1024 lds
s_waitcnt lgkmcnt(6)
v_mfma_f32_32x32x16_bf16 a[192:207], a[160:163], a[8:11], a[192:207]
ds_read_b64_tr_b16 a[176:177], v2 offset:6144
ds_read_b64_tr_b16 a[178:179], v2 offset:6656
buffer_load_dwordx4 v14, s[12:15], s32 offen offset:2048 lds
buffer_load_dwordx4 v15, s[12:15], s32 offen offset:3072 lds
s_waitcnt lgkmcnt(6)
v_mfma_f32_32x32x16_bf16 a[208:223], a[164:167], a[8:11], a[208:223]
ds_read_b64_tr_b16 a[180:181], v3 offset:6144
ds_read_b64_tr_b16 a[182:183], v3 offset:6656
s_waitcnt lgkmcnt(6)
v_mfma_f32_32x32x16_bf16 a[224:239], a[168:171], a[8:11], a[224:239]
ds_read_b64_tr_b16 a[184:185], v4 offset:6144
ds_read_b64_tr_b16 a[186:187], v4 offset:6656
s_waitcnt lgkmcnt(6)
v_mfma_f32_32x32x16_bf16 a[240:255], a[172:175], a[8:11], a[240:255]
ds_read_b64_tr_b16 a[188:189], v5 offset:6144
ds_read_b64_tr_b16 a[190:191], v5 offset:6656
s_waitcnt vmcnt(18)
s_barrier
s_waitcnt lgkmcnt(6)
v_mfma_f32_32x32x16_bf16 a[192:207], a[176:179], a[12:15], a[192:207]
ds_read_b64_tr_b16 a[160:161], v2 offset:16384
ds_read_b64_tr_b16 a[162:163], v2 offset:16896
s_waitcnt lgkmcnt(6)
v_mfma_f32_32x32x16_bf16 a[208:223], a[180:183], a[12:15], a[208:223]
ds_read_b64_tr_b16 a[164:165], v3 offset:16384
ds_read_b64_tr_b16 a[166:167], v3 offset:16896
s_waitcnt lgkmcnt(6)
v_mfma_f32_32x32x16_bf16 a[224:239], a[184:187], a[12:15], a[224:239]
ds_read_b64_tr_b16 a[168:169], v4 offset:16384
ds_read_b64_tr_b16 a[170:171], v4 offset:16896
s_waitcnt lgkmcnt(6)
v_mfma_f32_32x32x16_bf16 a[240:255], a[188:191], a[12:15], a[240:255]
ds_read_b64_tr_b16 a[172:173], v5 offset:16384
ds_read_b64_tr_b16 a[174:175], v5 offset:16896
s_waitcnt lgkmcnt(6)
v_mfma_f32_32x32x16_bf16 v[96:111], a[160:163], a[0:3], 0
ds_read_b64_tr_b16 a[176:177], v2 offset:18432
ds_read_b64_tr_b16 a[178:179], v2 offset:18944
s_waitcnt lgkmcnt(6)
v_mfma_f32_32x32x16_bf16 v[112:127], a[164:167], a[0:3], 0
ds_read_b64_tr_b16 a[180:181], v3 offset:18432
ds_read_b64_tr_b16 a[182:183], v3 offset:18944
s_waitcnt lgkmcnt(6)
v_mfma_f32_32x32x16_bf16 v[128:143], a[168:171], a[0:3], 0
ds_read_b64_tr_b16 a[184:185], v4 offset:18432
ds_read_b64_tr_b16 a[186:187], v4 offset:18944
ds_read_b64_tr_b16 v[212:213], v232 offset:0
ds_read_b64_tr_b16 v[214:215], v232 offset:384
s_waitcnt lgkmcnt(8)
v_mfma_f32_32x32x16_bf16 v[144:159], a[172:175], a[0:3], 0
ds_read_b64_tr_b16 a[188:189], v5 offset:18432
ds_read_b64_tr_b16 a[190:191], v5 offset:18944
ds_read_b64_tr_b16 v[216:217], v232 offset:1536
ds_read_b64_tr_b16 v[218:219], v232 offset:1920
s_waitcnt lgkmcnt(4)
v_mfma_f32_32x32x16_bf16 v[192:207], v[208:211], v[212:215], 0
v_mfma_f32_32x32x16_bf16 v[96:111], a[176:179], a[4:7], v[96:111]
ds_read_b64_tr_b16 a[160:161], v2 offset:20480
ds_read_b64_tr_b16 a[162:163], v2 offset:20992
ds_read_b64_tr_b16 v[212:213], v232 offset:3072
ds_read_b64_tr_b16 v[214:215], v232 offset:3456
s_waitcnt lgkmcnt(4)
v_mfma_f32_32x32x16_bf16 v[192:207], v[208:211], v[216:219], v[192:207]
v_mfma_f32_32x32x16_bf16 v[112:127], a[180:183], a[4:7], v[112:127]
ds_read_b64_tr_b16 a[164:165], v3 offset:20480
ds_read_b64_tr_b16 a[166:167], v3 offset:20992
ds_read_b64_tr_b16 v[216:217], v232 offset:4608
ds_read_b64_tr_b16 v[218:219], v232 offset:4992
s_waitcnt lgkmcnt(4)
v_mfma_f32_32x32x16_bf16 v[192:207], v[208:211], v[212:215], v[192:207]
v_mfma_f32_32x32x16_bf16 v[128:143], a[184:187], a[4:7], v[128:143]
ds_read_b64_tr_b16 a[168:169], v4 offset:20480
ds_read_b64_tr_b16 a[170:171], v4 offset:20992
ds_read_b64_tr_b16 v[212:213], v232 offset:6144
ds_read_b64_tr_b16 v[214:215], v232 offset:6528
s_waitcnt lgkmcnt(4)
v_mfma_f32_32x32x16_bf16 v[192:207], v[208:211], v[216:219], v[192:207]
v_mfma_f32_32x32x16_bf16 v[144:159], a[188:191], a[4:7], v[144:159]
ds_read_b64_tr_b16 a[172:173], v5 offset:20480
ds_read_b64_tr_b16 a[174:175], v5 offset:20992
ds_read_b64_tr_b16 v[216:217], v232 offset:7680
ds_read_b64_tr_b16 v[218:219], v232 offset:8064
s_waitcnt lgkmcnt(4)
v_mfma_f32_32x32x16_bf16 v[192:207], v[208:211], v[212:215], v[192:207]
v_mfma_f32_32x32x16_bf16 v[96:111], a[160:163], a[8:11], v[96:111]
ds_read_b64_tr_b16 a[176:177], v2 offset:22528
ds_read_b64_tr_b16 a[178:179], v2 offset:23040
ds_read_b64_tr_b16 v[212:213], v232 offset:9216
ds_read_b64_tr_b16 v[214:215], v232 offset:9600
s_waitcnt lgkmcnt(4)
v_mfma_f32_32x32x16_bf16 v[192:207], v[208:211], v[216:219], v[192:207]
v_mfma_f32_32x32x16_bf16 v[112:127], a[164:167], a[8:11], v[112:127]
ds_read_b64_tr_b16 a[180:181], v3 offset:22528
ds_read_b64_tr_b16 a[182:183], v3 offset:23040
ds_read_b64_tr_b16 v[216:217], v232 offset:10752
ds_read_b64_tr_b16 v[218:219], v232 offset:11136
s_waitcnt lgkmcnt(4)
v_mfma_f32_32x32x16_bf16 v[192:207], v[208:211], v[212:215], v[192:207]
v_mfma_f32_32x32x16_bf16 v[128:143], a[168:171], a[8:11], v[128:143]
ds_read_b64_tr_b16 a[184:185], v4 offset:22528
ds_read_b64_tr_b16 a[186:187], v4 offset:23040
ds_read_b64_tr_b16 v[212:213], v232 offset:12288
ds_read_b64_tr_b16 v[214:215], v232 offset:12672
s_waitcnt lgkmcnt(4)
v_mfma_f32_32x32x16_bf16 v[192:207], v[208:211], v[216:219], v[192:207]
v_mfma_f32_32x32x16_bf16 v[144:159], a[172:175], a[8:11], v[144:159]
ds_read_b64_tr_b16 a[188:189], v5 offset:22528
ds_read_b64_tr_b16 a[190:191], v5 offset:23040
ds_read_b64_tr_b16 v[216:217], v232 offset:13824
ds_read_b64_tr_b16 v[218:219], v232 offset:14208
s_waitcnt lgkmcnt(4)
v_mfma_f32_32x32x16_bf16 v[192:207], v[208:211], v[212:215], v[192:207]
s_waitcnt vmcnt(8)
s_barrier
ds_read_b128 a[16:19], v21 offset:4096
ds_read_b128 a[20:23], v22 offset:4096
ds_read_b128 a[24:27], v23 offset:4096
ds_read_b128 a[28:31], v24 offset:4096
v_mfma_f32_32x32x16_bf16 v[96:111], a[176:179], a[12:15], v[96:111]
ds_read_b64_tr_b16 a[160:161], v2 offset:32768
ds_read_b64_tr_b16 a[162:163], v2 offset:33280
s_waitcnt lgkmcnt(6)
v_mfma_f32_32x32x16_bf16 v[192:207], v[208:211], v[216:219], v[192:207]
v_mfma_f32_32x32x16_bf16 v[112:127], a[180:183], a[12:15], v[112:127]
ds_read_b64_tr_b16 a[164:165], v3 offset:32768
ds_read_b64_tr_b16 a[166:167], v3 offset:33280
v_mfma_f32_32x32x16_bf16 v[128:143], a[184:187], a[12:15], v[128:143]
ds_read_b64_tr_b16 a[168:169], v4 offset:32768
ds_read_b64_tr_b16 a[170:171], v4 offset:33280
v_mfma_f32_32x32x16_bf16 v[144:159], a[188:191], a[12:15], v[144:159]
ds_read_b64_tr_b16 a[172:173], v5 offset:32768
ds_read_b64_tr_b16 a[174:175], v5 offset:33280
s_nop 2
buffer_store_dword v192, v233, s[16:19], 0 offen sc1
s_waitcnt lgkmcnt(6)
v_mfma_f32_32x32x16_bf16 a[192:207], a[160:163], a[16:19], a[192:207]
ds_read_b64_tr_b16 a[176:177], v2 offset:34816
ds_read_b64_tr_b16 a[178:179], v2 offset:35328
s_waitcnt lgkmcnt(6)
v_mfma_f32_32x32x16_bf16 a[208:223], a[164:167], a[16:19], a[208:223]
ds_read_b64_tr_b16 a[180:181], v3 offset:34816
ds_read_b64_tr_b16 a[182:183], v3 offset:35328
s_add_u32 m0, s26, 0
s_mov_b32 s24, 384
buffer_load_dwordx4 v17, s[8:11], s24 offen offset:0 lds
buffer_load_dwordx4 v18, s[8:11], s24 offen offset:1024 lds
s_waitcnt lgkmcnt(6)
v_mfma_f32_32x32x16_bf16 a[224:239], a[168:171], a[16:19], a[224:239]
ds_read_b64_tr_b16 a[184:185], v4 offset:34816
ds_read_b64_tr_b16 a[186:187], v4 offset:35328
buffer_load_dwordx4 v19, s[8:11], s24 offen offset:2048 lds
buffer_load_dwordx4 v20, s[8:11], s24 offen offset:3072 lds
s_waitcnt lgkmcnt(6)
v_mfma_f32_32x32x16_bf16 a[240:255], a[172:175], a[16:19], a[240:255]
ds_read_b64_tr_b16 a[188:189], v5 offset:34816
ds_read_b64_tr_b16 a[190:191], v5 offset:35328
s_add_u32 m0, s25, 81920
s_add_u32 s32, s23, 442496
buffer_load_dwordx4 v12, s[12:15], s32 offen offset:0 lds
buffer_load_dwordx4 v13, s[12:15], s32 offen offset:1024 lds
s_waitcnt lgkmcnt(6)
v_mfma_f32_32x32x16_bf16 a[192:207], a[176:179], a[20:23], a[192:207]
ds_read_b64_tr_b16 a[160:161], v2 offset:36864
ds_read_b64_tr_b16 a[162:163], v2 offset:37376
buffer_load_dwordx4 v14, s[12:15], s32 offen offset:2048 lds
buffer_load_dwordx4 v15, s[12:15], s32 offen offset:3072 lds
s_waitcnt lgkmcnt(6)
v_mfma_f32_32x32x16_bf16 a[208:223], a[180:183], a[20:23], a[208:223]
ds_read_b64_tr_b16 a[164:165], v3 offset:36864
ds_read_b64_tr_b16 a[166:167], v3 offset:37376
s_add_u32 m0, s25, 0
s_add_u32 s32, s23, 663552
buffer_load_dwordx4 v12, s[12:15], s32 offen offset:0 lds
buffer_load_dwordx4 v13, s[12:15], s32 offen offset:1024 lds
s_waitcnt lgkmcnt(6)
v_mfma_f32_32x32x16_bf16 a[224:239], a[184:187], a[20:23], a[224:239]
ds_read_b64_tr_b16 a[168:169], v4 offset:36864
ds_read_b64_tr_b16 a[170:171], v4 offset:37376
buffer_load_dwordx4 v14, s[12:15], s32 offen offset:2048 lds
buffer_load_dwordx4 v15, s[12:15], s32 offen offset:3072 lds
s_waitcnt lgkmcnt(6)
v_mfma_f32_32x32x16_bf16 a[240:255], a[188:191], a[20:23], a[240:255]
ds_read_b64_tr_b16 a[172:173], v5 offset:36864
ds_read_b64_tr_b16 a[174:175], v5 offset:37376
s_waitcnt lgkmcnt(6)
v_mfma_f32_32x32x16_bf16 a[192:207], a[160:163], a[24:27], a[192:207]
ds_read_b64_tr_b16 a[176:177], v2 offset:38912
ds_read_b64_tr_b16 a[178:179], v2 offset:39424
s_waitcnt lgkmcnt(6)
v_mfma_f32_32x32x16_bf16 a[208:223], a[164:167], a[24:27], a[208:223]
ds_read_b64_tr_b16 a[180:181], v3 offset:38912
ds_read_b64_tr_b16 a[182:183], v3 offset:39424
s_waitcnt lgkmcnt(6)
v_mfma_f32_32x32x16_bf16 a[224:239], a[168:171], a[24:27], a[224:239]
ds_read_b64_tr_b16 a[184:185], v4 offset:38912
ds_read_b64_tr_b16 a[186:187], v4 offset:39424
s_waitcnt lgkmcnt(6)
v_mfma_f32_32x32x16_bf16 a[240:255], a[172:175], a[24:27], a[240:255]
ds_read_b64_tr_b16 a[188:189], v5 offset:38912
ds_read_b64_tr_b16 a[190:191], v5 offset:39424
s_waitcnt vmcnt(17)
s_barrier
s_waitcnt lgkmcnt(6)
v_mfma_f32_32x32x16_bf16 a[192:207], a[176:179], a[28:31], a[192:207]
ds_read_b64_tr_b16 a[160:161], v2 offset:49152
ds_read_b64_tr_b16 a[162:163], v2 offset:49664
s_waitcnt lgkmcnt(6)
v_mfma_f32_32x32x16_bf16 a[208:223], a[180:183], a[28:31], a[208:223]
ds_read_b64_tr_b16 a[164:165], v3 offset:49152
ds_read_b64_tr_b16 a[166:167], v3 offset:49664
s_waitcnt lgkmcnt(6)
v_mfma_f32_32x32x16_bf16 a[224:239], a[184:187], a[28:31], a[224:239]
ds_read_b64_tr_b16 a[168:169], v4 offset:49152
ds_read_b64_tr_b16 a[170:171], v4 offset:49664
s_waitcnt lgkmcnt(6)
v_mfma_f32_32x32x16_bf16 a[240:255], a[188:191], a[28:31], a[240:255]
ds_read_b64_tr_b16 a[172:173], v5 offset:49152
ds_read_b64_tr_b16 a[174:175], v5 offset:49664
s_waitcnt lgkmcnt(6)
v_mfma_f32_32x32x16_bf16 v[96:111], a[160:163], a[16:19], v[96:111]
ds_read_b64_tr_b16 a[176:177], v2 offset:51200
ds_read_b64_tr_b16 a[178:179], v2 offset:51712
s_waitcnt lgkmcnt(6)
v_mfma_f32_32x32x16_bf16 v[112:127], a[164:167], a[16:19], v[112:127]
ds_read_b64_tr_b16 a[180:181], v3 offset:51200
ds_read_b64_tr_b16 a[182:183], v3 offset:51712
s_add_u32 m0, s25, 16384
s_add_u32 s32, s23, 663680
buffer_load_dwordx4 v12, s[12:15], s32 offen offset:0 lds
v_mov_b32 v45, 1
s_waitcnt lgkmcnt(6)
v_mfma_f32_32x32x16_bf16 v[128:143], a[168:171], a[16:19], v[128:143]
ds_read_b64_tr_b16 a[184:185], v4 offset:51200
ds_read_b64_tr_b16 a[186:187], v4 offset:51712
buffer_load_dwordx4 v13, s[12:15], s32 offen offset:1024 lds
s_waitcnt lgkmcnt(6)
v_mfma_f32_32x32x16_bf16 v[144:159], a[172:175], a[16:19], v[144:159]
ds_read_b64_tr_b16 a[188:189], v5 offset:51200
ds_read_b64_tr_b16 a[190:191], v5 offset:51712
buffer_load_dwordx4 v14, s[12:15], s32 offen offset:2048 lds
s_waitcnt lgkmcnt(6)
v_mfma_f32_32x32x16_bf16 v[96:111], a[176:179], a[20:23], v[96:111]
ds_read_b64_tr_b16 a[160:161], v2 offset:53248
ds_read_b64_tr_b16 a[162:163], v2 offset:53760
buffer_load_dwordx4 v15, s[12:15], s32 offen offset:3072 lds
s_waitcnt lgkmcnt(6)
v_mfma_f32_32x32x16_bf16 v[112:127], a[180:183], a[20:23], v[112:127]
ds_read_b64_tr_b16 a[164:165], v3 offset:53248
ds_read_b64_tr_b16 a[166:167], v3 offset:53760
s_waitcnt lgkmcnt(6)
v_mfma_f32_32x32x16_bf16 v[128:143], a[184:187], a[20:23], v[128:143]
ds_read_b64_tr_b16 a[168:169], v4 offset:53248
ds_read_b64_tr_b16 a[170:171], v4 offset:53760
s_waitcnt lgkmcnt(6)
v_mfma_f32_32x32x16_bf16 v[144:159], a[188:191], a[20:23], v[144:159]
ds_read_b64_tr_b16 a[172:173], v5 offset:53248
ds_read_b64_tr_b16 a[174:175], v5 offset:53760
s_waitcnt lgkmcnt(6)
v_mfma_f32_32x32x16_bf16 v[96:111], a[160:163], a[24:27], v[96:111]
ds_read_b64_tr_b16 a[176:177], v2 offset:55296
ds_read_b64_tr_b16 a[178:179], v2 offset:55808
s_waitcnt lgkmcnt(6)
v_mfma_f32_32x32x16_bf16 v[112:127], a[164:167], a[24:27], v[112:127]
ds_read_b64_tr_b16 a[180:181], v3 offset:55296
ds_read_b64_tr_b16 a[182:183], v3 offset:55808
s_waitcnt lgkmcnt(6)
v_mfma_f32_32x32x16_bf16 v[128:143], a[168:171], a[24:27], v[128:143]
ds_read_b64_tr_b16 a[184:185], v4 offset:55296
ds_read_b64_tr_b16 a[186:187], v4 offset:55808
s_waitcnt lgkmcnt(6)
v_mfma_f32_32x32x16_bf16 v[144:159], a[172:175], a[24:27], v[144:159]
ds_read_b64_tr_b16 a[188:189], v5 offset:55296
ds_read_b64_tr_b16 a[190:191], v5 offset:55808
s_waitcnt vmcnt(16)
s_waitcnt vmcnt(8)
s_barrier
ds_read_b128 a[32:35], v21 offset:8192
ds_read_b128 a[36:39], v22 offset:8192
ds_read_b128 a[40:43], v23 offset:8192
ds_read_b128 a[44:47], v24 offset:8192
s_waitcnt lgkmcnt(10)
v_mfma_f32_32x32x16_bf16 v[96:111], a[176:179], a[28:31], v[96:111]
ds_read_b64_tr_b16 a[160:161], v7 offset:0
ds_read_b64_tr_b16 a[162:163], v7 offset:512
s_waitcnt lgkmcnt(10)
v_mfma_f32_32x32x16_bf16 v[112:127], a[180:183], a[28:31], v[112:127]
ds_read_b64_tr_b16 a[164:165], v8 offset:0
ds_read_b64_tr_b16 a[166:167], v8 offset:512
s_waitcnt lgkmcnt(10)
v_mfma_f32_32x32x16_bf16 v[128:143], a[184:187], a[28:31], v[128:143]
ds_read_b64_tr_b16 a[168:169], v9 offset:0
ds_read_b64_tr_b16 a[170:171], v9 offset:512
s_waitcnt lgkmcnt(10)
v_mfma_f32_32x32x16_bf16 v[144:159], a[188:191], a[28:31], v[144:159]
ds_read_b64_tr_b16 a[172:173], v10 offset:0
ds_read_b64_tr_b16 a[174:175], v10 offset:512
buffer_store_byte v45, v234, s[52:55], 0 offen sc1
s_waitcnt lgkmcnt(6)
v_mfma_f32_32x32x16_bf16 a[192:207], a[160:163], a[32:35], a[192:207]
ds_read_b64_tr_b16 a[176:177], v7 offset:2048
ds_read_b64_tr_b16 a[178:179], v7 offset:2560
s_waitcnt lgkmcnt(6)
v_mfma_f32_32x32x16_bf16 a[208:223], a[164:167], a[32:35], a[208:223]
ds_read_b64_tr_b16 a[180:181], v8 offset:2048
ds_read_b64_tr_b16 a[182:183], v8 offset:2560
s_add_u32 m0, s26, 4096
s_mov_b32 s24, 512
buffer_load_dwordx4 v17, s[8:11], s24 offen offset:0 lds
s_waitcnt lgkmcnt(6)
v_mfma_f32_32x32x16_bf16 a[224:239], a[168:171], a[32:35], a[224:239]
ds_read_b64_tr_b16 a[184:185], v9 offset:2048
ds_read_b64_tr_b16 a[186:187], v9 offset:2560
buffer_load_dwordx4 v18, s[8:11], s24 offen offset:1024 lds
s_waitcnt lgkmcnt(6)
v_mfma_f32_32x32x16_bf16 a[240:255], a[172:175], a[32:35], a[240:255]
ds_read_b64_tr_b16 a[188:189], v10 offset:2048
ds_read_b64_tr_b16 a[190:191], v10 offset:2560
buffer_load_dwordx4 v19, s[8:11], s24 offen offset:2048 lds
s_waitcnt lgkmcnt(6)
v_mfma_f32_32x32x16_bf16 a[192:207], a[176:179], a[36:39], a[192:207]
ds_read_b64_tr_b16 a[160:161], v7 offset:4096
ds_read_b64_tr_b16 a[162:163], v7 offset:4608
buffer_load_dwordx4 v20, s[8:11], s24 offen offset:3072 lds
s_waitcnt lgkmcnt(6)
v_mfma_f32_32x32x16_bf16 a[208:223], a[180:183], a[36:39], a[208:223]
ds_read_b64_tr_b16 a[164:165], v8 offset:4096
ds_read_b64_tr_b16 a[166:167], v8 offset:4608
s_add_u32 m0, s25, 32768
s_add_u32 s32, s23, 884736
buffer_load_dwordx4 v12, s[12:15], s32 offen offset:0 lds
s_waitcnt lgkmcnt(6)
v_mfma_f32_32x32x16_bf16 a[224:239], a[184:187], a[36:39], a[224:239]
ds_read_b64_tr_b16 a[168:169], v9 offset:4096
ds_read_b64_tr_b16 a[170:171], v9 offset:4608
buffer_load_dwordx4 v13, s[12:15], s32 offen offset:1024 lds
s_waitcnt lgkmcnt(6)
v_mfma_f32_32x32x16_bf16 a[240:255], a[188:191], a[36:39], a[240:255]
ds_read_b64_tr_b16 a[172:173], v10 offset:4096
ds_read_b64_tr_b16 a[174:175], v10 offset:4608
buffer_load_dwordx4 v14, s[12:15], s32 offen offset:2048 lds
s_waitcnt lgkmcnt(6)
v_mfma_f32_32x32x16_bf16 a[192:207], a[160:163], a[40:43], a[192:207]
ds_read_b64_tr_b16 a[176:177], v7 offset:6144
ds_read_b64_tr_b16 a[178:179], v7 offset:6656
buffer_load_dwordx4 v15, s[12:15], s32 offen offset:3072 lds
s_waitcnt lgkmcnt(6)
v_mfma_f32_32x32x16_bf16 a[208:223], a[164:167], a[40:43], a[208:223]
ds_read_b64_tr_b16 a[180:181], v8 offset:6144
ds_read_b64_tr_b16 a[182:183], v8 offset:6656
s_waitcnt lgkmcnt(6)
v_mfma_f32_32x32x16_bf16 a[224:239], a[168:171], a[40:43], a[224:239]
ds_read_b64_tr_b16 a[184:185], v9 offset:6144
ds_read_b64_tr_b16 a[186:187], v9 offset:6656
s_waitcnt lgkmcnt(6)
v_mfma_f32_32x32x16_bf16 a[240:255], a[172:175], a[40:43], a[240:255]
ds_read_b64_tr_b16 a[188:189], v10 offset:6144
ds_read_b64_tr_b16 a[190:191], v10 offset:6656
s_waitcnt lgkmcnt(6)
v_mfma_f32_32x32x16_bf16 a[192:207], a[176:179], a[44:47], a[192:207]
ds_read_b64_tr_b16 a[160:161], v7 offset:16384
ds_read_b64_tr_b16 a[162:163], v7 offset:16896
s_waitcnt lgkmcnt(6)
v_mfma_f32_32x32x16_bf16 a[208:223], a[180:183], a[44:47], a[208:223]
ds_read_b64_tr_b16 a[164:165], v8 offset:16384
ds_read_b64_tr_b16 a[166:167], v8 offset:16896
s_waitcnt lgkmcnt(6)
v_mfma_f32_32x32x16_bf16 a[224:239], a[184:187], a[44:47], a[224:239]
ds_read_b64_tr_b16 a[168:169], v9 offset:16384
ds_read_b64_tr_b16 a[170:171], v9 offset:16896
s_waitcnt lgkmcnt(6)
v_mfma_f32_32x32x16_bf16 a[240:255], a[188:191], a[44:47], a[240:255]
ds_read_b64_tr_b16 a[172:173], v10 offset:16384
ds_read_b64_tr_b16 a[174:175], v10 offset:16896
s_waitcnt lgkmcnt(6)
v_mfma_f32_32x32x16_bf16 v[96:111], a[160:163], a[32:35], v[96:111]
ds_read_b64_tr_b16 a[176:177], v7 offset:18432
ds_read_b64_tr_b16 a[178:179], v7 offset:18944
s_waitcnt lgkmcnt(6)
v_mfma_f32_32x32x16_bf16 v[112:127], a[164:167], a[32:35], v[112:127]
ds_read_b64_tr_b16 a[180:181], v8 offset:18432
ds_read_b64_tr_b16 a[182:183], v8 offset:18944
s_add_u32 m0, s25, 49152
s_add_u32 s32, s23, 884864
buffer_load_dwordx4 v12, s[12:15], s32 offen offset:0 lds
s_waitcnt lgkmcnt(6)
v_mfma_f32_32x32x16_bf16 v[128:143], a[168:171], a[32:35], v[128:143]
ds_read_b64_tr_b16 a[184:185], v9 offset:18432
ds_read_b64_tr_b16 a[186:187], v9 offset:18944
buffer_load_dwordx4 v13, s[12:15], s32 offen offset:1024 lds
s_waitcnt lgkmcnt(6)
v_mfma_f32_32x32x16_bf16 v[144:159], a[172:175], a[32:35], v[144:159]
ds_read_b64_tr_b16 a[188:189], v10 offset:18432
ds_read_b64_tr_b16 a[190:191], v10 offset:18944
buffer_load_dwordx4 v14, s[12:15], s32 offen offset:2048 lds
s_waitcnt lgkmcnt(6)
v_mfma_f32_32x32x16_bf16 v[96:111], a[176:179], a[36:39], v[96:111]
ds_read_b64_tr_b16 a[160:161], v7 offset:20480
ds_read_b64_tr_b16 a[162:163], v7 offset:20992
buffer_load_dwordx4 v15, s[12:15], s32 offen offset:3072 lds
s_waitcnt lgkmcnt(6)
v_mfma_f32_32x32x16_bf16 v[112:127], a[180:183], a[36:39], v[112:127]
ds_read_b64_tr_b16 a[164:165], v8 offset:20480
ds_read_b64_tr_b16 a[166:167], v8 offset:20992
s_waitcnt lgkmcnt(6)
v_mfma_f32_32x32x16_bf16 v[128:143], a[184:187], a[36:39], v[128:143]
ds_read_b64_tr_b16 a[168:169], v9 offset:20480
ds_read_b64_tr_b16 a[170:171], v9 offset:20992
s_waitcnt lgkmcnt(6)
v_mfma_f32_32x32x16_bf16 v[144:159], a[188:191], a[36:39], v[144:159]
ds_read_b64_tr_b16 a[172:173], v10 offset:20480
ds_read_b64_tr_b16 a[174:175], v10 offset:20992
s_waitcnt lgkmcnt(6)
v_mfma_f32_32x32x16_bf16 v[96:111], a[160:163], a[40:43], v[96:111]
ds_read_b64_tr_b16 a[176:177], v7 offset:22528
ds_read_b64_tr_b16 a[178:179], v7 offset:23040
s_waitcnt lgkmcnt(6)
v_mfma_f32_32x32x16_bf16 v[112:127], a[164:167], a[40:43], v[112:127]
ds_read_b64_tr_b16 a[180:181], v8 offset:22528
ds_read_b64_tr_b16 a[182:183], v8 offset:23040
s_waitcnt lgkmcnt(6)
v_mfma_f32_32x32x16_bf16 v[128:143], a[168:171], a[40:43], v[128:143]
ds_read_b64_tr_b16 a[184:185], v9 offset:22528
ds_read_b64_tr_b16 a[186:187], v9 offset:23040
s_waitcnt lgkmcnt(6)
v_mfma_f32_32x32x16_bf16 v[144:159], a[172:175], a[40:43], v[144:159]
ds_read_b64_tr_b16 a[188:189], v10 offset:22528
ds_read_b64_tr_b16 a[190:191], v10 offset:23040
s_waitcnt vmcnt(13)
s_barrier
ds_read_b128 a[48:51], v21 offset:0
ds_read_b128 a[52:55], v22 offset:0
ds_read_b128 a[56:59], v23 offset:0
ds_read_b128 a[60:63], v24 offset:0
s_waitcnt lgkmcnt(10)
v_mfma_f32_32x32x16_bf16 v[96:111], a[176:179], a[44:47], v[96:111]
ds_read_b64_tr_b16 a[160:161], v2 offset:0
ds_read_b64_tr_b16 a[162:163], v2 offset:512
s_waitcnt lgkmcnt(10)
v_mfma_f32_32x32x16_bf16 v[112:127], a[180:183], a[44:47], v[112:127]
ds_read_b64_tr_b16 a[164:165], v3 offset:0
ds_read_b64_tr_b16 a[166:167], v3 offset:512
s_waitcnt lgkmcnt(10)
v_mfma_f32_32x32x16_bf16 v[128:143], a[184:187], a[44:47], v[128:143]
ds_read_b64_tr_b16 a[168:169], v4 offset:0
ds_read_b64_tr_b16 a[170:171], v4 offset:512
s_waitcnt lgkmcnt(10)
v_mfma_f32_32x32x16_bf16 v[144:159], a[188:191], a[44:47], v[144:159]
ds_read_b64_tr_b16 a[172:173], v5 offset:0
ds_read_b64_tr_b16 a[174:175], v5 offset:512
s_waitcnt lgkmcnt(6)
v_mfma_f32_32x32x16_bf16 a[192:207], a[160:163], a[48:51], a[192:207]
ds_read_b64_tr_b16 a[176:177], v2 offset:2048
ds_read_b64_tr_b16 a[178:179], v2 offset:2560
s_waitcnt lgkmcnt(6)
v_mfma_f32_32x32x16_bf16 a[208:223], a[164:167], a[48:51], a[208:223]
ds_read_b64_tr_b16 a[180:181], v3 offset:2048
ds_read_b64_tr_b16 a[182:183], v3 offset:2560
s_add_u32 m0, s26, 8192
s_mov_b32 s24, 640
buffer_load_dwordx4 v17, s[8:11], s24 offen offset:0 lds
s_waitcnt lgkmcnt(6)
v_mfma_f32_32x32x16_bf16 a[224:239], a[168:171], a[48:51], a[224:239]
ds_read_b64_tr_b16 a[184:185], v4 offset:2048
ds_read_b64_tr_b16 a[186:187], v4 offset:2560
buffer_load_dwordx4 v18, s[8:11], s24 offen offset:1024 lds
s_waitcnt lgkmcnt(6)
v_mfma_f32_32x32x16_bf16 a[240:255], a[172:175], a[48:51], a[240:255]
ds_read_b64_tr_b16 a[188:189], v5 offset:2048
ds_read_b64_tr_b16 a[190:191], v5 offset:2560
buffer_load_dwordx4 v19, s[8:11], s24 offen offset:2048 lds
s_waitcnt lgkmcnt(6)
v_mfma_f32_32x32x16_bf16 a[192:207], a[176:179], a[52:55], a[192:207]
ds_read_b64_tr_b16 a[160:161], v2 offset:4096
ds_read_b64_tr_b16 a[162:163], v2 offset:4608
buffer_load_dwordx4 v20, s[8:11], s24 offen offset:3072 lds
s_waitcnt lgkmcnt(6)
v_mfma_f32_32x32x16_bf16 a[208:223], a[180:183], a[52:55], a[208:223]
ds_read_b64_tr_b16 a[164:165], v3 offset:4096
ds_read_b64_tr_b16 a[166:167], v3 offset:4608
s_add_u32 m0, s25, 65536
s_add_u32 s32, s23, 1105920
buffer_load_dwordx4 v12, s[12:15], s32 offen offset:0 lds
s_waitcnt lgkmcnt(6)
v_mfma_f32_32x32x16_bf16 a[224:239], a[184:187], a[52:55], a[224:239]
ds_read_b64_tr_b16 a[168:169], v4 offset:4096
ds_read_b64_tr_b16 a[170:171], v4 offset:4608
buffer_load_dwordx4 v13, s[12:15], s32 offen offset:1024 lds
s_waitcnt lgkmcnt(6)
v_mfma_f32_32x32x16_bf16 a[240:255], a[188:191], a[52:55], a[240:255]
ds_read_b64_tr_b16 a[172:173], v5 offset:4096
ds_read_b64_tr_b16 a[174:175], v5 offset:4608
buffer_load_dwordx4 v14, s[12:15], s32 offen offset:2048 lds
s_waitcnt lgkmcnt(6)
v_mfma_f32_32x32x16_bf16 a[192:207], a[160:163], a[56:59], a[192:207]
ds_read_b64_tr_b16 a[176:177], v2 offset:6144
ds_read_b64_tr_b16 a[178:179], v2 offset:6656
buffer_load_dwordx4 v15, s[12:15], s32 offen offset:3072 lds
s_waitcnt lgkmcnt(6)
v_mfma_f32_32x32x16_bf16 a[208:223], a[164:167], a[56:59], a[208:223]
ds_read_b64_tr_b16 a[180:181], v3 offset:6144
ds_read_b64_tr_b16 a[182:183], v3 offset:6656
s_waitcnt lgkmcnt(6)
v_mfma_f32_32x32x16_bf16 a[224:239], a[168:171], a[56:59], a[224:239]
ds_read_b64_tr_b16 a[184:185], v4 offset:6144
ds_read_b64_tr_b16 a[186:187], v4 offset:6656
s_waitcnt lgkmcnt(6)
v_mfma_f32_32x32x16_bf16 a[240:255], a[172:175], a[56:59], a[240:255]
ds_read_b64_tr_b16 a[188:189], v5 offset:6144
ds_read_b64_tr_b16 a[190:191], v5 offset:6656
s_waitcnt lgkmcnt(6)
v_mfma_f32_32x32x16_bf16 a[192:207], a[176:179], a[60:63], a[192:207]
ds_read_b64_tr_b16 a[160:161], v2 offset:16384
ds_read_b64_tr_b16 a[162:163], v2 offset:16896
s_waitcnt lgkmcnt(6)
v_mfma_f32_32x32x16_bf16 a[208:223], a[180:183], a[60:63], a[208:223]
ds_read_b64_tr_b16 a[164:165], v3 offset:16384
ds_read_b64_tr_b16 a[166:167], v3 offset:16896
s_waitcnt lgkmcnt(6)
v_mfma_f32_32x32x16_bf16 a[224:239], a[184:187], a[60:63], a[224:239]
ds_read_b64_tr_b16 a[168:169], v4 offset:16384
ds_read_b64_tr_b16 a[170:171], v4 offset:16896
s_waitcnt lgkmcnt(6)
v_mfma_f32_32x32x16_bf16 a[240:255], a[188:191], a[60:63], a[240:255]
ds_read_b64_tr_b16 a[172:173], v5 offset:16384
ds_read_b64_tr_b16 a[174:175], v5 offset:16896
s_waitcnt lgkmcnt(6)
v_mfma_f32_32x32x16_bf16 v[96:111], a[160:163], a[48:51], v[96:111]
ds_read_b64_tr_b16 a[176:177], v2 offset:18432
ds_read_b64_tr_b16 a[178:179], v2 offset:18944
s_waitcnt lgkmcnt(6)
v_mfma_f32_32x32x16_bf16 v[112:127], a[164:167], a[48:51], v[112:127]
ds_read_b64_tr_b16 a[180:181], v3 offset:18432
ds_read_b64_tr_b16 a[182:183], v3 offset:18944
s_add_u32 m0, s25, 81920
s_add_u32 s32, s23, 1106048
buffer_load_dwordx4 v12, s[12:15], s32 offen offset:0 lds
s_waitcnt lgkmcnt(6)
v_mfma_f32_32x32x16_bf16 v[128:143], a[168:171], a[48:51], v[128:143]
ds_read_b64_tr_b16 a[184:185], v4 offset:18432
ds_read_b64_tr_b16 a[186:187], v4 offset:18944
buffer_load_dwordx4 v13, s[12:15], s32 offen offset:1024 lds
s_waitcnt lgkmcnt(6)
v_mfma_f32_32x32x16_bf16 v[144:159], a[172:175], a[48:51], v[144:159]
ds_read_b64_tr_b16 a[188:189], v5 offset:18432
ds_read_b64_tr_b16 a[190:191], v5 offset:18944
buffer_load_dwordx4 v14, s[12:15], s32 offen offset:2048 lds
s_waitcnt lgkmcnt(6)
v_mfma_f32_32x32x16_bf16 v[96:111], a[176:179], a[52:55], v[96:111]
ds_read_b64_tr_b16 a[160:161], v2 offset:20480
ds_read_b64_tr_b16 a[162:163], v2 offset:20992
buffer_load_dwordx4 v15, s[12:15], s32 offen offset:3072 lds
s_waitcnt lgkmcnt(6)
v_mfma_f32_32x32x16_bf16 v[112:127], a[180:183], a[52:55], v[112:127]
ds_read_b64_tr_b16 a[164:165], v3 offset:20480
ds_read_b64_tr_b16 a[166:167], v3 offset:20992
s_waitcnt lgkmcnt(6)
v_mfma_f32_32x32x16_bf16 v[128:143], a[184:187], a[52:55], v[128:143]
ds_read_b64_tr_b16 a[168:169], v4 offset:20480
ds_read_b64_tr_b16 a[170:171], v4 offset:20992
s_waitcnt lgkmcnt(6)
v_mfma_f32_32x32x16_bf16 v[144:159], a[188:191], a[52:55], v[144:159]
ds_read_b64_tr_b16 a[172:173], v5 offset:20480
ds_read_b64_tr_b16 a[174:175], v5 offset:20992
s_waitcnt lgkmcnt(6)
v_mfma_f32_32x32x16_bf16 v[96:111], a[160:163], a[56:59], v[96:111]
ds_read_b64_tr_b16 a[176:177], v2 offset:22528
ds_read_b64_tr_b16 a[178:179], v2 offset:23040
s_waitcnt lgkmcnt(6)
v_mfma_f32_32x32x16_bf16 v[112:127], a[164:167], a[56:59], v[112:127]
ds_read_b64_tr_b16 a[180:181], v3 offset:22528
ds_read_b64_tr_b16 a[182:183], v3 offset:23040
s_waitcnt lgkmcnt(6)
v_mfma_f32_32x32x16_bf16 v[128:143], a[168:171], a[56:59], v[128:143]
ds_read_b64_tr_b16 a[184:185], v4 offset:22528
ds_read_b64_tr_b16 a[186:187], v4 offset:23040
s_waitcnt lgkmcnt(6)
v_mfma_f32_32x32x16_bf16 v[144:159], a[172:175], a[56:59], v[144:159]
ds_read_b64_tr_b16 a[188:189], v5 offset:22528
ds_read_b64_tr_b16 a[190:191], v5 offset:23040
s_waitcnt vmcnt(12)
s_barrier
ds_read_b128 a[64:67], v21 offset:4096
ds_read_b128 a[68:71], v22 offset:4096
ds_read_b128 a[72:75], v23 offset:4096
ds_read_b128 a[76:79], v24 offset:4096
s_waitcnt lgkmcnt(10)
v_mfma_f32_32x32x16_bf16 v[96:111], a[176:179], a[60:63], v[96:111]
ds_read_b64_tr_b16 a[160:161], v2 offset:32768
ds_read_b64_tr_b16 a[162:163], v2 offset:33280
s_waitcnt lgkmcnt(10)
v_mfma_f32_32x32x16_bf16 v[112:127], a[180:183], a[60:63], v[112:127]
ds_read_b64_tr_b16 a[164:165], v3 offset:32768
ds_read_b64_tr_b16 a[166:167], v3 offset:33280
s_waitcnt lgkmcnt(10)
v_mfma_f32_32x32x16_bf16 v[128:143], a[184:187], a[60:63], v[128:143]
ds_read_b64_tr_b16 a[168:169], v4 offset:32768
ds_read_b64_tr_b16 a[170:171], v4 offset:33280
s_waitcnt lgkmcnt(10)
v_mfma_f32_32x32x16_bf16 v[144:159], a[188:191], a[60:63], v[144:159]
ds_read_b64_tr_b16 a[172:173], v5 offset:32768
ds_read_b64_tr_b16 a[174:175], v5 offset:33280
s_waitcnt lgkmcnt(6)
v_mfma_f32_32x32x16_bf16 a[192:207], a[160:163], a[64:67], a[192:207]
ds_read_b64_tr_b16 a[176:177], v2 offset:34816
ds_read_b64_tr_b16 a[178:179], v2 offset:35328
s_waitcnt lgkmcnt(6)
v_mfma_f32_32x32x16_bf16 a[208:223], a[164:167], a[64:67], a[208:223]
ds_read_b64_tr_b16 a[180:181], v3 offset:34816
ds_read_b64_tr_b16 a[182:183], v3 offset:35328
s_add_u32 m0, s26, 0
s_mov_b32 s24, 768
buffer_load_dwordx4 v17, s[8:11], s24 offen offset:0 lds
s_waitcnt lgkmcnt(6)
v_mfma_f32_32x32x16_bf16 a[224:239], a[168:171], a[64:67], a[224:239]
ds_read_b64_tr_b16 a[184:185], v4 offset:34816
ds_read_b64_tr_b16 a[186:187], v4 offset:35328
buffer_load_dwordx4 v18, s[8:11], s24 offen offset:1024 lds
s_waitcnt lgkmcnt(6)
v_mfma_f32_32x32x16_bf16 a[240:255], a[172:175], a[64:67], a[240:255]
ds_read_b64_tr_b16 a[188:189], v5 offset:34816
ds_read_b64_tr_b16 a[190:191], v5 offset:35328
buffer_load_dwordx4 v19, s[8:11], s24 offen offset:2048 lds
s_waitcnt lgkmcnt(6)
v_mfma_f32_32x32x16_bf16 a[192:207], a[176:179], a[68:71], a[192:207]
ds_read_b64_tr_b16 a[160:161], v2 offset:36864
ds_read_b64_tr_b16 a[162:163], v2 offset:37376
buffer_load_dwordx4 v20, s[8:11], s24 offen offset:3072 lds
s_waitcnt lgkmcnt(6)
v_mfma_f32_32x32x16_bf16 a[208:223], a[180:183], a[68:71], a[208:223]
ds_read_b64_tr_b16 a[164:165], v3 offset:36864
ds_read_b64_tr_b16 a[166:167], v3 offset:37376
s_add_u32 m0, s25, 0
s_add_u32 s32, s23, 1327104
buffer_load_dwordx4 v12, s[12:15], s32 offen offset:0 lds
s_waitcnt lgkmcnt(6)
v_mfma_f32_32x32x16_bf16 a[224:239], a[184:187], a[68:71], a[224:239]
ds_read_b64_tr_b16 a[168:169], v4 offset:36864
ds_read_b64_tr_b16 a[170:171], v4 offset:37376
buffer_load_dwordx4 v13, s[12:15], s32 offen offset:1024 lds
s_waitcnt lgkmcnt(6)
v_mfma_f32_32x32x16_bf16 a[240:255], a[188:191], a[68:71], a[240:255]
ds_read_b64_tr_b16 a[172:173], v5 offset:36864
ds_read_b64_tr_b16 a[174:175], v5 offset:37376
buffer_load_dwordx4 v14, s[12:15], s32 offen offset:2048 lds
s_waitcnt lgkmcnt(6)
v_mfma_f32_32x32x16_bf16 a[192:207], a[160:163], a[72:75], a[192:207]
ds_read_b64_tr_b16 a[176:177], v2 offset:38912
ds_read_b64_tr_b16 a[178:179], v2 offset:39424
buffer_load_dwordx4 v15, s[12:15], s32 offen offset:3072 lds
s_waitcnt lgkmcnt(6)
v_mfma_f32_32x32x16_bf16 a[208:223], a[164:167], a[72:75], a[208:223]
ds_read_b64_tr_b16 a[180:181], v3 offset:38912
ds_read_b64_tr_b16 a[182:183], v3 offset:39424
s_waitcnt lgkmcnt(6)
v_mfma_f32_32x32x16_bf16 a[224:239], a[168:171], a[72:75], a[224:239]
ds_read_b64_tr_b16 a[184:185], v4 offset:38912
ds_read_b64_tr_b16 a[186:187], v4 offset:39424
s_waitcnt lgkmcnt(6)
v_mfma_f32_32x32x16_bf16 a[240:255], a[172:175], a[72:75], a[240:255]
ds_read_b64_tr_b16 a[188:189], v5 offset:38912
ds_read_b64_tr_b16 a[190:191], v5 offset:39424
s_waitcnt lgkmcnt(6)
v_mfma_f32_32x32x16_bf16 a[192:207], a[176:179], a[76:79], a[192:207]
ds_read_b64_tr_b16 a[160:161], v2 offset:49152
ds_read_b64_tr_b16 a[162:163], v2 offset:49664
s_waitcnt lgkmcnt(6)
v_mfma_f32_32x32x16_bf16 a[208:223], a[180:183], a[76:79], a[208:223]
ds_read_b64_tr_b16 a[164:165], v3 offset:49152
ds_read_b64_tr_b16 a[166:167], v3 offset:49664
s_waitcnt lgkmcnt(6)
v_mfma_f32_32x32x16_bf16 a[224:239], a[184:187], a[76:79], a[224:239]
ds_read_b64_tr_b16 a[168:169], v4 offset:49152
ds_read_b64_tr_b16 a[170:171], v4 offset:49664
s_waitcnt lgkmcnt(6)
v_mfma_f32_32x32x16_bf16 a[240:255], a[188:191], a[76:79], a[240:255]
ds_read_b64_tr_b16 a[172:173], v5 offset:49152
ds_read_b64_tr_b16 a[174:175], v5 offset:49664
s_waitcnt lgkmcnt(6)
v_mfma_f32_32x32x16_bf16 v[96:111], a[160:163], a[64:67], v[96:111]
ds_read_b64_tr_b16 a[176:177], v2 offset:51200
ds_read_b64_tr_b16 a[178:179], v2 offset:51712
s_waitcnt lgkmcnt(6)
v_mfma_f32_32x32x16_bf16 v[112:127], a[164:167], a[64:67], v[112:127]
ds_read_b64_tr_b16 a[180:181], v3 offset:51200
ds_read_b64_tr_b16 a[182:183], v3 offset:51712
s_add_u32 m0, s25, 16384
s_add_u32 s32, s23, 1327232
buffer_load_dwordx4 v12, s[12:15], s32 offen offset:0 lds
s_waitcnt lgkmcnt(6)
v_mfma_f32_32x32x16_bf16 v[128:143], a[168:171], a[64:67], v[128:143]
ds_read_b64_tr_b16 a[184:185], v4 offset:51200
ds_read_b64_tr_b16 a[186:187], v4 offset:51712
buffer_load_dwordx4 v13, s[12:15], s32 offen offset:1024 lds
s_waitcnt lgkmcnt(6)
v_mfma_f32_32x32x16_bf16 v[144:159], a[172:175], a[64:67], v[144:159]
ds_read_b64_tr_b16 a[188:189], v5 offset:51200
ds_read_b64_tr_b16 a[190:191], v5 offset:51712
buffer_load_dwordx4 v14, s[12:15], s32 offen offset:2048 lds
s_waitcnt lgkmcnt(6)
v_mfma_f32_32x32x16_bf16 v[96:111], a[176:179], a[68:71], v[96:111]
ds_read_b64_tr_b16 a[160:161], v2 offset:53248
ds_read_b64_tr_b16 a[162:163], v2 offset:53760
buffer_load_dwordx4 v15, s[12:15], s32 offen offset:3072 lds
s_waitcnt lgkmcnt(6)
v_mfma_f32_32x32x16_bf16 v[112:127], a[180:183], a[68:71], v[112:127]
ds_read_b64_tr_b16 a[164:165], v3 offset:53248
ds_read_b64_tr_b16 a[166:167], v3 offset:53760
s_waitcnt lgkmcnt(6)
v_mfma_f32_32x32x16_bf16 v[128:143], a[184:187], a[68:71], v[128:143]
ds_read_b64_tr_b16 a[168:169], v4 offset:53248
ds_read_b64_tr_b16 a[170:171], v4 offset:53760
s_waitcnt lgkmcnt(6)
v_mfma_f32_32x32x16_bf16 v[144:159], a[188:191], a[68:71], v[144:159]
ds_read_b64_tr_b16 a[172:173], v5 offset:53248
ds_read_b64_tr_b16 a[174:175], v5 offset:53760
s_waitcnt lgkmcnt(6)
v_mfma_f32_32x32x16_bf16 v[96:111], a[160:163], a[72:75], v[96:111]
ds_read_b64_tr_b16 a[176:177], v2 offset:55296
ds_read_b64_tr_b16 a[178:179], v2 offset:55808
s_waitcnt lgkmcnt(6)
v_mfma_f32_32x32x16_bf16 v[112:127], a[164:167], a[72:75], v[112:127]
ds_read_b64_tr_b16 a[180:181], v3 offset:55296
ds_read_b64_tr_b16 a[182:183], v3 offset:55808
s_waitcnt lgkmcnt(6)
v_mfma_f32_32x32x16_bf16 v[128:143], a[168:171], a[72:75], v[128:143]
ds_read_b64_tr_b16 a[184:185], v4 offset:55296
ds_read_b64_tr_b16 a[186:187], v4 offset:55808
s_waitcnt lgkmcnt(6)
v_mfma_f32_32x32x16_bf16 v[144:159], a[172:175], a[72:75], v[144:159]
ds_read_b64_tr_b16 a[188:189], v5 offset:55296
ds_read_b64_tr_b16 a[190:191], v5 offset:55808
s_waitcnt vmcnt(12)
s_barrier
ds_read_b128 a[80:83], v21 offset:8192
ds_read_b128 a[84:87], v22 offset:8192
ds_read_b128 a[88:91], v23 offset:8192
ds_read_b128 a[92:95], v24 offset:8192
s_waitcnt lgkmcnt(10)
v_mfma_f32_32x32x16_bf16 v[96:111], a[176:179], a[76:79], v[96:111]
ds_read_b64_tr_b16 a[160:161], v7 offset:0
ds_read_b64_tr_b16 a[162:163], v7 offset:512
s_waitcnt lgkmcnt(10)
v_mfma_f32_32x32x16_bf16 v[112:127], a[180:183], a[76:79], v[112:127]
ds_read_b64_tr_b16 a[164:165], v8 offset:0
ds_read_b64_tr_b16 a[166:167], v8 offset:512
s_waitcnt lgkmcnt(10)
v_mfma_f32_32x32x16_bf16 v[128:143], a[184:187], a[76:79], v[128:143]
ds_read_b64_tr_b16 a[168:169], v9 offset:0
ds_read_b64_tr_b16 a[170:171], v9 offset:512
s_waitcnt lgkmcnt(10)
v_mfma_f32_32x32x16_bf16 v[144:159], a[188:191], a[76:79], v[144:159]
ds_read_b64_tr_b16 a[172:173], v10 offset:0
ds_read_b64_tr_b16 a[174:175], v10 offset:512
s_waitcnt lgkmcnt(6)
v_mfma_f32_32x32x16_bf16 a[192:207], a[160:163], a[80:83], a[192:207]
ds_read_b64_tr_b16 a[176:177], v7 offset:2048
ds_read_b64_tr_b16 a[178:179], v7 offset:2560
s_waitcnt lgkmcnt(6)
v_mfma_f32_32x32x16_bf16 a[208:223], a[164:167], a[80:83], a[208:223]
ds_read_b64_tr_b16 a[180:181], v8 offset:2048
ds_read_b64_tr_b16 a[182:183], v8 offset:2560
s_add_u32 m0, s26, 4096
s_mov_b32 s24, 896
buffer_load_dwordx4 v17, s[8:11], s24 offen offset:0 lds
s_waitcnt lgkmcnt(6)
v_mfma_f32_32x32x16_bf16 a[224:239], a[168:171], a[80:83], a[224:239]
ds_read_b64_tr_b16 a[184:185], v9 offset:2048
ds_read_b64_tr_b16 a[186:187], v9 offset:2560
buffer_load_dwordx4 v18, s[8:11], s24 offen offset:1024 lds
s_waitcnt lgkmcnt(6)
v_mfma_f32_32x32x16_bf16 a[240:255], a[172:175], a[80:83], a[240:255]
ds_read_b64_tr_b16 a[188:189], v10 offset:2048
ds_read_b64_tr_b16 a[190:191], v10 offset:2560
buffer_load_dwordx4 v19, s[8:11], s24 offen offset:2048 lds
s_waitcnt lgkmcnt(6)
v_mfma_f32_32x32x16_bf16 a[192:207], a[176:179], a[84:87], a[192:207]
ds_read_b64_tr_b16 a[160:161], v7 offset:4096
ds_read_b64_tr_b16 a[162:163], v7 offset:4608
buffer_load_dwordx4 v20, s[8:11], s24 offen offset:3072 lds
s_waitcnt lgkmcnt(6)
v_mfma_f32_32x32x16_bf16 a[208:223], a[180:183], a[84:87], a[208:223]
ds_read_b64_tr_b16 a[164:165], v8 offset:4096
ds_read_b64_tr_b16 a[166:167], v8 offset:4608
s_add_u32 m0, s25, 32768
s_add_u32 s32, s23, 1548288
buffer_load_dwordx4 v12, s[12:15], s32 offen offset:0 lds
s_waitcnt lgkmcnt(6)
v_mfma_f32_32x32x16_bf16 a[224:239], a[184:187], a[84:87], a[224:239]
ds_read_b64_tr_b16 a[168:169], v9 offset:4096
ds_read_b64_tr_b16 a[170:171], v9 offset:4608
buffer_load_dwordx4 v13, s[12:15], s32 offen offset:1024 lds
s_waitcnt lgkmcnt(6)
v_mfma_f32_32x32x16_bf16 a[240:255], a[188:191], a[84:87], a[240:255]
ds_read_b64_tr_b16 a[172:173], v10 offset:4096
ds_read_b64_tr_b16 a[174:175], v10 offset:4608
buffer_load_dwordx4 v14, s[12:15], s32 offen offset:2048 lds
s_waitcnt lgkmcnt(6)
v_mfma_f32_32x32x16_bf16 a[192:207], a[160:163], a[88:91], a[192:207]
ds_read_b64_tr_b16 a[176:177], v7 offset:6144
ds_read_b64_tr_b16 a[178:179], v7 offset:6656
buffer_load_dwordx4 v15, s[12:15], s32 offen offset:3072 lds
s_waitcnt lgkmcnt(6)
v_mfma_f32_32x32x16_bf16 a[208:223], a[164:167], a[88:91], a[208:223]
ds_read_b64_tr_b16 a[180:181], v8 offset:6144
ds_read_b64_tr_b16 a[182:183], v8 offset:6656
s_waitcnt lgkmcnt(6)
v_mfma_f32_32x32x16_bf16 a[224:239], a[168:171], a[88:91], a[224:239]
ds_read_b64_tr_b16 a[184:185], v9 offset:6144
ds_read_b64_tr_b16 a[186:187], v9 offset:6656
s_waitcnt lgkmcnt(6)
v_mfma_f32_32x32x16_bf16 a[240:255], a[172:175], a[88:91], a[240:255]
ds_read_b64_tr_b16 a[188:189], v10 offset:6144
ds_read_b64_tr_b16 a[190:191], v10 offset:6656
s_waitcnt lgkmcnt(6)
v_mfma_f32_32x32x16_bf16 a[192:207], a[176:179], a[92:95], a[192:207]
ds_read_b64_tr_b16 a[160:161], v7 offset:16384
ds_read_b64_tr_b16 a[162:163], v7 offset:16896
s_waitcnt lgkmcnt(6)
v_mfma_f32_32x32x16_bf16 a[208:223], a[180:183], a[92:95], a[208:223]
ds_read_b64_tr_b16 a[164:165], v8 offset:16384
ds_read_b64_tr_b16 a[166:167], v8 offset:16896
s_waitcnt lgkmcnt(6)
v_mfma_f32_32x32x16_bf16 a[224:239], a[184:187], a[92:95], a[224:239]
ds_read_b64_tr_b16 a[168:169], v9 offset:16384
ds_read_b64_tr_b16 a[170:171], v9 offset:16896
s_waitcnt lgkmcnt(6)
v_mfma_f32_32x32x16_bf16 a[240:255], a[188:191], a[92:95], a[240:255]
ds_read_b64_tr_b16 a[172:173], v10 offset:16384
ds_read_b64_tr_b16 a[174:175], v10 offset:16896
s_waitcnt lgkmcnt(6)
v_mfma_f32_32x32x16_bf16 v[96:111], a[160:163], a[80:83], v[96:111]
ds_read_b64_tr_b16 a[176:177], v7 offset:18432
ds_read_b64_tr_b16 a[178:179], v7 offset:18944
s_waitcnt lgkmcnt(6)
v_mfma_f32_32x32x16_bf16 v[112:127], a[164:167], a[80:83], v[112:127]
ds_read_b64_tr_b16 a[180:181], v8 offset:18432
ds_read_b64_tr_b16 a[182:183], v8 offset:18944
s_add_u32 m0, s25, 49152
s_add_u32 s32, s23, 1548416
buffer_load_dwordx4 v12, s[12:15], s32 offen offset:0 lds
s_waitcnt lgkmcnt(6)
v_mfma_f32_32x32x16_bf16 v[128:143], a[168:171], a[80:83], v[128:143]
ds_read_b64_tr_b16 a[184:185], v9 offset:18432
ds_read_b64_tr_b16 a[186:187], v9 offset:18944
buffer_load_dwordx4 v13, s[12:15], s32 offen offset:1024 lds
s_waitcnt lgkmcnt(6)
v_mfma_f32_32x32x16_bf16 v[144:159], a[172:175], a[80:83], v[144:159]
ds_read_b64_tr_b16 a[188:189], v10 offset:18432
ds_read_b64_tr_b16 a[190:191], v10 offset:18944
buffer_load_dwordx4 v14, s[12:15], s32 offen offset:2048 lds
s_waitcnt lgkmcnt(6)
v_mfma_f32_32x32x16_bf16 v[96:111], a[176:179], a[84:87], v[96:111]
ds_read_b64_tr_b16 a[160:161], v7 offset:20480
ds_read_b64_tr_b16 a[162:163], v7 offset:20992
buffer_load_dwordx4 v15, s[12:15], s32 offen offset:3072 lds
s_waitcnt lgkmcnt(6)
v_mfma_f32_32x32x16_bf16 v[112:127], a[180:183], a[84:87], v[112:127]
ds_read_b64_tr_b16 a[164:165], v8 offset:20480
ds_read_b64_tr_b16 a[166:167], v8 offset:20992
s_waitcnt lgkmcnt(6)
v_mfma_f32_32x32x16_bf16 v[128:143], a[184:187], a[84:87], v[128:143]
ds_read_b64_tr_b16 a[168:169], v9 offset:20480
ds_read_b64_tr_b16 a[170:171], v9 offset:20992
s_waitcnt lgkmcnt(6)
v_mfma_f32_32x32x16_bf16 v[144:159], a[188:191], a[84:87], v[144:159]
ds_read_b64_tr_b16 a[172:173], v10 offset:20480
ds_read_b64_tr_b16 a[174:175], v10 offset:20992
s_waitcnt lgkmcnt(6)
v_mfma_f32_32x32x16_bf16 v[96:111], a[160:163], a[88:91], v[96:111]
ds_read_b64_tr_b16 a[176:177], v7 offset:22528
ds_read_b64_tr_b16 a[178:179], v7 offset:23040
s_waitcnt lgkmcnt(6)
v_mfma_f32_32x32x16_bf16 v[112:127], a[164:167], a[88:91], v[112:127]
ds_read_b64_tr_b16 a[180:181], v8 offset:22528
ds_read_b64_tr_b16 a[182:183], v8 offset:23040
s_waitcnt lgkmcnt(6)
v_mfma_f32_32x32x16_bf16 v[128:143], a[168:171], a[88:91], v[128:143]
ds_read_b64_tr_b16 a[184:185], v9 offset:22528
ds_read_b64_tr_b16 a[186:187], v9 offset:23040
s_waitcnt lgkmcnt(6)
v_mfma_f32_32x32x16_bf16 v[144:159], a[172:175], a[88:91], v[144:159]
ds_read_b64_tr_b16 a[188:189], v10 offset:22528
ds_read_b64_tr_b16 a[190:191], v10 offset:23040
s_waitcnt vmcnt(12)
s_barrier
ds_read_b128 a[96:99], v21 offset:0
ds_read_b128 a[100:103], v22 offset:0
ds_read_b128 a[104:107], v23 offset:0
ds_read_b128 a[108:111], v24 offset:0
s_waitcnt lgkmcnt(10)
v_mfma_f32_32x32x16_bf16 v[96:111], a[176:179], a[92:95], v[96:111]
ds_read_b64_tr_b16 a[160:161], v2 offset:0
ds_read_b64_tr_b16 a[162:163], v2 offset:512
s_waitcnt lgkmcnt(10)
v_mfma_f32_32x32x16_bf16 v[112:127], a[180:183], a[92:95], v[112:127]
ds_read_b64_tr_b16 a[164:165], v3 offset:0
ds_read_b64_tr_b16 a[166:167], v3 offset:512
s_waitcnt lgkmcnt(10)
v_mfma_f32_32x32x16_bf16 v[128:143], a[184:187], a[92:95], v[128:143]
ds_read_b64_tr_b16 a[168:169], v4 offset:0
ds_read_b64_tr_b16 a[170:171], v4 offset:512
s_waitcnt lgkmcnt(10)
v_mfma_f32_32x32x16_bf16 v[144:159], a[188:191], a[92:95], v[144:159]
ds_read_b64_tr_b16 a[172:173], v5 offset:0
ds_read_b64_tr_b16 a[174:175], v5 offset:512
s_waitcnt lgkmcnt(6)
v_mfma_f32_32x32x16_bf16 a[192:207], a[160:163], a[96:99], a[192:207]
ds_read_b64_tr_b16 a[176:177], v2 offset:2048
ds_read_b64_tr_b16 a[178:179], v2 offset:2560
s_waitcnt lgkmcnt(6)
v_mfma_f32_32x32x16_bf16 a[208:223], a[164:167], a[96:99], a[208:223]
ds_read_b64_tr_b16 a[180:181], v3 offset:2048
ds_read_b64_tr_b16 a[182:183], v3 offset:2560
s_add_u32 m0, s26, 8192
s_mov_b32 s24, 1024
buffer_load_dwordx4 v17, s[8:11], s24 offen offset:0 lds
s_waitcnt lgkmcnt(6)
v_mfma_f32_32x32x16_bf16 a[224:239], a[168:171], a[96:99], a[224:239]
ds_read_b64_tr_b16 a[184:185], v4 offset:2048
ds_read_b64_tr_b16 a[186:187], v4 offset:2560
buffer_load_dwordx4 v18, s[8:11], s24 offen offset:1024 lds
s_waitcnt lgkmcnt(6)
v_mfma_f32_32x32x16_bf16 a[240:255], a[172:175], a[96:99], a[240:255]
ds_read_b64_tr_b16 a[188:189], v5 offset:2048
ds_read_b64_tr_b16 a[190:191], v5 offset:2560
buffer_load_dwordx4 v19, s[8:11], s24 offen offset:2048 lds
s_waitcnt lgkmcnt(6)
v_mfma_f32_32x32x16_bf16 a[192:207], a[176:179], a[100:103], a[192:207]
ds_read_b64_tr_b16 a[160:161], v2 offset:4096
ds_read_b64_tr_b16 a[162:163], v2 offset:4608
buffer_load_dwordx4 v20, s[8:11], s24 offen offset:3072 lds
s_waitcnt lgkmcnt(6)
v_mfma_f32_32x32x16_bf16 a[208:223], a[180:183], a[100:103], a[208:223]
ds_read_b64_tr_b16 a[164:165], v3 offset:4096
ds_read_b64_tr_b16 a[166:167], v3 offset:4608
s_add_u32 m0, s25, 65536
s_add_u32 s32, s23, 1769472
buffer_load_dwordx4 v12, s[12:15], s32 offen offset:0 lds
s_waitcnt lgkmcnt(6)
v_mfma_f32_32x32x16_bf16 a[224:239], a[184:187], a[100:103], a[224:239]
ds_read_b64_tr_b16 a[168:169], v4 offset:4096
ds_read_b64_tr_b16 a[170:171], v4 offset:4608
buffer_load_dwordx4 v13, s[12:15], s32 offen offset:1024 lds
s_waitcnt lgkmcnt(6)
v_mfma_f32_32x32x16_bf16 a[240:255], a[188:191], a[100:103], a[240:255]
ds_read_b64_tr_b16 a[172:173], v5 offset:4096
ds_read_b64_tr_b16 a[174:175], v5 offset:4608
buffer_load_dwordx4 v14, s[12:15], s32 offen offset:2048 lds
s_waitcnt lgkmcnt(6)
v_mfma_f32_32x32x16_bf16 a[192:207], a[160:163], a[104:107], a[192:207]
ds_read_b64_tr_b16 a[176:177], v2 offset:6144
ds_read_b64_tr_b16 a[178:179], v2 offset:6656
buffer_load_dwordx4 v15, s[12:15], s32 offen offset:3072 lds
s_waitcnt lgkmcnt(6)
v_mfma_f32_32x32x16_bf16 a[208:223], a[164:167], a[104:107], a[208:223]
ds_read_b64_tr_b16 a[180:181], v3 offset:6144
ds_read_b64_tr_b16 a[182:183], v3 offset:6656
s_waitcnt lgkmcnt(6)
v_mfma_f32_32x32x16_bf16 a[224:239], a[168:171], a[104:107], a[224:239]
ds_read_b64_tr_b16 a[184:185], v4 offset:6144
ds_read_b64_tr_b16 a[186:187], v4 offset:6656
s_waitcnt lgkmcnt(6)
v_mfma_f32_32x32x16_bf16 a[240:255], a[172:175], a[104:107], a[240:255]
ds_read_b64_tr_b16 a[188:189], v5 offset:6144
ds_read_b64_tr_b16 a[190:191], v5 offset:6656
s_waitcnt lgkmcnt(6)
v_mfma_f32_32x32x16_bf16 a[192:207], a[176:179], a[108:111], a[192:207]
ds_read_b64_tr_b16 a[160:161], v2 offset:16384
ds_read_b64_tr_b16 a[162:163], v2 offset:16896
s_waitcnt lgkmcnt(6)
v_mfma_f32_32x32x16_bf16 a[208:223], a[180:183], a[108:111], a[208:223]
ds_read_b64_tr_b16 a[164:165], v3 offset:16384
ds_read_b64_tr_b16 a[166:167], v3 offset:16896
s_waitcnt lgkmcnt(6)
v_mfma_f32_32x32x16_bf16 a[224:239], a[184:187], a[108:111], a[224:239]
ds_read_b64_tr_b16 a[168:169], v4 offset:16384
ds_read_b64_tr_b16 a[170:171], v4 offset:16896
s_waitcnt lgkmcnt(6)
v_mfma_f32_32x32x16_bf16 a[240:255], a[188:191], a[108:111], a[240:255]
ds_read_b64_tr_b16 a[172:173], v5 offset:16384
ds_read_b64_tr_b16 a[174:175], v5 offset:16896
s_waitcnt lgkmcnt(6)
v_mfma_f32_32x32x16_bf16 v[96:111], a[160:163], a[96:99], v[96:111]
ds_read_b64_tr_b16 a[176:177], v2 offset:18432
ds_read_b64_tr_b16 a[178:179], v2 offset:18944
s_waitcnt lgkmcnt(6)
v_mfma_f32_32x32x16_bf16 v[112:127], a[164:167], a[96:99], v[112:127]
ds_read_b64_tr_b16 a[180:181], v3 offset:18432
ds_read_b64_tr_b16 a[182:183], v3 offset:18944
s_add_u32 m0, s25, 81920
s_add_u32 s32, s23, 1769600
buffer_load_dwordx4 v12, s[12:15], s32 offen offset:0 lds
s_waitcnt lgkmcnt(6)
v_mfma_f32_32x32x16_bf16 v[128:143], a[168:171], a[96:99], v[128:143]
ds_read_b64_tr_b16 a[184:185], v4 offset:18432
ds_read_b64_tr_b16 a[186:187], v4 offset:18944
buffer_load_dwordx4 v13, s[12:15], s32 offen offset:1024 lds
s_waitcnt lgkmcnt(6)
v_mfma_f32_32x32x16_bf16 v[144:159], a[172:175], a[96:99], v[144:159]
ds_read_b64_tr_b16 a[188:189], v5 offset:18432
ds_read_b64_tr_b16 a[190:191], v5 offset:18944
buffer_load_dwordx4 v14, s[12:15], s32 offen offset:2048 lds
s_waitcnt lgkmcnt(6)
v_mfma_f32_32x32x16_bf16 v[96:111], a[176:179], a[100:103], v[96:111]
ds_read_b64_tr_b16 a[160:161], v2 offset:20480
ds_read_b64_tr_b16 a[162:163], v2 offset:20992
buffer_load_dwordx4 v15, s[12:15], s32 offen offset:3072 lds
s_waitcnt lgkmcnt(6)
v_mfma_f32_32x32x16_bf16 v[112:127], a[180:183], a[100:103], v[112:127]
ds_read_b64_tr_b16 a[164:165], v3 offset:20480
ds_read_b64_tr_b16 a[166:167], v3 offset:20992
s_waitcnt lgkmcnt(6)
v_mfma_f32_32x32x16_bf16 v[128:143], a[184:187], a[100:103], v[128:143]
ds_read_b64_tr_b16 a[168:169], v4 offset:20480
ds_read_b64_tr_b16 a[170:171], v4 offset:20992
s_waitcnt lgkmcnt(6)
v_mfma_f32_32x32x16_bf16 v[144:159], a[188:191], a[100:103], v[144:159]
ds_read_b64_tr_b16 a[172:173], v5 offset:20480
ds_read_b64_tr_b16 a[174:175], v5 offset:20992
s_waitcnt lgkmcnt(6)
v_mfma_f32_32x32x16_bf16 v[96:111], a[160:163], a[104:107], v[96:111]
ds_read_b64_tr_b16 a[176:177], v2 offset:22528
ds_read_b64_tr_b16 a[178:179], v2 offset:23040
s_waitcnt lgkmcnt(6)
v_mfma_f32_32x32x16_bf16 v[112:127], a[164:167], a[104:107], v[112:127]
ds_read_b64_tr_b16 a[180:181], v3 offset:22528
ds_read_b64_tr_b16 a[182:183], v3 offset:23040
s_waitcnt lgkmcnt(6)
v_mfma_f32_32x32x16_bf16 v[128:143], a[168:171], a[104:107], v[128:143]
ds_read_b64_tr_b16 a[184:185], v4 offset:22528
ds_read_b64_tr_b16 a[186:187], v4 offset:23040
s_waitcnt lgkmcnt(6)
v_mfma_f32_32x32x16_bf16 v[144:159], a[172:175], a[104:107], v[144:159]
ds_read_b64_tr_b16 a[188:189], v5 offset:22528
ds_read_b64_tr_b16 a[190:191], v5 offset:23040
s_waitcnt vmcnt(12)
s_barrier
ds_read_b128 a[112:115], v21 offset:4096
ds_read_b128 a[116:119], v22 offset:4096
ds_read_b128 a[120:123], v23 offset:4096
ds_read_b128 a[124:127], v24 offset:4096
s_waitcnt lgkmcnt(10)
v_mfma_f32_32x32x16_bf16 v[96:111], a[176:179], a[108:111], v[96:111]
ds_read_b64_tr_b16 a[160:161], v2 offset:32768
ds_read_b64_tr_b16 a[162:163], v2 offset:33280
s_waitcnt lgkmcnt(10)
v_mfma_f32_32x32x16_bf16 v[112:127], a[180:183], a[108:111], v[112:127]
ds_read_b64_tr_b16 a[164:165], v3 offset:32768
ds_read_b64_tr_b16 a[166:167], v3 offset:33280
s_waitcnt lgkmcnt(10)
v_mfma_f32_32x32x16_bf16 v[128:143], a[184:187], a[108:111], v[128:143]
ds_read_b64_tr_b16 a[168:169], v4 offset:32768
ds_read_b64_tr_b16 a[170:171], v4 offset:33280
s_waitcnt lgkmcnt(10)
v_mfma_f32_32x32x16_bf16 v[144:159], a[188:191], a[108:111], v[144:159]
ds_read_b64_tr_b16 a[172:173], v5 offset:32768
ds_read_b64_tr_b16 a[174:175], v5 offset:33280
buffer_load_dword v46, v47, s[52:55], 0 offen
s_waitcnt lgkmcnt(6)
v_mfma_f32_32x32x16_bf16 a[192:207], a[160:163], a[112:115], a[192:207]
ds_read_b64_tr_b16 a[176:177], v2 offset:34816
ds_read_b64_tr_b16 a[178:179], v2 offset:35328
s_waitcnt lgkmcnt(6)
v_mfma_f32_32x32x16_bf16 a[208:223], a[164:167], a[112:115], a[208:223]
ds_read_b64_tr_b16 a[180:181], v3 offset:34816
ds_read_b64_tr_b16 a[182:183], v3 offset:35328
s_add_u32 m0, s26, 0
s_mov_b32 s24, 1152
buffer_load_dwordx4 v17, s[8:11], s24 offen offset:0 lds
s_waitcnt lgkmcnt(6)
v_mfma_f32_32x32x16_bf16 a[224:239], a[168:171], a[112:115], a[224:239]
ds_read_b64_tr_b16 a[184:185], v4 offset:34816
ds_read_b64_tr_b16 a[186:187], v4 offset:35328
buffer_load_dwordx4 v18, s[8:11], s24 offen offset:1024 lds
s_waitcnt lgkmcnt(6)
v_mfma_f32_32x32x16_bf16 a[240:255], a[172:175], a[112:115], a[240:255]
ds_read_b64_tr_b16 a[188:189], v5 offset:34816
ds_read_b64_tr_b16 a[190:191], v5 offset:35328
buffer_load_dwordx4 v19, s[8:11], s24 offen offset:2048 lds
s_waitcnt lgkmcnt(6)
v_mfma_f32_32x32x16_bf16 a[192:207], a[176:179], a[116:119], a[192:207]
ds_read_b64_tr_b16 a[160:161], v2 offset:36864
ds_read_b64_tr_b16 a[162:163], v2 offset:37376
buffer_load_dwordx4 v20, s[8:11], s24 offen offset:3072 lds
s_waitcnt lgkmcnt(6)
v_mfma_f32_32x32x16_bf16 a[208:223], a[180:183], a[116:119], a[208:223]
ds_read_b64_tr_b16 a[164:165], v3 offset:36864
ds_read_b64_tr_b16 a[166:167], v3 offset:37376
s_add_u32 m0, s25, 0
s_add_u32 s32, s23, 1990656
buffer_load_dwordx4 v12, s[12:15], s32 offen offset:0 lds
s_waitcnt lgkmcnt(6)
v_mfma_f32_32x32x16_bf16 a[224:239], a[184:187], a[116:119], a[224:239]
ds_read_b64_tr_b16 a[168:169], v4 offset:36864
ds_read_b64_tr_b16 a[170:171], v4 offset:37376
buffer_load_dwordx4 v13, s[12:15], s32 offen offset:1024 lds
s_waitcnt lgkmcnt(6)
v_mfma_f32_32x32x16_bf16 a[240:255], a[188:191], a[116:119], a[240:255]
ds_read_b64_tr_b16 a[172:173], v5 offset:36864
ds_read_b64_tr_b16 a[174:175], v5 offset:37376
buffer_load_dwordx4 v14, s[12:15], s32 offen offset:2048 lds
s_waitcnt lgkmcnt(6)
v_mfma_f32_32x32x16_bf16 a[192:207], a[160:163], a[120:123], a[192:207]
ds_read_b64_tr_b16 a[176:177], v2 offset:38912
ds_read_b64_tr_b16 a[178:179], v2 offset:39424
buffer_load_dwordx4 v15, s[12:15], s32 offen offset:3072 lds
s_waitcnt lgkmcnt(6)
v_mfma_f32_32x32x16_bf16 a[208:223], a[164:167], a[120:123], a[208:223]
ds_read_b64_tr_b16 a[180:181], v3 offset:38912
ds_read_b64_tr_b16 a[182:183], v3 offset:39424
s_waitcnt lgkmcnt(6)
v_mfma_f32_32x32x16_bf16 a[224:239], a[168:171], a[120:123], a[224:239]
ds_read_b64_tr_b16 a[184:185], v4 offset:38912
ds_read_b64_tr_b16 a[186:187], v4 offset:39424
s_waitcnt lgkmcnt(6)
v_mfma_f32_32x32x16_bf16 a[240:255], a[172:175], a[120:123], a[240:255]
ds_read_b64_tr_b16 a[188:189], v5 offset:38912
ds_read_b64_tr_b16 a[190:191], v5 offset:39424
s_waitcnt lgkmcnt(6)
v_mfma_f32_32x32x16_bf16 a[192:207], a[176:179], a[124:127], a[192:207]
ds_read_b64_tr_b16 a[160:161], v2 offset:49152
ds_read_b64_tr_b16 a[162:163], v2 offset:49664
s_waitcnt lgkmcnt(6)
v_mfma_f32_32x32x16_bf16 a[208:223], a[180:183], a[124:127], a[208:223]
ds_read_b64_tr_b16 a[164:165], v3 offset:49152
ds_read_b64_tr_b16 a[166:167], v3 offset:49664
s_waitcnt lgkmcnt(6)
v_mfma_f32_32x32x16_bf16 a[224:239], a[184:187], a[124:127], a[224:239]
ds_read_b64_tr_b16 a[168:169], v4 offset:49152
ds_read_b64_tr_b16 a[170:171], v4 offset:49664
s_waitcnt lgkmcnt(6)
v_mfma_f32_32x32x16_bf16 a[240:255], a[188:191], a[124:127], a[240:255]
ds_read_b64_tr_b16 a[172:173], v5 offset:49152
ds_read_b64_tr_b16 a[174:175], v5 offset:49664
s_waitcnt lgkmcnt(6)
v_mfma_f32_32x32x16_bf16 v[96:111], a[160:163], a[112:115], v[96:111]
ds_read_b64_tr_b16 a[176:177], v2 offset:51200
ds_read_b64_tr_b16 a[178:179], v2 offset:51712
s_waitcnt lgkmcnt(6)
v_mfma_f32_32x32x16_bf16 v[112:127], a[164:167], a[112:115], v[112:127]
ds_read_b64_tr_b16 a[180:181], v3 offset:51200
ds_read_b64_tr_b16 a[182:183], v3 offset:51712
s_add_u32 m0, s25, 16384
s_add_u32 s32, s23, 1990784
buffer_load_dwordx4 v12, s[12:15], s32 offen offset:0 lds
s_waitcnt lgkmcnt(6)
v_mfma_f32_32x32x16_bf16 v[128:143], a[168:171], a[112:115], v[128:143]
ds_read_b64_tr_b16 a[184:185], v4 offset:51200
ds_read_b64_tr_b16 a[186:187], v4 offset:51712
buffer_load_dwordx4 v13, s[12:15], s32 offen offset:1024 lds
s_waitcnt lgkmcnt(6)
v_mfma_f32_32x32x16_bf16 v[144:159], a[172:175], a[112:115], v[144:159]
ds_read_b64_tr_b16 a[188:189], v5 offset:51200
ds_read_b64_tr_b16 a[190:191], v5 offset:51712
buffer_load_dwordx4 v14, s[12:15], s32 offen offset:2048 lds
s_waitcnt lgkmcnt(6)
v_mfma_f32_32x32x16_bf16 v[96:111], a[176:179], a[116:119], v[96:111]
ds_read_b64_tr_b16 a[160:161], v2 offset:53248
ds_read_b64_tr_b16 a[162:163], v2 offset:53760
buffer_load_dwordx4 v15, s[12:15], s32 offen offset:3072 lds
s_waitcnt lgkmcnt(6)
v_mfma_f32_32x32x16_bf16 v[112:127], a[180:183], a[116:119], v[112:127]
ds_read_b64_tr_b16 a[164:165], v3 offset:53248
ds_read_b64_tr_b16 a[166:167], v3 offset:53760
s_waitcnt lgkmcnt(6)
v_mfma_f32_32x32x16_bf16 v[128:143], a[184:187], a[116:119], v[128:143]
ds_read_b64_tr_b16 a[168:169], v4 offset:53248
ds_read_b64_tr_b16 a[170:171], v4 offset:53760
s_waitcnt lgkmcnt(6)
v_mfma_f32_32x32x16_bf16 v[144:159], a[188:191], a[116:119], v[144:159]
ds_read_b64_tr_b16 a[172:173], v5 offset:53248
ds_read_b64_tr_b16 a[174:175], v5 offset:53760
s_waitcnt lgkmcnt(6)
v_mfma_f32_32x32x16_bf16 v[96:111], a[160:163], a[120:123], v[96:111]
ds_read_b64_tr_b16 a[176:177], v2 offset:55296
ds_read_b64_tr_b16 a[178:179], v2 offset:55808
s_waitcnt lgkmcnt(6)
v_mfma_f32_32x32x16_bf16 v[112:127], a[164:167], a[120:123], v[112:127]
ds_read_b64_tr_b16 a[180:181], v3 offset:55296
ds_read_b64_tr_b16 a[182:183], v3 offset:55808
s_waitcnt lgkmcnt(6)
v_mfma_f32_32x32x16_bf16 v[128:143], a[168:171], a[120:123], v[128:143]
ds_read_b64_tr_b16 a[184:185], v4 offset:55296
ds_read_b64_tr_b16 a[186:187], v4 offset:55808
s_waitcnt lgkmcnt(6)
v_mfma_f32_32x32x16_bf16 v[144:159], a[172:175], a[120:123], v[144:159]
ds_read_b64_tr_b16 a[188:189], v5 offset:55296
ds_read_b64_tr_b16 a[190:191], v5 offset:55808
s_waitcnt vmcnt(12)
v_and_b32 v46, v46, v67
v_cmp_ne_u32 vcc, v46, v67
s_nop 4
s_cbranch_vccnz K1_SPIN_G
K1_GO_G:
s_barrier
ds_read_b128 a[128:131], v21 offset:8192
ds_read_b128 a[132:135], v22 offset:8192
ds_read_b128 a[136:139], v23 offset:8192
ds_read_b128 a[140:143], v24 offset:8192
s_waitcnt lgkmcnt(10)
v_mfma_f32_32x32x16_bf16 v[96:111], a[176:179], a[124:127], v[96:111]
ds_read_b64_tr_b16 a[160:161], v7 offset:0
ds_read_b64_tr_b16 a[162:163], v7 offset:512
s_waitcnt lgkmcnt(10)
v_mfma_f32_32x32x16_bf16 v[112:127], a[180:183], a[124:127], v[112:127]
ds_read_b64_tr_b16 a[164:165], v8 offset:0
ds_read_b64_tr_b16 a[166:167], v8 offset:512
s_waitcnt lgkmcnt(10)
v_mfma_f32_32x32x16_bf16 v[128:143], a[184:187], a[124:127], v[128:143]
ds_read_b64_tr_b16 a[168:169], v9 offset:0
ds_read_b64_tr_b16 a[170:171], v9 offset:512
s_waitcnt lgkmcnt(10)
v_mfma_f32_32x32x16_bf16 v[144:159], a[188:191], a[124:127], v[144:159]
ds_read_b64_tr_b16 a[172:173], v10 offset:0
ds_read_b64_tr_b16 a[174:175], v10 offset:512
buffer_load_dword v32, v90, s[16:19], 0 offen offset:0
buffer_load_dword v33, v90, s[16:19], 0 offen offset:1536
buffer_load_dword v34, v90, s[16:19], s59 offen offset:0
buffer_load_dword v35, v90, s[16:19], s59 offen offset:1536
buffer_load_dword v36, v90, s[16:19], 0 offen offset:256
buffer_load_dword v37, v90, s[16:19], 0 offen offset:1792
buffer_load_dword v38, v90, s[16:19], s59 offen offset:256
buffer_load_dword v39, v90, s[16:19], s59 offen offset:1792
buffer_load_dword v40, v90, s[16:19], 0 offen offset:512
buffer_load_dword v41, v90, s[16:19], 0 offen offset:2048
buffer_load_dword v42, v90, s[16:19], s59 offen offset:512
buffer_load_dword v43, v90, s[16:19], s59 offen offset:2048
buffer_load_dwordx4 v[84:87], v92, s[16:19], 0 offen
s_waitcnt lgkmcnt(6)
v_mfma_f32_32x32x16_bf16 a[192:207], a[160:163], a[128:131], a[192:207]
ds_read_b64_tr_b16 a[176:177], v7 offset:2048
ds_read_b64_tr_b16 a[178:179], v7 offset:2560
s_waitcnt lgkmcnt(6)
v_mfma_f32_32x32x16_bf16 a[208:223], a[164:167], a[128:131], a[208:223]
ds_read_b64_tr_b16 a[180:181], v8 offset:2048
ds_read_b64_tr_b16 a[182:183], v8 offset:2560
s_add_u32 m0, s25, 32768
s_add_u32 s32, s23, 256
buffer_load_dwordx4 v12, s[12:15], s32 offen offset:0 lds
s_waitcnt lgkmcnt(6)
v_mfma_f32_32x32x16_bf16 a[224:239], a[168:171], a[128:131], a[224:239]
ds_read_b64_tr_b16 a[184:185], v9 offset:2048
ds_read_b64_tr_b16 a[186:187], v9 offset:2560
buffer_load_dwordx4 v13, s[12:15], s32 offen offset:1024 lds
s_waitcnt lgkmcnt(6)
v_mfma_f32_32x32x16_bf16 a[240:255], a[172:175], a[128:131], a[240:255]
ds_read_b64_tr_b16 a[188:189], v10 offset:2048
ds_read_b64_tr_b16 a[190:191], v10 offset:2560
buffer_load_dwordx4 v14, s[12:15], s32 offen offset:2048 lds
s_waitcnt lgkmcnt(6)
v_mfma_f32_32x32x16_bf16 a[192:207], a[176:179], a[132:135], a[192:207]
ds_read_b64_tr_b16 a[160:161], v7 offset:4096
ds_read_b64_tr_b16 a[162:163], v7 offset:4608
buffer_load_dwordx4 v15, s[12:15], s32 offen offset:3072 lds
s_waitcnt lgkmcnt(6)
v_mfma_f32_32x32x16_bf16 a[208:223], a[180:183], a[132:135], a[208:223]
ds_read_b64_tr_b16 a[164:165], v8 offset:4096
ds_read_b64_tr_b16 a[166:167], v8 offset:4608
s_waitcnt lgkmcnt(6)
v_mfma_f32_32x32x16_bf16 a[224:239], a[184:187], a[132:135], a[224:239]
ds_read_b64_tr_b16 a[168:169], v9 offset:4096
ds_read_b64_tr_b16 a[170:171], v9 offset:4608
s_waitcnt lgkmcnt(6)
v_mfma_f32_32x32x16_bf16 a[240:255], a[188:191], a[132:135], a[240:255]
ds_read_b64_tr_b16 a[172:173], v10 offset:4096
ds_read_b64_tr_b16 a[174:175], v10 offset:4608
s_waitcnt lgkmcnt(6)
v_mfma_f32_32x32x16_bf16 a[192:207], a[160:163], a[136:139], a[192:207]
ds_read_b64_tr_b16 a[176:177], v7 offset:6144
ds_read_b64_tr_b16 a[178:179], v7 offset:6656
s_waitcnt lgkmcnt(6)
v_mfma_f32_32x32x16_bf16 a[208:223], a[164:167], a[136:139], a[208:223]
ds_read_b64_tr_b16 a[180:181], v8 offset:6144
ds_read_b64_tr_b16 a[182:183], v8 offset:6656
s_waitcnt lgkmcnt(6)
v_mfma_f32_32x32x16_bf16 a[224:239], a[168:171], a[136:139], a[224:239]
ds_read_b64_tr_b16 a[184:185], v9 offset:6144
ds_read_b64_tr_b16 a[186:187], v9 offset:6656
s_waitcnt lgkmcnt(6)
v_mfma_f32_32x32x16_bf16 a[240:255], a[172:175], a[136:139], a[240:255]
ds_read_b64_tr_b16 a[188:189], v10 offset:6144
ds_read_b64_tr_b16 a[190:191], v10 offset:6656
s_waitcnt lgkmcnt(6)
v_mfma_f32_32x32x16_bf16 a[192:207], a[176:179], a[140:143], a[192:207]
ds_read_b64_tr_b16 a[160:161], v7 offset:16384
ds_read_b64_tr_b16 a[162:163], v7 offset:16896
s_waitcnt lgkmcnt(6)
v_mfma_f32_32x32x16_bf16 a[208:223], a[180:183], a[140:143], a[208:223]
ds_read_b64_tr_b16 a[164:165], v8 offset:16384
ds_read_b64_tr_b16 a[166:167], v8 offset:16896
s_waitcnt lgkmcnt(6)
v_mfma_f32_32x32x16_bf16 a[224:239], a[184:187], a[140:143], a[224:239]
ds_read_b64_tr_b16 a[168:169], v9 offset:16384
ds_read_b64_tr_b16 a[170:171], v9 offset:16896
s_waitcnt lgkmcnt(6)
v_mfma_f32_32x32x16_bf16 a[240:255], a[188:191], a[140:143], a[240:255]
ds_read_b64_tr_b16 a[172:173], v10 offset:16384
ds_read_b64_tr_b16 a[174:175], v10 offset:16896
s_waitcnt lgkmcnt(6)
v_mfma_f32_32x32x16_bf16 v[96:111], a[160:163], a[128:131], v[96:111]
ds_read_b64_tr_b16 a[176:177], v7 offset:18432
ds_read_b64_tr_b16 a[178:179], v7 offset:18944
s_waitcnt lgkmcnt(6)
v_mfma_f32_32x32x16_bf16 v[112:127], a[164:167], a[128:131], v[112:127]
ds_read_b64_tr_b16 a[180:181], v8 offset:18432
ds_read_b64_tr_b16 a[182:183], v8 offset:18944
s_add_u32 m0, s25, 49152
s_add_u32 s32, s23, 221440
buffer_load_dwordx4 v12, s[12:15], s32 offen offset:0 lds
s_waitcnt lgkmcnt(6)
v_mfma_f32_32x32x16_bf16 v[128:143], a[168:171], a[128:131], v[128:143]
ds_read_b64_tr_b16 a[184:185], v9 offset:18432
ds_read_b64_tr_b16 a[186:187], v9 offset:18944
buffer_load_dwordx4 v13, s[12:15], s32 offen offset:1024 lds
s_waitcnt lgkmcnt(6)
v_mfma_f32_32x32x16_bf16 v[144:159], a[172:175], a[128:131], v[144:159]
ds_read_b64_tr_b16 a[188:189], v10 offset:18432
ds_read_b64_tr_b16 a[190:191], v10 offset:18944
buffer_load_dwordx4 v14, s[12:15], s32 offen offset:2048 lds
s_waitcnt lgkmcnt(6)
v_mfma_f32_32x32x16_bf16 v[96:111], a[176:179], a[132:135], v[96:111]
ds_read_b64_tr_b16 a[160:161], v7 offset:20480
ds_read_b64_tr_b16 a[162:163], v7 offset:20992
buffer_load_dwordx4 v15, s[12:15], s32 offen offset:3072 lds
s_waitcnt vmcnt(19)
v_add_f32 v32, v32, v33
s_waitcnt vmcnt(17)
v_add_f32 v34, v34, v35
s_waitcnt lgkmcnt(6)
v_mfma_f32_32x32x16_bf16 v[112:127], a[180:183], a[132:135], v[112:127]
ds_read_b64_tr_b16 a[164:165], v8 offset:20480
ds_read_b64_tr_b16 a[166:167], v8 offset:20992
v_add_f32 v32, v32, v34
ds_write_b32 v91, v32 offset:0
s_waitcnt lgkmcnt(7)
v_mfma_f32_32x32x16_bf16 v[128:143], a[184:187], a[132:135], v[128:143]
ds_read_b64_tr_b16 a[168:169], v9 offset:20480
ds_read_b64_tr_b16 a[170:171], v9 offset:20992
s_waitcnt vmcnt(15)
v_add_f32 v36, v36, v37
s_waitcnt vmcnt(13)
v_add_f32 v38, v38, v39
s_waitcnt lgkmcnt(7)
v_mfma_f32_32x32x16_bf16 v[144:159], a[188:191], a[132:135], v[144:159]
ds_read_b64_tr_b16 a[172:173], v10 offset:20480
ds_read_b64_tr_b16 a[174:175], v10 offset:20992
v_add_f32 v36, v36, v38
ds_write_b32 v91, v36 offset:512
s_waitcnt lgkmcnt(8)
v_mfma_f32_32x32x16_bf16 v[96:111], a[160:163], a[136:139], v[96:111]
ds_read_b64_tr_b16 a[176:177], v7 offset:22528
ds_read_b64_tr_b16 a[178:179], v7 offset:23040
s_waitcnt vmcnt(11)
v_add_f32 v40, v40, v41
s_waitcnt vmcnt(9)
v_add_f32 v42, v42, v43
s_waitcnt lgkmcnt(8)
v_mfma_f32_32x32x16_bf16 v[112:127], a[164:167], a[136:139], v[112:127]
ds_read_b64_tr_b16 a[180:181], v8 offset:22528
ds_read_b64_tr_b16 a[182:183], v8 offset:23040
v_add_f32 v40, v40, v42
ds_write_b32 v91, v40 offset:1024
s_waitcnt lgkmcnt(8)
v_mfma_f32_32x32x16_bf16 v[128:143], a[168:171], a[136:139], v[128:143]
ds_read_b64_tr_b16 a[184:185], v9 offset:22528
ds_read_b64_tr_b16 a[186:187], v9 offset:23040
s_waitcnt vmcnt(8)
v_cvt_pk_bf16_f32 v44, v84, v84
v_and_b32 v45, 0xffff0000, v44
s_waitcnt lgkmcnt(8)
v_mfma_f32_32x32x16_bf16 v[144:159], a[172:175], a[136:139], v[144:159]
ds_read_b64_tr_b16 a[188:189], v10 offset:22528
ds_read_b64_tr_b16 a[190:191], v10 offset:23040
v_sub_f32 v45, v84, v45
v_cvt_pk_bf16_f32 v45, v45, v45
s_waitcnt lgkmcnt(0)
s_barrier
ds_read_b128 a[144:147], v21 offset:0
ds_read_b128 a[148:151], v22 offset:0
ds_read_b128 a[152:155], v23 offset:0
ds_read_b128 a[156:159], v24 offset:0
v_mfma_f32_32x32x16_bf16 v[96:111], a[176:179], a[140:143], v[96:111]
ds_read_b64_tr_b16 a[160:161], v2 offset:0
ds_read_b64_tr_b16 a[162:163], v2 offset:512
s_mov_b32 s33, 0xffff
v_bfi_b32 v44, s33, v44, v45
v_mfma_f32_32x32x16_bf16 v[112:127], a[180:183], a[140:143], v[112:127]
ds_read_b64_tr_b16 a[164:165], v3 offset:0
ds_read_b64_tr_b16 a[166:167], v3 offset:512
v_cmp_gt_u32 vcc, 32, v1
s_nop 1
v_cndmask_b32 v88, 0, v44, vcc
v_mfma_f32_32x32x16_bf16 v[128:143], a[184:187], a[140:143], v[128:143]
ds_read_b64_tr_b16 a[168:169], v4 offset:0
ds_read_b64_tr_b16 a[170:171], v4 offset:512
v_mov_b32 v89, v88
v_mul_f32 v93, 0xbfb8aa3b, v85
v_mfma_f32_32x32x16_bf16 v[144:159], a[188:191], a[140:143], v[144:159]
ds_read_b64_tr_b16 a[172:173], v5 offset:0
ds_read_b64_tr_b16 a[174:175], v5 offset:512
v_mov_b32 v94, v86
s_waitcnt lgkmcnt(6)
v_mfma_f32_32x32x16_bf16 a[192:207], a[160:163], a[144:147], a[192:207]
ds_read_b64_tr_b16 a[176:177], v2 offset:2048
ds_read_b64_tr_b16 a[178:179], v2 offset:2560
s_waitcnt lgkmcnt(6)
v_mfma_f32_32x32x16_bf16 a[208:223], a[164:167], a[144:147], a[208:223]
ds_read_b64_tr_b16 a[180:181], v3 offset:2048
ds_read_b64_tr_b16 a[182:183], v3 offset:2560
s_add_u32 m0, s25, 65536
s_add_u32 s32, s23, 442624
buffer_load_dwordx4 v12, s[12:15], s32 offen offset:0 lds
ds_read_b32 v62, v95 offset:0
ds_read_b32 v63, v95 offset:128
s_waitcnt lgkmcnt(8)
v_mfma_f32_32x32x16_bf16 a[224:239], a[168:171], a[144:147], a[224:239]
ds_read_b64_tr_b16 a[184:185], v4 offset:2048
ds_read_b64_tr_b16 a[186:187], v4 offset:2560
buffer_load_dwordx4 v13, s[12:15], s32 offen offset:1024 lds
ds_read_b32 v64, v95 offset:256
ds_read_b32 v65, v95 offset:384
s_waitcnt lgkmcnt(10)
v_mfma_f32_32x32x16_bf16 a[240:255], a[172:175], a[144:147], a[240:255]
ds_read_b64_tr_b16 a[188:189], v5 offset:2048
ds_read_b64_tr_b16 a[190:191], v5 offset:2560
buffer_load_dwordx4 v14, s[12:15], s32 offen offset:2048 lds
s_waitcnt lgkmcnt(7)
v_cvt_pk_bf16_f32 v52, v62, v62
v_and_b32 v53, 0xffff0000, v52
v_mfma_f32_32x32x16_bf16 a[192:207], a[176:179], a[148:151], a[192:207]
ds_read_b64_tr_b16 a[160:161], v2 offset:4096
ds_read_b64_tr_b16 a[162:163], v2 offset:4608
buffer_load_dwordx4 v15, s[12:15], s32 offen offset:3072 lds
v_sub_f32 v53, v62, v53
v_cvt_pk_bf16_f32 v53, v53, v53
v_mfma_f32_32x32x16_bf16 a[208:223], a[180:183], a[148:151], a[208:223]
ds_read_b64_tr_b16 a[164:165], v3 offset:4096
ds_read_b64_tr_b16 a[166:167], v3 offset:4608
s_waitcnt lgkmcnt(10)
v_cvt_pk_bf16_f32 v54, v63, v63
v_and_b32 v55, 0xffff0000, v54
s_waitcnt lgkmcnt(8)
v_mfma_f32_32x32x16_bf16 a[224:239], a[184:187], a[148:151], a[224:239]
ds_read_b64_tr_b16 a[168:169], v4 offset:4096
ds_read_b64_tr_b16 a[170:171], v4 offset:4608
v_sub_f32 v55, v63, v55
v_cvt_pk_bf16_f32 v55, v55, v55
s_waitcnt lgkmcnt(6)
v_mfma_f32_32x32x16_bf16 a[240:255], a[188:191], a[148:151], a[240:255]
ds_read_b64_tr_b16 a[172:173], v5 offset:4096
ds_read_b64_tr_b16 a[174:175], v5 offset:4608
v_cvt_pk_bf16_f32 v56, v64, v64
v_and_b32 v57, 0xffff0000, v56
s_waitcnt lgkmcnt(6)
v_mfma_f32_32x32x16_bf16 a[192:207], a[160:163], a[152:155], a[192:207]
ds_read_b64_tr_b16 a[176:177], v2 offset:6144
ds_read_b64_tr_b16 a[178:179], v2 offset:6656
v_sub_f32 v57, v64, v57
v_cvt_pk_bf16_f32 v57, v57, v57
s_waitcnt lgkmcnt(6)
v_mfma_f32_32x32x16_bf16 a[208:223], a[164:167], a[152:155], a[208:223]
ds_read_b64_tr_b16 a[180:181], v3 offset:6144
ds_read_b64_tr_b16 a[182:183], v3 offset:6656
v_cvt_pk_bf16_f32 v58, v65, v65
v_and_b32 v59, 0xffff0000, v58
s_waitcnt lgkmcnt(6)
v_mfma_f32_32x32x16_bf16 a[224:239], a[168:171], a[152:155], a[224:239]
ds_read_b64_tr_b16 a[184:185], v4 offset:6144
ds_read_b64_tr_b16 a[186:187], v4 offset:6656
v_sub_f32 v59, v65, v59
v_cvt_pk_bf16_f32 v59, v59, v59
s_waitcnt lgkmcnt(6)
v_mfma_f32_32x32x16_bf16 a[240:255], a[172:175], a[152:155], a[240:255]
ds_read_b64_tr_b16 a[188:189], v5 offset:6144
ds_read_b64_tr_b16 a[190:191], v5 offset:6656
v_mfma_f32_32x32x8_bf16 a[192:207], v[52:53], v[88:89], a[192:207]
v_mfma_f32_32x32x8_bf16 a[208:223], v[54:55], v[88:89], a[208:223]
s_waitcnt lgkmcnt(6)
v_mfma_f32_32x32x16_bf16 a[192:207], a[176:179], a[156:159], a[192:207]
ds_read_b64_tr_b16 a[160:161], v2 offset:16384
ds_read_b64_tr_b16 a[162:163], v2 offset:16896
v_mfma_f32_32x32x8_bf16 a[224:239], v[56:57], v[88:89], a[224:239]
v_mfma_f32_32x32x8_bf16 a[240:255], v[58:59], v[88:89], a[240:255]
s_waitcnt lgkmcnt(6)
v_mfma_f32_32x32x16_bf16 a[208:223], a[180:183], a[156:159], a[208:223]
ds_read_b64_tr_b16 a[164:165], v3 offset:16384
ds_read_b64_tr_b16 a[166:167], v3 offset:16896
s_waitcnt lgkmcnt(6)
v_mfma_f32_32x32x16_bf16 a[224:239], a[184:187], a[156:159], a[224:239]
ds_read_b64_tr_b16 a[168:169], v4 offset:16384
ds_read_b64_tr_b16 a[170:171], v4 offset:16896
s_waitcnt lgkmcnt(6)
v_mfma_f32_32x32x16_bf16 a[240:255], a[188:191], a[156:159], a[240:255]
ds_read_b64_tr_b16 a[172:173], v5 offset:16384
ds_read_b64_tr_b16 a[174:175], v5 offset:16896
s_waitcnt lgkmcnt(6)
v_mfma_f32_32x32x16_bf16 v[96:111], a[160:163], a[144:147], v[96:111]
ds_read_b64_tr_b16 a[176:177], v2 offset:18432
ds_read_b64_tr_b16 a[178:179], v2 offset:18944
s_waitcnt lgkmcnt(6)
v_mfma_f32_32x32x16_bf16 v[112:127], a[164:167], a[144:147], v[112:127]
ds_read_b64_tr_b16 a[180:181], v3 offset:18432
ds_read_b64_tr_b16 a[182:183], v3 offset:18944
s_add_u32 m0, s25, 81920
s_add_u32 s32, s23, 663808
buffer_load_dwordx4 v12, s[12:15], s32 offen offset:0 lds
ds_read_b32 v62, v95 offset:512
ds_read_b32 v63, v95 offset:640
s_waitcnt lgkmcnt(8)
v_mfma_f32_32x32x16_bf16 v[128:143], a[168:171], a[144:147], v[128:143]
ds_read_b64_tr_b16 a[184:185], v4 offset:18432
ds_read_b64_tr_b16 a[186:187], v4 offset:18944
buffer_load_dwordx4 v13, s[12:15], s32 offen offset:1024 lds
ds_read_b32 v64, v95 offset:768
ds_read_b32 v65, v95 offset:896
s_waitcnt lgkmcnt(10)
v_mfma_f32_32x32x16_bf16 v[144:159], a[172:175], a[144:147], v[144:159]
ds_read_b64_tr_b16 a[188:189], v5 offset:18432
ds_read_b64_tr_b16 a[190:191], v5 offset:18944
buffer_load_dwordx4 v14, s[12:15], s32 offen offset:2048 lds
s_waitcnt lgkmcnt(7)
v_cvt_pk_bf16_f32 v52, v62, v62
v_and_b32 v53, 0xffff0000, v52
v_mfma_f32_32x32x16_bf16 v[96:111], a[176:179], a[148:151], v[96:111]
ds_read_b64_tr_b16 a[160:161], v2 offset:20480
ds_read_b64_tr_b16 a[162:163], v2 offset:20992
buffer_load_dwordx4 v15, s[12:15], s32 offen offset:3072 lds
v_sub_f32 v53, v62, v53
v_cvt_pk_bf16_f32 v53, v53, v53
v_mfma_f32_32x32x16_bf16 v[112:127], a[180:183], a[148:151], v[112:127]
ds_read_b64_tr_b16 a[164:165], v3 offset:20480
ds_read_b64_tr_b16 a[166:167], v3 offset:20992
s_waitcnt lgkmcnt(10)
v_cvt_pk_bf16_f32 v54, v63, v63
v_and_b32 v55, 0xffff0000, v54
s_waitcnt lgkmcnt(8)
v_mfma_f32_32x32x16_bf16 v[128:143], a[184:187], a[148:151], v[128:143]
ds_read_b64_tr_b16 a[168:169], v4 offset:20480
ds_read_b64_tr_b16 a[170:171], v4 offset:20992
v_sub_f32 v55, v63, v55
v_cvt_pk_bf16_f32 v55, v55, v55
s_waitcnt lgkmcnt(6)
v_mfma_f32_32x32x16_bf16 v[144:159], a[188:191], a[148:151], v[144:159]
ds_read_b64_tr_b16 a[172:173], v5 offset:20480
ds_read_b64_tr_b16 a[174:175], v5 offset:20992
v_cvt_pk_bf16_f32 v56, v64, v64
v_and_b32 v57, 0xffff0000, v56
s_waitcnt lgkmcnt(6)
v_mfma_f32_32x32x16_bf16 v[96:111], a[160:163], a[152:155], v[96:111]
ds_read_b64_tr_b16 a[176:177], v2 offset:22528
ds_read_b64_tr_b16 a[178:179], v2 offset:23040
v_sub_f32 v57, v64, v57
v_cvt_pk_bf16_f32 v57, v57, v57
s_waitcnt lgkmcnt(6)
v_mfma_f32_32x32x16_bf16 v[112:127], a[164:167], a[152:155], v[112:127]
ds_read_b64_tr_b16 a[180:181], v3 offset:22528
ds_read_b64_tr_b16 a[182:183], v3 offset:23040
v_cvt_pk_bf16_f32 v58, v65, v65
v_and_b32 v59, 0xffff0000, v58
s_waitcnt lgkmcnt(6)
v_mfma_f32_32x32x16_bf16 v[128:143], a[168:171], a[152:155], v[128:143]
ds_read_b64_tr_b16 a[184:185], v4 offset:22528
ds_read_b64_tr_b16 a[186:187], v4 offset:23040
v_sub_f32 v59, v65, v59
v_cvt_pk_bf16_f32 v59, v59, v59
s_waitcnt lgkmcnt(6)
v_mfma_f32_32x32x16_bf16 v[144:159], a[172:175], a[152:155], v[144:159]
ds_read_b64_tr_b16 a[188:189], v5 offset:22528
ds_read_b64_tr_b16 a[190:191], v5 offset:23040
v_mfma_f32_32x32x8_bf16 v[96:111], v[52:53], v[88:89], v[96:111]
v_mfma_f32_32x32x8_bf16 v[112:127], v[54:55], v[88:89], v[112:127]
s_waitcnt vmcnt(8)
s_barrier
s_waitcnt lgkmcnt(6)
v_mfma_f32_32x32x16_bf16 v[96:111], a[176:179], a[156:159], v[96:111]
ds_read_b64_tr_b16 a[160:161], v2 offset:32768
ds_read_b64_tr_b16 a[162:163], v2 offset:33280
v_mfma_f32_32x32x8_bf16 v[128:143], v[56:57], v[88:89], v[128:143]
v_mfma_f32_32x32x8_bf16 v[144:159], v[58:59], v[88:89], v[144:159]
s_waitcnt lgkmcnt(6)
v_mfma_f32_32x32x16_bf16 v[112:127], a[180:183], a[156:159], v[112:127]
ds_read_b64_tr_b16 a[164:165], v3 offset:32768
ds_read_b64_tr_b16 a[166:167], v3 offset:33280
s_waitcnt lgkmcnt(6)
v_mfma_f32_32x32x16_bf16 v[128:143], a[184:187], a[156:159], v[128:143]
ds_read_b64_tr_b16 a[168:169], v4 offset:32768
ds_read_b64_tr_b16 a[170:171], v4 offset:33280
s_waitcnt lgkmcnt(6)
v_mfma_f32_32x32x16_bf16 v[144:159], a[188:191], a[156:159], v[144:159]
ds_read_b64_tr_b16 a[172:173], v5 offset:32768
ds_read_b64_tr_b16 a[174:175], v5 offset:33280
s_waitcnt lgkmcnt(6)
v_mfma_f32_32x32x16_bf16 v[176:191], a[160:163], a[0:3], 0
ds_read_b64_tr_b16 a[176:177], v2 offset:34816
ds_read_b64_tr_b16 a[178:179], v2 offset:35328
s_waitcnt lgkmcnt(6)
v_mfma_f32_32x32x16_bf16 v[192:207], a[164:167], a[0:3], 0
ds_read_b64_tr_b16 a[180:181], v3 offset:34816
ds_read_b64_tr_b16 a[182:183], v3 offset:35328
s_add_u32 m0, s25, 0
s_add_u32 s32, s23, 884992
buffer_load_dwordx4 v12, s[12:15], s32 offen offset:0 lds
s_waitcnt lgkmcnt(6)
v_mfma_f32_32x32x16_bf16 v[208:223], a[168:171], a[0:3], 0
ds_read_b64_tr_b16 a[184:185], v4 offset:34816
ds_read_b64_tr_b16 a[186:187], v4 offset:35328
buffer_load_dwordx4 v13, s[12:15], s32 offen offset:1024 lds
s_waitcnt lgkmcnt(6)
v_mfma_f32_32x32x16_bf16 v[224:239], a[172:175], a[0:3], 0
ds_read_b64_tr_b16 a[188:189], v5 offset:34816
ds_read_b64_tr_b16 a[190:191], v5 offset:35328
buffer_load_dwordx4 v14, s[12:15], s32 offen offset:2048 lds
s_waitcnt lgkmcnt(6)
v_mfma_f32_32x32x16_bf16 v[176:191], a[176:179], a[4:7], v[176:191]
ds_read_b64_tr_b16 a[160:161], v2 offset:36864
ds_read_b64_tr_b16 a[162:163], v2 offset:37376
buffer_load_dwordx4 v15, s[12:15], s32 offen offset:3072 lds
s_waitcnt lgkmcnt(6)
v_mfma_f32_32x32x16_bf16 v[192:207], a[180:183], a[4:7], v[192:207]
ds_read_b64_tr_b16 a[164:165], v3 offset:36864
ds_read_b64_tr_b16 a[166:167], v3 offset:37376
s_waitcnt lgkmcnt(6)
v_mfma_f32_32x32x16_bf16 v[208:223], a[184:187], a[4:7], v[208:223]
ds_read_b64_tr_b16 a[168:169], v4 offset:36864
ds_read_b64_tr_b16 a[170:171], v4 offset:37376
v_mul_f32 v96, v93, v96
v_mul_f32 v97, v93, v97
v_exp_f32 v96, v96
s_waitcnt lgkmcnt(6)
v_mfma_f32_32x32x16_bf16 v[224:239], a[188:191], a[4:7], v[224:239]
ds_read_b64_tr_b16 a[172:173], v5 offset:36864
ds_read_b64_tr_b16 a[174:175], v5 offset:37376
v_mul_f32 v98, v93, v98
v_exp_f32 v97, v97
v_mul_f32 v99, v93, v99
s_waitcnt lgkmcnt(6)
v_mfma_f32_32x32x16_bf16 v[176:191], a[160:163], a[8:11], v[176:191]
ds_read_b64_tr_b16 a[176:177], v2 offset:38912
ds_read_b64_tr_b16 a[178:179], v2 offset:39424
v_exp_f32 v98, v98
v_mul_f32 v100, v93, v100
v_fma_f32 v96, v96, v94, v94
s_waitcnt lgkmcnt(6)
v_mfma_f32_32x32x16_bf16 v[192:207], a[164:167], a[8:11], v[192:207]
ds_read_b64_tr_b16 a[180:181], v3 offset:38912
ds_read_b64_tr_b16 a[182:183], v3 offset:39424
v_exp_f32 v99, v99
v_mul_f32 v101, v93, v101
v_fma_f32 v97, v97, v94, v94
s_waitcnt lgkmcnt(6)
v_mfma_f32_32x32x16_bf16 v[208:223], a[168:171], a[8:11], v[208:223]
ds_read_b64_tr_b16 a[184:185], v4 offset:38912
ds_read_b64_tr_b16 a[186:187], v4 offset:39424
v_exp_f32 v100, v100
v_mul_f32 v102, v93, v102
v_fma_f32 v98, v98, v94, v94
s_waitcnt lgkmcnt(6)
v_mfma_f32_32x32x16_bf16 v[224:239], a[172:175], a[8:11], v[224:239]
ds_read_b64_tr_b16 a[188:189], v5 offset:38912
ds_read_b64_tr_b16 a[190:191], v5 offset:39424
v_rcp_f32 v96, v96
v_exp_f32 v101, v101
v_mul_f32 v103, v93, v103
s_waitcnt lgkmcnt(6)
v_mfma_f32_32x32x16_bf16 v[176:191], a[176:179], a[12:15], v[176:191]
ds_read_b64_tr_b16 a[160:161], v2 offset:49152
ds_read_b64_tr_b16 a[162:163], v2 offset:49664
v_fma_f32 v99, v99, v94, v94
v_rcp_f32 v97, v97
v_exp_f32 v102, v102
s_waitcnt lgkmcnt(6)
v_mfma_f32_32x32x16_bf16 v[192:207], a[180:183], a[12:15], v[192:207]
ds_read_b64_tr_b16 a[164:165], v3 offset:49152
ds_read_b64_tr_b16 a[166:167], v3 offset:49664
v_mul_f32 v112, v93, v112
v_fma_f32 v100, v100, v94, v94
v_rcp_f32 v98, v98
s_waitcnt lgkmcnt(6)
v_mfma_f32_32x32x16_bf16 v[208:223], a[184:187], a[12:15], v[208:223]
ds_read_b64_tr_b16 a[168:169], v4 offset:49152
ds_read_b64_tr_b16 a[170:171], v4 offset:49664
v_mul_f32 v104, v104, v96
v_exp_f32 v103, v103
v_mul_f32 v113, v93, v113
s_waitcnt lgkmcnt(6)
v_mfma_f32_32x32x16_bf16 v[224:239], a[188:191], a[12:15], v[224:239]
ds_read_b64_tr_b16 a[172:173], v5 offset:49152
ds_read_b64_tr_b16 a[174:175], v5 offset:49664
v_fma_f32 v101, v101, v94, v94
v_rcp_f32 v99, v99
v_mul_f32 v105, v105, v97
s_waitcnt lgkmcnt(6)
v_mfma_f32_32x32x16_bf16 v[176:191], a[160:163], a[16:19], v[176:191]
ds_read_b64_tr_b16 a[176:177], v2 offset:51200
ds_read_b64_tr_b16 a[178:179], v2 offset:51712
v_cvt_pk_bf16_f32 v96, v104, v105
v_exp_f32 v112, v112
v_mul_f32 v114, v93, v114
s_waitcnt lgkmcnt(6)
v_mfma_f32_32x32x16_bf16 v[192:207], a[164:167], a[16:19], v[192:207]
ds_read_b64_tr_b16 a[180:181], v3 offset:51200
ds_read_b64_tr_b16 a[182:183], v3 offset:51712
s_add_u32 m0, s25, 16384
s_add_u32 s32, s23, 1106176
buffer_load_dwordx4 v12, s[12:15], s32 offen offset:0 lds
v_fma_f32 v102, v102, v94, v94
v_rcp_f32 v100, v100
v_mul_f32 v106, v106, v98
s_waitcnt lgkmcnt(6)
v_mfma_f32_32x32x16_bf16 v[208:223], a[168:171], a[16:19], v[208:223]
ds_read_b64_tr_b16 a[184:185], v4 offset:51200
ds_read_b64_tr_b16 a[186:187], v4 offset:51712
buffer_load_dwordx4 v13, s[12:15], s32 offen offset:1024 lds
v_exp_f32 v113, v113
v_mul_f32 v115, v93, v115
v_fma_f32 v103, v103, v94, v94
s_waitcnt lgkmcnt(6)
v_mfma_f32_32x32x16_bf16 v[224:239], a[172:175], a[16:19], v[224:239]
ds_read_b64_tr_b16 a[188:189], v5 offset:51200
ds_read_b64_tr_b16 a[190:191], v5 offset:51712
buffer_load_dwordx4 v14, s[12:15], s32 offen offset:2048 lds
v_rcp_f32 v101, v101
v_mul_f32 v107, v107, v99
v_cvt_pk_bf16_f32 v97, v106, v107
s_waitcnt lgkmcnt(6)
v_mfma_f32_32x32x16_bf16 v[176:191], a[176:179], a[20:23], v[176:191]
ds_read_b64_tr_b16 a[160:161], v2 offset:53248
ds_read_b64_tr_b16 a[162:163], v2 offset:53760
buffer_load_dwordx4 v15, s[12:15], s32 offen offset:3072 lds
v_exp_f32 v114, v114
v_mul_f32 v116, v93, v116
v_fma_f32 v112, v112, v94, v94
s_waitcnt lgkmcnt(6)
v_mfma_f32_32x32x16_bf16 v[192:207], a[180:183], a[20:23], v[192:207]
ds_read_b64_tr_b16 a[164:165], v3 offset:53248
ds_read_b64_tr_b16 a[166:167], v3 offset:53760
v_rcp_f32 v102, v102
v_mul_f32 v108, v108, v100
v_exp_f32 v115, v115
s_waitcnt lgkmcnt(6)
v_mfma_f32_32x32x16_bf16 v[208:223], a[184:187], a[20:23], v[208:223]
ds_read_b64_tr_b16 a[168:169], v4 offset:53248
ds_read_b64_tr_b16 a[170:171], v4 offset:53760
v_mul_f32 v117, v93, v117
v_fma_f32 v113, v113, v94, v94
v_rcp_f32 v103, v103
s_waitcnt lgkmcnt(6)
v_mfma_f32_32x32x16_bf16 v[224:239], a[188:191], a[20:23], v[224:239]
ds_read_b64_tr_b16 a[172:173], v5 offset:53248
ds_read_b64_tr_b16 a[174:175], v5 offset:53760
v_mul_f32 v109, v109, v101
v_cvt_pk_bf16_f32 v98, v108, v109
v_exp_f32 v116, v116
s_waitcnt lgkmcnt(6)
v_mfma_f32_32x32x16_bf16 v[176:191], a[160:163], a[24:27], v[176:191]
ds_read_b64_tr_b16 a[176:177], v2 offset:55296
ds_read_b64_tr_b16 a[178:179], v2 offset:55808
v_mul_f32 v118, v93, v118
v_fma_f32 v114, v114, v94, v94
v_rcp_f32 v112, v112
s_waitcnt lgkmcnt(6)
v_mfma_f32_32x32x16_bf16 v[192:207], a[164:167], a[24:27], v[192:207]
ds_read_b64_tr_b16 a[180:181], v3 offset:55296
ds_read_b64_tr_b16 a[182:183], v3 offset:55808
v_mul_f32 v110, v110, v102
v_exp_f32 v117, v117
v_mul_f32 v119, v93, v119
s_waitcnt lgkmcnt(6)
v_mfma_f32_32x32x16_bf16 v[208:223], a[168:171], a[24:27], v[208:223]
ds_read_b64_tr_b16 a[184:185], v4 offset:55296
ds_read_b64_tr_b16 a[186:187], v4 offset:55808
v_fma_f32 v115, v115, v94, v94
v_rcp_f32 v113, v113
v_mul_f32 v111, v111, v103
s_waitcnt lgkmcnt(6)
v_mfma_f32_32x32x16_bf16 v[224:239], a[172:175], a[24:27], v[224:239]
ds_read_b64_tr_b16 a[188:189], v5 offset:55296
ds_read_b64_tr_b16 a[190:191], v5 offset:55808
v_cvt_pk_bf16_f32 v99, v110, v111
buffer_store_dwordx4 v[96:99], v25, s[16:19], s48 offen offset:0 sc1
v_exp_f32 v118, v118
s_waitcnt vmcnt(9)
s_barrier
s_waitcnt lgkmcnt(6)
v_mfma_f32_32x32x16_bf16 v[176:191], a[176:179], a[28:31], v[176:191]
ds_read_b64_tr_b16 a[160:161], v7 offset:0
ds_read_b64_tr_b16 a[162:163], v7 offset:512
v_mul_f32 v128, v93, v128
v_fma_f32 v116, v116, v94, v94
v_rcp_f32 v114, v114
s_waitcnt lgkmcnt(6)
v_mfma_f32_32x32x16_bf16 v[192:207], a[180:183], a[28:31], v[192:207]
ds_read_b64_tr_b16 a[164:165], v8 offset:0
ds_read_b64_tr_b16 a[166:167], v8 offset:512
v_mul_f32 v120, v120, v112
v_exp_f32 v119, v119
v_mul_f32 v129, v93, v129
s_waitcnt lgkmcnt(6)
v_mfma_f32_32x32x16_bf16 v[208:223], a[184:187], a[28:31], v[208:223]
ds_read_b64_tr_b16 a[168:169], v9 offset:0
ds_read_b64_tr_b16 a[170:171], v9 offset:512
v_fma_f32 v117, v117, v94, v94
v_rcp_f32 v115, v115
v_mul_f32 v121, v121, v113
s_waitcnt lgkmcnt(6)
v_mfma_f32_32x32x16_bf16 v[224:239], a[188:191], a[28:31], v[224:239]
ds_read_b64_tr_b16 a[172:173], v10 offset:0
ds_read_b64_tr_b16 a[174:175], v10 offset:512
v_cvt_pk_bf16_f32 v112, v120, v121
v_exp_f32 v128, v128
v_mul_f32 v130, v93, v130
s_waitcnt lgkmcnt(6)
v_mfma_f32_32x32x16_bf16 v[176:191], a[160:163], a[32:35], v[176:191]
ds_read_b64_tr_b16 a[176:177], v7 offset:2048
ds_read_b64_tr_b16 a[178:179], v7 offset:2560
v_fma_f32 v118, v118, v94, v94
v_rcp_f32 v116, v116
v_mul_f32 v122, v122, v114
s_waitcnt lgkmcnt(6)
v_mfma_f32_32x32x16_bf16 v[192:207], a[164:167], a[32:35], v[192:207]
ds_read_b64_tr_b16 a[180:181], v8 offset:2048
ds_read_b64_tr_b16 a[182:183], v8 offset:2560
s_add_u32 m0, s25, 32768
s_add_u32 s32, s23, 1327360
buffer_load_dwordx4 v12, s[12:15], s32 offen offset:0 lds
v_exp_f32 v129, v129
v_mul_f32 v131, v93, v131
v_fma_f32 v119, v119, v94, v94
s_waitcnt lgkmcnt(6)
v_mfma_f32_32x32x16_bf16 v[208:223], a[168:171], a[32:35], v[208:223]
ds_read_b64_tr_b16 a[184:185], v9 offset:2048
ds_read_b64_tr_b16 a[186:187], v9 offset:2560
buffer_load_dwordx4 v13, s[12:15], s32 offen offset:1024 lds
v_rcp_f32 v117, v117
v_mul_f32 v123, v123, v115
v_cvt_pk_bf16_f32 v113, v122, v123
s_waitcnt lgkmcnt(6)
v_mfma_f32_32x32x16_bf16 v[224:239], a[172:175], a[32:35], v[224:239]
ds_read_b64_tr_b16 a[188:189], v10 offset:2048
ds_read_b64_tr_b16 a[190:191], v10 offset:2560
buffer_load_dwordx4 v14, s[12:15], s32 offen offset:2048 lds
v_exp_f32 v130, v130
v_mul_f32 v132, v93, v132
v_fma_f32 v128, v128, v94, v94
s_waitcnt lgkmcnt(6)
v_mfma_f32_32x32x16_bf16 v[176:191], a[176:179], a[36:39], v[176:191]
ds_read_b64_tr_b16 a[160:161], v7 offset:4096
ds_read_b64_tr_b16 a[162:163], v7 offset:4608
buffer_load_dwordx4 v15, s[12:15], s32 offen offset:3072 lds
v_rcp_f32 v118, v118
v_mul_f32 v124, v124, v116
v_exp_f32 v131, v131
s_waitcnt lgkmcnt(6)
v_mfma_f32_32x32x16_bf16 v[192:207], a[180:183], a[36:39], v[192:207]
ds_read_b64_tr_b16 a[164:165], v8 offset:4096
ds_read_b64_tr_b16 a[166:167], v8 offset:4608
v_mul_f32 v133, v93, v133
v_fma_f32 v129, v129, v94, v94
v_rcp_f32 v119, v119
s_waitcnt lgkmcnt(6)
v_mfma_f32_32x32x16_bf16 v[208:223], a[184:187], a[36:39], v[208:223]
ds_read_b64_tr_b16 a[168:169], v9 offset:4096
ds_read_b64_tr_b16 a[170:171], v9 offset:4608
v_mul_f32 v125, v125, v117
v_cvt_pk_bf16_f32 v114, v124, v125
v_exp_f32 v132, v132
s_waitcnt lgkmcnt(6)
v_mfma_f32_32x32x16_bf16 v[224:239], a[188:191], a[36:39], v[224:239]
ds_read_b64_tr_b16 a[172:173], v10 offset:4096
ds_read_b64_tr_b16 a[174:175], v10 offset:4608
v_mul_f32 v134, v93, v134
v_fma_f32 v130, v130, v94, v94
v_rcp_f32 v128, v128
s_waitcnt lgkmcnt(6)
v_mfma_f32_32x32x16_bf16 v[176:191], a[160:163], a[40:43], v[176:191]
ds_read_b64_tr_b16 a[176:177], v7 offset:6144
ds_read_b64_tr_b16 a[178:179], v7 offset:6656
v_mul_f32 v126, v126, v118
v_exp_f32 v133, v133
v_mul_f32 v135, v93, v135
s_waitcnt lgkmcnt(6)
v_mfma_f32_32x32x16_bf16 v[192:207], a[164:167], a[40:43], v[192:207]
ds_read_b64_tr_b16 a[180:181], v8 offset:6144
ds_read_b64_tr_b16 a[182:183], v8 offset:6656
v_fma_f32 v131, v131, v94, v94
v_rcp_f32 v129, v129
v_mul_f32 v127, v127, v119
s_waitcnt lgkmcnt(6)
v_mfma_f32_32x32x16_bf16 v[208:223], a[168:171], a[40:43], v[208:223]
ds_read_b64_tr_b16 a[184:185], v9 offset:6144
ds_read_b64_tr_b16 a[186:187], v9 offset:6656
v_cvt_pk_bf16_f32 v115, v126, v127
buffer_store_dwordx4 v[112:115], v25, s[16:19], s48 offen offset:512 sc1
v_exp_f32 v134, v134
s_waitcnt lgkmcnt(6)
v_mfma_f32_32x32x16_bf16 v[224:239], a[172:175], a[40:43], v[224:239]
ds_read_b64_tr_b16 a[188:189], v10 offset:6144
ds_read_b64_tr_b16 a[190:191], v10 offset:6656
v_mul_f32 v144, v93, v144
v_fma_f32 v132, v132, v94, v94
v_rcp_f32 v130, v130
s_waitcnt lgkmcnt(6)
v_mfma_f32_32x32x16_bf16 v[176:191], a[176:179], a[44:47], v[176:191]
ds_read_b64_tr_b16 a[160:161], v7 offset:16384
ds_read_b64_tr_b16 a[162:163], v7 offset:16896
v_mul_f32 v136, v136, v128
v_exp_f32 v135, v135
v_mul_f32 v145, v93, v145
s_waitcnt lgkmcnt(6)
v_mfma_f32_32x32x16_bf16 v[192:207], a[180:183], a[44:47], v[192:207]
ds_read_b64_tr_b16 a[164:165], v8 offset:16384
ds_read_b64_tr_b16 a[166:167], v8 offset:16896
v_fma_f32 v133, v133, v94, v94
v_rcp_f32 v131, v131
v_mul_f32 v137, v137, v129
s_waitcnt lgkmcnt(6)
v_mfma_f32_32x32x16_bf16 v[208:223], a[184:187], a[44:47], v[208:223]
ds_read_b64_tr_b16 a[168:169], v9 offset:16384
ds_read_b64_tr_b16 a[170:171], v9 offset:16896
v_cvt_pk_bf16_f32 v128, v136, v137
v_exp_f32 v144, v144
v_mul_f32 v146, v93, v146
s_waitcnt lgkmcnt(6)
v_mfma_f32_32x32x16_bf16 v[224:239], a[188:191], a[44:47], v[224:239]
ds_read_b64_tr_b16 a[172:173], v10 offset:16384
ds_read_b64_tr_b16 a[174:175], v10 offset:16896
v_fma_f32 v134, v134, v94, v94
v_rcp_f32 v132, v132
v_mul_f32 v138, v138, v130
s_waitcnt lgkmcnt(6)
v_mfma_f32_32x32x16_bf16 v[176:191], a[160:163], a[48:51], v[176:191]
ds_read_b64_tr_b16 a[176:177], v7 offset:18432
ds_read_b64_tr_b16 a[178:179], v7 offset:18944
v_exp_f32 v145, v145
v_mul_f32 v147, v93, v147
v_fma_f32 v135, v135, v94, v94
s_waitcnt lgkmcnt(6)
v_mfma_f32_32x32x16_bf16 v[192:207], a[164:167], a[48:51], v[192:207]
ds_read_b64_tr_b16 a[180:181], v8 offset:18432
ds_read_b64_tr_b16 a[182:183], v8 offset:18944
s_add_u32 m0, s25, 49152
s_add_u32 s32, s23, 1548544
buffer_load_dwordx4 v12, s[12:15], s32 offen offset:0 lds
v_rcp_f32 v133, v133
v_mul_f32 v139, v139, v131
v_cvt_pk_bf16_f32 v129, v138, v139
s_waitcnt lgkmcnt(6)
v_mfma_f32_32x32x16_bf16 v[208:223], a[168:171], a[48:51], v[208:223]
ds_read_b64_tr_b16 a[184:185], v9 offset:18432
ds_read_b64_tr_b16 a[186:187], v9 offset:18944
buffer_load_dwordx4 v13, s[12:15], s32 offen offset:1024 lds
v_exp_f32 v146, v146
v_mul_f32 v148, v93, v148
v_fma_f32 v144, v144, v94, v94
s_waitcnt lgkmcnt(6)
v_mfma_f32_32x32x16_bf16 v[224:239], a[172:175], a[48:51], v[224:239]
ds_read_b64_tr_b16 a[188:189], v10 offset:18432
ds_read_b64_tr_b16 a[190:191], v10 offset:18944
buffer_load_dwordx4 v14, s[12:15], s32 offen offset:2048 lds
v_rcp_f32 v134, v134
v_mul_f32 v140, v140, v132
v_exp_f32 v147, v147
s_waitcnt lgkmcnt(6)
v_mfma_f32_32x32x16_bf16 v[176:191], a[176:179], a[52:55], v[176:191]
ds_read_b64_tr_b16 a[160:161], v7 offset:20480
ds_read_b64_tr_b16 a[162:163], v7 offset:20992
buffer_load_dwordx4 v15, s[12:15], s32 offen offset:3072 lds
v_mul_f32 v149, v93, v149
v_fma_f32 v145, v145, v94, v94
v_rcp_f32 v135, v135
s_waitcnt lgkmcnt(6)
v_mfma_f32_32x32x16_bf16 v[192:207], a[180:183], a[52:55], v[192:207]
ds_read_b64_tr_b16 a[164:165], v8 offset:20480
ds_read_b64_tr_b16 a[166:167], v8 offset:20992
v_mul_f32 v141, v141, v133
v_cvt_pk_bf16_f32 v130, v140, v141
v_exp_f32 v148, v148
s_waitcnt lgkmcnt(6)
v_mfma_f32_32x32x16_bf16 v[208:223], a[184:187], a[52:55], v[208:223]
ds_read_b64_tr_b16 a[168:169], v9 offset:20480
ds_read_b64_tr_b16 a[170:171], v9 offset:20992
v_mul_f32 v150, v93, v150
v_fma_f32 v146, v146, v94, v94
v_rcp_f32 v144, v144
s_waitcnt lgkmcnt(6)
v_mfma_f32_32x32x16_bf16 v[224:239], a[188:191], a[52:55], v[224:239]
ds_read_b64_tr_b16 a[172:173], v10 offset:20480
ds_read_b64_tr_b16 a[174:175], v10 offset:20992
v_mul_f32 v142, v142, v134
v_exp_f32 v149, v149
v_mul_f32 v151, v93, v151
s_waitcnt lgkmcnt(6)
v_mfma_f32_32x32x16_bf16 v[176:191], a[160:163], a[56:59], v[176:191]
ds_read_b64_tr_b16 a[176:177], v7 offset:22528
ds_read_b64_tr_b16 a[178:179], v7 offset:23040
v_fma_f32 v147, v147, v94, v94
v_rcp_f32 v145, v145
v_mul_f32 v143, v143, v135
s_waitcnt lgkmcnt(6)
v_mfma_f32_32x32x16_bf16 v[192:207], a[164:167], a[56:59], v[192:207]
ds_read_b64_tr_b16 a[180:181], v8 offset:22528
ds_read_b64_tr_b16 a[182:183], v8 offset:23040
v_cvt_pk_bf16_f32 v131, v142, v143
buffer_store_dwordx4 v[128:131], v25, s[16:19], s49 offen offset:0 sc1
v_exp_f32 v150, v150
s_waitcnt lgkmcnt(6)
v_mfma_f32_32x32x16_bf16 v[208:223], a[168:171], a[56:59], v[208:223]
ds_read_b64_tr_b16 a[184:185], v9 offset:22528
ds_read_b64_tr_b16 a[186:187], v9 offset:23040
v_fma_f32 v148, v148, v94, v94
v_rcp_f32 v146, v146
v_mul_f32 v152, v152, v144
s_waitcnt lgkmcnt(6)
v_mfma_f32_32x32x16_bf16 v[224:239], a[172:175], a[56:59], v[224:239]
ds_read_b64_tr_b16 a[188:189], v10 offset:22528
ds_read_b64_tr_b16 a[190:191], v10 offset:23040
v_exp_f32 v151, v151
v_fma_f32 v149, v149, v94, v94
v_rcp_f32 v147, v147
s_waitcnt vmcnt(11)
s_barrier
s_waitcnt lgkmcnt(6)
v_mfma_f32_32x32x16_bf16 v[176:191], a[176:179], a[60:63], v[176:191]
ds_read_b64_tr_b16 a[160:161], v2 offset:0
ds_read_b64_tr_b16 a[162:163], v2 offset:512
v_mul_f32 v153, v153, v145
v_cvt_pk_bf16_f32 v144, v152, v153
v_fma_f32 v150, v150, v94, v94
s_waitcnt lgkmcnt(6)
v_mfma_f32_32x32x16_bf16 v[192:207], a[180:183], a[60:63], v[192:207]
ds_read_b64_tr_b16 a[164:165], v3 offset:0
ds_read_b64_tr_b16 a[166:167], v3 offset:512
v_rcp_f32 v148, v148
v_mul_f32 v154, v154, v146
v_fma_f32 v151, v151, v94, v94
s_waitcnt lgkmcnt(6)
v_mfma_f32_32x32x16_bf16 v[208:223], a[184:187], a[60:63], v[208:223]
ds_read_b64_tr_b16 a[168:169], v4 offset:0
ds_read_b64_tr_b16 a[170:171], v4 offset:512
v_rcp_f32 v149, v149
v_mul_f32 v155, v155, v147
v_cvt_pk_bf16_f32 v145, v154, v155
s_waitcnt lgkmcnt(6)
v_mfma_f32_32x32x16_bf16 v[224:239], a[188:191], a[60:63], v[224:239]
ds_read_b64_tr_b16 a[172:173], v5 offset:0
ds_read_b64_tr_b16 a[174:175], v5 offset:512
v_rcp_f32 v150, v150
v_mul_f32 v156, v156, v148
v_rcp_f32 v151, v151
s_waitcnt lgkmcnt(6)
v_mfma_f32_32x32x16_bf16 v[176:191], a[160:163], a[64:67], v[176:191]
ds_read_b64_tr_b16 a[176:177], v2 offset:2048
ds_read_b64_tr_b16 a[178:179], v2 offset:2560
v_mul_f32 v157, v157, v149
v_cvt_pk_bf16_f32 v146, v156, v157
v_mul_f32 v158, v158, v150
s_waitcnt lgkmcnt(6)
v_mfma_f32_32x32x16_bf16 v[192:207], a[164:167], a[64:67], v[192:207]
ds_read_b64_tr_b16 a[180:181], v3 offset:2048
ds_read_b64_tr_b16 a[182:183], v3 offset:2560
s_add_u32 m0, s25, 65536
s_add_u32 s32, s23, 1769728
buffer_load_dwordx4 v12, s[12:15], s32 offen offset:0 lds
ds_read_b32 v62, v95 offset:1024
ds_read_b32 v63, v95 offset:1152
v_mul_f32 v159, v159, v151
v_cvt_pk_bf16_f32 v147, v158, v159
buffer_store_dwordx4 v[144:147], v25, s[16:19], s49 offen offset:512 sc1
s_waitcnt lgkmcnt(8)
v_mfma_f32_32x32x16_bf16 v[208:223], a[168:171], a[64:67], v[208:223]
ds_read_b64_tr_b16 a[184:185], v4 offset:2048
ds_read_b64_tr_b16 a[186:187], v4 offset:2560
buffer_load_dwordx4 v13, s[12:15], s32 offen offset:1024 lds
ds_read_b32 v64, v95 offset:1280
ds_read_b32 v65, v95 offset:1408
v_accvgpr_read_b32 v96, a192
v_accvgpr_read_b32 v97, a193
v_accvgpr_read_b32 v98, a194
s_waitcnt lgkmcnt(10)
v_mfma_f32_32x32x16_bf16 v[224:239], a[172:175], a[64:67], v[224:239]
ds_read_b64_tr_b16 a[188:189], v5 offset:2048
ds_read_b64_tr_b16 a[190:191], v5 offset:2560
buffer_load_dwordx4 v14, s[12:15], s32 offen offset:2048 lds
s_waitcnt lgkmcnt(7)
v_cvt_pk_bf16_f32 v52, v62, v62
v_and_b32 v53, 0xffff0000, v52
v_accvgpr_read_b32 v99, a195
v_accvgpr_read_b32 v100, a196
v_mul_f32 v96, v93, v96
v_mfma_f32_32x32x16_bf16 v[176:191], a[176:179], a[68:71], v[176:191]
ds_read_b64_tr_b16 a[160:161], v2 offset:4096
ds_read_b64_tr_b16 a[162:163], v2 offset:4608
buffer_load_dwordx4 v15, s[12:15], s32 offen offset:3072 lds
v_sub_f32 v53, v62, v53
v_cvt_pk_bf16_f32 v53, v53, v53
v_accvgpr_read_b32 v101, a197
v_mul_f32 v97, v93, v97
v_accvgpr_read_b32 v102, a198
v_mfma_f32_32x32x16_bf16 v[192:207], a[180:183], a[68:71], v[192:207]
ds_read_b64_tr_b16 a[164:165], v3 offset:4096
ds_read_b64_tr_b16 a[166:167], v3 offset:4608
s_waitcnt lgkmcnt(10)
v_cvt_pk_bf16_f32 v54, v63, v63
v_and_b32 v55, 0xffff0000, v54
v_exp_f32 v96, v96
v_mul_f32 v98, v93, v98
v_accvgpr_read_b32 v104, a200
s_waitcnt lgkmcnt(8)
v_mfma_f32_32x32x16_bf16 v[208:223], a[184:187], a[68:71], v[208:223]
ds_read_b64_tr_b16 a[168:169], v4 offset:4096
ds_read_b64_tr_b16 a[170:171], v4 offset:4608
v_sub_f32 v55, v63, v55
v_cvt_pk_bf16_f32 v55, v55, v55
v_accvgpr_read_b32 v103, a199
v_exp_f32 v97, v97
v_mul_f32 v99, v93, v99
s_waitcnt lgkmcnt(6)
v_mfma_f32_32x32x16_bf16 v[224:239], a[188:191], a[68:71], v[224:239]
ds_read_b64_tr_b16 a[172:173], v5 offset:4096
ds_read_b64_tr_b16 a[174:175], v5 offset:4608
v_cvt_pk_bf16_f32 v56, v64, v64
v_and_b32 v57, 0xffff0000, v56
v_accvgpr_read_b32 v105, a201
v_accvgpr_read_b32 v112, a208
v_exp_f32 v98, v98
s_waitcnt lgkmcnt(6)
v_mfma_f32_32x32x16_bf16 v[176:191], a[160:163], a[72:75], v[176:191]
ds_read_b64_tr_b16 a[176:177], v2 offset:6144
ds_read_b64_tr_b16 a[178:179], v2 offset:6656
v_sub_f32 v57, v64, v57
v_cvt_pk_bf16_f32 v57, v57, v57
v_mul_f32 v100, v93, v100
v_fma_f32 v96, v96, v94, v94
v_accvgpr_read_b32 v106, a202
s_waitcnt lgkmcnt(6)
v_mfma_f32_32x32x16_bf16 v[192:207], a[164:167], a[72:75], v[192:207]
ds_read_b64_tr_b16 a[180:181], v3 offset:6144
ds_read_b64_tr_b16 a[182:183], v3 offset:6656
v_cvt_pk_bf16_f32 v58, v65, v65
v_and_b32 v59, 0xffff0000, v58
v_accvgpr_read_b32 v113, a209
v_exp_f32 v99, v99
v_mul_f32 v101, v93, v101
s_waitcnt lgkmcnt(6)
v_mfma_f32_32x32x16_bf16 v[208:223], a[168:171], a[72:75], v[208:223]
ds_read_b64_tr_b16 a[184:185], v4 offset:6144
ds_read_b64_tr_b16 a[186:187], v4 offset:6656
v_sub_f32 v59, v65, v59
v_cvt_pk_bf16_f32 v59, v59, v59
v_fma_f32 v97, v97, v94, v94
v_accvgpr_read_b32 v107, a203
v_accvgpr_read_b32 v114, a210
s_waitcnt lgkmcnt(6)
v_mfma_f32_32x32x16_bf16 v[224:239], a[172:175], a[72:75], v[224:239]
ds_read_b64_tr_b16 a[188:189], v5 offset:6144
ds_read_b64_tr_b16 a[190:191], v5 offset:6656
v_mfma_f32_32x32x8_bf16 v[176:191], v[52:53], v[88:89], v[176:191]
v_mfma_f32_32x32x8_bf16 v[192:207], v[54:55], v[88:89], v[192:207]
v_exp_f32 v100, v100
v_mul_f32 v102, v93, v102
v_fma_f32 v98, v98, v94, v94
s_waitcnt lgkmcnt(6)
v_mfma_f32_32x32x16_bf16 v[176:191], a[176:179], a[76:79], v[176:191]
ds_read_b64_tr_b16 a[160:161], v2 offset:16384
ds_read_b64_tr_b16 a[162:163], v2 offset:16896
v_mfma_f32_32x32x8_bf16 v[208:223], v[56:57], v[88:89], v[208:223]
v_mfma_f32_32x32x8_bf16 v[224:239], v[58:59], v[88:89], v[224:239]
v_rcp_f32 v96, v96
v_accvgpr_read_b32 v108, a204
v_accvgpr_read_b32 v115, a211
s_waitcnt lgkmcnt(6)
v_mfma_f32_32x32x16_bf16 v[192:207], a[180:183], a[76:79], v[192:207]
ds_read_b64_tr_b16 a[164:165], v3 offset:16384
ds_read_b64_tr_b16 a[166:167], v3 offset:16896
v_exp_f32 v101, v101
v_mul_f32 v103, v93, v103
v_fma_f32 v99, v99, v94, v94
s_waitcnt lgkmcnt(6)
v_mfma_f32_32x32x16_bf16 v[208:223], a[184:187], a[76:79], v[208:223]
ds_read_b64_tr_b16 a[168:169], v4 offset:16384
ds_read_b64_tr_b16 a[170:171], v4 offset:16896
v_rcp_f32 v97, v97
v_accvgpr_read_b32 v109, a205
v_accvgpr_read_b32 v116, a212
s_waitcnt lgkmcnt(6)
v_mfma_f32_32x32x16_bf16 v[224:239], a[188:191], a[76:79], v[224:239]
ds_read_b64_tr_b16 a[172:173], v5 offset:16384
ds_read_b64_tr_b16 a[174:175], v5 offset:16896
v_exp_f32 v102, v102
v_mul_f32 v112, v93, v112
v_fma_f32 v100, v100, v94, v94
s_waitcnt lgkmcnt(6)
v_mfma_f32_32x32x16_bf16 v[176:191], a[160:163], a[80:83], v[176:191]
ds_read_b64_tr_b16 a[176:177], v2 offset:18432
ds_read_b64_tr_b16 a[178:179], v2 offset:18944
v_rcp_f32 v98, v98
v_accvgpr_read_b32 v110, a206
v_mul_f32 v104, v104, v96
s_waitcnt lgkmcnt(6)
v_mfma_f32_32x32x16_bf16 v[192:207], a[164:167], a[80:83], v[192:207]
ds_read_b64_tr_b16 a[180:181], v3 offset:18432
ds_read_b64_tr_b16 a[182:183], v3 offset:18944
s_add_u32 m0, s25, 81920
s_add_u32 s32, s23, 1990912
buffer_load_dwordx4 v12, s[12:15], s32 offen offset:0 lds
v_accvgpr_read_b32 v117, a213
v_exp_f32 v103, v103
v_mul_f32 v113, v93, v113
s_waitcnt lgkmcnt(6)
v_mfma_f32_32x32x16_bf16 v[208:223], a[168:171], a[80:83], v[208:223]
ds_read_b64_tr_b16 a[184:185], v4 offset:18432
ds_read_b64_tr_b16 a[186:187], v4 offset:18944
buffer_load_dwordx4 v13, s[12:15], s32 offen offset:1024 lds
v_fma_f32 v101, v101, v94, v94
v_rcp_f32 v99, v99
v_accvgpr_read_b32 v111, a207
s_waitcnt lgkmcnt(6)
v_mfma_f32_32x32x16_bf16 v[224:239], a[172:175], a[80:83], v[224:239]
ds_read_b64_tr_b16 a[188:189], v5 offset:18432
ds_read_b64_tr_b16 a[190:191], v5 offset:18944
buffer_load_dwordx4 v14, s[12:15], s32 offen offset:2048 lds
v_mul_f32 v105, v105, v97
v_cvt_pk_bf16_f32 v96, v104, v105
v_accvgpr_read_b32 v118, a214
s_waitcnt lgkmcnt(6)
v_mfma_f32_32x32x16_bf16 v[176:191], a[176:179], a[84:87], v[176:191]
ds_read_b64_tr_b16 a[160:161], v2 offset:20480
ds_read_b64_tr_b16 a[162:163], v2 offset:20992
buffer_load_dwordx4 v15, s[12:15], s32 offen offset:3072 lds
v_exp_f32 v112, v112
v_mul_f32 v114, v93, v114
v_fma_f32 v102, v102, v94, v94
s_waitcnt lgkmcnt(6)
v_mfma_f32_32x32x16_bf16 v[192:207], a[180:183], a[84:87], v[192:207]
ds_read_b64_tr_b16 a[164:165], v3 offset:20480
ds_read_b64_tr_b16 a[166:167], v3 offset:20992
v_rcp_f32 v100, v100
v_accvgpr_read_b32 v120, a216
v_mul_f32 v106, v106, v98
s_waitcnt lgkmcnt(6)
v_mfma_f32_32x32x16_bf16 v[208:223], a[184:187], a[84:87], v[208:223]
ds_read_b64_tr_b16 a[168:169], v4 offset:20480
ds_read_b64_tr_b16 a[170:171], v4 offset:20992
v_accvgpr_read_b32 v119, a215
v_exp_f32 v113, v113
v_mul_f32 v115, v93, v115
s_waitcnt lgkmcnt(6)
v_mfma_f32_32x32x16_bf16 v[224:239], a[188:191], a[84:87], v[224:239]
ds_read_b64_tr_b16 a[172:173], v5 offset:20480
ds_read_b64_tr_b16 a[174:175], v5 offset:20992
v_fma_f32 v103, v103, v94, v94
v_rcp_f32 v101, v101
v_accvgpr_read_b32 v121, a217
s_waitcnt lgkmcnt(6)
v_mfma_f32_32x32x16_bf16 v[176:191], a[160:163], a[88:91], v[176:191]
ds_read_b64_tr_b16 a[176:177], v2 offset:22528
ds_read_b64_tr_b16 a[178:179], v2 offset:23040
v_mul_f32 v107, v107, v99
v_cvt_pk_bf16_f32 v97, v106, v107
v_accvgpr_read_b32 v128, a224
s_waitcnt lgkmcnt(6)
v_mfma_f32_32x32x16_bf16 v[192:207], a[164:167], a[88:91], v[192:207]
ds_read_b64_tr_b16 a[180:181], v3 offset:22528
ds_read_b64_tr_b16 a[182:183], v3 offset:23040
v_exp_f32 v114, v114
v_mul_f32 v116, v93, v116
v_fma_f32 v112, v112, v94, v94
s_waitcnt lgkmcnt(6)
v_mfma_f32_32x32x16_bf16 v[208:223], a[168:171], a[88:91], v[208:223]
ds_read_b64_tr_b16 a[184:185], v4 offset:22528
ds_read_b64_tr_b16 a[186:187], v4 offset:23040
v_rcp_f32 v102, v102
v_accvgpr_read_b32 v122, a218
v_mul_f32 v108, v108, v100
s_waitcnt lgkmcnt(6)
v_mfma_f32_32x32x16_bf16 v[224:239], a[172:175], a[88:91], v[224:239]
ds_read_b64_tr_b16 a[188:189], v5 offset:22528
ds_read_b64_tr_b16 a[190:191], v5 offset:23040
v_accvgpr_read_b32 v129, a225
v_exp_f32 v115, v115
v_mul_f32 v117, v93, v117
s_waitcnt vmcnt(10)
s_barrier
s_waitcnt lgkmcnt(6)
v_mfma_f32_32x32x16_bf16 v[176:191], a[176:179], a[92:95], v[176:191]
ds_read_b64_tr_b16 a[160:161], v2 offset:32768
ds_read_b64_tr_b16 a[162:163], v2 offset:33280
v_fma_f32 v113, v113, v94, v94
v_rcp_f32 v103, v103
v_accvgpr_read_b32 v123, a219
s_waitcnt lgkmcnt(6)
v_mfma_f32_32x32x16_bf16 v[192:207], a[180:183], a[92:95], v[192:207]
ds_read_b64_tr_b16 a[164:165], v3 offset:32768
ds_read_b64_tr_b16 a[166:167], v3 offset:33280
v_mul_f32 v109, v109, v101
v_cvt_pk_bf16_f32 v98, v108, v109
v_accvgpr_read_b32 v130, a226
s_waitcnt lgkmcnt(6)
v_mfma_f32_32x32x16_bf16 v[208:223], a[184:187], a[92:95], v[208:223]
ds_read_b64_tr_b16 a[168:169], v4 offset:32768
ds_read_b64_tr_b16 a[170:171], v4 offset:33280
v_exp_f32 v116, v116
v_mul_f32 v118, v93, v118
v_fma_f32 v114, v114, v94, v94
s_waitcnt lgkmcnt(6)
v_mfma_f32_32x32x16_bf16 v[224:239], a[188:191], a[92:95], v[224:239]
ds_read_b64_tr_b16 a[172:173], v5 offset:32768
ds_read_b64_tr_b16 a[174:175], v5 offset:33280
v_rcp_f32 v112, v112
v_accvgpr_read_b32 v124, a220
v_mul_f32 v110, v110, v102
s_waitcnt lgkmcnt(6)
v_mfma_f32_32x32x16_bf16 v[176:191], a[160:163], a[96:99], v[176:191]
ds_read_b64_tr_b16 a[176:177], v2 offset:34816
ds_read_b64_tr_b16 a[178:179], v2 offset:35328
v_accvgpr_read_b32 v131, a227
v_exp_f32 v117, v117
v_mul_f32 v119, v93, v119
s_waitcnt lgkmcnt(6)
v_mfma_f32_32x32x16_bf16 v[192:207], a[164:167], a[96:99], v[192:207]
ds_read_b64_tr_b16 a[180:181], v3 offset:34816
ds_read_b64_tr_b16 a[182:183], v3 offset:35328
v_fma_f32 v115, v115, v94, v94
v_rcp_f32 v113, v113
v_accvgpr_read_b32 v125, a221
s_waitcnt lgkmcnt(6)
v_mfma_f32_32x32x16_bf16 v[208:223], a[168:171], a[96:99], v[208:223]
ds_read_b64_tr_b16 a[184:185], v4 offset:34816
ds_read_b64_tr_b16 a[186:187], v4 offset:35328
v_mul_f32 v111, v111, v103
v_cvt_pk_bf16_f32 v99, v110, v111
buffer_store_dwordx4 v[96:99], v25, s[16:19], s46 offen offset:0 sc1
s_waitcnt lgkmcnt(6)
v_mfma_f32_32x32x16_bf16 v[224:239], a[172:175], a[96:99], v[224:239]
ds_read_b64_tr_b16 a[188:189], v5 offset:34816
ds_read_b64_tr_b16 a[190:191], v5 offset:35328
v_accvgpr_read_b32 v132, a228
v_exp_f32 v118, v118
v_mul_f32 v128, v93, v128
s_waitcnt lgkmcnt(6)
v_mfma_f32_32x32x16_bf16 v[176:191], a[176:179], a[100:103], v[176:191]
ds_read_b64_tr_b16 a[160:161], v2 offset:36864
ds_read_b64_tr_b16 a[162:163], v2 offset:37376
v_fma_f32 v116, v116, v94, v94
v_rcp_f32 v114, v114
v_accvgpr_read_b32 v126, a222
s_waitcnt lgkmcnt(6)
v_mfma_f32_32x32x16_bf16 v[192:207], a[180:183], a[100:103], v[192:207]
ds_read_b64_tr_b16 a[164:165], v3 offset:36864
ds_read_b64_tr_b16 a[166:167], v3 offset:37376
v_mul_f32 v120, v120, v112
v_accvgpr_read_b32 v133, a229
v_exp_f32 v119, v119
s_waitcnt lgkmcnt(6)
v_mfma_f32_32x32x16_bf16 v[208:223], a[184:187], a[100:103], v[208:223]
ds_read_b64_tr_b16 a[168:169], v4 offset:36864
ds_read_b64_tr_b16 a[170:171], v4 offset:37376
v_mul_f32 v129, v93, v129
v_fma_f32 v117, v117, v94, v94
v_rcp_f32 v115, v115
s_waitcnt lgkmcnt(6)
v_mfma_f32_32x32x16_bf16 v[224:239], a[188:191], a[100:103], v[224:239]
ds_read_b64_tr_b16 a[172:173], v5 offset:36864
ds_read_b64_tr_b16 a[174:175], v5 offset:37376
v_accvgpr_read_b32 v127, a223
v_mul_f32 v121, v121, v113
v_cvt_pk_bf16_f32 v112, v120, v121
s_waitcnt lgkmcnt(6)
v_mfma_f32_32x32x16_bf16 v[176:191], a[160:163], a[104:107], v[176:191]
ds_read_b64_tr_b16 a[176:177], v2 offset:38912
ds_read_b64_tr_b16 a[178:179], v2 offset:39424
v_accvgpr_read_b32 v134, a230
v_exp_f32 v128, v128
v_mul_f32 v130, v93, v130
s_waitcnt lgkmcnt(6)
v_mfma_f32_32x32x16_bf16 v[192:207], a[164:167], a[104:107], v[192:207]
ds_read_b64_tr_b16 a[180:181], v3 offset:38912
ds_read_b64_tr_b16 a[182:183], v3 offset:39424
v_fma_f32 v118, v118, v94, v94
v_rcp_f32 v116, v116
v_accvgpr_read_b32 v136, a232
s_waitcnt lgkmcnt(6)
v_mfma_f32_32x32x16_bf16 v[208:223], a[168:171], a[104:107], v[208:223]
ds_read_b64_tr_b16 a[184:185], v4 offset:38912
ds_read_b64_tr_b16 a[186:187], v4 offset:39424
v_mul_f32 v122, v122, v114
v_accvgpr_read_b32 v135, a231
v_exp_f32 v129, v129
s_waitcnt lgkmcnt(6)
v_mfma_f32_32x32x16_bf16 v[224:239], a[172:175], a[104:107], v[224:239]
ds_read_b64_tr_b16 a[188:189], v5 offset:38912
ds_read_b64_tr_b16 a[190:191], v5 offset:39424
v_mul_f32 v131, v93, v131
v_fma_f32 v119, v119, v94, v94
v_rcp_f32 v117, v117
s_waitcnt lgkmcnt(6)
v_mfma_f32_32x32x16_bf16 v[176:191], a[176:179], a[108:111], v[176:191]
ds_read_b64_tr_b16 a[160:161], v2 offset:49152
ds_read_b64_tr_b16 a[162:163], v2 offset:49664
v_accvgpr_read_b32 v137, a233
v_mul_f32 v123, v123, v115
v_cvt_pk_bf16_f32 v113, v122, v123
s_waitcnt lgkmcnt(6)
v_mfma_f32_32x32x16_bf16 v[192:207], a[180:183], a[108:111], v[192:207]
ds_read_b64_tr_b16 a[164:165], v3 offset:49152
ds_read_b64_tr_b16 a[166:167], v3 offset:49664
v_accvgpr_read_b32 v144, a240
v_exp_f32 v130, v130
v_mul_f32 v132, v93, v132
s_waitcnt lgkmcnt(6)
v_mfma_f32_32x32x16_bf16 v[208:223], a[184:187], a[108:111], v[208:223]
ds_read_b64_tr_b16 a[168:169], v4 offset:49152
ds_read_b64_tr_b16 a[170:171], v4 offset:49664
v_fma_f32 v128, v128, v94, v94
v_rcp_f32 v118, v118
v_accvgpr_read_b32 v138, a234
s_waitcnt lgkmcnt(6)
v_mfma_f32_32x32x16_bf16 v[224:239], a[188:191], a[108:111], v[224:239]
ds_read_b64_tr_b16 a[172:173], v5 offset:49152
ds_read_b64_tr_b16 a[174:175], v5 offset:49664
v_mul_f32 v124, v124, v116
v_accvgpr_read_b32 v145, a241
v_exp_f32 v131, v131
s_waitcnt lgkmcnt(6)
v_mfma_f32_32x32x16_bf16 v[176:191], a[160:163], a[112:115], v[176:191]
ds_read_b64_tr_b16 a[176:177], v2 offset:51200
ds_read_b64_tr_b16 a[178:179], v2 offset:51712
v_mul_f32 v133, v93, v133
v_fma_f32 v129, v129, v94, v94
v_rcp_f32 v119, v119
s_waitcnt lgkmcnt(6)
v_mfma_f32_32x32x16_bf16 v[192:207], a[164:167], a[112:115], v[192:207]
ds_read_b64_tr_b16 a[180:181], v3 offset:51200
ds_read_b64_tr_b16 a[182:183], v3 offset:51712
v_accvgpr_read_b32 v139, a235
v_mul_f32 v125, v125, v117
v_cvt_pk_bf16_f32 v114, v124, v125
s_waitcnt lgkmcnt(6)
v_mfma_f32_32x32x16_bf16 v[208:223], a[168:171], a[112:115], v[208:223]
ds_read_b64_tr_b16 a[184:185], v4 offset:51200
ds_read_b64_tr_b16 a[186:187], v4 offset:51712
v_accvgpr_read_b32 v146, a242
v_exp_f32 v132, v132
v_mul_f32 v134, v93, v134
s_waitcnt lgkmcnt(6)
v_mfma_f32_32x32x16_bf16 v[224:239], a[172:175], a[112:115], v[224:239]
ds_read_b64_tr_b16 a[188:189], v5 offset:51200
ds_read_b64_tr_b16 a[190:191], v5 offset:51712
v_fma_f32 v130, v130, v94, v94
v_rcp_f32 v128, v128
v_accvgpr_read_b32 v140, a236
s_waitcnt lgkmcnt(6)
v_mfma_f32_32x32x16_bf16 v[176:191], a[176:179], a[116:119], v[176:191]
ds_read_b64_tr_b16 a[160:161], v2 offset:53248
ds_read_b64_tr_b16 a[162:163], v2 offset:53760
v_mul_f32 v126, v126, v118
v_accvgpr_read_b32 v147, a243
v_exp_f32 v133, v133
s_waitcnt lgkmcnt(6)
v_mfma_f32_32x32x16_bf16 v[192:207], a[180:183], a[116:119], v[192:207]
ds_read_b64_tr_b16 a[164:165], v3 offset:53248
ds_read_b64_tr_b16 a[166:167], v3 offset:53760
v_mul_f32 v135, v93, v135
v_fma_f32 v131, v131, v94, v94
v_rcp_f32 v129, v129
s_waitcnt lgkmcnt(6)
v_mfma_f32_32x32x16_bf16 v[208:223], a[184:187], a[116:119], v[208:223]
ds_read_b64_tr_b16 a[168:169], v4 offset:53248
ds_read_b64_tr_b16 a[170:171], v4 offset:53760
v_accvgpr_read_b32 v141, a237
v_mul_f32 v127, v127, v119
v_cvt_pk_bf16_f32 v115, v126, v127
s_waitcnt lgkmcnt(6)
v_mfma_f32_32x32x16_bf16 v[224:239], a[188:191], a[116:119], v[224:239]
ds_read_b64_tr_b16 a[172:173], v5 offset:53248
ds_read_b64_tr_b16 a[174:175], v5 offset:53760
buffer_store_dwordx4 v[112:115], v25, s[16:19], s46 offen offset:512 sc1
v_accvgpr_read_b32 v148, a244
v_exp_f32 v134, v134
s_waitcnt lgkmcnt(6)
v_mfma_f32_32x32x16_bf16 v[176:191], a[160:163], a[120:123], v[176:191]
ds_read_b64_tr_b16 a[176:177], v2 offset:55296
ds_read_b64_tr_b16 a[178:179], v2 offset:55808
v_mul_f32 v144, v93, v144
v_fma_f32 v132, v132, v94, v94
v_rcp_f32 v130, v130
s_waitcnt lgkmcnt(6)
v_mfma_f32_32x32x16_bf16 v[192:207], a[164:167], a[120:123], v[192:207]
ds_read_b64_tr_b16 a[180:181], v3 offset:55296
ds_read_b64_tr_b16 a[182:183], v3 offset:55808
v_accvgpr_read_b32 v142, a238
v_mul_f32 v136, v136, v128
v_accvgpr_read_b32 v149, a245
s_waitcnt lgkmcnt(6)
v_mfma_f32_32x32x16_bf16 v[208:223], a[168:171], a[120:123], v[208:223]
ds_read_b64_tr_b16 a[184:185], v4 offset:55296
ds_read_b64_tr_b16 a[186:187], v4 offset:55808
v_exp_f32 v135, v135
v_mul_f32 v145, v93, v145
v_fma_f32 v133, v133, v94, v94
s_waitcnt lgkmcnt(6)
v_mfma_f32_32x32x16_bf16 v[224:239], a[172:175], a[120:123], v[224:239]
ds_read_b64_tr_b16 a[188:189], v5 offset:55296
ds_read_b64_tr_b16 a[190:191], v5 offset:55808
v_rcp_f32 v131, v131
v_accvgpr_read_b32 v143, a239
v_mul_f32 v137, v137, v129
s_waitcnt vmcnt(2)
s_barrier
s_waitcnt lgkmcnt(6)
v_mfma_f32_32x32x16_bf16 v[176:191], a[176:179], a[124:127], v[176:191]
ds_read_b64_tr_b16 a[160:161], v7 offset:0
ds_read_b64_tr_b16 a[162:163], v7 offset:512
v_cvt_pk_bf16_f32 v128, v136, v137
v_accvgpr_read_b32 v150, a246
v_exp_f32 v144, v144
s_waitcnt lgkmcnt(6)
v_mfma_f32_32x32x16_bf16 v[192:207], a[180:183], a[124:127], v[192:207]
ds_read_b64_tr_b16 a[164:165], v8 offset:0
ds_read_b64_tr_b16 a[166:167], v8 offset:512
v_mul_f32 v146, v93, v146
v_fma_f32 v134, v134, v94, v94
v_rcp_f32 v132, v132
s_waitcnt lgkmcnt(6)
v_mfma_f32_32x32x16_bf16 v[208:223], a[184:187], a[124:127], v[208:223]
ds_read_b64_tr_b16 a[168:169], v9 offset:0
ds_read_b64_tr_b16 a[170:171], v9 offset:512
v_accvgpr_read_b32 v152, a248
v_mul_f32 v138, v138, v130
v_accvgpr_read_b32 v151, a247
s_waitcnt lgkmcnt(6)
v_mfma_f32_32x32x16_bf16 v[224:239], a[188:191], a[124:127], v[224:239]
ds_read_b64_tr_b16 a[172:173], v10 offset:0
ds_read_b64_tr_b16 a[174:175], v10 offset:512
v_exp_f32 v145, v145
v_mul_f32 v147, v93, v147
v_fma_f32 v135, v135, v94, v94
s_waitcnt lgkmcnt(6)
v_mfma_f32_32x32x16_bf16 v[176:191], a[160:163], a[128:131], v[176:191]
ds_read_b64_tr_b16 a[176:177], v7 offset:2048
ds_read_b64_tr_b16 a[178:179], v7 offset:2560
v_rcp_f32 v133, v133
v_accvgpr_read_b32 v153, a249
v_mul_f32 v139, v139, v131
s_waitcnt lgkmcnt(6)
v_mfma_f32_32x32x16_bf16 v[192:207], a[164:167], a[128:131], v[192:207]
ds_read_b64_tr_b16 a[180:181], v8 offset:2048
ds_read_b64_tr_b16 a[182:183], v8 offset:2560
v_cvt_pk_bf16_f32 v129, v138, v139
v_exp_f32 v146, v146
v_mul_f32 v148, v93, v148
s_waitcnt lgkmcnt(6)
v_mfma_f32_32x32x16_bf16 v[208:223], a[168:171], a[128:131], v[208:223]
ds_read_b64_tr_b16 a[184:185], v9 offset:2048
ds_read_b64_tr_b16 a[186:187], v9 offset:2560
v_fma_f32 v144, v144, v94, v94
v_rcp_f32 v134, v134
s_waitcnt lgkmcnt(6)
v_mfma_f32_32x32x16_bf16 v[224:239], a[172:175], a[128:131], v[224:239]
ds_read_b64_tr_b16 a[188:189], v10 offset:2048
ds_read_b64_tr_b16 a[190:191], v10 offset:2560
v_accvgpr_read_b32 v154, a250
v_mul_f32 v140, v140, v132
s_waitcnt lgkmcnt(6)
v_mfma_f32_32x32x16_bf16 v[176:191], a[176:179], a[132:135], v[176:191]
ds_read_b64_tr_b16 a[160:161], v7 offset:4096
ds_read_b64_tr_b16 a[162:163], v7 offset:4608
v_exp_f32 v147, v147
v_mul_f32 v149, v93, v149
s_waitcnt lgkmcnt(6)
v_mfma_f32_32x32x16_bf16 v[192:207], a[180:183], a[132:135], v[192:207]
ds_read_b64_tr_b16 a[164:165], v8 offset:4096
ds_read_b64_tr_b16 a[166:167], v8 offset:4608
v_fma_f32 v145, v145, v94, v94
v_rcp_f32 v135, v135
s_waitcnt lgkmcnt(6)
v_mfma_f32_32x32x16_bf16 v[208:223], a[184:187], a[132:135], v[208:223]
ds_read_b64_tr_b16 a[168:169], v9 offset:4096
ds_read_b64_tr_b16 a[170:171], v9 offset:4608
v_accvgpr_read_b32 v155, a251
v_mul_f32 v141, v141, v133
s_waitcnt lgkmcnt(6)
v_mfma_f32_32x32x16_bf16 v[224:239], a[188:191], a[132:135], v[224:239]
ds_read_b64_tr_b16 a[172:173], v10 offset:4096
ds_read_b64_tr_b16 a[174:175], v10 offset:4608
v_cvt_pk_bf16_f32 v130, v140, v141
v_exp_f32 v148, v148
s_waitcnt lgkmcnt(6)
v_mfma_f32_32x32x16_bf16 v[176:191], a[160:163], a[136:139], v[176:191]
ds_read_b64_tr_b16 a[176:177], v7 offset:6144
ds_read_b64_tr_b16 a[178:179], v7 offset:6656
v_mul_f32 v150, v93, v150
v_fma_f32 v146, v146, v94, v94
s_waitcnt lgkmcnt(6)
v_mfma_f32_32x32x16_bf16 v[192:207], a[164:167], a[136:139], v[192:207]
ds_read_b64_tr_b16 a[180:181], v8 offset:6144
ds_read_b64_tr_b16 a[182:183], v8 offset:6656
v_rcp_f32 v144, v144
v_accvgpr_read_b32 v156, a252
s_waitcnt lgkmcnt(6)
v_mfma_f32_32x32x16_bf16 v[208:223], a[168:171], a[136:139], v[208:223]
ds_read_b64_tr_b16 a[184:185], v9 offset:6144
ds_read_b64_tr_b16 a[186:187], v9 offset:6656
v_mul_f32 v142, v142, v134
v_exp_f32 v149, v149
s_waitcnt lgkmcnt(6)
v_mfma_f32_32x32x16_bf16 v[224:239], a[172:175], a[136:139], v[224:239]
ds_read_b64_tr_b16 a[188:189], v10 offset:6144
ds_read_b64_tr_b16 a[190:191], v10 offset:6656
v_mul_f32 v151, v93, v151
v_fma_f32 v147, v147, v94, v94
s_waitcnt lgkmcnt(6)
v_mfma_f32_32x32x16_bf16 v[176:191], a[176:179], a[140:143], v[176:191]
ds_read_b64_tr_b16 a[160:161], v7 offset:16384
ds_read_b64_tr_b16 a[162:163], v7 offset:16896
v_rcp_f32 v145, v145
v_accvgpr_read_b32 v157, a253
s_waitcnt lgkmcnt(6)
v_mfma_f32_32x32x16_bf16 v[192:207], a[180:183], a[140:143], v[192:207]
ds_read_b64_tr_b16 a[164:165], v8 offset:16384
ds_read_b64_tr_b16 a[166:167], v8 offset:16896
v_mul_f32 v143, v143, v135
v_cvt_pk_bf16_f32 v131, v142, v143
s_waitcnt lgkmcnt(6)
v_mfma_f32_32x32x16_bf16 v[208:223], a[184:187], a[140:143], v[208:223]
ds_read_b64_tr_b16 a[168:169], v9 offset:16384
ds_read_b64_tr_b16 a[170:171], v9 offset:16896
buffer_store_dwordx4 v[128:131], v25, s[16:19], s47 offen offset:0 sc1
v_exp_f32 v150, v150
s_waitcnt lgkmcnt(6)
v_mfma_f32_32x32x16_bf16 v[224:239], a[188:191], a[140:143], v[224:239]
ds_read_b64_tr_b16 a[172:173], v10 offset:16384
ds_read_b64_tr_b16 a[174:175], v10 offset:16896
v_fma_f32 v148, v148, v94, v94
v_rcp_f32 v146, v146
s_waitcnt lgkmcnt(6)
v_mfma_f32_32x32x16_bf16 v[176:191], a[160:163], a[144:147], v[176:191]
ds_read_b64_tr_b16 a[176:177], v7 offset:18432
ds_read_b64_tr_b16 a[178:179], v7 offset:18944
v_accvgpr_read_b32 v158, a254
v_mul_f32 v152, v152, v144
s_waitcnt lgkmcnt(6)
v_mfma_f32_32x32x16_bf16 v[192:207], a[164:167], a[144:147], v[192:207]
ds_read_b64_tr_b16 a[180:181], v8 offset:18432
ds_read_b64_tr_b16 a[182:183], v8 offset:18944
v_exp_f32 v151, v151
v_fma_f32 v149, v149, v94, v94
s_waitcnt lgkmcnt(6)
v_mfma_f32_32x32x16_bf16 v[208:223], a[168:171], a[144:147], v[208:223]
ds_read_b64_tr_b16 a[184:185], v9 offset:18432
ds_read_b64_tr_b16 a[186:187], v9 offset:18944
v_rcp_f32 v147, v147
v_accvgpr_read_b32 v159, a255
s_waitcnt lgkmcnt(6)
v_mfma_f32_32x32x16_bf16 v[224:239], a[172:175], a[144:147], v[224:239]
ds_read_b64_tr_b16 a[188:189], v10 offset:18432
ds_read_b64_tr_b16 a[190:191], v10 offset:18944
v_mul_f32 v153, v153, v145
v_cvt_pk_bf16_f32 v144, v152, v153
s_waitcnt lgkmcnt(6)
v_mfma_f32_32x32x16_bf16 v[176:191], a[176:179], a[148:151], v[176:191]
ds_read_b64_tr_b16 a[160:161], v7 offset:20480
ds_read_b64_tr_b16 a[162:163], v7 offset:20992
v_fma_f32 v150, v150, v94, v94
v_rcp_f32 v148, v148
s_waitcnt lgkmcnt(6)
v_mfma_f32_32x32x16_bf16 v[192:207], a[180:183], a[148:151], v[192:207]
ds_read_b64_tr_b16 a[164:165], v8 offset:20480
ds_read_b64_tr_b16 a[166:167], v8 offset:20992
v_mul_f32 v154, v154, v146
v_fma_f32 v151, v151, v94, v94
s_waitcnt lgkmcnt(6)
v_mfma_f32_32x32x16_bf16 v[208:223], a[184:187], a[148:151], v[208:223]
ds_read_b64_tr_b16 a[168:169], v9 offset:20480
ds_read_b64_tr_b16 a[170:171], v9 offset:20992
v_rcp_f32 v149, v149
v_mul_f32 v155, v155, v147
s_waitcnt lgkmcnt(6)
v_mfma_f32_32x32x16_bf16 v[224:239], a[188:191], a[148:151], v[224:239]
ds_read_b64_tr_b16 a[172:173], v10 offset:20480
ds_read_b64_tr_b16 a[174:175], v10 offset:20992
v_cvt_pk_bf16_f32 v145, v154, v155
v_rcp_f32 v150, v150
s_waitcnt lgkmcnt(6)
v_mfma_f32_32x32x16_bf16 v[176:191], a[160:163], a[152:155], v[176:191]
ds_read_b64_tr_b16 a[176:177], v7 offset:22528
ds_read_b64_tr_b16 a[178:179], v7 offset:23040
v_mul_f32 v156, v156, v148
v_rcp_f32 v151, v151
s_waitcnt lgkmcnt(6)
v_mfma_f32_32x32x16_bf16 v[192:207], a[164:167], a[152:155], v[192:207]
ds_read_b64_tr_b16 a[180:181], v8 offset:22528
ds_read_b64_tr_b16 a[182:183], v8 offset:23040
v_mul_f32 v157, v157, v149
v_cvt_pk_bf16_f32 v146, v156, v157
s_waitcnt lgkmcnt(6)
v_mfma_f32_32x32x16_bf16 v[208:223], a[168:171], a[152:155], v[208:223]
ds_read_b64_tr_b16 a[184:185], v9 offset:22528
ds_read_b64_tr_b16 a[186:187], v9 offset:23040
v_mul_f32 v158, v158, v150
v_mul_f32 v159, v159, v151
s_waitcnt lgkmcnt(6)
v_mfma_f32_32x32x16_bf16 v[224:239], a[172:175], a[152:155], v[224:239]
ds_read_b64_tr_b16 a[188:189], v10 offset:22528
ds_read_b64_tr_b16 a[190:191], v10 offset:23040
v_cvt_pk_bf16_f32 v147, v158, v159
buffer_store_dwordx4 v[144:147], v25, s[16:19], s47 offen offset:512 sc1
s_waitcnt lgkmcnt(6)
v_mfma_f32_32x32x16_bf16 v[176:191], a[176:179], a[156:159], v[176:191]
s_waitcnt lgkmcnt(4)
v_mfma_f32_32x32x16_bf16 v[192:207], a[180:183], a[156:159], v[192:207]
s_waitcnt lgkmcnt(2)
v_mfma_f32_32x32x16_bf16 v[208:223], a[184:187], a[156:159], v[208:223]
s_waitcnt lgkmcnt(0)
v_mfma_f32_32x32x16_bf16 v[224:239], a[188:191], a[156:159], v[224:239]
s_nop 5
v_mul_f32 v176, v93, v176
v_mul_f32 v177, v93, v177
v_exp_f32 v176, v176
v_mul_f32 v178, v93, v178
v_exp_f32 v177, v177
v_mul_f32 v179, v93, v179
v_exp_f32 v178, v178
v_mul_f32 v180, v93, v180
v_fma_f32 v176, v176, v94, v94
v_exp_f32 v179, v179
v_mul_f32 v181, v93, v181
v_fma_f32 v177, v177, v94, v94
v_exp_f32 v180, v180
v_mul_f32 v182, v93, v182
v_fma_f32 v178, v178, v94, v94
v_rcp_f32 v176, v176
v_exp_f32 v181, v181
v_mul_f32 v183, v93, v183
v_fma_f32 v179, v179, v94, v94
v_rcp_f32 v177, v177
v_exp_f32 v182, v182
v_mul_f32 v192, v93, v192
v_fma_f32 v180, v180, v94, v94
v_rcp_f32 v178, v178
v_mul_f32 v184, v184, v176
v_exp_f32 v183, v183
v_mul_f32 v193, v93, v193
v_fma_f32 v181, v181, v94, v94
v_rcp_f32 v179, v179
v_mul_f32 v185, v185, v177
v_cvt_pk_bf16_f32 v176, v184, v185
v_exp_f32 v192, v192
v_mul_f32 v194, v93, v194
v_fma_f32 v182, v182, v94, v94
v_rcp_f32 v180, v180
v_mul_f32 v186, v186, v178
v_exp_f32 v193, v193
v_mul_f32 v195, v93, v195
v_fma_f32 v183, v183, v94, v94
v_rcp_f32 v181, v181
v_mul_f32 v187, v187, v179
v_cvt_pk_bf16_f32 v177, v186, v187
v_exp_f32 v194, v194
v_mul_f32 v196, v93, v196
v_fma_f32 v192, v192, v94, v94
v_rcp_f32 v182, v182
v_mul_f32 v188, v188, v180
v_exp_f32 v195, v195
v_mul_f32 v197, v93, v197
v_fma_f32 v193, v193, v94, v94
v_rcp_f32 v183, v183
v_mul_f32 v189, v189, v181
v_cvt_pk_bf16_f32 v178, v188, v189
v_exp_f32 v196, v196
v_mul_f32 v198, v93, v198
v_fma_f32 v194, v194, v94, v94
v_rcp_f32 v192, v192
v_mul_f32 v190, v190, v182
v_exp_f32 v197, v197
v_mul_f32 v199, v93, v199
v_fma_f32 v195, v195, v94, v94
v_rcp_f32 v193, v193
v_mul_f32 v191, v191, v183
v_cvt_pk_bf16_f32 v179, v190, v191
buffer_store_dwordx4 v[176:179], v25, s[16:19], s50 offen offset:0 sc1
v_exp_f32 v198, v198
v_mul_f32 v208, v93, v208
v_fma_f32 v196, v196, v94, v94
v_rcp_f32 v194, v194
v_mul_f32 v200, v200, v192
v_exp_f32 v199, v199
v_mul_f32 v209, v93, v209
v_fma_f32 v197, v197, v94, v94
v_rcp_f32 v195, v195
v_mul_f32 v201, v201, v193
v_cvt_pk_bf16_f32 v192, v200, v201
v_exp_f32 v208, v208
v_mul_f32 v210, v93, v210
v_fma_f32 v198, v198, v94, v94
v_rcp_f32 v196, v196
v_mul_f32 v202, v202, v194
v_exp_f32 v209, v209
v_mul_f32 v211, v93, v211
v_fma_f32 v199, v199, v94, v94
v_rcp_f32 v197, v197
v_mul_f32 v203, v203, v195
v_cvt_pk_bf16_f32 v193, v202, v203
v_exp_f32 v210, v210
v_mul_f32 v212, v93, v212
v_fma_f32 v208, v208, v94, v94
v_rcp_f32 v198, v198
v_mul_f32 v204, v204, v196
v_exp_f32 v211, v211
v_mul_f32 v213, v93, v213
v_fma_f32 v209, v209, v94, v94
v_rcp_f32 v199, v199
v_mul_f32 v205, v205, v197
v_cvt_pk_bf16_f32 v194, v204, v205
v_exp_f32 v212, v212
v_mul_f32 v214, v93, v214
v_fma_f32 v210, v210, v94, v94
v_rcp_f32 v208, v208
v_mul_f32 v206, v206, v198
v_exp_f32 v213, v213
v_mul_f32 v215, v93, v215
v_fma_f32 v211, v211, v94, v94
v_rcp_f32 v209, v209
v_mul_f32 v207, v207, v199
v_cvt_pk_bf16_f32 v195, v206, v207
buffer_store_dwordx4 v[192:195], v25, s[16:19], s50 offen offset:512 sc1
v_exp_f32 v214, v214
v_mul_f32 v224, v93, v224
v_fma_f32 v212, v212, v94, v94
v_rcp_f32 v210, v210
v_mul_f32 v216, v216, v208
v_exp_f32 v215, v215
v_mul_f32 v225, v93, v225
v_fma_f32 v213, v213, v94, v94
v_rcp_f32 v211, v211
v_mul_f32 v217, v217, v209
v_cvt_pk_bf16_f32 v208, v216, v217
v_exp_f32 v224, v224
v_mul_f32 v226, v93, v226
v_fma_f32 v214, v214, v94, v94
v_rcp_f32 v212, v212
v_mul_f32 v218, v218, v210
v_exp_f32 v225, v225
v_mul_f32 v227, v93, v227
v_fma_f32 v215, v215, v94, v94
v_rcp_f32 v213, v213
v_mul_f32 v219, v219, v211
v_cvt_pk_bf16_f32 v209, v218, v219
v_exp_f32 v226, v226
v_mul_f32 v228, v93, v228
v_fma_f32 v224, v224, v94, v94
v_rcp_f32 v214, v214
v_mul_f32 v220, v220, v212
v_exp_f32 v227, v227
v_mul_f32 v229, v93, v229
v_fma_f32 v225, v225, v94, v94
v_rcp_f32 v215, v215
v_mul_f32 v221, v221, v213
v_cvt_pk_bf16_f32 v210, v220, v221
v_exp_f32 v228, v228
v_mul_f32 v230, v93, v230
v_fma_f32 v226, v226, v94, v94
v_rcp_f32 v224, v224
v_mul_f32 v222, v222, v214
v_exp_f32 v229, v229
v_mul_f32 v231, v93, v231
v_fma_f32 v227, v227, v94, v94
v_rcp_f32 v225, v225
v_mul_f32 v223, v223, v215
v_cvt_pk_bf16_f32 v211, v222, v223
buffer_store_dwordx4 v[208:211], v25, s[16:19], s51 offen offset:0 sc1
v_exp_f32 v230, v230
v_fma_f32 v228, v228, v94, v94
v_rcp_f32 v226, v226
v_mul_f32 v232, v232, v224
v_exp_f32 v231, v231
v_fma_f32 v229, v229, v94, v94
v_rcp_f32 v227, v227
v_mul_f32 v233, v233, v225
v_cvt_pk_bf16_f32 v224, v232, v233
v_fma_f32 v230, v230, v94, v94
v_rcp_f32 v228, v228
v_mul_f32 v234, v234, v226
v_fma_f32 v231, v231, v94, v94
v_rcp_f32 v229, v229
v_mul_f32 v235, v235, v227
v_cvt_pk_bf16_f32 v225, v234, v235
v_rcp_f32 v230, v230
v_mul_f32 v236, v236, v228
v_rcp_f32 v231, v231
v_mul_f32 v237, v237, v229
v_cvt_pk_bf16_f32 v226, v236, v237
v_mul_f32 v238, v238, v230
v_mul_f32 v239, v239, v231
v_cvt_pk_bf16_f32 v227, v238, v239
buffer_store_dwordx4 v[224:227], v25, s[16:19], s51 offen offset:512 sc1
s_endpgm
K1_SPIN_Q:
buffer_load_dword v46, v47, s[52:55], 0 offen sc0 sc1
s_waitcnt vmcnt(0)
v_and_b32 v46, v46, v67
v_cmp_ne_u32 vcc, v46, v67
s_nop 4
s_cbranch_vccnz K1_SPIN_Q
s_branch K1_GO_Q

K1_SPIN_V:
buffer_load_dword v46, v47, s[52:55], 0 offen sc0 sc1
s_waitcnt vmcnt(0)
v_and_b32 v46, v46, v67
v_cmp_ne_u32 vcc, v46, v67
s_nop 4
s_cbranch_vccnz K1_SPIN_V
s_branch K1_GO_V

K1_SPIN_G:
buffer_load_dword v46, v47, s[52:55], 0 offen sc0 sc1
s_waitcnt vmcnt(0)
v_and_b32 v46, v46, v67
v_cmp_ne_u32 vcc, v46, v67
s_nop 4
s_cbranch_vccnz K1_SPIN_G
s_branch K1_GO_G

K1_SPARE:
s_nop 4
s_waitcnt lgkmcnt(0)
s_mov_b32 s16, s4
s_and_b32 s17, s5, 0xffff
s_mov_b32 s18, 33554432
s_mov_b32 s19, 0x20000
s_mov_b32 s8, s36
s_and_b32 s9, s37, 0xffff
s_mov_b32 s10, 2621440
s_mov_b32 s11, 0x20000
s_mov_b32 s52, s48
s_and_b32 s53, s49, 0xffff
s_mov_b32 s54, 256
s_mov_b32 s55, 0x20000
s_load_dwordx2 s[60:61], s[0:1], 16
s_load_dwordx2 s[62:63], s[0:1], 48
v_and_b32 v1, 63, v0
v_lshrrev_b32 v32, 6, v0
s_nop 0
v_readfirstlane_b32 s20, v32
s_lshl_b32 s28, s21, 7
s_lshl_b32 s29, s22, 3
s_add_u32 s28, s28, s29
s_nop 0
s_lshl_b32 s29, s20, 1
s_add_u32 s28, s28, s29
v_lshrrev_b32 v238, 5, v1
v_add_u32 v238, s28, v238
v_and_b32 v237, 31, v1
v_lshlrev_b32 v237, 3, v237
v_mul_u32_u24 v235, 1280, v238
v_add_u32 v237, v237, v235
buffer_load_dwordx2 v[176:177], v237, s[8:11], 0 offen offset:0
buffer_load_dwordx2 v[178:179], v237, s[8:11], 0 offen offset:256
buffer_load_dwordx2 v[180:181], v237, s[8:11], 0 offen offset:512
buffer_load_dwordx2 v[182:183], v237, s[8:11], 0 offen offset:768
buffer_load_dwordx2 v[184:185], v237, s[8:11], 0 offen offset:1024
s_waitcnt vmcnt(4)
v_lshlrev_b32 v240, 16, v176
v_and_b32 v241, 0xffff0000, v176
v_lshlrev_b32 v242, 16, v177
v_and_b32 v243, 0xffff0000, v177
s_waitcnt vmcnt(3)
v_lshlrev_b32 v244, 16, v178
v_and_b32 v245, 0xffff0000, v178
v_lshlrev_b32 v246, 16, v179
v_and_b32 v247, 0xffff0000, v179
s_waitcnt vmcnt(2)
v_lshlrev_b32 v248, 16, v180
v_and_b32 v249, 0xffff0000, v180
v_add_f32 v250, v240, v241
v_mul_f32 v251, v240, v240
v_fmac_f32 v251, v241, v241
v_add_f32 v250, v250, v242
v_fmac_f32 v251, v242, v242
v_add_f32 v250, v250, v243
v_fmac_f32 v251, v243, v243
v_add_f32 v250, v250, v244
v_fmac_f32 v251, v244, v244
v_add_f32 v250, v250, v245
v_fmac_f32 v251, v245, v245
v_add_f32 v250, v250, v246
v_fmac_f32 v251, v246, v246
v_add_f32 v250, v250, v247
v_fmac_f32 v251, v247, v247
v_add_f32 v250, v250, v248
v_fmac_f32 v251, v248, v248
v_add_f32 v250, v250, v249
v_fmac_f32 v251, v249, v249
v_lshlrev_b32 v240, 16, v181
v_and_b32 v241, 0xffff0000, v181
s_waitcnt vmcnt(1)
v_lshlrev_b32 v242, 16, v182
v_and_b32 v243, 0xffff0000, v182
v_lshlrev_b32 v244, 16, v183
v_and_b32 v245, 0xffff0000, v183
s_waitcnt vmcnt(0)
v_lshlrev_b32 v246, 16, v184
v_and_b32 v247, 0xffff0000, v184
v_lshlrev_b32 v248, 16, v185
v_and_b32 v249, 0xffff0000, v185
v_add_f32 v250, v250, v240
v_fmac_f32 v251, v240, v240
v_add_f32 v250, v250, v241
v_fmac_f32 v251, v241, v241
v_add_f32 v250, v250, v242
v_fmac_f32 v251, v242, v242
v_add_f32 v250, v250, v243
v_fmac_f32 v251, v243, v243
v_add_f32 v250, v250, v244
v_fmac_f32 v251, v244, v244
v_add_f32 v250, v250, v245
v_fmac_f32 v251, v245, v245
v_add_f32 v250, v250, v246
v_fmac_f32 v251, v246, v246
v_add_f32 v250, v250, v247
v_fmac_f32 v251, v247, v247
v_add_f32 v250, v250, v248
v_fmac_f32 v251, v248, v248
v_add_f32 v250, v250, v249
v_fmac_f32 v251, v249, v249
s_nop 0
v_add_f32_dpp v250, v250, v250 row_ror:8 row_mask:0xf bank_mask:0xf
v_add_f32_dpp v251, v251, v251 row_ror:8 row_mask:0xf bank_mask:0xf
s_nop 0
v_add_f32_dpp v250, v250, v250 row_ror:4 row_mask:0xf bank_mask:0xf
v_add_f32_dpp v251, v251, v251 row_ror:4 row_mask:0xf bank_mask:0xf
s_nop 0
v_add_f32_dpp v250, v250, v250 row_ror:2 row_mask:0xf bank_mask:0xf
v_add_f32_dpp v251, v251, v251 row_ror:2 row_mask:0xf bank_mask:0xf
s_nop 0
v_add_f32_dpp v250, v250, v250 row_ror:1 row_mask:0xf bank_mask:0xf
v_add_f32_dpp v251, v251, v251 row_ror:1 row_mask:0xf bank_mask:0xf
ds_swizzle_b32 v252, v250 offset:16415
ds_swizzle_b32 v253, v251 offset:16415
v_and_b32 v254, 31, v1
v_cmp_eq_u32 vcc, 0, v254
v_mov_b32 v254, 2147483648
v_lshlrev_b32 v235, 4, v238
v_add_u32 v235, 30539776, v235
v_cndmask_b32 v235, v254, v235, vcc
v_lshlrev_b32 v236, 2, v238
v_add_u32 v236, 30605312, v236
v_cndmask_b32 v236, v254, v236, vcc
s_waitcnt lgkmcnt(0)
v_add_f32 v250, v250, v252
v_add_f32 v251, v251, v253
v_mul_f32 v240, 0xbacccccd, v250
v_mul_f32 v252, v240, v240
v_mov_b32 v253, 0x3acccccd
v_fma_f32 v252, v251, v253, -v252
v_max_f32 v252, 0, v252
v_add_f32 v252, 0x3727c5ac, v252
v_rsq_f32 v241, v252
v_sqrt_f32 v242, v252
v_mov_b32 v243, 0
buffer_store_dwordx4 v[240:243], v235, s[16:19], 0 offen sc1
buffer_store_dword v241, v236, s[16:19], 0 offen sc1
s_lshl_b32 s33, s22, 4
s_add_u32 s33, s33, s21
v_mov_b32 v32, s33
v_mov_b32 v33, 2147483648
v_cmp_eq_u32 vcc, 0, v0
s_nop 1
v_cndmask_b32 v234, v33, v32, vcc
v_mov_b32 v75, 1
v_lshlrev_b32 v32, 4, v0
s_lshl_b32 s28, s21, 8
s_add_u32 s28, s28, 31457280
v_add_u32 v32, s28, v32
v_mov_b32 v33, 2147483648
v_cmp_gt_u32 vcc, 16, v0
s_nop 1
v_cndmask_b32 v32, v33, v32, vcc
v_mov_b32 v36, 0
v_mov_b32 v37, 0
v_mov_b32 v38, 0
v_mov_b32 v39, 0
buffer_store_dwordx4 v[36:39], v32, s[16:19], 0 offen sc1
s_waitcnt lgkmcnt(0)
s_mov_b32 s64, s60
s_and_b32 s65, s61, 0xffff
s_mov_b32 s66, 819200
s_mov_b32 s67, 0x20000
s_mov_b32 s68, s62
s_and_b32 s69, s63, 0xffff
s_mov_b32 s70, 2211840
s_mov_b32 s71, 0x20000
s_mul_i32 s28, s20, 640
v_add_u32 v32, s28, v1
v_lshlrev_b32 v40, 4, v32
v_mul_u32_u24 v33, 52429, v32
v_lshrrev_b32 v33, 22, v33
v_mul_u32_u24 v34, 80, v33
v_sub_u32 v34, v32, v34
v_lshrrev_b32 v35, 3, v33
v_and_b32 v36, 3, v33
v_bfe_u32 v37, v33, 2, 1
v_lshrrev_b32 v38, 1, v35
v_mul_u32_u24 v38, 20, v38
v_and_b32 v39, 1, v35
v_lshl_add_u32 v38, v39, 2, v38
v_add_u32 v38, v38, v36
v_lshl_add_u32 v38, v37, 3, v38
v_mul_u32_u24 v38, 1280, v38
v_lshl_add_u32 v50, v34, 4, v38
v_mul_u32_u24 v38, 40, v35
v_mul_u32_u24 v39, 20, v37
v_add_u32 v38, v38, v39
v_add_u32 v38, v38, v36
v_add_u32 v38, 16, v38
v_mul_u32_u24 v38, 1280, v38
v_lshl_add_u32 v60, v34, 4, v38
v_add_u32 v32, s28, v1
v_add_u32 v32, 64, v32
v_lshlrev_b32 v41, 4, v32
v_mul_u32_u24 v33, 52429, v32
v_lshrrev_b32 v33, 22, v33
v_mul_u32_u24 v34, 80, v33
v_sub_u32 v34, v32, v34
v_lshrrev_b32 v35, 3, v33
v_and_b32 v36, 3, v33
v_bfe_u32 v37, v33, 2, 1
v_lshrrev_b32 v38, 1, v35
v_mul_u32_u24 v38, 20, v38
v_and_b32 v39, 1, v35
v_lshl_add_u32 v38, v39, 2, v38
v_add_u32 v38, v38, v36
v_lshl_add_u32 v38, v37, 3, v38
v_mul_u32_u24 v38, 1280, v38
v_lshl_add_u32 v51, v34, 4, v38
v_mul_u32_u24 v38, 40, v35
v_mul_u32_u24 v39, 20, v37
v_add_u32 v38, v38, v39
v_add_u32 v38, v38, v36
v_add_u32 v38, 16, v38
v_mul_u32_u24 v38, 1280, v38
v_lshl_add_u32 v61, v34, 4, v38
v_subrev_u32 v41, 1024, v41
v_subrev_u32 v51, 1024, v51
v_subrev_u32 v61, 1024, v61
v_add_u32 v32, s28, v1
v_add_u32 v32, 128, v32
v_lshlrev_b32 v42, 4, v32
v_mul_u32_u24 v33, 52429, v32
v_lshrrev_b32 v33, 22, v33
v_mul_u32_u24 v34, 80, v33
v_sub_u32 v34, v32, v34
v_lshrrev_b32 v35, 3, v33
v_and_b32 v36, 3, v33
v_bfe_u32 v37, v33, 2, 1
v_lshrrev_b32 v38, 1, v35
v_mul_u32_u24 v38, 20, v38
v_and_b32 v39, 1, v35
v_lshl_add_u32 v38, v39, 2, v38
v_add_u32 v38, v38, v36
v_lshl_add_u32 v38, v37, 3, v38
v_mul_u32_u24 v38, 1280, v38
v_lshl_add_u32 v52, v34, 4, v38
v_mul_u32_u24 v38, 40, v35
v_mul_u32_u24 v39, 20, v37
v_add_u32 v38, v38, v39
v_add_u32 v38, v38, v36
v_add_u32 v38, 16, v38
v_mul_u32_u24 v38, 1280, v38
v_lshl_add_u32 v62, v34, 4, v38
v_subrev_u32 v42, 2048, v42
v_subrev_u32 v52, 2048, v52
v_subrev_u32 v62, 2048, v62
v_add_u32 v32, s28, v1
v_add_u32 v32, 192, v32
v_lshlrev_b32 v43, 4, v32
v_mul_u32_u24 v33, 52429, v32
v_lshrrev_b32 v33, 22, v33
v_mul_u32_u24 v34, 80, v33
v_sub_u32 v34, v32, v34
v_lshrrev_b32 v35, 3, v33
v_and_b32 v36, 3, v33
v_bfe_u32 v37, v33, 2, 1
v_lshrrev_b32 v38, 1, v35
v_mul_u32_u24 v38, 20, v38
v_and_b32 v39, 1, v35
v_lshl_add_u32 v38, v39, 2, v38
v_add_u32 v38, v38, v36
v_lshl_add_u32 v38, v37, 3, v38
v_mul_u32_u24 v38, 1280, v38
v_lshl_add_u32 v53, v34, 4, v38
v_mul_u32_u24 v38, 40, v35
v_mul_u32_u24 v39, 20, v37
v_add_u32 v38, v38, v39
v_add_u32 v38, v38, v36
v_add_u32 v38, 16, v38
v_mul_u32_u24 v38, 1280, v38
v_lshl_add_u32 v63, v34, 4, v38
v_subrev_u32 v43, 3072, v43
v_subrev_u32 v53, 3072, v53
v_subrev_u32 v63, 3072, v63
v_add_u32 v32, s28, v1
v_add_u32 v32, 256, v32
v_lshlrev_b32 v44, 4, v32
v_mul_u32_u24 v33, 52429, v32
v_lshrrev_b32 v33, 22, v33
v_mul_u32_u24 v34, 80, v33
v_sub_u32 v34, v32, v34
v_lshrrev_b32 v35, 3, v33
v_and_b32 v36, 3, v33
v_bfe_u32 v37, v33, 2, 1
v_lshrrev_b32 v38, 1, v35
v_mul_u32_u24 v38, 20, v38
v_and_b32 v39, 1, v35
v_lshl_add_u32 v38, v39, 2, v38
v_add_u32 v38, v38, v36
v_lshl_add_u32 v38, v37, 3, v38
v_mul_u32_u24 v38, 1280, v38
v_lshl_add_u32 v54, v34, 4, v38
v_mul_u32_u24 v38, 40, v35
v_mul_u32_u24 v39, 20, v37
v_add_u32 v38, v38, v39
v_add_u32 v38, v38, v36
v_add_u32 v38, 16, v38
v_mul_u32_u24 v38, 1280, v38
v_lshl_add_u32 v64, v34, 4, v38
v_add_u32 v32, s28, v1
v_add_u32 v32, 320, v32
v_lshlrev_b32 v45, 4, v32
v_mul_u32_u24 v33, 52429, v32
v_lshrrev_b32 v33, 22, v33
v_mul_u32_u24 v34, 80, v33
v_sub_u32 v34, v32, v34
v_lshrrev_b32 v35, 3, v33
v_and_b32 v36, 3, v33
v_bfe_u32 v37, v33, 2, 1
v_lshrrev_b32 v38, 1, v35
v_mul_u32_u24 v38, 20, v38
v_and_b32 v39, 1, v35
v_lshl_add_u32 v38, v39, 2, v38
v_add_u32 v38, v38, v36
v_lshl_add_u32 v38, v37, 3, v38
v_mul_u32_u24 v38, 1280, v38
v_lshl_add_u32 v55, v34, 4, v38
v_mul_u32_u24 v38, 40, v35
v_mul_u32_u24 v39, 20, v37
v_add_u32 v38, v38, v39
v_add_u32 v38, v38, v36
v_add_u32 v38, 16, v38
v_mul_u32_u24 v38, 1280, v38
v_lshl_add_u32 v65, v34, 4, v38
v_subrev_u32 v45, 1024, v45
v_subrev_u32 v55, 1024, v55
v_subrev_u32 v65, 1024, v65
v_add_u32 v32, s28, v1
v_add_u32 v32, 384, v32
v_lshlrev_b32 v46, 4, v32
v_mul_u32_u24 v33, 52429, v32
v_lshrrev_b32 v33, 22, v33
v_mul_u32_u24 v34, 80, v33
v_sub_u32 v34, v32, v34
v_lshrrev_b32 v35, 3, v33
v_and_b32 v36, 3, v33
v_bfe_u32 v37, v33, 2, 1
v_lshrrev_b32 v38, 1, v35
v_mul_u32_u24 v38, 20, v38
v_and_b32 v39, 1, v35
v_lshl_add_u32 v38, v39, 2, v38
v_add_u32 v38, v38, v36
v_lshl_add_u32 v38, v37, 3, v38
v_mul_u32_u24 v38, 1280, v38
v_lshl_add_u32 v56, v34, 4, v38
v_mul_u32_u24 v38, 40, v35
v_mul_u32_u24 v39, 20, v37
v_add_u32 v38, v38, v39
v_add_u32 v38, v38, v36
v_add_u32 v38, 16, v38
v_mul_u32_u24 v38, 1280, v38
v_lshl_add_u32 v66, v34, 4, v38
v_subrev_u32 v46, 2048, v46
v_subrev_u32 v56, 2048, v56
v_subrev_u32 v66, 2048, v66
v_add_u32 v32, s28, v1
v_add_u32 v32, 448, v32
v_lshlrev_b32 v47, 4, v32
v_mul_u32_u24 v33, 52429, v32
v_lshrrev_b32 v33, 22, v33
v_mul_u32_u24 v34, 80, v33
v_sub_u32 v34, v32, v34
v_lshrrev_b32 v35, 3, v33
v_and_b32 v36, 3, v33
v_bfe_u32 v37, v33, 2, 1
v_lshrrev_b32 v38, 1, v35
v_mul_u32_u24 v38, 20, v38
v_and_b32 v39, 1, v35
v_lshl_add_u32 v38, v39, 2, v38
v_add_u32 v38, v38, v36
v_lshl_add_u32 v38, v37, 3, v38
v_mul_u32_u24 v38, 1280, v38
v_lshl_add_u32 v57, v34, 4, v38
v_mul_u32_u24 v38, 40, v35
v_mul_u32_u24 v39, 20, v37
v_add_u32 v38, v38, v39
v_add_u32 v38, v38, v36
v_add_u32 v38, 16, v38
v_mul_u32_u24 v38, 1280, v38
v_lshl_add_u32 v67, v34, 4, v38
v_subrev_u32 v47, 3072, v47
v_subrev_u32 v57, 3072, v57
v_subrev_u32 v67, 3072, v67
v_add_u32 v32, s28, v1
v_add_u32 v32, 512, v32
v_lshlrev_b32 v48, 4, v32
v_mul_u32_u24 v33, 52429, v32
v_lshrrev_b32 v33, 22, v33
v_mul_u32_u24 v34, 80, v33
v_sub_u32 v34, v32, v34
v_lshrrev_b32 v35, 3, v33
v_and_b32 v36, 3, v33
v_bfe_u32 v37, v33, 2, 1
v_lshrrev_b32 v38, 1, v35
v_mul_u32_u24 v38, 20, v38
v_and_b32 v39, 1, v35
v_lshl_add_u32 v38, v39, 2, v38
v_add_u32 v38, v38, v36
v_lshl_add_u32 v38, v37, 3, v38
v_mul_u32_u24 v38, 1280, v38
v_lshl_add_u32 v58, v34, 4, v38
v_mul_u32_u24 v38, 40, v35
v_mul_u32_u24 v39, 20, v37
v_add_u32 v38, v38, v39
v_add_u32 v38, v38, v36
v_add_u32 v38, 16, v38
v_mul_u32_u24 v38, 1280, v38
v_lshl_add_u32 v68, v34, 4, v38
v_add_u32 v32, s28, v1
v_add_u32 v32, 576, v32
v_lshlrev_b32 v49, 4, v32
v_mul_u32_u24 v33, 52429, v32
v_lshrrev_b32 v33, 22, v33
v_mul_u32_u24 v34, 80, v33
v_sub_u32 v34, v32, v34
v_lshrrev_b32 v35, 3, v33
v_and_b32 v36, 3, v33
v_bfe_u32 v37, v33, 2, 1
v_lshrrev_b32 v38, 1, v35
v_mul_u32_u24 v38, 20, v38
v_and_b32 v39, 1, v35
v_lshl_add_u32 v38, v39, 2, v38
v_add_u32 v38, v38, v36
v_lshl_add_u32 v38, v37, 3, v38
v_mul_u32_u24 v38, 1280, v38
v_lshl_add_u32 v59, v34, 4, v38
v_mul_u32_u24 v38, 40, v35
v_mul_u32_u24 v39, 20, v37
v_add_u32 v38, v38, v39
v_add_u32 v38, v38, v36
v_add_u32 v38, 16, v38
v_mul_u32_u24 v38, 1280, v38
v_lshl_add_u32 v69, v34, 4, v38
v_subrev_u32 v49, 1024, v49
v_subrev_u32 v59, 1024, v59
v_subrev_u32 v69, 1024, v69
v_lshrrev_b32 v32, 4, v1
v_bfe_u32 v33, v1, 2, 2
v_lshl_add_u32 v32, v32, 3, v33
v_mul_u32_u24 v32, 1280, v32
v_and_b32 v33, 3, v1
v_lshl_add_u32 v32, v33, 3, v32
s_mul_i32 s28, s20, 320
v_add_u32 v70, s28, v32
v_add_u32 v71, 40960, v70
v_add_u32 v72, 81920, v70
v_add_u32 v73, 122880, v70
v_lshlrev_b32 v74, 4, v1
s_mul_i32 s25, s20, 10240
s_mul_i32 s42, s20, 757760
s_add_u32 s42, s42, 27262976
s_waitcnt vmcnt(1)
s_barrier
buffer_store_byte v75, v234, s[52:55], 0 offen sc1
s_nop 4
s_mul_i32 s43, s21, 51200
s_add_u32 m0, s25, 0
s_nop 0
buffer_load_dwordx4 v50, s[64:67], s43 offen offset:0 lds
buffer_load_dwordx4 v51, s[64:67], s43 offen offset:1024 lds
buffer_load_dwordx4 v52, s[64:67], s43 offen offset:2048 lds
buffer_load_dwordx4 v53, s[64:67], s43 offen offset:3072 lds
s_add_u32 m0, s25, 4096
s_nop 0
buffer_load_dwordx4 v54, s[64:67], s43 offen offset:0 lds
buffer_load_dwordx4 v55, s[64:67], s43 offen offset:1024 lds
buffer_load_dwordx4 v56, s[64:67], s43 offen offset:2048 lds
buffer_load_dwordx4 v57, s[64:67], s43 offen offset:3072 lds
s_add_u32 m0, s25, 8192
s_nop 0
buffer_load_dwordx4 v58, s[64:67], s43 offen offset:0 lds
buffer_load_dwordx4 v59, s[64:67], s43 offen offset:1024 lds
s_cmp_lt_u32 s21, 4
s_cbranch_scc1 K1_SP_C
s_sub_u32 s43, s21, 4
s_mul_i32 s43, s43, 40960
s_add_u32 m0, s25, 40960
s_nop 0
buffer_load_dwordx4 v40, s[68:71], s43 offen offset:0 lds
buffer_load_dwordx4 v41, s[68:71], s43 offen offset:1024 lds
buffer_load_dwordx4 v42, s[68:71], s43 offen offset:2048 lds
buffer_load_dwordx4 v43, s[68:71], s43 offen offset:3072 lds
s_add_u32 m0, s25, 45056
s_nop 0
buffer_load_dwordx4 v44, s[68:71], s43 offen offset:0 lds
buffer_load_dwordx4 v45, s[68:71], s43 offen offset:1024 lds
buffer_load_dwordx4 v46, s[68:71], s43 offen offset:2048 lds
buffer_load_dwordx4 v47, s[68:71], s43 offen offset:3072 lds
s_add_u32 m0, s25, 49152
s_nop 0
buffer_load_dwordx4 v48, s[68:71], s43 offen offset:0 lds
buffer_load_dwordx4 v49, s[68:71], s43 offen offset:1024 lds
s_branch K1_SP_D
K1_SP_C:
s_mul_i32 s43, s21, 204800
s_add_u32 m0, s25, 40960
s_nop 0
buffer_load_dwordx4 v60, s[64:67], s43 offen offset:0 lds
buffer_load_dwordx4 v61, s[64:67], s43 offen offset:1024 lds
buffer_load_dwordx4 v62, s[64:67], s43 offen offset:2048 lds
buffer_load_dwordx4 v63, s[64:67], s43 offen offset:3072 lds
s_add_u32 m0, s25, 45056
s_nop 0
buffer_load_dwordx4 v64, s[64:67], s43 offen offset:0 lds
buffer_load_dwordx4 v65, s[64:67], s43 offen offset:1024 lds
buffer_load_dwordx4 v66, s[64:67], s43 offen offset:2048 lds
buffer_load_dwordx4 v67, s[64:67], s43 offen offset:3072 lds
s_add_u32 m0, s25, 49152
s_nop 0
buffer_load_dwordx4 v68, s[64:67], s43 offen offset:0 lds
buffer_load_dwordx4 v69, s[64:67], s43 offen offset:1024 lds
K1_SP_D:
s_add_u32 s43, s21, 12
s_mul_i32 s43, s43, 40960
s_add_u32 m0, s25, 81920
s_nop 0
buffer_load_dwordx4 v40, s[68:71], s43 offen offset:0 lds
buffer_load_dwordx4 v41, s[68:71], s43 offen offset:1024 lds
buffer_load_dwordx4 v42, s[68:71], s43 offen offset:2048 lds
buffer_load_dwordx4 v43, s[68:71], s43 offen offset:3072 lds
s_add_u32 m0, s25, 86016
s_nop 0
buffer_load_dwordx4 v44, s[68:71], s43 offen offset:0 lds
buffer_load_dwordx4 v45, s[68:71], s43 offen offset:1024 lds
buffer_load_dwordx4 v46, s[68:71], s43 offen offset:2048 lds
buffer_load_dwordx4 v47, s[68:71], s43 offen offset:3072 lds
s_add_u32 m0, s25, 90112
s_nop 0
buffer_load_dwordx4 v48, s[68:71], s43 offen offset:0 lds
buffer_load_dwordx4 v49, s[68:71], s43 offen offset:1024 lds
s_add_u32 s43, s21, 28
s_mul_i32 s43, s43, 40960
s_add_u32 m0, s25, 122880
s_nop 0
buffer_load_dwordx4 v40, s[68:71], s43 offen offset:0 lds
buffer_load_dwordx4 v41, s[68:71], s43 offen offset:1024 lds
buffer_load_dwordx4 v42, s[68:71], s43 offen offset:2048 lds
buffer_load_dwordx4 v43, s[68:71], s43 offen offset:3072 lds
s_add_u32 m0, s25, 126976
s_nop 0
buffer_load_dwordx4 v44, s[68:71], s43 offen offset:0 lds
buffer_load_dwordx4 v45, s[68:71], s43 offen offset:1024 lds
buffer_load_dwordx4 v46, s[68:71], s43 offen offset:2048 lds
buffer_load_dwordx4 v47, s[68:71], s43 offen offset:3072 lds
s_add_u32 m0, s25, 131072
s_nop 0
buffer_load_dwordx4 v48, s[68:71], s43 offen offset:0 lds
buffer_load_dwordx4 v49, s[68:71], s43 offen offset:1024 lds
s_waitcnt vmcnt(30)
s_barrier
s_add_u32 s44, s21, 0
s_mul_i32 s44, s44, 5120
s_add_u32 s44, s44, s42
ds_read_b64_tr_b16 v[96:97], v70 offset:0
ds_read_b64_tr_b16 v[98:99], v70 offset:5120
ds_read_b64_tr_b16 v[100:101], v70 offset:32
ds_read_b64_tr_b16 v[102:103], v70 offset:5152
ds_read_b64_tr_b16 v[104:105], v70 offset:64
ds_read_b64_tr_b16 v[106:107], v70 offset:5184
ds_read_b64_tr_b16 v[108:109], v70 offset:96
ds_read_b64_tr_b16 v[110:111], v70 offset:5216
ds_read_b64_tr_b16 v[112:113], v70 offset:128
ds_read_b64_tr_b16 v[114:115], v70 offset:5248
ds_read_b64_tr_b16 v[116:117], v70 offset:160
ds_read_b64_tr_b16 v[118:119], v70 offset:5280
ds_read_b64_tr_b16 v[120:121], v70 offset:192
ds_read_b64_tr_b16 v[122:123], v70 offset:5312
ds_read_b64_tr_b16 v[124:125], v70 offset:224
ds_read_b64_tr_b16 v[126:127], v70 offset:5344
ds_read_b64_tr_b16 v[128:129], v70 offset:256
ds_read_b64_tr_b16 v[130:131], v70 offset:5376
ds_read_b64_tr_b16 v[132:133], v70 offset:288
ds_read_b64_tr_b16 v[134:135], v70 offset:5408
s_waitcnt lgkmcnt(0)
s_add_u32 s45, s44, 0
buffer_store_dwordx4 v[96:99], v74, s[16:19], s45 offen sc1
s_add_u32 s45, s44, 1024
buffer_store_dwordx4 v[100:103], v74, s[16:19], s45 offen sc1
s_add_u32 s45, s44, 2048
buffer_store_dwordx4 v[104:107], v74, s[16:19], s45 offen sc1
s_add_u32 s45, s44, 3072
buffer_store_dwordx4 v[108:111], v74, s[16:19], s45 offen sc1
s_add_u32 s45, s44, 4096
buffer_store_dwordx4 v[112:115], v74, s[16:19], s45 offen sc1
s_add_u32 s45, s44, 378880
buffer_store_dwordx4 v[116:119], v74, s[16:19], s45 offen sc1
s_add_u32 s45, s44, 379904
buffer_store_dwordx4 v[120:123], v74, s[16:19], s45 offen sc1
s_add_u32 s45, s44, 380928
buffer_store_dwordx4 v[124:127], v74, s[16:19], s45 offen sc1
s_add_u32 s45, s44, 381952
buffer_store_dwordx4 v[128:131], v74, s[16:19], s45 offen sc1
s_add_u32 s45, s44, 382976
buffer_store_dwordx4 v[132:135], v74, s[16:19], s45 offen sc1
s_cmp_ge_u32 s21, 10
s_cbranch_scc1 K1_SP_E
s_barrier
s_add_u32 s43, s21, 44
s_mul_i32 s43, s43, 40960
s_add_u32 m0, s25, 0
s_nop 0
buffer_load_dwordx4 v40, s[68:71], s43 offen offset:0 lds
buffer_load_dwordx4 v41, s[68:71], s43 offen offset:1024 lds
buffer_load_dwordx4 v42, s[68:71], s43 offen offset:2048 lds
buffer_load_dwordx4 v43, s[68:71], s43 offen offset:3072 lds
s_add_u32 m0, s25, 4096
s_nop 0
buffer_load_dwordx4 v44, s[68:71], s43 offen offset:0 lds
buffer_load_dwordx4 v45, s[68:71], s43 offen offset:1024 lds
buffer_load_dwordx4 v46, s[68:71], s43 offen offset:2048 lds
buffer_load_dwordx4 v47, s[68:71], s43 offen offset:3072 lds
s_add_u32 m0, s25, 8192
s_nop 0
buffer_load_dwordx4 v48, s[68:71], s43 offen offset:0 lds
buffer_load_dwordx4 v49, s[68:71], s43 offen offset:1024 lds
K1_SP_E:
s_waitcnt vmcnt(30)
s_barrier
s_add_u32 s44, s21, 16
s_mul_i32 s44, s44, 5120
s_add_u32 s44, s44, s42
ds_read_b64_tr_b16 v[96:97], v71 offset:0
ds_read_b64_tr_b16 v[98:99], v71 offset:5120
ds_read_b64_tr_b16 v[100:101], v71 offset:32
ds_read_b64_tr_b16 v[102:103], v71 offset:5152
ds_read_b64_tr_b16 v[104:105], v71 offset:64
ds_read_b64_tr_b16 v[106:107], v71 offset:5184
ds_read_b64_tr_b16 v[108:109], v71 offset:96
ds_read_b64_tr_b16 v[110:111], v71 offset:5216
ds_read_b64_tr_b16 v[112:113], v71 offset:128
ds_read_b64_tr_b16 v[114:115], v71 offset:5248
ds_read_b64_tr_b16 v[116:117], v71 offset:160
ds_read_b64_tr_b16 v[118:119], v71 offset:5280
ds_read_b64_tr_b16 v[120:121], v71 offset:192
ds_read_b64_tr_b16 v[122:123], v71 offset:5312
ds_read_b64_tr_b16 v[124:125], v71 offset:224
ds_read_b64_tr_b16 v[126:127], v71 offset:5344
ds_read_b64_tr_b16 v[128:129], v71 offset:256
ds_read_b64_tr_b16 v[130:131], v71 offset:5376
ds_read_b64_tr_b16 v[132:133], v71 offset:288
ds_read_b64_tr_b16 v[134:135], v71 offset:5408
s_waitcnt lgkmcnt(0)
s_add_u32 s45, s44, 0
buffer_store_dwordx4 v[96:99], v74, s[16:19], s45 offen sc1
s_add_u32 s45, s44, 1024
buffer_store_dwordx4 v[100:103], v74, s[16:19], s45 offen sc1
s_add_u32 s45, s44, 2048
buffer_store_dwordx4 v[104:107], v74, s[16:19], s45 offen sc1
s_add_u32 s45, s44, 3072
buffer_store_dwordx4 v[108:111], v74, s[16:19], s45 offen sc1
s_add_u32 s45, s44, 4096
buffer_store_dwordx4 v[112:115], v74, s[16:19], s45 offen sc1
s_add_u32 s45, s44, 378880
buffer_store_dwordx4 v[116:119], v74, s[16:19], s45 offen sc1
s_add_u32 s45, s44, 379904
buffer_store_dwordx4 v[120:123], v74, s[16:19], s45 offen sc1
s_add_u32 s45, s44, 380928
buffer_store_dwordx4 v[124:127], v74, s[16:19], s45 offen sc1
s_add_u32 s45, s44, 381952
buffer_store_dwordx4 v[128:131], v74, s[16:19], s45 offen sc1
s_add_u32 s45, s44, 382976
buffer_store_dwordx4 v[132:135], v74, s[16:19], s45 offen sc1
s_waitcnt vmcnt(30)
s_barrier
s_add_u32 s44, s21, 32
s_mul_i32 s44, s44, 5120
s_add_u32 s44, s44, s42
ds_read_b64_tr_b16 v[96:97], v72 offset:0
ds_read_b64_tr_b16 v[98:99], v72 offset:5120
ds_read_b64_tr_b16 v[100:101], v72 offset:32
ds_read_b64_tr_b16 v[102:103], v72 offset:5152
ds_read_b64_tr_b16 v[104:105], v72 offset:64
ds_read_b64_tr_b16 v[106:107], v72 offset:5184
ds_read_b64_tr_b16 v[108:109], v72 offset:96
ds_read_b64_tr_b16 v[110:111], v72 offset:5216
ds_read_b64_tr_b16 v[112:113], v72 offset:128
ds_read_b64_tr_b16 v[114:115], v72 offset:5248
ds_read_b64_tr_b16 v[116:117], v72 offset:160
ds_read_b64_tr_b16 v[118:119], v72 offset:5280
ds_read_b64_tr_b16 v[120:121], v72 offset:192
ds_read_b64_tr_b16 v[122:123], v72 offset:5312
ds_read_b64_tr_b16 v[124:125], v72 offset:224
ds_read_b64_tr_b16 v[126:127], v72 offset:5344
ds_read_b64_tr_b16 v[128:129], v72 offset:256
ds_read_b64_tr_b16 v[130:131], v72 offset:5376
ds_read_b64_tr_b16 v[132:133], v72 offset:288
ds_read_b64_tr_b16 v[134:135], v72 offset:5408
s_waitcnt lgkmcnt(0)
s_add_u32 s45, s44, 0
buffer_store_dwordx4 v[96:99], v74, s[16:19], s45 offen sc1
s_add_u32 s45, s44, 1024
buffer_store_dwordx4 v[100:103], v74, s[16:19], s45 offen sc1
s_add_u32 s45, s44, 2048
buffer_store_dwordx4 v[104:107], v74, s[16:19], s45 offen sc1
s_add_u32 s45, s44, 3072
buffer_store_dwordx4 v[108:111], v74, s[16:19], s45 offen sc1
s_add_u32 s45, s44, 4096
buffer_store_dwordx4 v[112:115], v74, s[16:19], s45 offen sc1
s_add_u32 s45, s44, 378880
buffer_store_dwordx4 v[116:119], v74, s[16:19], s45 offen sc1
s_add_u32 s45, s44, 379904
buffer_store_dwordx4 v[120:123], v74, s[16:19], s45 offen sc1
s_add_u32 s45, s44, 380928
buffer_store_dwordx4 v[124:127], v74, s[16:19], s45 offen sc1
s_add_u32 s45, s44, 381952
buffer_store_dwordx4 v[128:131], v74, s[16:19], s45 offen sc1
s_add_u32 s45, s44, 382976
buffer_store_dwordx4 v[132:135], v74, s[16:19], s45 offen sc1
s_waitcnt vmcnt(30)
s_barrier
s_add_u32 s44, s21, 48
s_mul_i32 s44, s44, 5120
s_add_u32 s44, s44, s42
ds_read_b64_tr_b16 v[96:97], v73 offset:0
ds_read_b64_tr_b16 v[98:99], v73 offset:5120
ds_read_b64_tr_b16 v[100:101], v73 offset:32
ds_read_b64_tr_b16 v[102:103], v73 offset:5152
ds_read_b64_tr_b16 v[104:105], v73 offset:64
ds_read_b64_tr_b16 v[106:107], v73 offset:5184
ds_read_b64_tr_b16 v[108:109], v73 offset:96
ds_read_b64_tr_b16 v[110:111], v73 offset:5216
ds_read_b64_tr_b16 v[112:113], v73 offset:128
ds_read_b64_tr_b16 v[114:115], v73 offset:5248
ds_read_b64_tr_b16 v[116:117], v73 offset:160
ds_read_b64_tr_b16 v[118:119], v73 offset:5280
ds_read_b64_tr_b16 v[120:121], v73 offset:192
ds_read_b64_tr_b16 v[122:123], v73 offset:5312
ds_read_b64_tr_b16 v[124:125], v73 offset:224
ds_read_b64_tr_b16 v[126:127], v73 offset:5344
ds_read_b64_tr_b16 v[128:129], v73 offset:256
ds_read_b64_tr_b16 v[130:131], v73 offset:5376
ds_read_b64_tr_b16 v[132:133], v73 offset:288
ds_read_b64_tr_b16 v[134:135], v73 offset:5408
s_waitcnt lgkmcnt(0)
s_add_u32 s45, s44, 0
buffer_store_dwordx4 v[96:99], v74, s[16:19], s45 offen sc1
s_add_u32 s45, s44, 1024
buffer_store_dwordx4 v[100:103], v74, s[16:19], s45 offen sc1
s_add_u32 s45, s44, 2048
buffer_store_dwordx4 v[104:107], v74, s[16:19], s45 offen sc1
s_add_u32 s45, s44, 3072
buffer_store_dwordx4 v[108:111], v74, s[16:19], s45 offen sc1
s_add_u32 s45, s44, 4096
buffer_store_dwordx4 v[112:115], v74, s[16:19], s45 offen sc1
s_add_u32 s45, s44, 378880
buffer_store_dwordx4 v[116:119], v74, s[16:19], s45 offen sc1
s_add_u32 s45, s44, 379904
buffer_store_dwordx4 v[120:123], v74, s[16:19], s45 offen sc1
s_add_u32 s45, s44, 380928
buffer_store_dwordx4 v[124:127], v74, s[16:19], s45 offen sc1
s_add_u32 s45, s44, 381952
buffer_store_dwordx4 v[128:131], v74, s[16:19], s45 offen sc1
s_add_u32 s45, s44, 382976
buffer_store_dwordx4 v[132:135], v74, s[16:19], s45 offen sc1
s_cmp_ge_u32 s21, 10
s_cbranch_scc1 K1_END
s_waitcnt vmcnt(30)
s_barrier
s_add_u32 s44, s21, 64
s_mul_i32 s44, s44, 5120
s_add_u32 s44, s44, s42
ds_read_b64_tr_b16 v[96:97], v70 offset:0
ds_read_b64_tr_b16 v[98:99], v70 offset:5120
ds_read_b64_tr_b16 v[100:101], v70 offset:32
ds_read_b64_tr_b16 v[102:103], v70 offset:5152
ds_read_b64_tr_b16 v[104:105], v70 offset:64
ds_read_b64_tr_b16 v[106:107], v70 offset:5184
ds_read_b64_tr_b16 v[108:109], v70 offset:96
ds_read_b64_tr_b16 v[110:111], v70 offset:5216
ds_read_b64_tr_b16 v[112:113], v70 offset:128
ds_read_b64_tr_b16 v[114:115], v70 offset:5248
ds_read_b64_tr_b16 v[116:117], v70 offset:160
ds_read_b64_tr_b16 v[118:119], v70 offset:5280
ds_read_b64_tr_b16 v[120:121], v70 offset:192
ds_read_b64_tr_b16 v[122:123], v70 offset:5312
ds_read_b64_tr_b16 v[124:125], v70 offset:224
ds_read_b64_tr_b16 v[126:127], v70 offset:5344
ds_read_b64_tr_b16 v[128:129], v70 offset:256
ds_read_b64_tr_b16 v[130:131], v70 offset:5376
ds_read_b64_tr_b16 v[132:133], v70 offset:288
ds_read_b64_tr_b16 v[134:135], v70 offset:5408
s_waitcnt lgkmcnt(0)
s_add_u32 s45, s44, 0
buffer_store_dwordx4 v[96:99], v74, s[16:19], s45 offen sc1
s_add_u32 s45, s44, 1024
buffer_store_dwordx4 v[100:103], v74, s[16:19], s45 offen sc1
s_add_u32 s45, s44, 2048
buffer_store_dwordx4 v[104:107], v74, s[16:19], s45 offen sc1
s_add_u32 s45, s44, 3072
buffer_store_dwordx4 v[108:111], v74, s[16:19], s45 offen sc1
s_add_u32 s45, s44, 4096
buffer_store_dwordx4 v[112:115], v74, s[16:19], s45 offen sc1
s_add_u32 s45, s44, 378880
buffer_store_dwordx4 v[116:119], v74, s[16:19], s45 offen sc1
s_add_u32 s45, s44, 379904
buffer_store_dwordx4 v[120:123], v74, s[16:19], s45 offen sc1
s_add_u32 s45, s44, 380928
buffer_store_dwordx4 v[124:127], v74, s[16:19], s45 offen sc1
s_add_u32 s45, s44, 381952
buffer_store_dwordx4 v[128:131], v74, s[16:19], s45 offen sc1
s_add_u32 s45, s44, 382976
buffer_store_dwordx4 v[132:135], v74, s[16:19], s45 offen sc1
s_endpgm
K1_END:
s_endpgm
.section .rodata,"a"
.p2align 6
.amdhsa_kernel k1_kernel
  .amdhsa_next_free_vgpr 512
  .amdhsa_next_free_sgpr 102
  .amdhsa_accum_offset 256
  .amdhsa_group_segment_fixed_size 0
  .amdhsa_kernarg_size 80
  .amdhsa_user_sgpr_count 2
  .amdhsa_user_sgpr_kernarg_segment_ptr 1
  .amdhsa_system_sgpr_workgroup_id_x 1
  .amdhsa_float_denorm_mode_32 3
.end_amdhsa_kernel

.text
.globl parallel_sum__sliding_block__glu_gated_glu__prompt_kernel
.p2align 8
.type parallel_sum__sliding_block__glu_gated_glu__prompt_kernel,@function
parallel_sum__sliding_block__glu_gated_glu__prompt_kernel:
s_cmp_ge_u32 s2, 256
s_cbranch_scc1 K23_END
s_load_dwordx2 s[4:5], s[0:1], 72
s_load_dwordx2 s[6:7], s[0:1], 0
s_load_dwordx2 s[82:83], s[0:1], 56
v_lshrrev_b32 v1, 6, v0
s_nop 0
v_readfirstlane_b32 s20, v1
s_and_b32 s36, s2, 7
s_lshr_b32 s37, s2, 3
s_and_b32 s38, s36, 3
s_lshl_b32 s38, s38, 3
s_and_b32 s39, s37, 7
s_add_u32 s27, s38, s39
s_lshr_b32 s38, s36, 2
s_lshl_b32 s38, s38, 2
s_lshr_b32 s39, s37, 3
s_add_u32 s28, s38, s39
s_cmp_ge_u32 s20, 4
s_cbranch_scc1 K23_ATT
v_and_b32 v252, 63, v0
v_lshlrev_b32 v1, 4, v252
v_add_u32 v2, 4096, v1
s_mul_i32 s32, s20, 14
s_cmp_eq_u32 s20, 3
s_cselect_b32 s33, 1, 0
s_sub_u32 s32, s32, s33
s_add_u32 s32, s32, 20
s_mul_i32 s34, s27, 74
s_mul_i32 s35, s28, 74
s_add_u32 s21, s34, s32
s_lshl_b32 s21, s21, 12
s_add_u32 s21, s21, 16777216
s_add_u32 s22, s35, s32
s_mul_i32 s22, s22, 5120
s_add_u32 s22, s22, 27262976
s_add_u32 s36, s20, 0
s_and_b32 s36, s36, 3
s_lshl_b32 s36, s36, 10
v_add_u32 v5, s36, v1
s_add_u32 s36, s20, 1
s_and_b32 s36, s36, 3
s_lshl_b32 s36, s36, 10
v_add_u32 v6, s36, v1
s_add_u32 s36, s20, 2
s_and_b32 s36, s36, 3
s_lshl_b32 s36, s36, 10
v_add_u32 v7, s36, v1
s_add_u32 s36, s20, 3
s_and_b32 s36, s36, 3
s_lshl_b32 s36, s36, 10
v_add_u32 v10, s36, v1
s_waitcnt lgkmcnt(0)
s_mov_b32 s8, s4
s_and_b32 s9, s5, 0xffff
s_mov_b32 s10, 33554432
s_mov_b32 s11, 0x20000
s_mov_b32 s12, s6
s_and_b32 s13, s7, 0xffff
s_mov_b32 s14, 2621440
s_mov_b32 s15, 0x20000
s_mov_b32 s16, s82
s_and_b32 s17, s83, 0xffff
s_mov_b32 s18, 2621440
s_mov_b32 s19, 0x20000
s_add_u32 s36, s21, 0
buffer_load_dwordx4 v[16:19], v5, s[8:11], s36 offen
buffer_load_dwordx4 v[20:23], v6, s[8:11], s36 offen
buffer_load_dwordx4 v[24:27], v7, s[8:11], s36 offen
buffer_load_dwordx4 v[28:31], v10, s[8:11], s36 offen
s_add_u32 s37, s22, 0
buffer_load_dwordx4 v[32:35], v1, s[8:11], s37 offen offset:0
buffer_load_dwordx4 v[36:39], v1, s[8:11], s37 offen offset:1024
buffer_load_dwordx4 v[40:43], v1, s[8:11], s37 offen offset:2048
buffer_load_dwordx4 v[44:47], v1, s[8:11], s37 offen offset:3072
buffer_load_dwordx4 v[48:51], v2, s[8:11], s37 offen
s_add_u32 s36, s21, 4096
buffer_load_dwordx4 v[52:55], v5, s[8:11], s36 offen
buffer_load_dwordx4 v[56:59], v6, s[8:11], s36 offen
buffer_load_dwordx4 v[60:63], v7, s[8:11], s36 offen
buffer_load_dwordx4 v[64:67], v10, s[8:11], s36 offen
s_add_u32 s37, s22, 5120
buffer_load_dwordx4 v[68:71], v1, s[8:11], s37 offen offset:0
buffer_load_dwordx4 v[72:75], v1, s[8:11], s37 offen offset:1024
buffer_load_dwordx4 v[76:79], v1, s[8:11], s37 offen offset:2048
buffer_load_dwordx4 v[80:83], v1, s[8:11], s37 offen offset:3072
buffer_load_dwordx4 v[84:87], v2, s[8:11], s37 offen
s_add_u32 s36, s21, 8192
buffer_load_dwordx4 v[88:91], v5, s[8:11], s36 offen
buffer_load_dwordx4 v[92:95], v6, s[8:11], s36 offen
buffer_load_dwordx4 v[96:99], v7, s[8:11], s36 offen
buffer_load_dwordx4 v[100:103], v10, s[8:11], s36 offen
s_add_u32 s37, s22, 10240
buffer_load_dwordx4 v[104:107], v1, s[8:11], s37 offen offset:0
buffer_load_dwordx4 v[108:111], v1, s[8:11], s37 offen offset:1024
buffer_load_dwordx4 v[112:115], v1, s[8:11], s37 offen offset:2048
buffer_load_dwordx4 v[116:119], v1, s[8:11], s37 offen offset:3072
buffer_load_dwordx4 v[120:123], v2, s[8:11], s37 offen
s_mul_i32 s32, s20, 5
s_add_u32 s23, s34, s32
s_lshl_b32 s23, s23, 12
s_add_u32 s23, s23, 16777216
s_add_u32 s24, s35, s32
s_mul_i32 s24, s24, 5120
s_add_u32 s24, s24, 27262976
s_cmp_lt_u32 s20, 2
s_cselect_b32 s32, 0, 2147483648
v_or_b32 v3, s32, v1
v_or_b32 v4, s32, v2
s_lshl_b32 s82, s27, 7
s_add_u32 s82, s82, 31457280
v_and_b32 v8, 31, v252
v_lshlrev_b32 v8, 2, v8
s_lshl_b32 s32, s27, 6
s_lshl_b32 s33, s20, 4
s_add_u32 s32, s32, s33
s_mul_i32 s32, s32, 1280
s_mul_i32 s33, s28, 160
s_add_u32 s32, s32, s33
v_and_b32 v248, 15, v252
v_mul_u32_u24 v248, 1280, v248
v_add_u32 v248, s32, v248
v_lshrrev_b32 v249, 4, v252
v_lshl_add_u32 v12, v249, 3, v248
v_and_b32 v250, 1, v249
v_lshrrev_b32 v249, 1, v249
v_lshl_add_u32 v248, v250, 5, v248
v_lshl_add_u32 v11, v249, 4, v248
s_mul_i32 s33, s20, 15360
v_add_u32 v13, s33, v1
s_sub_u32 s40, s20, 1
s_and_b32 s40, s40, 3
s_mul_i32 s40, s40, 15360
s_add_u32 s40, s40, 0
s_sub_u32 s41, s20, 2
s_and_b32 s41, s41, 3
s_mul_i32 s41, s41, 15360
s_add_u32 s41, s41, 5120
s_sub_u32 s42, s20, 3
s_and_b32 s42, s42, 3
s_mul_i32 s42, s42, 15360
s_add_u32 s42, s42, 10240
s_cmp_lt_u32 s20, 2
s_cselect_b32 s33, 0, 2147483648
v_or_b32 v252, s33, v5
v_or_b32 v253, s33, v6
v_or_b32 v254, s33, v7
v_or_b32 v255, s33, v10
buffer_load_dwordx2 v[240:241], v12, s[12:15], 0 offen offset:0
buffer_load_dwordx2 v[242:243], v12, s[12:15], 0 offen offset:32
buffer_load_dwordx2 v[244:245], v12, s[12:15], 0 offen offset:64
buffer_load_dwordx2 v[246:247], v12, s[12:15], 0 offen offset:96
buffer_load_dwordx2 v[248:249], v12, s[12:15], 0 offen offset:128
s_waitcnt vmcnt(27)
v_mfma_f32_16x16x32_bf16 v[160:163], v[32:35], v[16:19], 0
s_add_u32 s37, s22, 15360
buffer_load_dwordx4 v[140:143], v1, s[8:11], s37 offen offset:0
v_mfma_f32_16x16x32_bf16 v[164:167], v[32:35], v[20:23], 0
v_mfma_f32_16x16x32_bf16 v[168:171], v[32:35], v[24:27], 0
buffer_load_dwordx4 v[144:147], v1, s[8:11], s37 offen offset:1024
v_mfma_f32_16x16x32_bf16 v[172:175], v[32:35], v[28:31], 0
s_waitcnt vmcnt(28)
v_mfma_f32_16x16x32_bf16 v[176:179], v[36:39], v[16:19], 0
buffer_load_dwordx4 v[148:151], v1, s[8:11], s37 offen offset:2048
v_mfma_f32_16x16x32_bf16 v[180:183], v[36:39], v[20:23], 0
v_mfma_f32_16x16x32_bf16 v[184:187], v[36:39], v[24:27], 0
buffer_load_dwordx4 v[152:155], v1, s[8:11], s37 offen offset:3072
v_mfma_f32_16x16x32_bf16 v[188:191], v[36:39], v[28:31], 0
s_waitcnt vmcnt(29)
v_mfma_f32_16x16x32_bf16 v[192:195], v[40:43], v[16:19], 0
buffer_load_dwordx4 v[156:159], v2, s[8:11], s37 offen
v_mfma_f32_16x16x32_bf16 v[196:199], v[40:43], v[20:23], 0
v_mfma_f32_16x16x32_bf16 v[200:203], v[40:43], v[24:27], 0
s_add_u32 s36, s21, 12288
buffer_load_dwordx4 v[124:127], v5, s[8:11], s36 offen
v_mfma_f32_16x16x32_bf16 v[204:207], v[40:43], v[28:31], 0
s_waitcnt vmcnt(30)
v_mfma_f32_16x16x32_bf16 v[208:211], v[44:47], v[16:19], 0
buffer_load_dwordx4 v[128:131], v6, s[8:11], s36 offen
v_mfma_f32_16x16x32_bf16 v[212:215], v[44:47], v[20:23], 0
v_mfma_f32_16x16x32_bf16 v[216:219], v[44:47], v[24:27], 0
buffer_load_dwordx4 v[132:135], v7, s[8:11], s36 offen
v_mfma_f32_16x16x32_bf16 v[220:223], v[44:47], v[28:31], 0
s_waitcnt vmcnt(31)
v_mfma_f32_16x16x32_bf16 v[224:227], v[48:51], v[16:19], 0
buffer_load_dwordx4 v[136:139], v10, s[8:11], s36 offen
v_mfma_f32_16x16x32_bf16 v[228:231], v[48:51], v[20:23], 0
v_mfma_f32_16x16x32_bf16 v[232:235], v[48:51], v[24:27], 0
v_mfma_f32_16x16x32_bf16 v[236:239], v[48:51], v[28:31], 0
s_waitcnt vmcnt(27)
v_mfma_f32_16x16x32_bf16 v[160:163], v[68:71], v[52:55], v[160:163]
s_add_u32 s37, s22, 20480
buffer_load_dwordx4 v[32:35], v1, s[8:11], s37 offen offset:0
v_mfma_f32_16x16x32_bf16 v[164:167], v[68:71], v[56:59], v[164:167]
v_mfma_f32_16x16x32_bf16 v[168:171], v[68:71], v[60:63], v[168:171]
buffer_load_dwordx4 v[36:39], v1, s[8:11], s37 offen offset:1024
v_mfma_f32_16x16x32_bf16 v[172:175], v[68:71], v[64:67], v[172:175]
s_waitcnt vmcnt(28)
v_mfma_f32_16x16x32_bf16 v[176:179], v[72:75], v[52:55], v[176:179]
buffer_load_dwordx4 v[40:43], v1, s[8:11], s37 offen offset:2048
v_mfma_f32_16x16x32_bf16 v[180:183], v[72:75], v[56:59], v[180:183]
v_mfma_f32_16x16x32_bf16 v[184:187], v[72:75], v[60:63], v[184:187]
buffer_load_dwordx4 v[44:47], v1, s[8:11], s37 offen offset:3072
v_mfma_f32_16x16x32_bf16 v[188:191], v[72:75], v[64:67], v[188:191]
s_waitcnt vmcnt(29)
v_mfma_f32_16x16x32_bf16 v[192:195], v[76:79], v[52:55], v[192:195]
buffer_load_dwordx4 v[48:51], v2, s[8:11], s37 offen
v_mfma_f32_16x16x32_bf16 v[196:199], v[76:79], v[56:59], v[196:199]
v_mfma_f32_16x16x32_bf16 v[200:203], v[76:79], v[60:63], v[200:203]
s_add_u32 s36, s21, 16384
buffer_load_dwordx4 v[16:19], v5, s[8:11], s36 offen
v_mfma_f32_16x16x32_bf16 v[204:207], v[76:79], v[64:67], v[204:207]
s_waitcnt vmcnt(30)
v_mfma_f32_16x16x32_bf16 v[208:211], v[80:83], v[52:55], v[208:211]
buffer_load_dwordx4 v[20:23], v6, s[8:11], s36 offen
v_mfma_f32_16x16x32_bf16 v[212:215], v[80:83], v[56:59], v[212:215]
v_mfma_f32_16x16x32_bf16 v[216:219], v[80:83], v[60:63], v[216:219]
buffer_load_dwordx4 v[24:27], v7, s[8:11], s36 offen
v_mfma_f32_16x16x32_bf16 v[220:223], v[80:83], v[64:67], v[220:223]
s_waitcnt vmcnt(31)
v_mfma_f32_16x16x32_bf16 v[224:227], v[84:87], v[52:55], v[224:227]
buffer_load_dwordx4 v[28:31], v10, s[8:11], s36 offen
v_mfma_f32_16x16x32_bf16 v[228:231], v[84:87], v[56:59], v[228:231]
v_mfma_f32_16x16x32_bf16 v[232:235], v[84:87], v[60:63], v[232:235]
v_mfma_f32_16x16x32_bf16 v[236:239], v[84:87], v[64:67], v[236:239]
s_waitcnt vmcnt(27)
v_mfma_f32_16x16x32_bf16 v[160:163], v[104:107], v[88:91], v[160:163]
s_add_u32 s37, s22, 25600
buffer_load_dwordx4 v[68:71], v1, s[8:11], s37 offen offset:0
v_mfma_f32_16x16x32_bf16 v[164:167], v[104:107], v[92:95], v[164:167]
v_mfma_f32_16x16x32_bf16 v[168:171], v[104:107], v[96:99], v[168:171]
buffer_load_dwordx4 v[72:75], v1, s[8:11], s37 offen offset:1024
v_mfma_f32_16x16x32_bf16 v[172:175], v[104:107], v[100:103], v[172:175]
s_waitcnt vmcnt(28)
v_mfma_f32_16x16x32_bf16 v[176:179], v[108:111], v[88:91], v[176:179]
buffer_load_dwordx4 v[76:79], v1, s[8:11], s37 offen offset:2048
v_mfma_f32_16x16x32_bf16 v[180:183], v[108:111], v[92:95], v[180:183]
v_mfma_f32_16x16x32_bf16 v[184:187], v[108:111], v[96:99], v[184:187]
buffer_load_dwordx4 v[80:83], v1, s[8:11], s37 offen offset:3072
v_mfma_f32_16x16x32_bf16 v[188:191], v[108:111], v[100:103], v[188:191]
s_waitcnt vmcnt(29)
v_mfma_f32_16x16x32_bf16 v[192:195], v[112:115], v[88:91], v[192:195]
buffer_load_dwordx4 v[84:87], v2, s[8:11], s37 offen
v_mfma_f32_16x16x32_bf16 v[196:199], v[112:115], v[92:95], v[196:199]
v_mfma_f32_16x16x32_bf16 v[200:203], v[112:115], v[96:99], v[200:203]
s_add_u32 s36, s21, 20480
buffer_load_dwordx4 v[52:55], v5, s[8:11], s36 offen
v_mfma_f32_16x16x32_bf16 v[204:207], v[112:115], v[100:103], v[204:207]
s_waitcnt vmcnt(30)
v_mfma_f32_16x16x32_bf16 v[208:211], v[116:119], v[88:91], v[208:211]
buffer_load_dwordx4 v[56:59], v6, s[8:11], s36 offen
v_mfma_f32_16x16x32_bf16 v[212:215], v[116:119], v[92:95], v[212:215]
v_mfma_f32_16x16x32_bf16 v[216:219], v[116:119], v[96:99], v[216:219]
buffer_load_dwordx4 v[60:63], v7, s[8:11], s36 offen
v_mfma_f32_16x16x32_bf16 v[220:223], v[116:119], v[100:103], v[220:223]
s_waitcnt vmcnt(31)
v_mfma_f32_16x16x32_bf16 v[224:227], v[120:123], v[88:91], v[224:227]
buffer_load_dwordx4 v[64:67], v10, s[8:11], s36 offen
v_mfma_f32_16x16x32_bf16 v[228:231], v[120:123], v[92:95], v[228:231]
v_mfma_f32_16x16x32_bf16 v[232:235], v[120:123], v[96:99], v[232:235]
v_mfma_f32_16x16x32_bf16 v[236:239], v[120:123], v[100:103], v[236:239]
s_waitcnt vmcnt(21)
v_mfma_f32_16x16x32_bf16 v[160:163], v[140:143], v[124:127], v[160:163]
s_add_u32 s37, s22, 30720
buffer_load_dwordx4 v[104:107], v1, s[8:11], s37 offen offset:0
s_waitcnt vmcnt(21)
v_mfma_f32_16x16x32_bf16 v[164:167], v[140:143], v[128:131], v[164:167]
s_waitcnt vmcnt(20)
v_mfma_f32_16x16x32_bf16 v[168:171], v[140:143], v[132:135], v[168:171]
buffer_load_dwordx4 v[108:111], v1, s[8:11], s37 offen offset:1024
s_waitcnt vmcnt(20)
v_mfma_f32_16x16x32_bf16 v[172:175], v[140:143], v[136:139], v[172:175]
v_mfma_f32_16x16x32_bf16 v[176:179], v[144:147], v[124:127], v[176:179]
buffer_load_dwordx4 v[112:115], v1, s[8:11], s37 offen offset:2048
v_mfma_f32_16x16x32_bf16 v[180:183], v[144:147], v[128:131], v[180:183]
v_mfma_f32_16x16x32_bf16 v[184:187], v[144:147], v[132:135], v[184:187]
buffer_load_dwordx4 v[116:119], v1, s[8:11], s37 offen offset:3072
v_mfma_f32_16x16x32_bf16 v[188:191], v[144:147], v[136:139], v[188:191]
v_mfma_f32_16x16x32_bf16 v[192:195], v[148:151], v[124:127], v[192:195]
buffer_load_dwordx4 v[120:123], v2, s[8:11], s37 offen
v_mfma_f32_16x16x32_bf16 v[196:199], v[148:151], v[128:131], v[196:199]
v_mfma_f32_16x16x32_bf16 v[200:203], v[148:151], v[132:135], v[200:203]
s_add_u32 s36, s21, 24576
buffer_load_dwordx4 v[88:91], v5, s[8:11], s36 offen
v_mfma_f32_16x16x32_bf16 v[204:207], v[148:151], v[136:139], v[204:207]
v_mfma_f32_16x16x32_bf16 v[208:211], v[152:155], v[124:127], v[208:211]
buffer_load_dwordx4 v[92:95], v6, s[8:11], s36 offen
v_mfma_f32_16x16x32_bf16 v[212:215], v[152:155], v[128:131], v[212:215]
v_mfma_f32_16x16x32_bf16 v[216:219], v[152:155], v[132:135], v[216:219]
buffer_load_dwordx4 v[96:99], v7, s[8:11], s36 offen
v_mfma_f32_16x16x32_bf16 v[220:223], v[152:155], v[136:139], v[220:223]
v_mfma_f32_16x16x32_bf16 v[224:227], v[156:159], v[124:127], v[224:227]
buffer_load_dwordx4 v[100:103], v10, s[8:11], s36 offen
v_mfma_f32_16x16x32_bf16 v[228:231], v[156:159], v[128:131], v[228:231]
v_mfma_f32_16x16x32_bf16 v[232:235], v[156:159], v[132:135], v[232:235]
v_mfma_f32_16x16x32_bf16 v[236:239], v[156:159], v[136:139], v[236:239]
s_waitcnt vmcnt(21)
v_mfma_f32_16x16x32_bf16 v[160:163], v[32:35], v[16:19], v[160:163]
s_add_u32 s37, s22, 35840
buffer_load_dwordx4 v[140:143], v1, s[8:11], s37 offen offset:0
s_waitcnt vmcnt(21)
v_mfma_f32_16x16x32_bf16 v[164:167], v[32:35], v[20:23], v[164:167]
s_waitcnt vmcnt(20)
v_mfma_f32_16x16x32_bf16 v[168:171], v[32:35], v[24:27], v[168:171]
buffer_load_dwordx4 v[144:147], v1, s[8:11], s37 offen offset:1024
s_waitcnt vmcnt(20)
v_mfma_f32_16x16x32_bf16 v[172:175], v[32:35], v[28:31], v[172:175]
v_mfma_f32_16x16x32_bf16 v[176:179], v[36:39], v[16:19], v[176:179]
buffer_load_dwordx4 v[148:151], v1, s[8:11], s37 offen offset:2048
v_mfma_f32_16x16x32_bf16 v[180:183], v[36:39], v[20:23], v[180:183]
v_mfma_f32_16x16x32_bf16 v[184:187], v[36:39], v[24:27], v[184:187]
buffer_load_dwordx4 v[152:155], v1, s[8:11], s37 offen offset:3072
v_mfma_f32_16x16x32_bf16 v[188:191], v[36:39], v[28:31], v[188:191]
v_mfma_f32_16x16x32_bf16 v[192:195], v[40:43], v[16:19], v[192:195]
buffer_load_dwordx4 v[156:159], v2, s[8:11], s37 offen
v_mfma_f32_16x16x32_bf16 v[196:199], v[40:43], v[20:23], v[196:199]
v_mfma_f32_16x16x32_bf16 v[200:203], v[40:43], v[24:27], v[200:203]
s_add_u32 s36, s21, 28672
buffer_load_dwordx4 v[124:127], v5, s[8:11], s36 offen
v_mfma_f32_16x16x32_bf16 v[204:207], v[40:43], v[28:31], v[204:207]
v_mfma_f32_16x16x32_bf16 v[208:211], v[44:47], v[16:19], v[208:211]
buffer_load_dwordx4 v[128:131], v6, s[8:11], s36 offen
v_mfma_f32_16x16x32_bf16 v[212:215], v[44:47], v[20:23], v[212:215]
v_mfma_f32_16x16x32_bf16 v[216:219], v[44:47], v[24:27], v[216:219]
buffer_load_dwordx4 v[132:135], v7, s[8:11], s36 offen
v_mfma_f32_16x16x32_bf16 v[220:223], v[44:47], v[28:31], v[220:223]
v_mfma_f32_16x16x32_bf16 v[224:227], v[48:51], v[16:19], v[224:227]
buffer_load_dwordx4 v[136:139], v10, s[8:11], s36 offen
v_mfma_f32_16x16x32_bf16 v[228:231], v[48:51], v[20:23], v[228:231]
v_mfma_f32_16x16x32_bf16 v[232:235], v[48:51], v[24:27], v[232:235]
v_mfma_f32_16x16x32_bf16 v[236:239], v[48:51], v[28:31], v[236:239]
s_waitcnt vmcnt(21)
v_mfma_f32_16x16x32_bf16 v[160:163], v[68:71], v[52:55], v[160:163]
s_add_u32 s37, s22, 40960
buffer_load_dwordx4 v[32:35], v1, s[8:11], s37 offen offset:0
s_waitcnt vmcnt(21)
v_mfma_f32_16x16x32_bf16 v[164:167], v[68:71], v[56:59], v[164:167]
s_waitcnt vmcnt(20)
v_mfma_f32_16x16x32_bf16 v[168:171], v[68:71], v[60:63], v[168:171]
buffer_load_dwordx4 v[36:39], v1, s[8:11], s37 offen offset:1024
s_waitcnt vmcnt(20)
v_mfma_f32_16x16x32_bf16 v[172:175], v[68:71], v[64:67], v[172:175]
v_mfma_f32_16x16x32_bf16 v[176:179], v[72:75], v[52:55], v[176:179]
buffer_load_dwordx4 v[40:43], v1, s[8:11], s37 offen offset:2048
v_mfma_f32_16x16x32_bf16 v[180:183], v[72:75], v[56:59], v[180:183]
v_mfma_f32_16x16x32_bf16 v[184:187], v[72:75], v[60:63], v[184:187]
buffer_load_dwordx4 v[44:47], v1, s[8:11], s37 offen offset:3072
v_mfma_f32_16x16x32_bf16 v[188:191], v[72:75], v[64:67], v[188:191]
v_mfma_f32_16x16x32_bf16 v[192:195], v[76:79], v[52:55], v[192:195]
buffer_load_dwordx4 v[48:51], v2, s[8:11], s37 offen
v_mfma_f32_16x16x32_bf16 v[196:199], v[76:79], v[56:59], v[196:199]
v_mfma_f32_16x16x32_bf16 v[200:203], v[76:79], v[60:63], v[200:203]
s_add_u32 s36, s21, 32768
buffer_load_dwordx4 v[16:19], v5, s[8:11], s36 offen
v_mfma_f32_16x16x32_bf16 v[204:207], v[76:79], v[64:67], v[204:207]
v_mfma_f32_16x16x32_bf16 v[208:211], v[80:83], v[52:55], v[208:211]
buffer_load_dwordx4 v[20:23], v6, s[8:11], s36 offen
v_mfma_f32_16x16x32_bf16 v[212:215], v[80:83], v[56:59], v[212:215]
v_mfma_f32_16x16x32_bf16 v[216:219], v[80:83], v[60:63], v[216:219]
buffer_load_dwordx4 v[24:27], v7, s[8:11], s36 offen
v_mfma_f32_16x16x32_bf16 v[220:223], v[80:83], v[64:67], v[220:223]
v_mfma_f32_16x16x32_bf16 v[224:227], v[84:87], v[52:55], v[224:227]
buffer_load_dwordx4 v[28:31], v10, s[8:11], s36 offen
v_mfma_f32_16x16x32_bf16 v[228:231], v[84:87], v[56:59], v[228:231]
v_mfma_f32_16x16x32_bf16 v[232:235], v[84:87], v[60:63], v[232:235]
v_mfma_f32_16x16x32_bf16 v[236:239], v[84:87], v[64:67], v[236:239]
s_waitcnt vmcnt(21)
v_mfma_f32_16x16x32_bf16 v[160:163], v[104:107], v[88:91], v[160:163]
s_add_u32 s37, s22, 46080
buffer_load_dwordx4 v[68:71], v1, s[8:11], s37 offen offset:0
s_waitcnt vmcnt(21)
v_mfma_f32_16x16x32_bf16 v[164:167], v[104:107], v[92:95], v[164:167]
s_waitcnt vmcnt(20)
v_mfma_f32_16x16x32_bf16 v[168:171], v[104:107], v[96:99], v[168:171]
buffer_load_dwordx4 v[72:75], v1, s[8:11], s37 offen offset:1024
s_waitcnt vmcnt(20)
v_mfma_f32_16x16x32_bf16 v[172:175], v[104:107], v[100:103], v[172:175]
v_mfma_f32_16x16x32_bf16 v[176:179], v[108:111], v[88:91], v[176:179]
buffer_load_dwordx4 v[76:79], v1, s[8:11], s37 offen offset:2048
v_mfma_f32_16x16x32_bf16 v[180:183], v[108:111], v[92:95], v[180:183]
v_mfma_f32_16x16x32_bf16 v[184:187], v[108:111], v[96:99], v[184:187]
buffer_load_dwordx4 v[80:83], v1, s[8:11], s37 offen offset:3072
v_mfma_f32_16x16x32_bf16 v[188:191], v[108:111], v[100:103], v[188:191]
v_mfma_f32_16x16x32_bf16 v[192:195], v[112:115], v[88:91], v[192:195]
buffer_load_dwordx4 v[84:87], v2, s[8:11], s37 offen
v_mfma_f32_16x16x32_bf16 v[196:199], v[112:115], v[92:95], v[196:199]
v_mfma_f32_16x16x32_bf16 v[200:203], v[112:115], v[96:99], v[200:203]
s_add_u32 s36, s21, 36864
buffer_load_dwordx4 v[52:55], v5, s[8:11], s36 offen
v_mfma_f32_16x16x32_bf16 v[204:207], v[112:115], v[100:103], v[204:207]
v_mfma_f32_16x16x32_bf16 v[208:211], v[116:119], v[88:91], v[208:211]
buffer_load_dwordx4 v[56:59], v6, s[8:11], s36 offen
v_mfma_f32_16x16x32_bf16 v[212:215], v[116:119], v[92:95], v[212:215]
v_mfma_f32_16x16x32_bf16 v[216:219], v[116:119], v[96:99], v[216:219]
buffer_load_dwordx4 v[60:63], v7, s[8:11], s36 offen
v_mfma_f32_16x16x32_bf16 v[220:223], v[116:119], v[100:103], v[220:223]
v_mfma_f32_16x16x32_bf16 v[224:227], v[120:123], v[88:91], v[224:227]
buffer_load_dwordx4 v[64:67], v10, s[8:11], s36 offen
v_mfma_f32_16x16x32_bf16 v[228:231], v[120:123], v[92:95], v[228:231]
v_mfma_f32_16x16x32_bf16 v[232:235], v[120:123], v[96:99], v[232:235]
v_mfma_f32_16x16x32_bf16 v[236:239], v[120:123], v[100:103], v[236:239]
s_waitcnt vmcnt(21)
v_mfma_f32_16x16x32_bf16 v[160:163], v[140:143], v[124:127], v[160:163]
s_add_u32 s37, s22, 51200
buffer_load_dwordx4 v[104:107], v1, s[8:11], s37 offen offset:0
s_waitcnt vmcnt(21)
v_mfma_f32_16x16x32_bf16 v[164:167], v[140:143], v[128:131], v[164:167]
s_waitcnt vmcnt(20)
v_mfma_f32_16x16x32_bf16 v[168:171], v[140:143], v[132:135], v[168:171]
buffer_load_dwordx4 v[108:111], v1, s[8:11], s37 offen offset:1024
s_waitcnt vmcnt(20)
v_mfma_f32_16x16x32_bf16 v[172:175], v[140:143], v[136:139], v[172:175]
v_mfma_f32_16x16x32_bf16 v[176:179], v[144:147], v[124:127], v[176:179]
buffer_load_dwordx4 v[112:115], v1, s[8:11], s37 offen offset:2048
v_mfma_f32_16x16x32_bf16 v[180:183], v[144:147], v[128:131], v[180:183]
v_mfma_f32_16x16x32_bf16 v[184:187], v[144:147], v[132:135], v[184:187]
buffer_load_dwordx4 v[116:119], v1, s[8:11], s37 offen offset:3072
v_mfma_f32_16x16x32_bf16 v[188:191], v[144:147], v[136:139], v[188:191]
v_mfma_f32_16x16x32_bf16 v[192:195], v[148:151], v[124:127], v[192:195]
buffer_load_dwordx4 v[120:123], v2, s[8:11], s37 offen
v_mfma_f32_16x16x32_bf16 v[196:199], v[148:151], v[128:131], v[196:199]
v_mfma_f32_16x16x32_bf16 v[200:203], v[148:151], v[132:135], v[200:203]
s_add_u32 s36, s21, 40960
buffer_load_dwordx4 v[88:91], v5, s[8:11], s36 offen
v_mfma_f32_16x16x32_bf16 v[204:207], v[148:151], v[136:139], v[204:207]
v_mfma_f32_16x16x32_bf16 v[208:211], v[152:155], v[124:127], v[208:211]
buffer_load_dwordx4 v[92:95], v6, s[8:11], s36 offen
v_mfma_f32_16x16x32_bf16 v[212:215], v[152:155], v[128:131], v[212:215]
v_mfma_f32_16x16x32_bf16 v[216:219], v[152:155], v[132:135], v[216:219]
buffer_load_dwordx4 v[96:99], v7, s[8:11], s36 offen
v_mfma_f32_16x16x32_bf16 v[220:223], v[152:155], v[136:139], v[220:223]
v_mfma_f32_16x16x32_bf16 v[224:227], v[156:159], v[124:127], v[224:227]
buffer_load_dwordx4 v[100:103], v10, s[8:11], s36 offen
v_mfma_f32_16x16x32_bf16 v[228:231], v[156:159], v[128:131], v[228:231]
v_mfma_f32_16x16x32_bf16 v[232:235], v[156:159], v[132:135], v[232:235]
v_mfma_f32_16x16x32_bf16 v[236:239], v[156:159], v[136:139], v[236:239]
s_waitcnt vmcnt(21)
v_mfma_f32_16x16x32_bf16 v[160:163], v[32:35], v[16:19], v[160:163]
s_add_u32 s37, s22, 56320
buffer_load_dwordx4 v[140:143], v1, s[8:11], s37 offen offset:0
s_waitcnt vmcnt(21)
v_mfma_f32_16x16x32_bf16 v[164:167], v[32:35], v[20:23], v[164:167]
s_waitcnt vmcnt(20)
v_mfma_f32_16x16x32_bf16 v[168:171], v[32:35], v[24:27], v[168:171]
buffer_load_dwordx4 v[144:147], v1, s[8:11], s37 offen offset:1024
s_waitcnt vmcnt(20)
v_mfma_f32_16x16x32_bf16 v[172:175], v[32:35], v[28:31], v[172:175]
v_mfma_f32_16x16x32_bf16 v[176:179], v[36:39], v[16:19], v[176:179]
buffer_load_dwordx4 v[148:151], v1, s[8:11], s37 offen offset:2048
v_mfma_f32_16x16x32_bf16 v[180:183], v[36:39], v[20:23], v[180:183]
v_mfma_f32_16x16x32_bf16 v[184:187], v[36:39], v[24:27], v[184:187]
buffer_load_dwordx4 v[152:155], v1, s[8:11], s37 offen offset:3072
v_mfma_f32_16x16x32_bf16 v[188:191], v[36:39], v[28:31], v[188:191]
v_mfma_f32_16x16x32_bf16 v[192:195], v[40:43], v[16:19], v[192:195]
buffer_load_dwordx4 v[156:159], v2, s[8:11], s37 offen
v_mfma_f32_16x16x32_bf16 v[196:199], v[40:43], v[20:23], v[196:199]
v_mfma_f32_16x16x32_bf16 v[200:203], v[40:43], v[24:27], v[200:203]
s_add_u32 s36, s21, 45056
buffer_load_dwordx4 v[124:127], v5, s[8:11], s36 offen
v_mfma_f32_16x16x32_bf16 v[204:207], v[40:43], v[28:31], v[204:207]
v_mfma_f32_16x16x32_bf16 v[208:211], v[44:47], v[16:19], v[208:211]
buffer_load_dwordx4 v[128:131], v6, s[8:11], s36 offen
v_mfma_f32_16x16x32_bf16 v[212:215], v[44:47], v[20:23], v[212:215]
v_mfma_f32_16x16x32_bf16 v[216:219], v[44:47], v[24:27], v[216:219]
buffer_load_dwordx4 v[132:135], v7, s[8:11], s36 offen
v_mfma_f32_16x16x32_bf16 v[220:223], v[44:47], v[28:31], v[220:223]
v_mfma_f32_16x16x32_bf16 v[224:227], v[48:51], v[16:19], v[224:227]
buffer_load_dwordx4 v[136:139], v10, s[8:11], s36 offen
v_mfma_f32_16x16x32_bf16 v[228:231], v[48:51], v[20:23], v[228:231]
v_mfma_f32_16x16x32_bf16 v[232:235], v[48:51], v[24:27], v[232:235]
v_mfma_f32_16x16x32_bf16 v[236:239], v[48:51], v[28:31], v[236:239]
s_waitcnt vmcnt(21)
v_mfma_f32_16x16x32_bf16 v[160:163], v[68:71], v[52:55], v[160:163]
s_add_u32 s37, s22, 61440
buffer_load_dwordx4 v[32:35], v1, s[8:11], s37 offen offset:0
s_waitcnt vmcnt(21)
v_mfma_f32_16x16x32_bf16 v[164:167], v[68:71], v[56:59], v[164:167]
s_waitcnt vmcnt(20)
v_mfma_f32_16x16x32_bf16 v[168:171], v[68:71], v[60:63], v[168:171]
buffer_load_dwordx4 v[36:39], v1, s[8:11], s37 offen offset:1024
s_waitcnt vmcnt(20)
v_mfma_f32_16x16x32_bf16 v[172:175], v[68:71], v[64:67], v[172:175]
v_mfma_f32_16x16x32_bf16 v[176:179], v[72:75], v[52:55], v[176:179]
buffer_load_dwordx4 v[40:43], v1, s[8:11], s37 offen offset:2048
v_mfma_f32_16x16x32_bf16 v[180:183], v[72:75], v[56:59], v[180:183]
v_mfma_f32_16x16x32_bf16 v[184:187], v[72:75], v[60:63], v[184:187]
buffer_load_dwordx4 v[44:47], v1, s[8:11], s37 offen offset:3072
v_mfma_f32_16x16x32_bf16 v[188:191], v[72:75], v[64:67], v[188:191]
v_mfma_f32_16x16x32_bf16 v[192:195], v[76:79], v[52:55], v[192:195]
buffer_load_dwordx4 v[48:51], v2, s[8:11], s37 offen
v_mfma_f32_16x16x32_bf16 v[196:199], v[76:79], v[56:59], v[196:199]
v_mfma_f32_16x16x32_bf16 v[200:203], v[76:79], v[60:63], v[200:203]
s_add_u32 s36, s21, 49152
buffer_load_dwordx4 v[16:19], v5, s[8:11], s36 offen
v_mfma_f32_16x16x32_bf16 v[204:207], v[76:79], v[64:67], v[204:207]
v_mfma_f32_16x16x32_bf16 v[208:211], v[80:83], v[52:55], v[208:211]
buffer_load_dwordx4 v[20:23], v6, s[8:11], s36 offen
v_mfma_f32_16x16x32_bf16 v[212:215], v[80:83], v[56:59], v[212:215]
v_mfma_f32_16x16x32_bf16 v[216:219], v[80:83], v[60:63], v[216:219]
buffer_load_dwordx4 v[24:27], v7, s[8:11], s36 offen
v_mfma_f32_16x16x32_bf16 v[220:223], v[80:83], v[64:67], v[220:223]
v_mfma_f32_16x16x32_bf16 v[224:227], v[84:87], v[52:55], v[224:227]
buffer_load_dwordx4 v[28:31], v10, s[8:11], s36 offen
v_mfma_f32_16x16x32_bf16 v[228:231], v[84:87], v[56:59], v[228:231]
v_mfma_f32_16x16x32_bf16 v[232:235], v[84:87], v[60:63], v[232:235]
v_mfma_f32_16x16x32_bf16 v[236:239], v[84:87], v[64:67], v[236:239]
buffer_load_dword v9, v8, s[8:11], s82 offen sc0 sc1
s_waitcnt vmcnt(22)
v_mfma_f32_16x16x32_bf16 v[160:163], v[104:107], v[88:91], v[160:163]
s_add_u32 s37, s22, 66560
buffer_load_dwordx4 v[68:71], v3, s[8:11], s37 offen offset:0
s_waitcnt vmcnt(22)
v_mfma_f32_16x16x32_bf16 v[164:167], v[104:107], v[92:95], v[164:167]
s_waitcnt vmcnt(21)
v_mfma_f32_16x16x32_bf16 v[168:171], v[104:107], v[96:99], v[168:171]
buffer_load_dwordx4 v[72:75], v3, s[8:11], s37 offen offset:1024
s_waitcnt vmcnt(21)
v_mfma_f32_16x16x32_bf16 v[172:175], v[104:107], v[100:103], v[172:175]
v_mfma_f32_16x16x32_bf16 v[176:179], v[108:111], v[88:91], v[176:179]
buffer_load_dwordx4 v[76:79], v3, s[8:11], s37 offen offset:2048
v_mfma_f32_16x16x32_bf16 v[180:183], v[108:111], v[92:95], v[180:183]
v_mfma_f32_16x16x32_bf16 v[184:187], v[108:111], v[96:99], v[184:187]
buffer_load_dwordx4 v[80:83], v3, s[8:11], s37 offen offset:3072
v_mfma_f32_16x16x32_bf16 v[188:191], v[108:111], v[100:103], v[188:191]
v_mfma_f32_16x16x32_bf16 v[192:195], v[112:115], v[88:91], v[192:195]
buffer_load_dwordx4 v[84:87], v4, s[8:11], s37 offen
v_mfma_f32_16x16x32_bf16 v[196:199], v[112:115], v[92:95], v[196:199]
v_mfma_f32_16x16x32_bf16 v[200:203], v[112:115], v[96:99], v[200:203]
s_add_u32 s36, s21, 53248
buffer_load_dwordx4 v[52:55], v252, s[8:11], s36 offen
v_mfma_f32_16x16x32_bf16 v[204:207], v[112:115], v[100:103], v[204:207]
v_mfma_f32_16x16x32_bf16 v[208:211], v[116:119], v[88:91], v[208:211]
buffer_load_dwordx4 v[56:59], v253, s[8:11], s36 offen
v_mfma_f32_16x16x32_bf16 v[212:215], v[116:119], v[92:95], v[212:215]
v_mfma_f32_16x16x32_bf16 v[216:219], v[116:119], v[96:99], v[216:219]
buffer_load_dwordx4 v[60:63], v254, s[8:11], s36 offen
v_mfma_f32_16x16x32_bf16 v[220:223], v[116:119], v[100:103], v[220:223]
v_mfma_f32_16x16x32_bf16 v[224:227], v[120:123], v[88:91], v[224:227]
buffer_load_dwordx4 v[64:67], v255, s[8:11], s36 offen
v_mfma_f32_16x16x32_bf16 v[228:231], v[120:123], v[92:95], v[228:231]
v_mfma_f32_16x16x32_bf16 v[232:235], v[120:123], v[96:99], v[232:235]
v_mfma_f32_16x16x32_bf16 v[236:239], v[120:123], v[100:103], v[236:239]
s_waitcnt vmcnt(9)
v_cmp_ne_u32 vcc, 1, v9
s_nop 4
s_cbranch_vccnz K23_SPIN
K23_GO:
v_mfma_f32_16x16x32_bf16 v[160:163], v[140:143], v[124:127], v[160:163]
s_add_u32 s37, s24, 0
buffer_load_dwordx4 v[104:107], v1, s[8:11], s37 offen offset:0
v_mfma_f32_16x16x32_bf16 v[164:167], v[140:143], v[128:131], v[164:167]
v_mfma_f32_16x16x32_bf16 v[168:171], v[140:143], v[132:135], v[168:171]
buffer_load_dwordx4 v[108:111], v1, s[8:11], s37 offen offset:1024
v_mfma_f32_16x16x32_bf16 v[172:175], v[140:143], v[136:139], v[172:175]
v_mfma_f32_16x16x32_bf16 v[176:179], v[144:147], v[124:127], v[176:179]
buffer_load_dwordx4 v[112:115], v1, s[8:11], s37 offen offset:2048
v_mfma_f32_16x16x32_bf16 v[180:183], v[144:147], v[128:131], v[180:183]
v_mfma_f32_16x16x32_bf16 v[184:187], v[144:147], v[132:135], v[184:187]
buffer_load_dwordx4 v[116:119], v1, s[8:11], s37 offen offset:3072
v_mfma_f32_16x16x32_bf16 v[188:191], v[144:147], v[136:139], v[188:191]
v_mfma_f32_16x16x32_bf16 v[192:195], v[148:151], v[124:127], v[192:195]
buffer_load_dwordx4 v[120:123], v2, s[8:11], s37 offen
v_mfma_f32_16x16x32_bf16 v[196:199], v[148:151], v[128:131], v[196:199]
v_mfma_f32_16x16x32_bf16 v[200:203], v[148:151], v[132:135], v[200:203]
s_add_u32 s36, s23, 0
buffer_load_dwordx4 v[88:91], v5, s[8:11], s36 offen
v_mfma_f32_16x16x32_bf16 v[204:207], v[148:151], v[136:139], v[204:207]
v_mfma_f32_16x16x32_bf16 v[208:211], v[152:155], v[124:127], v[208:211]
buffer_load_dwordx4 v[92:95], v6, s[8:11], s36 offen
v_mfma_f32_16x16x32_bf16 v[212:215], v[152:155], v[128:131], v[212:215]
v_mfma_f32_16x16x32_bf16 v[216:219], v[152:155], v[132:135], v[216:219]
buffer_load_dwordx4 v[96:99], v7, s[8:11], s36 offen
v_mfma_f32_16x16x32_bf16 v[220:223], v[152:155], v[136:139], v[220:223]
v_mfma_f32_16x16x32_bf16 v[224:227], v[156:159], v[124:127], v[224:227]
buffer_load_dwordx4 v[100:103], v10, s[8:11], s36 offen
v_mfma_f32_16x16x32_bf16 v[228:231], v[156:159], v[128:131], v[228:231]
v_mfma_f32_16x16x32_bf16 v[232:235], v[156:159], v[132:135], v[232:235]
v_mfma_f32_16x16x32_bf16 v[236:239], v[156:159], v[136:139], v[236:239]
v_mfma_f32_16x16x32_bf16 v[160:163], v[32:35], v[16:19], v[160:163]
s_add_u32 s37, s24, 5120
buffer_load_dwordx4 v[140:143], v1, s[8:11], s37 offen offset:0
v_mfma_f32_16x16x32_bf16 v[164:167], v[32:35], v[20:23], v[164:167]
v_mfma_f32_16x16x32_bf16 v[168:171], v[32:35], v[24:27], v[168:171]
buffer_load_dwordx4 v[144:147], v1, s[8:11], s37 offen offset:1024
v_mfma_f32_16x16x32_bf16 v[172:175], v[32:35], v[28:31], v[172:175]
v_mfma_f32_16x16x32_bf16 v[176:179], v[36:39], v[16:19], v[176:179]
buffer_load_dwordx4 v[148:151], v1, s[8:11], s37 offen offset:2048
v_mfma_f32_16x16x32_bf16 v[180:183], v[36:39], v[20:23], v[180:183]
v_mfma_f32_16x16x32_bf16 v[184:187], v[36:39], v[24:27], v[184:187]
buffer_load_dwordx4 v[152:155], v1, s[8:11], s37 offen offset:3072
v_mfma_f32_16x16x32_bf16 v[188:191], v[36:39], v[28:31], v[188:191]
v_mfma_f32_16x16x32_bf16 v[192:195], v[40:43], v[16:19], v[192:195]
buffer_load_dwordx4 v[156:159], v2, s[8:11], s37 offen
v_mfma_f32_16x16x32_bf16 v[196:199], v[40:43], v[20:23], v[196:199]
v_mfma_f32_16x16x32_bf16 v[200:203], v[40:43], v[24:27], v[200:203]
s_add_u32 s36, s23, 4096
buffer_load_dwordx4 v[124:127], v5, s[8:11], s36 offen
v_mfma_f32_16x16x32_bf16 v[204:207], v[40:43], v[28:31], v[204:207]
v_mfma_f32_16x16x32_bf16 v[208:211], v[44:47], v[16:19], v[208:211]
buffer_load_dwordx4 v[128:131], v6, s[8:11], s36 offen
v_mfma_f32_16x16x32_bf16 v[212:215], v[44:47], v[20:23], v[212:215]
v_mfma_f32_16x16x32_bf16 v[216:219], v[44:47], v[24:27], v[216:219]
buffer_load_dwordx4 v[132:135], v7, s[8:11], s36 offen
v_mfma_f32_16x16x32_bf16 v[220:223], v[44:47], v[28:31], v[220:223]
v_mfma_f32_16x16x32_bf16 v[224:227], v[48:51], v[16:19], v[224:227]
buffer_load_dwordx4 v[136:139], v10, s[8:11], s36 offen
v_mfma_f32_16x16x32_bf16 v[228:231], v[48:51], v[20:23], v[228:231]
v_mfma_f32_16x16x32_bf16 v[232:235], v[48:51], v[24:27], v[232:235]
v_mfma_f32_16x16x32_bf16 v[236:239], v[48:51], v[28:31], v[236:239]
s_waitcnt vmcnt(21)
v_mfma_f32_16x16x32_bf16 v[160:163], v[68:71], v[52:55], v[160:163]
s_add_u32 s37, s24, 10240
buffer_load_dwordx4 v[32:35], v1, s[8:11], s37 offen offset:0
s_waitcnt vmcnt(21)
v_mfma_f32_16x16x32_bf16 v[164:167], v[68:71], v[56:59], v[164:167]
s_waitcnt vmcnt(20)
v_mfma_f32_16x16x32_bf16 v[168:171], v[68:71], v[60:63], v[168:171]
buffer_load_dwordx4 v[36:39], v1, s[8:11], s37 offen offset:1024
s_waitcnt vmcnt(20)
v_mfma_f32_16x16x32_bf16 v[172:175], v[68:71], v[64:67], v[172:175]
v_mfma_f32_16x16x32_bf16 v[176:179], v[72:75], v[52:55], v[176:179]
buffer_load_dwordx4 v[40:43], v1, s[8:11], s37 offen offset:2048
v_mfma_f32_16x16x32_bf16 v[180:183], v[72:75], v[56:59], v[180:183]
v_mfma_f32_16x16x32_bf16 v[184:187], v[72:75], v[60:63], v[184:187]
buffer_load_dwordx4 v[44:47], v1, s[8:11], s37 offen offset:3072
v_mfma_f32_16x16x32_bf16 v[188:191], v[72:75], v[64:67], v[188:191]
v_mfma_f32_16x16x32_bf16 v[192:195], v[76:79], v[52:55], v[192:195]
buffer_load_dwordx4 v[48:51], v2, s[8:11], s37 offen
v_mfma_f32_16x16x32_bf16 v[196:199], v[76:79], v[56:59], v[196:199]
v_mfma_f32_16x16x32_bf16 v[200:203], v[76:79], v[60:63], v[200:203]
s_add_u32 s36, s23, 8192
buffer_load_dwordx4 v[16:19], v5, s[8:11], s36 offen
v_mfma_f32_16x16x32_bf16 v[204:207], v[76:79], v[64:67], v[204:207]
v_mfma_f32_16x16x32_bf16 v[208:211], v[80:83], v[52:55], v[208:211]
buffer_load_dwordx4 v[20:23], v6, s[8:11], s36 offen
v_mfma_f32_16x16x32_bf16 v[212:215], v[80:83], v[56:59], v[212:215]
v_mfma_f32_16x16x32_bf16 v[216:219], v[80:83], v[60:63], v[216:219]
buffer_load_dwordx4 v[24:27], v7, s[8:11], s36 offen
v_mfma_f32_16x16x32_bf16 v[220:223], v[80:83], v[64:67], v[220:223]
v_mfma_f32_16x16x32_bf16 v[224:227], v[84:87], v[52:55], v[224:227]
buffer_load_dwordx4 v[28:31], v10, s[8:11], s36 offen
v_mfma_f32_16x16x32_bf16 v[228:231], v[84:87], v[56:59], v[228:231]
v_mfma_f32_16x16x32_bf16 v[232:235], v[84:87], v[60:63], v[232:235]
v_mfma_f32_16x16x32_bf16 v[236:239], v[84:87], v[64:67], v[236:239]
s_waitcnt vmcnt(21)
v_mfma_f32_16x16x32_bf16 v[160:163], v[104:107], v[88:91], v[160:163]
s_add_u32 s37, s24, 15360
buffer_load_dwordx4 v[68:71], v1, s[8:11], s37 offen offset:0
s_waitcnt vmcnt(21)
v_mfma_f32_16x16x32_bf16 v[164:167], v[104:107], v[92:95], v[164:167]
s_waitcnt vmcnt(20)
v_mfma_f32_16x16x32_bf16 v[168:171], v[104:107], v[96:99], v[168:171]
buffer_load_dwordx4 v[72:75], v1, s[8:11], s37 offen offset:1024
s_waitcnt vmcnt(20)
v_mfma_f32_16x16x32_bf16 v[172:175], v[104:107], v[100:103], v[172:175]
v_mfma_f32_16x16x32_bf16 v[176:179], v[108:111], v[88:91], v[176:179]
buffer_load_dwordx4 v[76:79], v1, s[8:11], s37 offen offset:2048
v_mfma_f32_16x16x32_bf16 v[180:183], v[108:111], v[92:95], v[180:183]
v_mfma_f32_16x16x32_bf16 v[184:187], v[108:111], v[96:99], v[184:187]
buffer_load_dwordx4 v[80:83], v1, s[8:11], s37 offen offset:3072
v_mfma_f32_16x16x32_bf16 v[188:191], v[108:111], v[100:103], v[188:191]
v_mfma_f32_16x16x32_bf16 v[192:195], v[112:115], v[88:91], v[192:195]
buffer_load_dwordx4 v[84:87], v2, s[8:11], s37 offen
v_mfma_f32_16x16x32_bf16 v[196:199], v[112:115], v[92:95], v[196:199]
v_mfma_f32_16x16x32_bf16 v[200:203], v[112:115], v[96:99], v[200:203]
s_add_u32 s36, s23, 12288
buffer_load_dwordx4 v[52:55], v5, s[8:11], s36 offen
v_mfma_f32_16x16x32_bf16 v[204:207], v[112:115], v[100:103], v[204:207]
v_mfma_f32_16x16x32_bf16 v[208:211], v[116:119], v[88:91], v[208:211]
buffer_load_dwordx4 v[56:59], v6, s[8:11], s36 offen
v_mfma_f32_16x16x32_bf16 v[212:215], v[116:119], v[92:95], v[212:215]
v_mfma_f32_16x16x32_bf16 v[216:219], v[116:119], v[96:99], v[216:219]
buffer_load_dwordx4 v[60:63], v7, s[8:11], s36 offen
v_mfma_f32_16x16x32_bf16 v[220:223], v[116:119], v[100:103], v[220:223]
v_mfma_f32_16x16x32_bf16 v[224:227], v[120:123], v[88:91], v[224:227]
buffer_load_dwordx4 v[64:67], v10, s[8:11], s36 offen
v_mfma_f32_16x16x32_bf16 v[228:231], v[120:123], v[92:95], v[228:231]
v_mfma_f32_16x16x32_bf16 v[232:235], v[120:123], v[96:99], v[232:235]
v_mfma_f32_16x16x32_bf16 v[236:239], v[120:123], v[100:103], v[236:239]
s_waitcnt vmcnt(21)
v_mfma_f32_16x16x32_bf16 v[160:163], v[140:143], v[124:127], v[160:163]
s_add_u32 s37, s24, 20480
buffer_load_dwordx4 v[104:107], v1, s[8:11], s37 offen offset:0
s_waitcnt vmcnt(21)
v_mfma_f32_16x16x32_bf16 v[164:167], v[140:143], v[128:131], v[164:167]
s_waitcnt vmcnt(20)
v_mfma_f32_16x16x32_bf16 v[168:171], v[140:143], v[132:135], v[168:171]
buffer_load_dwordx4 v[108:111], v1, s[8:11], s37 offen offset:1024
s_waitcnt vmcnt(20)
v_mfma_f32_16x16x32_bf16 v[172:175], v[140:143], v[136:139], v[172:175]
v_mfma_f32_16x16x32_bf16 v[176:179], v[144:147], v[124:127], v[176:179]
buffer_load_dwordx4 v[112:115], v1, s[8:11], s37 offen offset:2048
v_mfma_f32_16x16x32_bf16 v[180:183], v[144:147], v[128:131], v[180:183]
v_mfma_f32_16x16x32_bf16 v[184:187], v[144:147], v[132:135], v[184:187]
buffer_load_dwordx4 v[116:119], v1, s[8:11], s37 offen offset:3072
v_mfma_f32_16x16x32_bf16 v[188:191], v[144:147], v[136:139], v[188:191]
v_mfma_f32_16x16x32_bf16 v[192:195], v[148:151], v[124:127], v[192:195]
buffer_load_dwordx4 v[120:123], v2, s[8:11], s37 offen
v_mfma_f32_16x16x32_bf16 v[196:199], v[148:151], v[128:131], v[196:199]
v_mfma_f32_16x16x32_bf16 v[200:203], v[148:151], v[132:135], v[200:203]
s_add_u32 s36, s23, 16384
buffer_load_dwordx4 v[88:91], v5, s[8:11], s36 offen
v_mfma_f32_16x16x32_bf16 v[204:207], v[148:151], v[136:139], v[204:207]
v_mfma_f32_16x16x32_bf16 v[208:211], v[152:155], v[124:127], v[208:211]
buffer_load_dwordx4 v[92:95], v6, s[8:11], s36 offen
v_mfma_f32_16x16x32_bf16 v[212:215], v[152:155], v[128:131], v[212:215]
v_mfma_f32_16x16x32_bf16 v[216:219], v[152:155], v[132:135], v[216:219]
buffer_load_dwordx4 v[96:99], v7, s[8:11], s36 offen
v_mfma_f32_16x16x32_bf16 v[220:223], v[152:155], v[136:139], v[220:223]
v_mfma_f32_16x16x32_bf16 v[224:227], v[156:159], v[124:127], v[224:227]
buffer_load_dwordx4 v[100:103], v10, s[8:11], s36 offen
v_mfma_f32_16x16x32_bf16 v[228:231], v[156:159], v[128:131], v[228:231]
v_mfma_f32_16x16x32_bf16 v[232:235], v[156:159], v[132:135], v[232:235]
v_mfma_f32_16x16x32_bf16 v[236:239], v[156:159], v[136:139], v[236:239]
s_waitcnt vmcnt(21)
v_mfma_f32_16x16x32_bf16 v[160:163], v[32:35], v[16:19], v[160:163]
s_waitcnt vmcnt(20)
v_mfma_f32_16x16x32_bf16 v[164:167], v[32:35], v[20:23], v[164:167]
s_waitcnt vmcnt(19)
v_mfma_f32_16x16x32_bf16 v[168:171], v[32:35], v[24:27], v[168:171]
s_waitcnt vmcnt(18)
v_mfma_f32_16x16x32_bf16 v[172:175], v[32:35], v[28:31], v[172:175]
v_mfma_f32_16x16x32_bf16 v[176:179], v[36:39], v[16:19], v[176:179]
v_mfma_f32_16x16x32_bf16 v[180:183], v[36:39], v[20:23], v[180:183]
v_mfma_f32_16x16x32_bf16 v[184:187], v[36:39], v[24:27], v[184:187]
v_mfma_f32_16x16x32_bf16 v[188:191], v[36:39], v[28:31], v[188:191]
v_mfma_f32_16x16x32_bf16 v[192:195], v[40:43], v[16:19], v[192:195]
v_mfma_f32_16x16x32_bf16 v[196:199], v[40:43], v[20:23], v[196:199]
v_mfma_f32_16x16x32_bf16 v[200:203], v[40:43], v[24:27], v[200:203]
v_mfma_f32_16x16x32_bf16 v[204:207], v[40:43], v[28:31], v[204:207]
v_mfma_f32_16x16x32_bf16 v[208:211], v[44:47], v[16:19], v[208:211]
v_mfma_f32_16x16x32_bf16 v[212:215], v[44:47], v[20:23], v[212:215]
v_mfma_f32_16x16x32_bf16 v[216:219], v[44:47], v[24:27], v[216:219]
v_mfma_f32_16x16x32_bf16 v[220:223], v[44:47], v[28:31], v[220:223]
v_mfma_f32_16x16x32_bf16 v[224:227], v[48:51], v[16:19], v[224:227]
v_mfma_f32_16x16x32_bf16 v[228:231], v[48:51], v[20:23], v[228:231]
v_mfma_f32_16x16x32_bf16 v[232:235], v[48:51], v[24:27], v[232:235]
v_mfma_f32_16x16x32_bf16 v[236:239], v[48:51], v[28:31], v[236:239]
s_waitcnt vmcnt(12)
v_mfma_f32_16x16x32_bf16 v[160:163], v[68:71], v[52:55], v[160:163]
s_waitcnt vmcnt(11)
v_mfma_f32_16x16x32_bf16 v[164:167], v[68:71], v[56:59], v[164:167]
s_waitcnt vmcnt(10)
v_mfma_f32_16x16x32_bf16 v[168:171], v[68:71], v[60:63], v[168:171]
s_waitcnt vmcnt(9)
v_mfma_f32_16x16x32_bf16 v[172:175], v[68:71], v[64:67], v[172:175]
v_mfma_f32_16x16x32_bf16 v[176:179], v[72:75], v[52:55], v[176:179]
v_mfma_f32_16x16x32_bf16 v[180:183], v[72:75], v[56:59], v[180:183]
v_mfma_f32_16x16x32_bf16 v[184:187], v[72:75], v[60:63], v[184:187]
v_mfma_f32_16x16x32_bf16 v[188:191], v[72:75], v[64:67], v[188:191]
v_mfma_f32_16x16x32_bf16 v[192:195], v[76:79], v[52:55], v[192:195]
v_mfma_f32_16x16x32_bf16 v[196:199], v[76:79], v[56:59], v[196:199]
v_mfma_f32_16x16x32_bf16 v[200:203], v[76:79], v[60:63], v[200:203]
v_mfma_f32_16x16x32_bf16 v[204:207], v[76:79], v[64:67], v[204:207]
v_mfma_f32_16x16x32_bf16 v[208:211], v[80:83], v[52:55], v[208:211]
v_mfma_f32_16x16x32_bf16 v[212:215], v[80:83], v[56:59], v[212:215]
v_mfma_f32_16x16x32_bf16 v[216:219], v[80:83], v[60:63], v[216:219]
v_mfma_f32_16x16x32_bf16 v[220:223], v[80:83], v[64:67], v[220:223]
v_mfma_f32_16x16x32_bf16 v[224:227], v[84:87], v[52:55], v[224:227]
v_mfma_f32_16x16x32_bf16 v[228:231], v[84:87], v[56:59], v[228:231]
v_mfma_f32_16x16x32_bf16 v[232:235], v[84:87], v[60:63], v[232:235]
v_mfma_f32_16x16x32_bf16 v[236:239], v[84:87], v[64:67], v[236:239]
s_waitcnt vmcnt(2)
v_mfma_f32_16x16x32_bf16 v[164:167], v[104:107], v[92:95], v[164:167]
v_mfma_f32_16x16x32_bf16 v[180:183], v[108:111], v[92:95], v[180:183]
v_mfma_f32_16x16x32_bf16 v[196:199], v[112:115], v[92:95], v[196:199]
v_mfma_f32_16x16x32_bf16 v[212:215], v[116:119], v[92:95], v[212:215]
v_mfma_f32_16x16x32_bf16 v[228:231], v[120:123], v[92:95], v[228:231]
s_waitcnt vmcnt(1)
v_mfma_f32_16x16x32_bf16 v[168:171], v[104:107], v[96:99], v[168:171]
v_mfma_f32_16x16x32_bf16 v[184:187], v[108:111], v[96:99], v[184:187]
v_mfma_f32_16x16x32_bf16 v[200:203], v[112:115], v[96:99], v[200:203]
v_mfma_f32_16x16x32_bf16 v[216:219], v[116:119], v[96:99], v[216:219]
v_mfma_f32_16x16x32_bf16 v[232:235], v[120:123], v[96:99], v[232:235]
s_waitcnt vmcnt(0)
v_mfma_f32_16x16x32_bf16 v[172:175], v[104:107], v[100:103], v[172:175]
ds_write_b128 v13, v[164:167] offset:0
v_mfma_f32_16x16x32_bf16 v[188:191], v[108:111], v[100:103], v[188:191]
ds_write_b128 v13, v[180:183] offset:1024
v_mfma_f32_16x16x32_bf16 v[204:207], v[112:115], v[100:103], v[204:207]
ds_write_b128 v13, v[196:199] offset:2048
v_mfma_f32_16x16x32_bf16 v[220:223], v[116:119], v[100:103], v[220:223]
ds_write_b128 v13, v[212:215] offset:3072
v_mfma_f32_16x16x32_bf16 v[236:239], v[120:123], v[100:103], v[236:239]
ds_write_b128 v13, v[228:231] offset:4096
v_mfma_f32_16x16x32_bf16 v[160:163], v[104:107], v[88:91], v[160:163]
ds_write_b128 v13, v[168:171] offset:5120
v_mfma_f32_16x16x32_bf16 v[176:179], v[108:111], v[88:91], v[176:179]
ds_write_b128 v13, v[184:187] offset:6144
v_mfma_f32_16x16x32_bf16 v[192:195], v[112:115], v[88:91], v[192:195]
ds_write_b128 v13, v[200:203] offset:7168
v_mfma_f32_16x16x32_bf16 v[208:211], v[116:119], v[88:91], v[208:211]
ds_write_b128 v13, v[216:219] offset:8192
v_mfma_f32_16x16x32_bf16 v[224:227], v[120:123], v[88:91], v[224:227]
ds_write_b128 v13, v[232:235] offset:9216
ds_write_b128 v13, v[172:175] offset:10240
ds_write_b128 v13, v[188:191] offset:11264
ds_write_b128 v13, v[204:207] offset:12288
ds_write_b128 v13, v[220:223] offset:13312
ds_write_b128 v13, v[236:239] offset:14336
v_add_u32 v2, s40, v1
v_add_u32 v3, s41, v1
v_add_u32 v4, s42, v1
v_lshlrev_b32 v124, 16, v240
v_and_b32 v125, 0xffff0000, v240
v_lshlrev_b32 v126, 16, v241
v_and_b32 v127, 0xffff0000, v241
v_lshlrev_b32 v128, 16, v242
v_and_b32 v129, 0xffff0000, v242
v_lshlrev_b32 v130, 16, v243
v_and_b32 v131, 0xffff0000, v243
v_lshlrev_b32 v132, 16, v244
v_and_b32 v133, 0xffff0000, v244
v_lshlrev_b32 v134, 16, v245
v_and_b32 v135, 0xffff0000, v245
v_lshlrev_b32 v136, 16, v246
v_and_b32 v137, 0xffff0000, v246
v_lshlrev_b32 v138, 16, v247
v_and_b32 v139, 0xffff0000, v247
v_lshlrev_b32 v140, 16, v248
v_and_b32 v141, 0xffff0000, v248
v_lshlrev_b32 v142, 16, v249
v_and_b32 v143, 0xffff0000, v249
v_add_f32 v160, v160, v124
v_add_f32 v161, v161, v125
v_add_f32 v162, v162, v126
v_add_f32 v163, v163, v127
v_add_f32 v176, v176, v128
v_add_f32 v177, v177, v129
v_add_f32 v178, v178, v130
v_add_f32 v179, v179, v131
v_add_f32 v192, v192, v132
v_add_f32 v193, v193, v133
v_add_f32 v194, v194, v134
v_add_f32 v195, v195, v135
v_add_f32 v208, v208, v136
v_add_f32 v209, v209, v137
v_add_f32 v210, v210, v138
v_add_f32 v211, v211, v139
v_add_f32 v224, v224, v140
v_add_f32 v225, v225, v141
v_add_f32 v226, v226, v142
v_add_f32 v227, v227, v143
s_waitcnt lgkmcnt(0)
s_barrier
ds_read_b128 v[16:19], v2 offset:0
ds_read_b128 v[20:23], v3 offset:0
ds_read_b128 v[24:27], v4 offset:0
ds_read_b128 v[28:31], v2 offset:1024
ds_read_b128 v[32:35], v3 offset:1024
ds_read_b128 v[36:39], v4 offset:1024
ds_read_b128 v[40:43], v2 offset:2048
ds_read_b128 v[44:47], v3 offset:2048
ds_read_b128 v[48:51], v4 offset:2048
ds_read_b128 v[52:55], v2 offset:3072
ds_read_b128 v[56:59], v3 offset:3072
ds_read_b128 v[60:63], v4 offset:3072
ds_read_b128 v[64:67], v2 offset:4096
ds_read_b128 v[68:71], v3 offset:4096
ds_read_b128 v[72:75], v4 offset:4096
s_waitcnt lgkmcnt(13)
v_add_f32 v16, v16, v20
v_add_f32 v17, v17, v21
v_add_f32 v18, v18, v22
v_add_f32 v19, v19, v23
s_waitcnt lgkmcnt(12)
v_add_f32 v160, v160, v24
v_add_f32 v161, v161, v25
v_add_f32 v162, v162, v26
v_add_f32 v163, v163, v27
v_add_f32 v160, v160, v16
v_add_f32 v161, v161, v17
v_add_f32 v162, v162, v18
v_add_f32 v163, v163, v19
v_cvt_pk_bf16_f32 v144, v160, v161
v_cvt_pk_bf16_f32 v145, v162, v163
s_waitcnt lgkmcnt(10)
v_add_f32 v28, v28, v32
v_add_f32 v29, v29, v33
v_add_f32 v30, v30, v34
v_add_f32 v31, v31, v35
s_waitcnt lgkmcnt(9)
v_add_f32 v176, v176, v36
v_add_f32 v177, v177, v37
v_add_f32 v178, v178, v38
v_add_f32 v179, v179, v39
v_add_f32 v176, v176, v28
v_add_f32 v177, v177, v29
v_add_f32 v178, v178, v30
v_add_f32 v179, v179, v31
v_cvt_pk_bf16_f32 v146, v176, v177
v_cvt_pk_bf16_f32 v147, v178, v179
s_nop 0
v_permlane16_swap_b32 v144, v146
v_permlane16_swap_b32 v145, v147
buffer_store_dwordx4 v[144:147], v11, s[16:19], 0 offen offset:0
s_waitcnt lgkmcnt(7)
v_add_f32 v40, v40, v44
v_add_f32 v41, v41, v45
v_add_f32 v42, v42, v46
v_add_f32 v43, v43, v47
s_waitcnt lgkmcnt(6)
v_add_f32 v192, v192, v48
v_add_f32 v193, v193, v49
v_add_f32 v194, v194, v50
v_add_f32 v195, v195, v51
v_add_f32 v192, v192, v40
v_add_f32 v193, v193, v41
v_add_f32 v194, v194, v42
v_add_f32 v195, v195, v43
v_cvt_pk_bf16_f32 v148, v192, v193
v_cvt_pk_bf16_f32 v149, v194, v195
s_waitcnt lgkmcnt(4)
v_add_f32 v52, v52, v56
v_add_f32 v53, v53, v57
v_add_f32 v54, v54, v58
v_add_f32 v55, v55, v59
s_waitcnt lgkmcnt(3)
v_add_f32 v208, v208, v60
v_add_f32 v209, v209, v61
v_add_f32 v210, v210, v62
v_add_f32 v211, v211, v63
v_add_f32 v208, v208, v52
v_add_f32 v209, v209, v53
v_add_f32 v210, v210, v54
v_add_f32 v211, v211, v55
v_cvt_pk_bf16_f32 v150, v208, v209
v_cvt_pk_bf16_f32 v151, v210, v211
s_nop 0
v_permlane16_swap_b32 v148, v150
v_permlane16_swap_b32 v149, v151
buffer_store_dwordx4 v[148:151], v11, s[16:19], 0 offen offset:64
s_waitcnt lgkmcnt(1)
v_add_f32 v64, v64, v68
v_add_f32 v65, v65, v69
v_add_f32 v66, v66, v70
v_add_f32 v67, v67, v71
s_waitcnt lgkmcnt(0)
v_add_f32 v224, v224, v72
v_add_f32 v225, v225, v73
v_add_f32 v226, v226, v74
v_add_f32 v227, v227, v75
v_add_f32 v224, v224, v64
v_add_f32 v225, v225, v65
v_add_f32 v226, v226, v66
v_add_f32 v227, v227, v67
v_cvt_pk_bf16_f32 v152, v224, v225
v_cvt_pk_bf16_f32 v153, v226, v227
buffer_store_dwordx2 v[152:153], v12, s[16:19], 0 offen offset:128
s_endpgm
K23_SPIN:
buffer_load_dword v9, v8, s[8:11], s82 offen sc0 sc1
s_waitcnt vmcnt(0)
v_cmp_ne_u32 vcc, 1, v9
s_nop 4
s_cbranch_vccnz K23_SPIN
s_branch K23_GO

K23_ATT:
s_nop 4
s_setprio 3
s_and_b32 s32, s27, 3
s_lshl_b32 s25, s28, 2
s_add_u32 s25, s25, s32
s_and_b32 s27, s27, 28
s_add_u32 s27, s27, s20
s_sub_u32 s27, s27, 4
s_lshl_b32 s26, s27, 1
v_and_b32 v228, 63, v0
v_lshlrev_b32 v1, 4, v228
v_and_b32 v229, 31, v228
v_lshrrev_b32 v230, 5, v228
v_lshlrev_b32 v2, 3, v229
v_lshl_or_b32 v2, v230, 31, v2
s_lshl_b32 s32, s25, 16
s_lshl_b32 s33, s26, 10
s_add_u32 s33, s33, s32
s_add_u32 s33, s33, 4194304
s_waitcnt lgkmcnt(0)
s_mov_b32 s8, s4
s_and_b32 s9, s5, 0xffff
s_mov_b32 s10, 33554432
s_mov_b32 s11, 0x20000
buffer_load_dwordx4 v[8:11], v1, s[8:11], s33 offen offset:0
buffer_load_dwordx4 v[12:15], v1, s[8:11], s33 offen offset:1024
s_add_u32 s29, s32, 8388608
s_lshl_b32 s32, s25, 14
s_lshl_b32 s33, s26, 8
s_add_u32 s33, s33, s32
s_add_u32 s33, s33, 6291456
buffer_load_dwordx2 v[16:17], v2, s[8:11], s33 offen offset:0
buffer_load_dwordx2 v[18:19], v2, s[8:11], s33 offen offset:256
s_add_u32 s30, s32, 10485760
s_mov_b32 s3, 0x3f80f149
s_mov_b32 s4, 0x3f800000
s_mov_b32 s5, 0x00003f80
s_mov_b32 s6, 0
s_mov_b32 s7, -1
s_add_i32 s32, s26, 0
s_cmp_lt_i32 s32, 0
s_cselect_b32 s80, s3, s4
s_max_i32 s32, s32, 0
s_lshl_b32 s33, s32, 10
s_add_u32 s33, s33, s29
buffer_load_dwordx4 v[54:57], v1, s[8:11], s33 offen
s_lshl_b32 s34, s32, 8
s_add_u32 s34, s34, s30
buffer_load_dwordx2 v[74:75], v2, s[8:11], s34 offen
s_add_i32 s32, s26, -8
s_cmp_lt_i32 s32, 0
s_cselect_b32 s72, s3, s4
s_max_i32 s32, s32, 0
s_lshl_b32 s33, s32, 10
s_add_u32 s33, s33, s29
buffer_load_dwordx4 v[22:25], v1, s[8:11], s33 offen
s_lshl_b32 s34, s32, 8
s_add_u32 s34, s34, s30
buffer_load_dwordx2 v[58:59], v2, s[8:11], s34 offen
s_add_i32 s32, s26, -7
s_cmp_lt_i32 s32, 0
s_cselect_b32 s73, s3, s4
s_max_i32 s32, s32, 0
s_lshl_b32 s33, s32, 10
s_add_u32 s33, s33, s29
buffer_load_dwordx4 v[26:29], v1, s[8:11], s33 offen
s_lshl_b32 s34, s32, 8
s_add_u32 s34, s34, s30
buffer_load_dwordx2 v[60:61], v2, s[8:11], s34 offen
s_add_i32 s32, s26, -6
s_cmp_lt_i32 s32, 0
s_cselect_b32 s74, s3, s4
s_max_i32 s32, s32, 0
s_lshl_b32 s33, s32, 10
s_add_u32 s33, s33, s29
buffer_load_dwordx4 v[30:33], v1, s[8:11], s33 offen
s_lshl_b32 s34, s32, 8
s_add_u32 s34, s34, s30
buffer_load_dwordx2 v[62:63], v2, s[8:11], s34 offen
s_add_i32 s32, s26, -5
s_cmp_lt_i32 s32, 0
s_cselect_b32 s75, s3, s4
s_max_i32 s32, s32, 0
s_lshl_b32 s33, s32, 10
s_add_u32 s33, s33, s29
buffer_load_dwordx4 v[34:37], v1, s[8:11], s33 offen
s_lshl_b32 s34, s32, 8
s_add_u32 s34, s34, s30
buffer_load_dwordx2 v[64:65], v2, s[8:11], s34 offen
s_add_i32 s32, s26, -4
s_cmp_lt_i32 s32, 0
s_cselect_b32 s76, s3, s4
s_max_i32 s32, s32, 0
s_lshl_b32 s33, s32, 10
s_add_u32 s33, s33, s29
buffer_load_dwordx4 v[38:41], v1, s[8:11], s33 offen
s_lshl_b32 s34, s32, 8
s_add_u32 s34, s34, s30
buffer_load_dwordx2 v[66:67], v2, s[8:11], s34 offen
s_add_i32 s32, s26, -3
s_cmp_lt_i32 s32, 0
s_cselect_b32 s77, s3, s4
s_max_i32 s32, s32, 0
s_lshl_b32 s33, s32, 10
s_add_u32 s33, s33, s29
buffer_load_dwordx4 v[42:45], v1, s[8:11], s33 offen
s_lshl_b32 s34, s32, 8
s_add_u32 s34, s34, s30
buffer_load_dwordx2 v[68:69], v2, s[8:11], s34 offen
s_add_i32 s32, s26, -2
s_cmp_lt_i32 s32, 0
s_cselect_b32 s78, s3, s4
s_max_i32 s32, s32, 0
s_lshl_b32 s33, s32, 10
s_add_u32 s33, s33, s29
buffer_load_dwordx4 v[46:49], v1, s[8:11], s33 offen
s_lshl_b32 s34, s32, 8
s_add_u32 s34, s34, s30
buffer_load_dwordx2 v[70:71], v2, s[8:11], s34 offen
s_add_i32 s32, s26, -1
s_cmp_lt_i32 s32, 0
s_cselect_b32 s79, s3, s4
s_max_i32 s32, s32, 0
s_lshl_b32 s33, s32, 10
s_add_u32 s33, s33, s29
buffer_load_dwordx4 v[50:53], v1, s[8:11], s33 offen
s_lshl_b32 s34, s32, 8
s_add_u32 s34, s34, s30
buffer_load_dwordx2 v[72:73], v2, s[8:11], s34 offen
v_mul_u32_u24 v3, 336, v230
v_lshl_add_u32 v3, v229, 4, v3
v_cmp_lt_u32 vcc, 20, v229
v_mov_b32 v231, 2147483648
s_nop 0
v_cndmask_b32 v3, v3, v231, vcc
s_mul_i32 s31, s25, 86016
s_add_u32 s31, s31, 12582912
s_add_i32 s34, s26, -8
s_max_i32 s34, s34, 0
s_mul_i32 s35, s34, 1344
s_add_u32 s35, s35, s31
buffer_load_dwordx4 v[76:79], v3, s[8:11], s35 offen offset:0
buffer_load_dwordx4 v[80:83], v3, s[8:11], s35 offen offset:672
s_add_i32 s34, s26, 0
s_max_i32 s34, s34, 0
s_mul_i32 s35, s34, 1344
s_add_u32 s35, s35, s31
buffer_load_dwordx4 v[140:143], v3, s[8:11], s35 offen offset:0
buffer_load_dwordx4 v[144:147], v3, s[8:11], s35 offen offset:672
s_add_i32 s34, s26, -7
s_max_i32 s34, s34, 0
s_mul_i32 s35, s34, 1344
s_add_u32 s35, s35, s31
buffer_load_dwordx4 v[84:87], v3, s[8:11], s35 offen offset:0
buffer_load_dwordx4 v[88:91], v3, s[8:11], s35 offen offset:672
s_add_i32 s34, s26, -6
s_max_i32 s34, s34, 0
s_mul_i32 s35, s34, 1344
s_add_u32 s35, s35, s31
buffer_load_dwordx4 v[92:95], v3, s[8:11], s35 offen offset:0
buffer_load_dwordx4 v[96:99], v3, s[8:11], s35 offen offset:672
s_add_i32 s34, s26, -5
s_max_i32 s34, s34, 0
s_mul_i32 s35, s34, 1344
s_add_u32 s35, s35, s31
buffer_load_dwordx4 v[100:103], v3, s[8:11], s35 offen offset:0
buffer_load_dwordx4 v[104:107], v3, s[8:11], s35 offen offset:672
s_add_i32 s34, s26, -4
s_max_i32 s34, s34, 0
s_mul_i32 s35, s34, 1344
s_add_u32 s35, s35, s31
buffer_load_dwordx4 v[108:111], v3, s[8:11], s35 offen offset:0
buffer_load_dwordx4 v[112:115], v3, s[8:11], s35 offen offset:672
s_add_i32 s34, s26, -3
s_max_i32 s34, s34, 0
s_mul_i32 s35, s34, 1344
s_add_u32 s35, s35, s31
buffer_load_dwordx4 v[116:119], v3, s[8:11], s35 offen offset:0
buffer_load_dwordx4 v[120:123], v3, s[8:11], s35 offen offset:672
s_add_i32 s34, s26, -2
s_max_i32 s34, s34, 0
s_mul_i32 s35, s34, 1344
s_add_u32 s35, s35, s31
buffer_load_dwordx4 v[124:127], v3, s[8:11], s35 offen offset:0
buffer_load_dwordx4 v[128:131], v3, s[8:11], s35 offen offset:672
s_add_i32 s34, s26, -1
s_max_i32 s34, s34, 0
s_mul_i32 s35, s34, 1344
s_add_u32 s35, s35, s31
buffer_load_dwordx4 v[132:135], v3, s[8:11], s35 offen offset:0
buffer_load_dwordx4 v[136:139], v3, s[8:11], s35 offen offset:672
v_sub_u32 v4, 0, v230
v_bfe_u32 v6, v228, 4, 1
v_lshlrev_b32 v6, 10, v6
v_and_b32 v232, 15, v228
v_lshl_add_u32 v6, v232, 4, v6
v_lshl_add_u32 v5, v230, 8, v6
v_lshl_or_b32 v6, v230, 31, v6
s_mul_i32 s32, s27, 303104
s_add_u32 s32, s32, 16777216
s_lshr_b32 s33, s25, 1
s_and_b32 s34, s25, 1
s_lshl_b32 s38, s33, 12
s_lshl_b32 s35, s34, 9
s_add_u32 s38, s38, s35
s_add_u32 s38, s38, s32
s_lshr_b32 s39, s33, 2
s_add_u32 s39, s39, 16
s_lshl_b32 s39, s39, 12
s_and_b32 s35, s33, 3
s_lshl_b32 s35, s35, 8
s_add_u32 s39, s39, s35
s_lshl_b32 s35, s34, 3
s_add_u32 s39, s39, s35
s_add_u32 s39, s39, s32
s_lshl_b32 s82, s27, 7
s_add_u32 s82, s82, 31457280
s_lshl_b32 s32, s25, 2
s_add_u32 s82, s82, s32
s_mov_b32 s40, 0x0
s_mov_b32 s41, 0xf
s_mov_b32 s42, 0x1
s_mov_b32 s43, 0x1f
s_mov_b32 s44, 0x3
s_mov_b32 s45, 0x3f
s_mov_b32 s46, 0x7
s_mov_b32 s47, 0x7f
s_mov_b32 s48, 0xff
s_mov_b32 s49, 0xfff
s_mov_b32 s50, 0x1ff
s_mov_b32 s51, 0x1fff
s_mov_b32 s52, 0x3ff
s_mov_b32 s53, 0x3fff
s_mov_b32 s54, 0x7ff
s_mov_b32 s55, 0x7fff
s_mov_b32 s56, 0xffff
s_mov_b32 s57, 0xfffff
s_mov_b32 s58, 0x1ffff
s_mov_b32 s59, 0x1fffff
s_mov_b32 s60, 0x3ffff
s_mov_b32 s61, 0x3fffff
s_mov_b32 s62, 0x7ffff
s_mov_b32 s63, 0x7fffff
s_mov_b32 s64, 0xffffff
s_mov_b32 s65, 0xfffffff
s_mov_b32 s66, 0x1ffffff
s_mov_b32 s67, 0x1fffffff
s_mov_b32 s68, 0x3ffffff
s_mov_b32 s69, 0x3fffffff
s_mov_b32 s70, 0x7ffffff
s_mov_b32 s71, 0x7fffffff
v_mov_b32 v233, 0xffff0000
v_cndmask_b32 v248, 0, v233, s[42:43]
v_cndmask_b32 v248, v248, -1, s[40:41]
v_cndmask_b32 v249, 0, v233, s[46:47]
v_cndmask_b32 v249, v249, -1, s[44:45]
v_cndmask_b32 v250, 0, v233, s[50:51]
v_cndmask_b32 v250, v250, -1, s[48:49]
v_cndmask_b32 v251, 0, v233, s[54:55]
v_cndmask_b32 v251, v251, -1, s[52:53]
v_cndmask_b32 v252, 0, v233, s[58:59]
v_cndmask_b32 v252, v252, -1, s[56:57]
v_cndmask_b32 v253, 0, v233, s[62:63]
v_cndmask_b32 v253, v253, -1, s[60:61]
v_cndmask_b32 v254, 0, v233, s[66:67]
v_cndmask_b32 v254, v254, -1, s[64:65]
v_cndmask_b32 v255, 0, v233, s[70:71]
v_cndmask_b32 v255, v255, -1, s[68:69]
s_mov_b32 s32, 0x3f80
s_waitcnt vmcnt(37)
v_and_or_b32 v16, v4, s32, v16
s_waitcnt vmcnt(36)
v_and_or_b32 v18, v4, s32, v18
s_waitcnt vmcnt(34)
v_and_or_b32 v74, v4, s80, v74
v_and_or_b32 v75, v4, s5, v75
s_waitcnt vmcnt(32)
v_and_or_b32 v58, v4, s72, v58
v_and_or_b32 v59, v4, s5, v59
s_waitcnt vmcnt(30)
v_and_or_b32 v60, v4, s73, v60
v_and_or_b32 v61, v4, s5, v61
s_waitcnt vmcnt(28)
v_and_or_b32 v62, v4, s74, v62
v_and_or_b32 v63, v4, s5, v63
s_waitcnt vmcnt(26)
v_and_or_b32 v64, v4, s75, v64
v_and_or_b32 v65, v4, s5, v65
s_waitcnt vmcnt(24)
v_and_or_b32 v66, v4, s76, v66
v_and_or_b32 v67, v4, s5, v67
s_waitcnt vmcnt(22)
v_and_or_b32 v68, v4, s77, v68
v_and_or_b32 v69, v4, s5, v69
s_waitcnt vmcnt(20)
v_and_or_b32 v70, v4, s78, v70
v_and_or_b32 v71, v4, s5, v71
s_waitcnt vmcnt(18)
v_and_or_b32 v72, v4, s79, v72
v_and_or_b32 v73, v4, s5, v73
v_mfma_f32_32x32x16_bf16 v[148:163], v[54:57], v[8:11], 0
v_mfma_f32_32x32x8_bf16 v[148:163], v[74:75], v[16:17], v[148:163]
v_mfma_f32_32x32x16_bf16 v[164:179], v[22:25], v[8:11], 0
v_mfma_f32_32x32x8_bf16 v[164:179], v[58:59], v[16:17], v[164:179]
v_mfma_f32_32x32x16_bf16 v[196:211], v[26:29], v[8:11], 0
v_mfma_f32_32x32x8_bf16 v[196:211], v[60:61], v[16:17], v[196:211]
s_nop 9
v_cndmask_b32 v180, v148, v164, s[40:41]
v_cndmask_b32 v181, v149, v165, s[42:43]
v_cndmask_b32 v182, v150, v166, s[44:45]
v_cndmask_b32 v183, v151, v167, s[46:47]
v_cndmask_b32 v184, v152, v168, s[48:49]
v_cndmask_b32 v185, v153, v169, s[50:51]
v_cndmask_b32 v186, v154, v170, s[52:53]
v_cndmask_b32 v187, v155, v171, s[54:55]
v_cndmask_b32 v188, v156, v172, s[56:57]
v_cndmask_b32 v189, v157, v173, s[58:59]
v_cndmask_b32 v190, v158, v174, s[60:61]
v_cndmask_b32 v191, v159, v175, s[62:63]
v_cndmask_b32 v192, v160, v176, s[64:65]
v_cndmask_b32 v193, v161, v177, s[66:67]
v_cndmask_b32 v194, v162, v178, s[68:69]
v_cndmask_b32 v195, v163, v179, s[70:71]
s_add_i32 s32, s26, 1
s_cmp_lt_i32 s32, 0
s_cselect_b32 s81, s3, s4
s_max_i32 s32, s32, 0
s_lshl_b32 s33, s32, 10
s_add_u32 s33, s33, s29
buffer_load_dwordx4 v[22:25], v1, s[8:11], s33 offen
s_lshl_b32 s34, s32, 8
s_add_u32 s34, s34, s30
buffer_load_dwordx2 v[58:59], v2, s[8:11], s34 offen
v_mfma_f32_32x32x16_bf16 v[148:163], v[30:33], v[8:11], 0
v_max_f32 v228, v180, v181
v_max_f32 v229, v182, v183
v_max3_f32 v228, v184, v185, v228
v_max3_f32 v229, v186, v187, v229
v_mfma_f32_32x32x8_bf16 v[148:163], v[62:63], v[16:17], v[148:163]
v_max3_f32 v228, v188, v189, v228
v_max3_f32 v229, v190, v191, v229
v_max3_f32 v228, v192, v193, v228
v_max3_f32 v229, v194, v195, v229
v_mfma_f32_32x32x16_bf16 v[164:179], v[34:37], v[8:11], 0
v_max3_f32 v228, v196, v197, v228
v_max3_f32 v229, v198, v199, v229
v_max3_f32 v228, v200, v201, v228
v_max3_f32 v229, v202, v203, v229
v_mfma_f32_32x32x8_bf16 v[164:179], v[64:65], v[16:17], v[164:179]
v_max3_f32 v228, v204, v205, v228
v_max3_f32 v229, v206, v207, v229
v_max3_f32 v228, v208, v209, v228
v_max3_f32 v229, v210, v211, v229
v_mfma_f32_32x32x16_bf16 v[196:211], v[38:41], v[8:11], 0
v_max3_f32 v228, v148, v149, v228
v_max3_f32 v229, v150, v151, v229
v_max3_f32 v228, v152, v153, v228
v_max3_f32 v229, v154, v155, v229
v_mfma_f32_32x32x8_bf16 v[196:211], v[66:67], v[16:17], v[196:211]
v_max3_f32 v228, v156, v157, v228
v_max3_f32 v229, v158, v159, v229
v_max3_f32 v228, v160, v161, v228
v_max3_f32 v229, v162, v163, v229
v_mfma_f32_32x32x16_bf16 v[148:163], v[42:45], v[8:11], 0
v_max3_f32 v228, v164, v165, v228
v_max3_f32 v229, v166, v167, v229
v_max3_f32 v228, v168, v169, v228
v_max3_f32 v229, v170, v171, v229
v_mfma_f32_32x32x8_bf16 v[148:163], v[68:69], v[16:17], v[148:163]
v_max3_f32 v228, v172, v173, v228
v_max3_f32 v229, v174, v175, v229
v_max3_f32 v228, v176, v177, v228
v_max3_f32 v229, v178, v179, v229
v_mfma_f32_32x32x16_bf16 v[164:179], v[46:49], v[8:11], 0
v_max3_f32 v228, v196, v197, v228
v_max3_f32 v229, v198, v199, v229
v_max3_f32 v228, v200, v201, v228
v_max3_f32 v229, v202, v203, v229
v_mfma_f32_32x32x8_bf16 v[164:179], v[70:71], v[16:17], v[164:179]
v_max3_f32 v228, v204, v205, v228
v_max3_f32 v229, v206, v207, v229
v_max3_f32 v228, v208, v209, v228
v_max3_f32 v229, v210, v211, v229
v_mfma_f32_32x32x16_bf16 v[196:211], v[50:53], v[8:11], 0
v_max3_f32 v228, v148, v149, v228
v_max3_f32 v229, v150, v151, v229
v_max3_f32 v228, v152, v153, v228
v_max3_f32 v229, v154, v155, v229
v_mfma_f32_32x32x8_bf16 v[196:211], v[72:73], v[16:17], v[196:211]
v_max3_f32 v228, v156, v157, v228
v_max3_f32 v229, v158, v159, v229
v_max3_f32 v228, v160, v161, v228
v_max3_f32 v229, v162, v163, v229
v_max3_f32 v228, v164, v165, v228
v_max3_f32 v229, v166, v167, v229
v_max3_f32 v228, v168, v169, v228
v_max3_f32 v229, v170, v171, v229
v_max3_f32 v228, v172, v173, v228
v_max3_f32 v229, v174, v175, v229
v_max3_f32 v228, v176, v177, v228
v_max3_f32 v229, v178, v179, v229
v_max3_f32 v228, v196, v197, v228
v_max3_f32 v229, v198, v199, v229
v_max3_f32 v228, v200, v201, v228
v_max3_f32 v229, v202, v203, v229
v_max3_f32 v228, v204, v205, v228
v_max3_f32 v229, v206, v207, v229
v_max3_f32 v228, v208, v209, v228
v_max3_f32 v229, v210, v211, v229
v_max_f32 v228, v228, v229
v_mov_b32 v229, v228
s_nop 1
v_permlane32_swap_b32 v228, v229
v_max_f32 v7, v228, v229
v_cvt_pk_bf16_f32 v230, v7, v7
v_and_b32 v231, 0xffff0000, v230
v_sub_f32 v231, v231, v7
v_cvt_pk_bf16_f32 v231, v231, 0
v_and_b32 v230, 0xffff0000, v230
v_xor_b32 v230, 0x80000000, v230
v_or_b32 v230, 0x3f80, v230
v_cndmask_b32 v20, v16, v230, s[6:7]
v_cndmask_b32 v21, v17, v231, s[6:7]
v_sub_f32 v180, v180, v7
v_sub_f32 v181, v181, v7
v_sub_f32 v182, v182, v7
v_sub_f32 v183, v183, v7
v_sub_f32 v184, v184, v7
v_sub_f32 v185, v185, v7
v_sub_f32 v186, v186, v7
v_sub_f32 v187, v187, v7
v_mfma_f32_32x32x16_bf16 v[148:163], v[26:29], v[8:11], 0
v_sub_f32 v188, v188, v7
v_sub_f32 v189, v189, v7
v_sub_f32 v190, v190, v7
v_sub_f32 v191, v191, v7
v_sub_f32 v192, v192, v7
v_sub_f32 v193, v193, v7
v_mfma_f32_32x32x8_bf16 v[148:163], v[60:61], v[20:21], v[148:163]
v_sub_f32 v194, v194, v7
v_sub_f32 v195, v195, v7
v_exp_f32 v180, v180
v_exp_f32 v181, v181
v_exp_f32 v182, v182
v_exp_f32 v183, v183
v_mfma_f32_32x32x16_bf16 v[164:179], v[30:33], v[8:11], 0
v_exp_f32 v184, v184
v_exp_f32 v185, v185
v_exp_f32 v186, v186
v_exp_f32 v187, v187
v_exp_f32 v188, v188
v_exp_f32 v189, v189
v_mfma_f32_32x32x8_bf16 v[164:179], v[62:63], v[20:21], v[164:179]
v_exp_f32 v190, v190
v_exp_f32 v191, v191
v_exp_f32 v192, v192
v_exp_f32 v193, v193
v_exp_f32 v194, v194
v_exp_f32 v195, v195
v_cvt_pk_bf16_f32 v180, v180, v181
v_cvt_pk_bf16_f32 v181, v182, v183
v_cvt_pk_bf16_f32 v182, v184, v185
v_cvt_pk_bf16_f32 v183, v186, v187
v_cvt_pk_bf16_f32 v184, v188, v189
v_cvt_pk_bf16_f32 v185, v190, v191
v_cvt_pk_bf16_f32 v186, v192, v193
v_cvt_pk_bf16_f32 v187, v194, v195
v_and_b32 v196, v180, v248
v_xor_b32 v204, v180, v196
v_and_b32 v197, v181, v249
v_xor_b32 v205, v181, v197
v_and_b32 v198, v182, v250
v_xor_b32 v206, v182, v198
v_and_b32 v199, v183, v251
v_xor_b32 v207, v183, v199
v_and_b32 v200, v184, v252
v_xor_b32 v208, v184, v200
v_and_b32 v201, v185, v253
v_xor_b32 v209, v185, v201
v_and_b32 v202, v186, v254
v_xor_b32 v210, v186, v202
v_and_b32 v203, v187, v255
v_xor_b32 v211, v187, v203
s_waitcnt vmcnt(19)
v_mfma_f32_32x32x16_bf16 v[212:227], v[76:79], v[196:199], 0
v_exp_f32 v148, v148
v_exp_f32 v149, v149
v_exp_f32 v150, v150
v_exp_f32 v151, v151
s_waitcnt vmcnt(18)
v_mfma_f32_32x32x16_bf16 v[212:227], v[80:83], v[200:203], v[212:227]
v_exp_f32 v152, v152
v_exp_f32 v153, v153
v_exp_f32 v154, v154
v_exp_f32 v155, v155
s_waitcnt vmcnt(17)
v_mfma_f32_32x32x16_bf16 v[212:227], v[140:143], v[204:207], v[212:227]
v_exp_f32 v156, v156
v_exp_f32 v157, v157
v_exp_f32 v158, v158
v_exp_f32 v159, v159
s_waitcnt vmcnt(16)
v_mfma_f32_32x32x16_bf16 v[212:227], v[144:147], v[208:211], v[212:227]
v_exp_f32 v160, v160
v_exp_f32 v161, v161
v_exp_f32 v162, v162
v_exp_f32 v163, v163
s_add_i32 s34, s26, 1
s_max_i32 s34, s34, 0
s_mul_i32 s35, s34, 1344
s_add_u32 s35, s35, s31
buffer_load_dwordx4 v[76:79], v3, s[8:11], s35 offen offset:0
buffer_load_dwordx4 v[80:83], v3, s[8:11], s35 offen offset:672
v_cvt_pk_bf16_f32 v196, v148, v149
v_cvt_pk_bf16_f32 v197, v150, v151
v_cvt_pk_bf16_f32 v198, v152, v153
v_cvt_pk_bf16_f32 v199, v154, v155
v_cvt_pk_bf16_f32 v200, v156, v157
v_cvt_pk_bf16_f32 v201, v158, v159
v_cvt_pk_bf16_f32 v202, v160, v161
v_cvt_pk_bf16_f32 v203, v162, v163
v_mfma_f32_32x32x16_bf16 v[148:163], v[34:37], v[8:11], 0
v_exp_f32 v164, v164
v_exp_f32 v165, v165
v_exp_f32 v166, v166
v_exp_f32 v167, v167
v_mfma_f32_32x32x8_bf16 v[148:163], v[64:65], v[20:21], v[148:163]
v_exp_f32 v168, v168
v_exp_f32 v169, v169
v_exp_f32 v170, v170
v_exp_f32 v171, v171
s_waitcnt vmcnt(17)
v_mfma_f32_32x32x16_bf16 v[212:227], v[84:87], v[196:199], v[212:227]
v_exp_f32 v172, v172
v_exp_f32 v173, v173
v_exp_f32 v174, v174
v_exp_f32 v175, v175
s_waitcnt vmcnt(16)
v_mfma_f32_32x32x16_bf16 v[212:227], v[88:91], v[200:203], v[212:227]
v_exp_f32 v176, v176
v_exp_f32 v177, v177
v_exp_f32 v178, v178
v_exp_f32 v179, v179
v_cvt_pk_bf16_f32 v204, v164, v165
v_cvt_pk_bf16_f32 v205, v166, v167
v_cvt_pk_bf16_f32 v206, v168, v169
v_cvt_pk_bf16_f32 v207, v170, v171
v_cvt_pk_bf16_f32 v208, v172, v173
v_cvt_pk_bf16_f32 v209, v174, v175
v_cvt_pk_bf16_f32 v210, v176, v177
v_cvt_pk_bf16_f32 v211, v178, v179
v_mfma_f32_32x32x16_bf16 v[164:179], v[38:41], v[8:11], 0
v_exp_f32 v148, v148
v_exp_f32 v149, v149
v_exp_f32 v150, v150
v_exp_f32 v151, v151
v_mfma_f32_32x32x8_bf16 v[164:179], v[66:67], v[20:21], v[164:179]
v_exp_f32 v152, v152
v_exp_f32 v153, v153
v_exp_f32 v154, v154
v_exp_f32 v155, v155
s_waitcnt vmcnt(15)
v_mfma_f32_32x32x16_bf16 v[212:227], v[92:95], v[204:207], v[212:227]
v_exp_f32 v156, v156
v_exp_f32 v157, v157
v_exp_f32 v158, v158
v_exp_f32 v159, v159
s_waitcnt vmcnt(14)
v_mfma_f32_32x32x16_bf16 v[212:227], v[96:99], v[208:211], v[212:227]
v_exp_f32 v160, v160
v_exp_f32 v161, v161
v_exp_f32 v162, v162
v_exp_f32 v163, v163
v_cvt_pk_bf16_f32 v196, v148, v149
v_cvt_pk_bf16_f32 v197, v150, v151
v_cvt_pk_bf16_f32 v198, v152, v153
v_cvt_pk_bf16_f32 v199, v154, v155
v_cvt_pk_bf16_f32 v200, v156, v157
v_cvt_pk_bf16_f32 v201, v158, v159
v_cvt_pk_bf16_f32 v202, v160, v161
v_cvt_pk_bf16_f32 v203, v162, v163
v_mfma_f32_32x32x16_bf16 v[148:163], v[42:45], v[8:11], 0
v_exp_f32 v164, v164
v_exp_f32 v165, v165
v_exp_f32 v166, v166
v_exp_f32 v167, v167
v_mfma_f32_32x32x8_bf16 v[148:163], v[68:69], v[20:21], v[148:163]
v_exp_f32 v168, v168
v_exp_f32 v169, v169
v_exp_f32 v170, v170
v_exp_f32 v171, v171
s_waitcnt vmcnt(13)
v_mfma_f32_32x32x16_bf16 v[212:227], v[100:103], v[196:199], v[212:227]
v_exp_f32 v172, v172
v_exp_f32 v173, v173
v_exp_f32 v174, v174
v_exp_f32 v175, v175
s_waitcnt vmcnt(12)
v_mfma_f32_32x32x16_bf16 v[212:227], v[104:107], v[200:203], v[212:227]
v_exp_f32 v176, v176
v_exp_f32 v177, v177
v_exp_f32 v178, v178
v_exp_f32 v179, v179
v_cvt_pk_bf16_f32 v204, v164, v165
v_cvt_pk_bf16_f32 v205, v166, v167
v_cvt_pk_bf16_f32 v206, v168, v169
v_cvt_pk_bf16_f32 v207, v170, v171
v_cvt_pk_bf16_f32 v208, v172, v173
v_cvt_pk_bf16_f32 v209, v174, v175
v_cvt_pk_bf16_f32 v210, v176, v177
v_cvt_pk_bf16_f32 v211, v178, v179
v_mfma_f32_32x32x16_bf16 v[164:179], v[46:49], v[8:11], 0
v_exp_f32 v148, v148
v_exp_f32 v149, v149
v_exp_f32 v150, v150
v_exp_f32 v151, v151
v_mfma_f32_32x32x8_bf16 v[164:179], v[70:71], v[20:21], v[164:179]
v_exp_f32 v152, v152
v_exp_f32 v153, v153
v_exp_f32 v154, v154
v_exp_f32 v155, v155
s_waitcnt vmcnt(11)
v_mfma_f32_32x32x16_bf16 v[212:227], v[108:111], v[204:207], v[212:227]
v_exp_f32 v156, v156
v_exp_f32 v157, v157
v_exp_f32 v158, v158
v_exp_f32 v159, v159
s_waitcnt vmcnt(10)
v_mfma_f32_32x32x16_bf16 v[212:227], v[112:115], v[208:211], v[212:227]
v_exp_f32 v160, v160
v_exp_f32 v161, v161
v_exp_f32 v162, v162
v_exp_f32 v163, v163
v_cvt_pk_bf16_f32 v196, v148, v149
v_cvt_pk_bf16_f32 v197, v150, v151
v_cvt_pk_bf16_f32 v198, v152, v153
v_cvt_pk_bf16_f32 v199, v154, v155
v_cvt_pk_bf16_f32 v200, v156, v157
v_cvt_pk_bf16_f32 v201, v158, v159
v_cvt_pk_bf16_f32 v202, v160, v161
v_cvt_pk_bf16_f32 v203, v162, v163
v_mfma_f32_32x32x16_bf16 v[148:163], v[50:53], v[8:11], 0
v_exp_f32 v164, v164
v_exp_f32 v165, v165
v_exp_f32 v166, v166
v_exp_f32 v167, v167
v_mfma_f32_32x32x8_bf16 v[148:163], v[72:73], v[20:21], v[148:163]
v_exp_f32 v168, v168
v_exp_f32 v169, v169
v_exp_f32 v170, v170
v_exp_f32 v171, v171
s_waitcnt vmcnt(9)
v_mfma_f32_32x32x16_bf16 v[212:227], v[116:119], v[196:199], v[212:227]
v_exp_f32 v172, v172
v_exp_f32 v173, v173
v_exp_f32 v174, v174
v_exp_f32 v175, v175
s_waitcnt vmcnt(8)
v_mfma_f32_32x32x16_bf16 v[212:227], v[120:123], v[200:203], v[212:227]
v_exp_f32 v176, v176
v_exp_f32 v177, v177
v_exp_f32 v178, v178
v_exp_f32 v179, v179
v_cvt_pk_bf16_f32 v204, v164, v165
v_cvt_pk_bf16_f32 v205, v166, v167
v_cvt_pk_bf16_f32 v206, v168, v169
v_cvt_pk_bf16_f32 v207, v170, v171
v_cvt_pk_bf16_f32 v208, v172, v173
v_cvt_pk_bf16_f32 v209, v174, v175
v_cvt_pk_bf16_f32 v210, v176, v177
v_cvt_pk_bf16_f32 v211, v178, v179
s_waitcnt vmcnt(7)
v_mfma_f32_32x32x16_bf16 v[212:227], v[124:127], v[204:207], v[212:227]
v_exp_f32 v148, v148
v_exp_f32 v149, v149
v_exp_f32 v150, v150
v_exp_f32 v151, v151
v_exp_f32 v152, v152
v_exp_f32 v153, v153
v_exp_f32 v154, v154
v_exp_f32 v155, v155
s_waitcnt vmcnt(6)
v_mfma_f32_32x32x16_bf16 v[212:227], v[128:131], v[208:211], v[212:227]
v_exp_f32 v156, v156
v_exp_f32 v157, v157
v_exp_f32 v158, v158
v_exp_f32 v159, v159
v_exp_f32 v160, v160
v_exp_f32 v161, v161
v_exp_f32 v162, v162
v_exp_f32 v163, v163
v_cvt_pk_bf16_f32 v196, v148, v149
v_cvt_pk_bf16_f32 v197, v150, v151
v_cvt_pk_bf16_f32 v198, v152, v153
v_cvt_pk_bf16_f32 v199, v154, v155
v_cvt_pk_bf16_f32 v200, v156, v157
v_cvt_pk_bf16_f32 v201, v158, v159
v_cvt_pk_bf16_f32 v202, v160, v161
v_cvt_pk_bf16_f32 v203, v162, v163
s_waitcnt vmcnt(5)
v_mfma_f32_32x32x16_bf16 v[212:227], v[132:135], v[196:199], v[212:227]
s_waitcnt vmcnt(4)
v_mfma_f32_32x32x16_bf16 v[212:227], v[136:139], v[200:203], v[212:227]
s_waitcnt vmcnt(2)
v_and_or_b32 v58, v4, s81, v58
v_and_or_b32 v59, v4, s5, v59
s_nop 8
v_mov_b32 v234, v220
v_mov_b32 v235, v220
s_nop 1
v_permlane32_swap_b32 v234, v235
v_rcp_f32 v234, v235
s_nop 0
v_mul_f32 v212, v212, v234
v_mul_f32 v213, v213, v234
v_mul_f32 v214, v214, v234
v_mul_f32 v215, v215, v234
v_mul_f32 v216, v216, v234
v_mul_f32 v217, v217, v234
v_mul_f32 v218, v218, v234
v_mul_f32 v219, v219, v234
v_mul_f32 v220, v220, v234
v_mul_f32 v221, v221, v234
v_mul_f32 v222, v222, v234
v_mul_f32 v223, v223, v234
v_cvt_pk_bf16_f32 v236, v212, v213
v_cvt_pk_bf16_f32 v237, v214, v215
v_cvt_pk_bf16_f32 v238, v216, v217
v_cvt_pk_bf16_f32 v239, v218, v219
v_cvt_pk_bf16_f32 v240, v220, v221
v_cvt_pk_bf16_f32 v241, v222, v223
s_add_u32 s32, s38, 0
buffer_store_dwordx4 v[236:239], v5, s[8:11], s32 offen sc1
s_add_u32 s33, s39, 0
buffer_store_dwordx2 v[240:241], v6, s[8:11], s33 offen sc1
v_mfma_f32_32x32x16_bf16 v[148:163], v[22:25], v[12:15], 0
v_mfma_f32_32x32x8_bf16 v[148:163], v[58:59], v[18:19], v[148:163]
v_mfma_f32_32x32x16_bf16 v[164:179], v[26:29], v[12:15], 0
v_mfma_f32_32x32x8_bf16 v[164:179], v[60:61], v[18:19], v[164:179]
v_mfma_f32_32x32x16_bf16 v[196:211], v[30:33], v[12:15], 0
v_mfma_f32_32x32x8_bf16 v[196:211], v[62:63], v[18:19], v[196:211]
s_nop 9
v_cndmask_b32 v180, v148, v164, s[40:41]
v_cndmask_b32 v181, v149, v165, s[42:43]
v_cndmask_b32 v182, v150, v166, s[44:45]
v_cndmask_b32 v183, v151, v167, s[46:47]
v_cndmask_b32 v184, v152, v168, s[48:49]
v_cndmask_b32 v185, v153, v169, s[50:51]
v_cndmask_b32 v186, v154, v170, s[52:53]
v_cndmask_b32 v187, v155, v171, s[54:55]
v_cndmask_b32 v188, v156, v172, s[56:57]
v_cndmask_b32 v189, v157, v173, s[58:59]
v_cndmask_b32 v190, v158, v174, s[60:61]
v_cndmask_b32 v191, v159, v175, s[62:63]
v_cndmask_b32 v192, v160, v176, s[64:65]
v_cndmask_b32 v193, v161, v177, s[66:67]
v_cndmask_b32 v194, v162, v178, s[68:69]
v_cndmask_b32 v195, v163, v179, s[70:71]
v_mfma_f32_32x32x16_bf16 v[148:163], v[34:37], v[12:15], 0
v_max_f32 v228, v180, v181
v_max_f32 v229, v182, v183
v_max3_f32 v228, v184, v185, v228
v_max3_f32 v229, v186, v187, v229
v_mfma_f32_32x32x8_bf16 v[148:163], v[64:65], v[18:19], v[148:163]
v_max3_f32 v228, v188, v189, v228
v_max3_f32 v229, v190, v191, v229
v_max3_f32 v228, v192, v193, v228
v_max3_f32 v229, v194, v195, v229
v_mfma_f32_32x32x16_bf16 v[164:179], v[38:41], v[12:15], 0
v_max3_f32 v228, v196, v197, v228
v_max3_f32 v229, v198, v199, v229
v_max3_f32 v228, v200, v201, v228
v_max3_f32 v229, v202, v203, v229
v_mfma_f32_32x32x8_bf16 v[164:179], v[66:67], v[18:19], v[164:179]
v_max3_f32 v228, v204, v205, v228
v_max3_f32 v229, v206, v207, v229
v_max3_f32 v228, v208, v209, v228
v_max3_f32 v229, v210, v211, v229
v_mfma_f32_32x32x16_bf16 v[196:211], v[42:45], v[12:15], 0
v_max3_f32 v228, v148, v149, v228
v_max3_f32 v229, v150, v151, v229
v_max3_f32 v228, v152, v153, v228
v_max3_f32 v229, v154, v155, v229
v_mfma_f32_32x32x8_bf16 v[196:211], v[68:69], v[18:19], v[196:211]
v_max3_f32 v228, v156, v157, v228
v_max3_f32 v229, v158, v159, v229
v_max3_f32 v228, v160, v161, v228
v_max3_f32 v229, v162, v163, v229
v_mfma_f32_32x32x16_bf16 v[148:163], v[46:49], v[12:15], 0
v_max3_f32 v228, v164, v165, v228
v_max3_f32 v229, v166, v167, v229
v_max3_f32 v228, v168, v169, v228
v_max3_f32 v229, v170, v171, v229
v_mfma_f32_32x32x8_bf16 v[148:163], v[70:71], v[18:19], v[148:163]
v_max3_f32 v228, v172, v173, v228
v_max3_f32 v229, v174, v175, v229
v_max3_f32 v228, v176, v177, v228
v_max3_f32 v229, v178, v179, v229
v_mfma_f32_32x32x16_bf16 v[164:179], v[50:53], v[12:15], 0
v_max3_f32 v228, v196, v197, v228
v_max3_f32 v229, v198, v199, v229
v_max3_f32 v228, v200, v201, v228
v_max3_f32 v229, v202, v203, v229
v_mfma_f32_32x32x8_bf16 v[164:179], v[72:73], v[18:19], v[164:179]
v_max3_f32 v228, v204, v205, v228
v_max3_f32 v229, v206, v207, v229
v_max3_f32 v228, v208, v209, v228
v_max3_f32 v229, v210, v211, v229
v_mfma_f32_32x32x16_bf16 v[196:211], v[54:57], v[12:15], 0
v_max3_f32 v228, v148, v149, v228
v_max3_f32 v229, v150, v151, v229
v_max3_f32 v228, v152, v153, v228
v_max3_f32 v229, v154, v155, v229
v_mfma_f32_32x32x8_bf16 v[196:211], v[74:75], v[18:19], v[196:211]
v_max3_f32 v228, v156, v157, v228
v_max3_f32 v229, v158, v159, v229
v_max3_f32 v228, v160, v161, v228
v_max3_f32 v229, v162, v163, v229
v_max3_f32 v228, v164, v165, v228
v_max3_f32 v229, v166, v167, v229
v_max3_f32 v228, v168, v169, v228
v_max3_f32 v229, v170, v171, v229
v_max3_f32 v228, v172, v173, v228
v_max3_f32 v229, v174, v175, v229
v_max3_f32 v228, v176, v177, v228
v_max3_f32 v229, v178, v179, v229
v_max3_f32 v228, v196, v197, v228
v_max3_f32 v229, v198, v199, v229
v_max3_f32 v228, v200, v201, v228
v_max3_f32 v229, v202, v203, v229
v_max3_f32 v228, v204, v205, v228
v_max3_f32 v229, v206, v207, v229
v_max3_f32 v228, v208, v209, v228
v_max3_f32 v229, v210, v211, v229
v_max_f32 v228, v228, v229
v_mov_b32 v229, v228
s_nop 1
v_permlane32_swap_b32 v228, v229
v_max_f32 v7, v228, v229
v_cvt_pk_bf16_f32 v230, v7, v7
v_and_b32 v231, 0xffff0000, v230
v_sub_f32 v231, v231, v7
v_cvt_pk_bf16_f32 v231, v231, 0
v_and_b32 v230, 0xffff0000, v230
v_xor_b32 v230, 0x80000000, v230
v_or_b32 v230, 0x3f80, v230
v_cndmask_b32 v20, v18, v230, s[6:7]
v_cndmask_b32 v21, v19, v231, s[6:7]
v_sub_f32 v180, v180, v7
v_sub_f32 v181, v181, v7
v_sub_f32 v182, v182, v7
v_sub_f32 v183, v183, v7
v_sub_f32 v184, v184, v7
v_sub_f32 v185, v185, v7
v_sub_f32 v186, v186, v7
v_sub_f32 v187, v187, v7
v_mfma_f32_32x32x16_bf16 v[148:163], v[30:33], v[12:15], 0
v_sub_f32 v188, v188, v7
v_sub_f32 v189, v189, v7
v_sub_f32 v190, v190, v7
v_sub_f32 v191, v191, v7
v_sub_f32 v192, v192, v7
v_sub_f32 v193, v193, v7
v_mfma_f32_32x32x8_bf16 v[148:163], v[62:63], v[20:21], v[148:163]
v_sub_f32 v194, v194, v7
v_sub_f32 v195, v195, v7
v_exp_f32 v180, v180
v_exp_f32 v181, v181
v_exp_f32 v182, v182
v_exp_f32 v183, v183
v_mfma_f32_32x32x16_bf16 v[164:179], v[34:37], v[12:15], 0
v_exp_f32 v184, v184
v_exp_f32 v185, v185
v_exp_f32 v186, v186
v_exp_f32 v187, v187
v_exp_f32 v188, v188
v_exp_f32 v189, v189
v_mfma_f32_32x32x8_bf16 v[164:179], v[64:65], v[20:21], v[164:179]
v_exp_f32 v190, v190
v_exp_f32 v191, v191
v_exp_f32 v192, v192
v_exp_f32 v193, v193
v_exp_f32 v194, v194
v_exp_f32 v195, v195
v_cvt_pk_bf16_f32 v180, v180, v181
v_cvt_pk_bf16_f32 v181, v182, v183
v_cvt_pk_bf16_f32 v182, v184, v185
v_cvt_pk_bf16_f32 v183, v186, v187
v_cvt_pk_bf16_f32 v184, v188, v189
v_cvt_pk_bf16_f32 v185, v190, v191
v_cvt_pk_bf16_f32 v186, v192, v193
v_cvt_pk_bf16_f32 v187, v194, v195
v_and_b32 v196, v180, v248
v_xor_b32 v204, v180, v196
v_and_b32 v197, v181, v249
v_xor_b32 v205, v181, v197
v_and_b32 v198, v182, v250
v_xor_b32 v206, v182, v198
v_and_b32 v199, v183, v251
v_xor_b32 v207, v183, v199
v_and_b32 v200, v184, v252
v_xor_b32 v208, v184, v200
v_and_b32 v201, v185, v253
v_xor_b32 v209, v185, v201
v_and_b32 v202, v186, v254
v_xor_b32 v210, v186, v202
v_and_b32 v203, v187, v255
v_xor_b32 v211, v187, v203
v_mfma_f32_32x32x16_bf16 v[212:227], v[84:87], v[196:199], 0
v_exp_f32 v148, v148
v_exp_f32 v149, v149
v_exp_f32 v150, v150
v_exp_f32 v151, v151
v_mfma_f32_32x32x16_bf16 v[212:227], v[88:91], v[200:203], v[212:227]
v_exp_f32 v152, v152
v_exp_f32 v153, v153
v_exp_f32 v154, v154
v_exp_f32 v155, v155
s_waitcnt vmcnt(3)
v_mfma_f32_32x32x16_bf16 v[212:227], v[76:79], v[204:207], v[212:227]
v_exp_f32 v156, v156
v_exp_f32 v157, v157
v_exp_f32 v158, v158
v_exp_f32 v159, v159
s_waitcnt vmcnt(2)
v_mfma_f32_32x32x16_bf16 v[212:227], v[80:83], v[208:211], v[212:227]
v_exp_f32 v160, v160
v_exp_f32 v161, v161
v_exp_f32 v162, v162
v_exp_f32 v163, v163
v_cvt_pk_bf16_f32 v196, v148, v149
v_cvt_pk_bf16_f32 v197, v150, v151
v_cvt_pk_bf16_f32 v198, v152, v153
v_cvt_pk_bf16_f32 v199, v154, v155
v_cvt_pk_bf16_f32 v200, v156, v157
v_cvt_pk_bf16_f32 v201, v158, v159
v_cvt_pk_bf16_f32 v202, v160, v161
v_cvt_pk_bf16_f32 v203, v162, v163
v_mfma_f32_32x32x16_bf16 v[148:163], v[38:41], v[12:15], 0
v_exp_f32 v164, v164
v_exp_f32 v165, v165
v_exp_f32 v166, v166
v_exp_f32 v167, v167
v_mfma_f32_32x32x8_bf16 v[148:163], v[66:67], v[20:21], v[148:163]
v_exp_f32 v168, v168
v_exp_f32 v169, v169
v_exp_f32 v170, v170
v_exp_f32 v171, v171
v_mfma_f32_32x32x16_bf16 v[212:227], v[92:95], v[196:199], v[212:227]
v_exp_f32 v172, v172
v_exp_f32 v173, v173
v_exp_f32 v174, v174
v_exp_f32 v175, v175
v_mfma_f32_32x32x16_bf16 v[212:227], v[96:99], v[200:203], v[212:227]
v_exp_f32 v176, v176
v_exp_f32 v177, v177
v_exp_f32 v178, v178
v_exp_f32 v179, v179
v_cvt_pk_bf16_f32 v204, v164, v165
v_cvt_pk_bf16_f32 v205, v166, v167
v_cvt_pk_bf16_f32 v206, v168, v169
v_cvt_pk_bf16_f32 v207, v170, v171
v_cvt_pk_bf16_f32 v208, v172, v173
v_cvt_pk_bf16_f32 v209, v174, v175
v_cvt_pk_bf16_f32 v210, v176, v177
v_cvt_pk_bf16_f32 v211, v178, v179
v_mfma_f32_32x32x16_bf16 v[164:179], v[42:45], v[12:15], 0
v_exp_f32 v148, v148
v_exp_f32 v149, v149
v_exp_f32 v150, v150
v_exp_f32 v151, v151
v_mfma_f32_32x32x8_bf16 v[164:179], v[68:69], v[20:21], v[164:179]
v_exp_f32 v152, v152
v_exp_f32 v153, v153
v_exp_f32 v154, v154
v_exp_f32 v155, v155
v_mfma_f32_32x32x16_bf16 v[212:227], v[100:103], v[204:207], v[212:227]
v_exp_f32 v156, v156
v_exp_f32 v157, v157
v_exp_f32 v158, v158
v_exp_f32 v159, v159
v_mfma_f32_32x32x16_bf16 v[212:227], v[104:107], v[208:211], v[212:227]
v_exp_f32 v160, v160
v_exp_f32 v161, v161
v_exp_f32 v162, v162
v_exp_f32 v163, v163
v_cvt_pk_bf16_f32 v196, v148, v149
v_cvt_pk_bf16_f32 v197, v150, v151
v_cvt_pk_bf16_f32 v198, v152, v153
v_cvt_pk_bf16_f32 v199, v154, v155
v_cvt_pk_bf16_f32 v200, v156, v157
v_cvt_pk_bf16_f32 v201, v158, v159
v_cvt_pk_bf16_f32 v202, v160, v161
v_cvt_pk_bf16_f32 v203, v162, v163
v_mfma_f32_32x32x16_bf16 v[148:163], v[46:49], v[12:15], 0
v_exp_f32 v164, v164
v_exp_f32 v165, v165
v_exp_f32 v166, v166
v_exp_f32 v167, v167
v_mfma_f32_32x32x8_bf16 v[148:163], v[70:71], v[20:21], v[148:163]
v_exp_f32 v168, v168
v_exp_f32 v169, v169
v_exp_f32 v170, v170
v_exp_f32 v171, v171
v_mfma_f32_32x32x16_bf16 v[212:227], v[108:111], v[196:199], v[212:227]
v_exp_f32 v172, v172
v_exp_f32 v173, v173
v_exp_f32 v174, v174
v_exp_f32 v175, v175
v_mfma_f32_32x32x16_bf16 v[212:227], v[112:115], v[200:203], v[212:227]
v_exp_f32 v176, v176
v_exp_f32 v177, v177
v_exp_f32 v178, v178
v_exp_f32 v179, v179
v_cvt_pk_bf16_f32 v204, v164, v165
v_cvt_pk_bf16_f32 v205, v166, v167
v_cvt_pk_bf16_f32 v206, v168, v169
v_cvt_pk_bf16_f32 v207, v170, v171
v_cvt_pk_bf16_f32 v208, v172, v173
v_cvt_pk_bf16_f32 v209, v174, v175
v_cvt_pk_bf16_f32 v210, v176, v177
v_cvt_pk_bf16_f32 v211, v178, v179
v_mfma_f32_32x32x16_bf16 v[164:179], v[50:53], v[12:15], 0
v_exp_f32 v148, v148
v_exp_f32 v149, v149
v_exp_f32 v150, v150
v_exp_f32 v151, v151
v_mfma_f32_32x32x8_bf16 v[164:179], v[72:73], v[20:21], v[164:179]
v_exp_f32 v152, v152
v_exp_f32 v153, v153
v_exp_f32 v154, v154
v_exp_f32 v155, v155
v_mfma_f32_32x32x16_bf16 v[212:227], v[116:119], v[204:207], v[212:227]
v_exp_f32 v156, v156
v_exp_f32 v157, v157
v_exp_f32 v158, v158
v_exp_f32 v159, v159
v_mfma_f32_32x32x16_bf16 v[212:227], v[120:123], v[208:211], v[212:227]
v_exp_f32 v160, v160
v_exp_f32 v161, v161
v_exp_f32 v162, v162
v_exp_f32 v163, v163
v_cvt_pk_bf16_f32 v196, v148, v149
v_cvt_pk_bf16_f32 v197, v150, v151
v_cvt_pk_bf16_f32 v198, v152, v153
v_cvt_pk_bf16_f32 v199, v154, v155
v_cvt_pk_bf16_f32 v200, v156, v157
v_cvt_pk_bf16_f32 v201, v158, v159
v_cvt_pk_bf16_f32 v202, v160, v161
v_cvt_pk_bf16_f32 v203, v162, v163
v_mfma_f32_32x32x16_bf16 v[148:163], v[54:57], v[12:15], 0
v_exp_f32 v164, v164
v_exp_f32 v165, v165
v_exp_f32 v166, v166
v_exp_f32 v167, v167
v_mfma_f32_32x32x8_bf16 v[148:163], v[74:75], v[20:21], v[148:163]
v_exp_f32 v168, v168
v_exp_f32 v169, v169
v_exp_f32 v170, v170
v_exp_f32 v171, v171
v_mfma_f32_32x32x16_bf16 v[212:227], v[124:127], v[196:199], v[212:227]
v_exp_f32 v172, v172
v_exp_f32 v173, v173
v_exp_f32 v174, v174
v_exp_f32 v175, v175
v_mfma_f32_32x32x16_bf16 v[212:227], v[128:131], v[200:203], v[212:227]
v_exp_f32 v176, v176
v_exp_f32 v177, v177
v_exp_f32 v178, v178
v_exp_f32 v179, v179
v_cvt_pk_bf16_f32 v204, v164, v165
v_cvt_pk_bf16_f32 v205, v166, v167
v_cvt_pk_bf16_f32 v206, v168, v169
v_cvt_pk_bf16_f32 v207, v170, v171
v_cvt_pk_bf16_f32 v208, v172, v173
v_cvt_pk_bf16_f32 v209, v174, v175
v_cvt_pk_bf16_f32 v210, v176, v177
v_cvt_pk_bf16_f32 v211, v178, v179
v_mfma_f32_32x32x16_bf16 v[212:227], v[132:135], v[204:207], v[212:227]
v_exp_f32 v148, v148
v_exp_f32 v149, v149
v_exp_f32 v150, v150
v_exp_f32 v151, v151
v_exp_f32 v152, v152
v_exp_f32 v153, v153
v_exp_f32 v154, v154
v_exp_f32 v155, v155
v_mfma_f32_32x32x16_bf16 v[212:227], v[136:139], v[208:211], v[212:227]
v_exp_f32 v156, v156
v_exp_f32 v157, v157
v_exp_f32 v158, v158
v_exp_f32 v159, v159
v_exp_f32 v160, v160
v_exp_f32 v161, v161
v_exp_f32 v162, v162
v_exp_f32 v163, v163
v_cvt_pk_bf16_f32 v196, v148, v149
v_cvt_pk_bf16_f32 v197, v150, v151
v_cvt_pk_bf16_f32 v198, v152, v153
v_cvt_pk_bf16_f32 v199, v154, v155
v_cvt_pk_bf16_f32 v200, v156, v157
v_cvt_pk_bf16_f32 v201, v158, v159
v_cvt_pk_bf16_f32 v202, v160, v161
v_cvt_pk_bf16_f32 v203, v162, v163
v_mfma_f32_32x32x16_bf16 v[212:227], v[140:143], v[196:199], v[212:227]
s_nop 0
v_mfma_f32_32x32x16_bf16 v[212:227], v[144:147], v[200:203], v[212:227]
s_nop 11
v_mov_b32 v234, v220
v_mov_b32 v235, v220
s_nop 1
v_permlane32_swap_b32 v234, v235
v_rcp_f32 v234, v235
s_nop 0
v_mul_f32 v212, v212, v234
v_mul_f32 v213, v213, v234
v_mul_f32 v214, v214, v234
v_mul_f32 v215, v215, v234
v_mul_f32 v216, v216, v234
v_mul_f32 v217, v217, v234
v_mul_f32 v218, v218, v234
v_mul_f32 v219, v219, v234
v_mul_f32 v220, v220, v234
v_mul_f32 v221, v221, v234
v_mul_f32 v222, v222, v234
v_mul_f32 v223, v223, v234
v_cvt_pk_bf16_f32 v236, v212, v213
v_cvt_pk_bf16_f32 v237, v214, v215
v_cvt_pk_bf16_f32 v238, v216, v217
v_cvt_pk_bf16_f32 v239, v218, v219
v_cvt_pk_bf16_f32 v240, v220, v221
v_cvt_pk_bf16_f32 v241, v222, v223
s_add_u32 s32, s38, 2048
buffer_store_dwordx4 v[236:239], v5, s[8:11], s32 offen sc1
s_add_u32 s33, s39, 2048
buffer_store_dwordx2 v[240:241], v6, s[8:11], s33 offen sc1
s_waitcnt vmcnt(0)
v_mov_b32 v228, 1
v_mov_b32 v229, 0
buffer_store_dword v228, v229, s[8:11], s82 offen sc1
K23_END:
s_endpgm
.section .rodata,"a"
.p2align 6
.amdhsa_kernel parallel_sum__sliding_block__glu_gated_glu__prompt_kernel
  .amdhsa_next_free_vgpr 256
  .amdhsa_next_free_sgpr 102
  .amdhsa_accum_offset 256
  .amdhsa_group_segment_fixed_size 0
  .amdhsa_kernarg_size 80
  .amdhsa_user_sgpr_count 2
  .amdhsa_user_sgpr_kernarg_segment_ptr 1
  .amdhsa_system_sgpr_workgroup_id_x 1
  .amdhsa_float_denorm_mode_32 3
.end_amdhsa_kernel
```
